```python
import torch

def _softmax(x, axis=-1):
    return torch.softmax(x, dim=axis)

def _gelu(x):
    return torch.nn.functional.gelu(x, approximate='tanh')

def _silu(x):
    return torch.nn.functional.silu(x)

def _sigmoid(x):
    return torch.sigmoid(x)

def _layernorm(x, axis=-1, eps=1e-05):
    m = x.mean(dim=axis, keepdim=True)
    v = x.var(dim=axis, keepdim=True, unbiased=False)
    return (x - m) / torch.sqrt(v + eps)

def _scatter_add(tgt, idx, src, axis=0):
    return tgt.clone().index_add_(axis, idx, src)

def _segment_sum(src, seg, n):
    out = torch.zeros((n,) + src.shape[1:], dtype=src.dtype)
    return out.index_add_(0, seg, src)

def _pad(x, pw):
    flat = tuple((v for pair in reversed(pw) for v in pair))
    return torch.nn.functional.pad(x, flat)
kernel_name = 'interleave_layers__memory_aug_recurrent_mem_tr__linear_attn_block__prompt'

def setup_inputs():

    _w = lambda a: (lambda t: t.to(torch.bfloat16) if t.is_floating_point() else t)(torch.as_tensor(a))

    def _A_setup():
        B, S, Dm = (1, 2048, 512)
        H, Dh = (32, 128)
        M, seg = (8, 32)
        seg = min(seg, S)
        S = S // seg * seg
        return {'x': _w((lambda *s: torch.randn(*s, dtype=torch.bfloat16) * 0.05)(B, S, Dm)), 'mem0': _w((lambda *s: torch.randn(*s, dtype=torch.bfloat16) * 0.2)(B, M, Dm)), 'Wq': _w((lambda *s: torch.randn(*s, dtype=torch.bfloat16) * 1.6)(Dm, H, Dh) * Dm ** (-0.5)), 'Wk': _w((lambda *s: torch.randn(*s, dtype=torch.bfloat16) * 1.6)(Dm, H, Dh) * Dm ** (-0.5)), 'Wv': _w((lambda *s: torch.randn(*s, dtype=torch.bfloat16) * 0.2)(Dm, H, Dh) * Dm ** (-0.5)), 'Wo': _w((lambda *s: torch.randn(*s, dtype=torch.bfloat16) * 0.2)(H, Dh, Dm) * (H * Dh) ** (-0.5)), 'seg_len': seg}
    _A_in = _A_setup()

    def _B_setup():
        B, S, D = (1, 2048, 512)
        return {'x': _w((lambda *s: torch.randn(*s, dtype=torch.bfloat16) * 0.05)(B, S, D)), 'wqkv': _w((lambda *s: torch.randn(*s, dtype=torch.bfloat16) * 0.1)(D, 3 * D)), 'wo': _w((lambda *s: torch.randn(*s, dtype=torch.bfloat16) * 0.05)(D, D))}
    _B_in = _B_setup()
    return {'A_x': _A_in['x'], 'A_mem0': _A_in['mem0'], 'A_Wq': _A_in['Wq'], 'A_Wk': _A_in['Wk'], 'A_Wv': _A_in['Wv'], 'A_Wo': _A_in['Wo'], 'A_seg_len': _A_in['seg_len'], 'B_x': _B_in['x'], 'B_wqkv': _B_in['wqkv'], 'B_wo': _B_in['wo']}

def reference(A_x, A_mem0, A_Wq, A_Wk, A_Wv, A_Wo, A_seg_len, B_x, B_wqkv, B_wo):

    def _A_ref(x, mem0, Wq, Wk, Wv, Wo, seg_len):
        B, S, Dm = x.shape
        H, Dh = (Wq.shape[1], Wq.shape[2])
        M = mem0.shape[1]
        scale = Dh ** (-0.5)
        n_seg = S // seg_len
        L = M + seg_len
        idx = torch.arange(L)
        mask = (idx[:, None] < M) | (idx[:, None] >= idx[None, :])
        mem = mem0
        outs = []
        for s in range(n_seg):
            xs = x[:, s * seg_len:(s + 1) * seg_len, :].clone()
            h = torch.concatenate([mem, xs], axis=1)
            q = torch.einsum('btd,dhe->bhte', h, Wq)
            k = torch.einsum('btd,dhe->bhte', h, Wk)
            v = torch.einsum('btd,dhe->bhte', h, Wv)
            scores = torch.einsum('bhqe,bhke->bhqk', q, k) * scale
            scores = torch.where(mask[None, None], scores, -1000000000.0)
            p = _softmax(scores, axis=-1)
            o = torch.einsum('bhqk,bhke->bhqe', p, v)
            o = torch.einsum('bhte,hed->btd', o, Wo)
            mem = o[:, :M, :].clone()
            outs.append(o[:, M:, :])
        return torch.concatenate(outs, axis=1)

    def _B_ref(x, wqkv, wo):
        B, S, D = x.shape
        H = 32
        Dh = D // H
        qkv = (lambda x, *d: x.permute(*d))((x @ wqkv).reshape(B, S, 3, H, Dh), 2, 0, 3, 1, 4)
        q, k, v = (qkv[0], qkv[1], qkv[2])
        phi = lambda t: torch.where(t > 0, t + 1, torch.exp(t)) + 1e-06
        pq, pk = (phi(q), phi(k))
        kv = torch.einsum('bhsd,bhse->bhde', pk, v)
        z = torch.einsum('bhsd->bhd', pk)
        num = torch.einsum('bhqd,bhde->bhqe', pq, kv)
        den = torch.einsum('bhqd,bhd->bhq', pq, z)[..., None] + 1e-06
        o = num / den
        return (lambda x, *d: x.permute(*d))(o, 0, 2, 1, 3).reshape(B, S, D) @ wo
    x = A_x
    x = x + _A_ref(_layernorm(x, axis=-1), A_mem0, A_Wq, A_Wk, A_Wv, A_Wo, A_seg_len)
    x = x + _B_ref(_layernorm(x, axis=-1), B_wqkv, B_wo)
    x = x + _A_ref(_layernorm(x, axis=-1), A_mem0, A_Wq, A_Wk, A_Wv, A_Wo, A_seg_len)
    x = x + _B_ref(_layernorm(x, axis=-1), B_wqkv, B_wo)
    return x
```

```asm
; @launch kernel=pre_kernel grid=(1169,1,1) block=(256,1,1) lds=512
; @launch kernel=chain_kernel grid=(256,1,1) block=(256,1,1) lds=156864
; @launch kernel=ln1_kernel grid=(128,1,1) block=(256,1,1) lds=512
; @launch kernel=g3_kernel grid=(192,1,1) block=(256,1,1) lds=65536
; @launch kernel=kvred_kernel grid=(64,1,1) block=(64,1,1) lds=0
; @launch kernel=b2af_kernel grid=(193,1,1) block=(256,1,1) lds=17408
; @launch kernel=chain_kernel grid=(256,1,1) block=(256,1,1) lds=156864
; @launch kernel=ln3_kernel grid=(128,1,1) block=(256,1,1) lds=512
; @launch kernel=g3_kernel grid=(192,1,1) block=(256,1,1) lds=65536
; @launch kernel=kvred_kernel grid=(64,1,1) block=(64,1,1) lds=0
; @launch kernel=b2b_kernel grid=(128,1,1) block=(256,1,1) lds=17408
.amdgcn_target "amdgcn-amd-amdhsa--gfx950"
.text
.globl pre_kernel
.p2align 8
.type pre_kernel,@function
pre_kernel:
    s_cmp_ge_u32 s2, 1169
    s_cbranch_scc1 M_pre_kernel_end
    s_cmp_ge_u32 s2, 193
    s_cbranch_scc1 M_pre_kernel_2
    s_cmp_ge_u32 s2, 128
    s_cbranch_scc1 M_pre_kernel_1
M_pre_kernel_0:
    s_load_dwordx2 s[4:5], s[0:1], 96
    s_load_dwordx2 s[6:7], s[0:1], 0
    s_cmp_ge_u32 s2, 128
    s_cbranch_scc1 L_ln0_kernel_1
    v_and_b32 v1, 15, v0
    v_bfe_u32 v2, v0, 4, 2
    v_lshrrev_b32 v3, 6, v0
    s_lshl_b32 s8, s2, 4
    v_add_u32 v4, s8, v1
    v_lshlrev_b32 v5, 10, v4
    v_lshl_add_u32 v5, v3, 8, v5
    v_lshl_add_u32 v5, v2, 4, v5
    s_waitcnt lgkmcnt(0)
    global_load_dwordx4 v[16:19], v5, s[6:7] offset:0
    global_load_dwordx4 v[20:23], v5, s[6:7] offset:64
    global_load_dwordx4 v[24:27], v5, s[6:7] offset:128
    global_load_dwordx4 v[28:31], v5, s[6:7] offset:192
    s_waitcnt vmcnt(0)
    v_lshlrev_b32 v32, 16, v16
    v_and_b32 v33, 0xffff0000, v16
    v_lshlrev_b32 v34, 16, v17
    v_and_b32 v35, 0xffff0000, v17
    v_lshlrev_b32 v36, 16, v18
    v_and_b32 v37, 0xffff0000, v18
    v_lshlrev_b32 v38, 16, v19
    v_and_b32 v39, 0xffff0000, v19
    v_lshlrev_b32 v40, 16, v20
    v_and_b32 v41, 0xffff0000, v20
    v_lshlrev_b32 v42, 16, v21
    v_and_b32 v43, 0xffff0000, v21
    v_lshlrev_b32 v44, 16, v22
    v_and_b32 v45, 0xffff0000, v22
    v_lshlrev_b32 v46, 16, v23
    v_and_b32 v47, 0xffff0000, v23
    v_lshlrev_b32 v48, 16, v24
    v_and_b32 v49, 0xffff0000, v24
    v_lshlrev_b32 v50, 16, v25
    v_and_b32 v51, 0xffff0000, v25
    v_lshlrev_b32 v52, 16, v26
    v_and_b32 v53, 0xffff0000, v26
    v_lshlrev_b32 v54, 16, v27
    v_and_b32 v55, 0xffff0000, v27
    v_lshlrev_b32 v56, 16, v28
    v_and_b32 v57, 0xffff0000, v28
    v_lshlrev_b32 v58, 16, v29
    v_and_b32 v59, 0xffff0000, v29
    v_lshlrev_b32 v60, 16, v30
    v_and_b32 v61, 0xffff0000, v30
    v_lshlrev_b32 v62, 16, v31
    v_and_b32 v63, 0xffff0000, v31
    v_add_f32 v8, v32, v33
    v_add_f32 v8, v8, v34
    v_add_f32 v8, v8, v35
    v_add_f32 v8, v8, v36
    v_add_f32 v8, v8, v37
    v_add_f32 v8, v8, v38
    v_add_f32 v8, v8, v39
    v_add_f32 v8, v8, v40
    v_add_f32 v8, v8, v41
    v_add_f32 v8, v8, v42
    v_add_f32 v8, v8, v43
    v_add_f32 v8, v8, v44
    v_add_f32 v8, v8, v45
    v_add_f32 v8, v8, v46
    v_add_f32 v8, v8, v47
    v_add_f32 v8, v8, v48
    v_add_f32 v8, v8, v49
    v_add_f32 v8, v8, v50
    v_add_f32 v8, v8, v51
    v_add_f32 v8, v8, v52
    v_add_f32 v8, v8, v53
    v_add_f32 v8, v8, v54
    v_add_f32 v8, v8, v55
    v_add_f32 v8, v8, v56
    v_add_f32 v8, v8, v57
    v_add_f32 v8, v8, v58
    v_add_f32 v8, v8, v59
    v_add_f32 v8, v8, v60
    v_add_f32 v8, v8, v61
    v_add_f32 v8, v8, v62
    v_add_f32 v8, v8, v63
    v_mov_b32 v9, v8
    v_mov_b32 v10, v8
    s_nop 1
    v_permlane32_swap_b32 v9, v10
    s_nop 1
    v_add_f32 v8, v9, v10
    v_mov_b32 v9, v8
    v_mov_b32 v10, v8
    s_nop 1
    v_permlane16_swap_b32 v9, v10
    s_nop 1
    v_add_f32 v8, v9, v10
    v_lshlrev_b32 v11, 2, v1
    v_lshl_add_u32 v12, v3, 6, v11
    ds_write_b32 v12, v8
    s_waitcnt lgkmcnt(0)
    s_barrier
    ds_read_b32 v8, v11
    ds_read_b32 v9, v11 offset:64
    ds_read_b32 v10, v11 offset:128
    ds_read_b32 v13, v11 offset:192
    s_waitcnt lgkmcnt(0)
    v_add_f32 v8, v8, v9
    v_add_f32 v10, v10, v13
    v_add_f32 v8, v8, v10
    v_mul_f32 v8, 0x3b000000, v8
    v_mov_b32 v14, 0
    v_sub_f32 v9, v32, v8
    v_fmac_f32 v14, v9, v9
    v_sub_f32 v9, v33, v8
    v_fmac_f32 v14, v9, v9
    v_sub_f32 v9, v34, v8
    v_fmac_f32 v14, v9, v9
    v_sub_f32 v9, v35, v8
    v_fmac_f32 v14, v9, v9
    v_sub_f32 v9, v36, v8
    v_fmac_f32 v14, v9, v9
    v_sub_f32 v9, v37, v8
    v_fmac_f32 v14, v9, v9
    v_sub_f32 v9, v38, v8
    v_fmac_f32 v14, v9, v9
    v_sub_f32 v9, v39, v8
    v_fmac_f32 v14, v9, v9
    v_sub_f32 v9, v40, v8
    v_fmac_f32 v14, v9, v9
    v_sub_f32 v9, v41, v8
    v_fmac_f32 v14, v9, v9
    v_sub_f32 v9, v42, v8
    v_fmac_f32 v14, v9, v9
    v_sub_f32 v9, v43, v8
    v_fmac_f32 v14, v9, v9
    v_sub_f32 v9, v44, v8
    v_fmac_f32 v14, v9, v9
    v_sub_f32 v9, v45, v8
    v_fmac_f32 v14, v9, v9
    v_sub_f32 v9, v46, v8
    v_fmac_f32 v14, v9, v9
    v_sub_f32 v9, v47, v8
    v_fmac_f32 v14, v9, v9
    v_sub_f32 v9, v48, v8
    v_fmac_f32 v14, v9, v9
    v_sub_f32 v9, v49, v8
    v_fmac_f32 v14, v9, v9
    v_sub_f32 v9, v50, v8
    v_fmac_f32 v14, v9, v9
    v_sub_f32 v9, v51, v8
    v_fmac_f32 v14, v9, v9
    v_sub_f32 v9, v52, v8
    v_fmac_f32 v14, v9, v9
    v_sub_f32 v9, v53, v8
    v_fmac_f32 v14, v9, v9
    v_sub_f32 v9, v54, v8
    v_fmac_f32 v14, v9, v9
    v_sub_f32 v9, v55, v8
    v_fmac_f32 v14, v9, v9
    v_sub_f32 v9, v56, v8
    v_fmac_f32 v14, v9, v9
    v_sub_f32 v9, v57, v8
    v_fmac_f32 v14, v9, v9
    v_sub_f32 v9, v58, v8
    v_fmac_f32 v14, v9, v9
    v_sub_f32 v9, v59, v8
    v_fmac_f32 v14, v9, v9
    v_sub_f32 v9, v60, v8
    v_fmac_f32 v14, v9, v9
    v_sub_f32 v9, v61, v8
    v_fmac_f32 v14, v9, v9
    v_sub_f32 v9, v62, v8
    v_fmac_f32 v14, v9, v9
    v_sub_f32 v9, v63, v8
    v_fmac_f32 v14, v9, v9
    v_mov_b32 v9, v14
    v_mov_b32 v10, v14
    s_nop 1
    v_permlane32_swap_b32 v9, v10
    s_nop 1
    v_add_f32 v14, v9, v10
    v_mov_b32 v9, v14
    v_mov_b32 v10, v14
    s_nop 1
    v_permlane16_swap_b32 v9, v10
    s_nop 1
    v_add_f32 v14, v9, v10
    ds_write_b32 v12, v14 offset:256
    s_waitcnt lgkmcnt(0)
    s_barrier
    ds_read_b32 v14, v11 offset:256
    ds_read_b32 v9, v11 offset:320
    ds_read_b32 v10, v11 offset:384
    ds_read_b32 v13, v11 offset:448
    s_waitcnt lgkmcnt(0)
    v_add_f32 v14, v14, v9
    v_add_f32 v10, v10, v13
    v_add_f32 v14, v14, v10
    v_mul_f32 v14, 0x3b000000, v14
    v_cvt_pk_bf16_f32 v9, v8, v14
    v_lshlrev_b32 v8, 16, v9
    v_and_b32 v14, 0xffff0000, v9
    v_add_f32 v14, 0x3727c5ac, v14
    v_cvt_pk_bf16_f32 v9, v14, v14
    v_lshlrev_b32 v14, 16, v9
    v_sqrt_f32 v14, v14
    s_nop 0
    v_cvt_pk_bf16_f32 v9, v14, v14
    v_lshlrev_b32 v14, 16, v9
    v_rcp_f32 v15, v14
    s_nop 0
    v_sub_f32 v32, v32, v8
    v_sub_f32 v33, v33, v8
    v_cvt_pk_bf16_f32 v9, v32, v33
    v_lshlrev_b32 v32, 16, v9
    v_and_b32 v33, 0xffff0000, v9
    v_mul_f32 v9, v32, v15
    v_fma_f32 v10, -v9, v14, v32
    v_fma_f32 v32, v10, v15, v9
    v_mul_f32 v9, v33, v15
    v_fma_f32 v10, -v9, v14, v33
    v_fma_f32 v33, v10, v15, v9
    v_cvt_pk_bf16_f32 v16, v32, v33
    v_sub_f32 v34, v34, v8
    v_sub_f32 v35, v35, v8
    v_cvt_pk_bf16_f32 v9, v34, v35
    v_lshlrev_b32 v34, 16, v9
    v_and_b32 v35, 0xffff0000, v9
    v_mul_f32 v9, v34, v15
    v_fma_f32 v10, -v9, v14, v34
    v_fma_f32 v34, v10, v15, v9
    v_mul_f32 v9, v35, v15
    v_fma_f32 v10, -v9, v14, v35
    v_fma_f32 v35, v10, v15, v9
    v_cvt_pk_bf16_f32 v17, v34, v35
    v_sub_f32 v36, v36, v8
    v_sub_f32 v37, v37, v8
    v_cvt_pk_bf16_f32 v9, v36, v37
    v_lshlrev_b32 v36, 16, v9
    v_and_b32 v37, 0xffff0000, v9
    v_mul_f32 v9, v36, v15
    v_fma_f32 v10, -v9, v14, v36
    v_fma_f32 v36, v10, v15, v9
    v_mul_f32 v9, v37, v15
    v_fma_f32 v10, -v9, v14, v37
    v_fma_f32 v37, v10, v15, v9
    v_cvt_pk_bf16_f32 v18, v36, v37
    v_sub_f32 v38, v38, v8
    v_sub_f32 v39, v39, v8
    v_cvt_pk_bf16_f32 v9, v38, v39
    v_lshlrev_b32 v38, 16, v9
    v_and_b32 v39, 0xffff0000, v9
    v_mul_f32 v9, v38, v15
    v_fma_f32 v10, -v9, v14, v38
    v_fma_f32 v38, v10, v15, v9
    v_mul_f32 v9, v39, v15
    v_fma_f32 v10, -v9, v14, v39
    v_fma_f32 v39, v10, v15, v9
    v_cvt_pk_bf16_f32 v19, v38, v39
    v_sub_f32 v40, v40, v8
    v_sub_f32 v41, v41, v8
    v_cvt_pk_bf16_f32 v9, v40, v41
    v_lshlrev_b32 v40, 16, v9
    v_and_b32 v41, 0xffff0000, v9
    v_mul_f32 v9, v40, v15
    v_fma_f32 v10, -v9, v14, v40
    v_fma_f32 v40, v10, v15, v9
    v_mul_f32 v9, v41, v15
    v_fma_f32 v10, -v9, v14, v41
    v_fma_f32 v41, v10, v15, v9
    v_cvt_pk_bf16_f32 v20, v40, v41
    v_sub_f32 v42, v42, v8
    v_sub_f32 v43, v43, v8
    v_cvt_pk_bf16_f32 v9, v42, v43
    v_lshlrev_b32 v42, 16, v9
    v_and_b32 v43, 0xffff0000, v9
    v_mul_f32 v9, v42, v15
    v_fma_f32 v10, -v9, v14, v42
    v_fma_f32 v42, v10, v15, v9
    v_mul_f32 v9, v43, v15
    v_fma_f32 v10, -v9, v14, v43
    v_fma_f32 v43, v10, v15, v9
    v_cvt_pk_bf16_f32 v21, v42, v43
    v_sub_f32 v44, v44, v8
    v_sub_f32 v45, v45, v8
    v_cvt_pk_bf16_f32 v9, v44, v45
    v_lshlrev_b32 v44, 16, v9
    v_and_b32 v45, 0xffff0000, v9
    v_mul_f32 v9, v44, v15
    v_fma_f32 v10, -v9, v14, v44
    v_fma_f32 v44, v10, v15, v9
    v_mul_f32 v9, v45, v15
    v_fma_f32 v10, -v9, v14, v45
    v_fma_f32 v45, v10, v15, v9
    v_cvt_pk_bf16_f32 v22, v44, v45
    v_sub_f32 v46, v46, v8
    v_sub_f32 v47, v47, v8
    v_cvt_pk_bf16_f32 v9, v46, v47
    v_lshlrev_b32 v46, 16, v9
    v_and_b32 v47, 0xffff0000, v9
    v_mul_f32 v9, v46, v15
    v_fma_f32 v10, -v9, v14, v46
    v_fma_f32 v46, v10, v15, v9
    v_mul_f32 v9, v47, v15
    v_fma_f32 v10, -v9, v14, v47
    v_fma_f32 v47, v10, v15, v9
    v_cvt_pk_bf16_f32 v23, v46, v47
    v_sub_f32 v48, v48, v8
    v_sub_f32 v49, v49, v8
    v_cvt_pk_bf16_f32 v9, v48, v49
    v_lshlrev_b32 v48, 16, v9
    v_and_b32 v49, 0xffff0000, v9
    v_mul_f32 v9, v48, v15
    v_fma_f32 v10, -v9, v14, v48
    v_fma_f32 v48, v10, v15, v9
    v_mul_f32 v9, v49, v15
    v_fma_f32 v10, -v9, v14, v49
    v_fma_f32 v49, v10, v15, v9
    v_cvt_pk_bf16_f32 v24, v48, v49
    v_sub_f32 v50, v50, v8
    v_sub_f32 v51, v51, v8
    v_cvt_pk_bf16_f32 v9, v50, v51
    v_lshlrev_b32 v50, 16, v9
    v_and_b32 v51, 0xffff0000, v9
    v_mul_f32 v9, v50, v15
    v_fma_f32 v10, -v9, v14, v50
    v_fma_f32 v50, v10, v15, v9
    v_mul_f32 v9, v51, v15
    v_fma_f32 v10, -v9, v14, v51
    v_fma_f32 v51, v10, v15, v9
    v_cvt_pk_bf16_f32 v25, v50, v51
    v_sub_f32 v52, v52, v8
    v_sub_f32 v53, v53, v8
    v_cvt_pk_bf16_f32 v9, v52, v53
    v_lshlrev_b32 v52, 16, v9
    v_and_b32 v53, 0xffff0000, v9
    v_mul_f32 v9, v52, v15
    v_fma_f32 v10, -v9, v14, v52
    v_fma_f32 v52, v10, v15, v9
    v_mul_f32 v9, v53, v15
    v_fma_f32 v10, -v9, v14, v53
    v_fma_f32 v53, v10, v15, v9
    v_cvt_pk_bf16_f32 v26, v52, v53
    v_sub_f32 v54, v54, v8
    v_sub_f32 v55, v55, v8
    v_cvt_pk_bf16_f32 v9, v54, v55
    v_lshlrev_b32 v54, 16, v9
    v_and_b32 v55, 0xffff0000, v9
    v_mul_f32 v9, v54, v15
    v_fma_f32 v10, -v9, v14, v54
    v_fma_f32 v54, v10, v15, v9
    v_mul_f32 v9, v55, v15
    v_fma_f32 v10, -v9, v14, v55
    v_fma_f32 v55, v10, v15, v9
    v_cvt_pk_bf16_f32 v27, v54, v55
    v_sub_f32 v56, v56, v8
    v_sub_f32 v57, v57, v8
    v_cvt_pk_bf16_f32 v9, v56, v57
    v_lshlrev_b32 v56, 16, v9
    v_and_b32 v57, 0xffff0000, v9
    v_mul_f32 v9, v56, v15
    v_fma_f32 v10, -v9, v14, v56
    v_fma_f32 v56, v10, v15, v9
    v_mul_f32 v9, v57, v15
    v_fma_f32 v10, -v9, v14, v57
    v_fma_f32 v57, v10, v15, v9
    v_cvt_pk_bf16_f32 v28, v56, v57
    v_sub_f32 v58, v58, v8
    v_sub_f32 v59, v59, v8
    v_cvt_pk_bf16_f32 v9, v58, v59
    v_lshlrev_b32 v58, 16, v9
    v_and_b32 v59, 0xffff0000, v9
    v_mul_f32 v9, v58, v15
    v_fma_f32 v10, -v9, v14, v58
    v_fma_f32 v58, v10, v15, v9
    v_mul_f32 v9, v59, v15
    v_fma_f32 v10, -v9, v14, v59
    v_fma_f32 v59, v10, v15, v9
    v_cvt_pk_bf16_f32 v29, v58, v59
    v_sub_f32 v60, v60, v8
    v_sub_f32 v61, v61, v8
    v_cvt_pk_bf16_f32 v9, v60, v61
    v_lshlrev_b32 v60, 16, v9
    v_and_b32 v61, 0xffff0000, v9
    v_mul_f32 v9, v60, v15
    v_fma_f32 v10, -v9, v14, v60
    v_fma_f32 v60, v10, v15, v9
    v_mul_f32 v9, v61, v15
    v_fma_f32 v10, -v9, v14, v61
    v_fma_f32 v61, v10, v15, v9
    v_cvt_pk_bf16_f32 v30, v60, v61
    v_sub_f32 v62, v62, v8
    v_sub_f32 v63, v63, v8
    v_cvt_pk_bf16_f32 v9, v62, v63
    v_lshlrev_b32 v62, 16, v9
    v_and_b32 v63, 0xffff0000, v9
    v_mul_f32 v9, v62, v15
    v_fma_f32 v10, -v9, v14, v62
    v_fma_f32 v62, v10, v15, v9
    v_mul_f32 v9, v63, v15
    v_fma_f32 v10, -v9, v14, v63
    v_fma_f32 v63, v10, v15, v9
    v_cvt_pk_bf16_f32 v31, v62, v63
    v_and_b32 v6, 63, v0
    v_lshlrev_b32 v6, 4, v6
    v_lshl_add_u32 v6, v3, 12, v6
    s_lshl_b32 s8, s2, 14
    v_add_u32 v6, s8, v6
    v_add_u32 v6, 18874368, v6
    global_store_dwordx4 v6, v[16:19], s[4:5] offset:0
    global_store_dwordx4 v6, v[20:23], s[4:5] offset:1024
    global_store_dwordx4 v6, v[24:27], s[4:5] offset:2048
    global_store_dwordx4 v6, v[28:31], s[4:5] offset:3072
L_ln0_kernel_1:
    s_endpgm
M_pre_kernel_1:
    s_sub_u32 s2, s2, 128
    s_load_dwordx2 s[4:5], s[0:1], 96
    s_cmp_ge_u32 s2, 65
    s_cbranch_scc1 L_fill_kernel_1
    v_mov_b32 v4, -1
    v_mov_b32 v5, -1
    v_mov_b32 v6, -1
    v_mov_b32 v7, -1
    s_lshl_b32 s6, s2, 14
    v_lshlrev_b32 v1, 4, v0
    v_add_u32 v1, s6, v1
    v_add_u32 v1, 127926272, v1
    s_waitcnt lgkmcnt(0)
    global_store_dwordx4 v1, v[4:7], s[4:5]
    v_add_u32 v1, 4096, v1
    global_store_dwordx4 v1, v[4:7], s[4:5]
    v_add_u32 v1, 4096, v1
    global_store_dwordx4 v1, v[4:7], s[4:5]
    v_add_u32 v1, 4096, v1
    global_store_dwordx4 v1, v[4:7], s[4:5]
    v_add_u32 v1, 4096, v1
    s_cmp_eq_u32 s2, 64
    s_cbranch_scc0 L_fill_kernel_1
    global_store_dwordx4 v1, v[4:7], s[4:5]
    v_add_u32 v1, 4096, v1
    global_store_dwordx4 v1, v[4:7], s[4:5]
    v_add_u32 v1, 4096, v1
    v_mov_b32 v8, 0
    v_mov_b32 v9, 0
    v_mov_b32 v10, 0
    v_mov_b32 v11, 0
    v_lshlrev_b32 v1, 4, v0
    v_add_u32 v1, 129007616, v1
    global_store_dwordx4 v1, v[8:11], s[4:5]
    global_store_dwordx4 v1, v[8:11], s[4:5] offset:4080
    v_add_u32 v1, 8176, v1
    global_store_dwordx4 v1, v[8:11], s[4:5]
L_fill_kernel_1:
    s_endpgm
M_pre_kernel_2:
    s_sub_u32 s2, s2, 193
    s_load_dwordx2 s[4:5], s[0:1], 96
    s_load_dwordx4 s[8:11], s[0:1], 16
    s_load_dwordx4 s[12:15], s[0:1], 32
    s_load_dwordx4 s[16:19], s[0:1], 64
    s_waitcnt lgkmcnt(0)
    s_cmp_ge_u32 s2, 976
    s_cbranch_scc1 L_prep_kernel_4
    s_cmp_ge_u32 s2, 592
    s_cbranch_scc1 L_prep_kernel_6
    s_cmp_ge_u32 s2, 576
    s_cbranch_scc1 L_prep_kernel_3
    s_cmp_ge_u32 s2, 512
    s_cbranch_scc1 L_prep_kernel_2
    s_cmp_ge_u32 s2, 384
    s_cbranch_scc1 L_prep_kernel_1
    s_lshr_b32 s22, s2, 7
    s_and_b32 s23, s2, 127
    s_mov_b32 s6, s8
    s_mov_b32 s7, s9
    s_cmp_eq_u32 s22, 1
    s_cselect_b32 s6, s10, s6
    s_cselect_b32 s7, s11, s7
    s_cmp_eq_u32 s22, 2
    s_cselect_b32 s6, s12, s6
    s_cselect_b32 s7, s13, s7
    s_lshl_b32 s24, s23, 8
    v_add_u32 v1, s24, v0
    v_and_b32 v2, 511, v1
    v_lshrrev_b32 v3, 9, v1
    v_lshlrev_b32 v4, 16, v3
    v_lshl_add_u32 v4, v2, 4, v4
    v_mov_b32 v8, v4
    v_add_u32 v9, 8192, v4
    v_add_u32 v10, 16384, v4
    v_add_u32 v11, 24576, v4
    v_add_u32 v12, 32768, v4
    v_add_u32 v13, 40960, v4
    v_add_u32 v14, 49152, v4
    v_add_u32 v15, 57344, v4
    global_load_dwordx4 v[16:19], v8, s[6:7]
    global_load_dwordx4 v[20:23], v9, s[6:7]
    global_load_dwordx4 v[24:27], v10, s[6:7]
    global_load_dwordx4 v[28:31], v11, s[6:7]
    global_load_dwordx4 v[32:35], v12, s[6:7]
    global_load_dwordx4 v[36:39], v13, s[6:7]
    global_load_dwordx4 v[40:43], v14, s[6:7]
    global_load_dwordx4 v[44:47], v15, s[6:7]
    s_waitcnt vmcnt(0)
    v_lshrrev_b32 v5, 4, v2
    v_mul_u32_u24 v5, 24, v5
    v_bfe_u32 v6, v2, 1, 3
    v_add_u32 v5, v5, v6
    s_lshl_b32 s25, s22, 3
    v_add_u32 v5, s25, v5
    v_lshlrev_b32 v5, 4, v5
    v_lshrrev_b32 v6, 2, v3
    v_add_u32 v5, v5, v6
    v_lshlrev_b32 v5, 6, v5
    v_and_b32 v6, 3, v3
    v_lshl_add_u32 v5, v6, 4, v5
    v_and_b32 v6, 1, v2
    v_lshl_add_u32 v5, v6, 3, v5
    v_lshlrev_b32 v5, 4, v5
    s_mov_b32 s20, 0x05040100
    s_mov_b32 s21, 0x07060302
    v_perm_b32 v48, v20, v16, s20
    v_perm_b32 v52, v20, v16, s21
    v_perm_b32 v49, v28, v24, s20
    v_perm_b32 v53, v28, v24, s21
    v_perm_b32 v50, v36, v32, s20
    v_perm_b32 v54, v36, v32, s21
    v_perm_b32 v51, v44, v40, s20
    v_perm_b32 v55, v44, v40, s21
    v_perm_b32 v56, v21, v17, s20
    v_perm_b32 v60, v21, v17, s21
    v_perm_b32 v57, v29, v25, s20
    v_perm_b32 v61, v29, v25, s21
    v_perm_b32 v58, v37, v33, s20
    v_perm_b32 v62, v37, v33, s21
    v_perm_b32 v59, v45, v41, s20
    v_perm_b32 v63, v45, v41, s21
    v_perm_b32 v64, v22, v18, s20
    v_perm_b32 v68, v22, v18, s21
    v_perm_b32 v65, v30, v26, s20
    v_perm_b32 v69, v30, v26, s21
    v_perm_b32 v66, v38, v34, s20
    v_perm_b32 v70, v38, v34, s21
    v_perm_b32 v67, v46, v42, s20
    v_perm_b32 v71, v46, v42, s21
    v_perm_b32 v72, v23, v19, s20
    v_perm_b32 v76, v23, v19, s21
    v_perm_b32 v73, v31, v27, s20
    v_perm_b32 v77, v31, v27, s21
    v_perm_b32 v74, v39, v35, s20
    v_perm_b32 v78, v39, v35, s21
    v_perm_b32 v75, v47, v43, s20
    v_perm_b32 v79, v47, v43, s21
    global_store_dwordx4 v5, v[48:51], s[4:5] offset:0
    global_store_dwordx4 v5, v[52:55], s[4:5] offset:16
    global_store_dwordx4 v5, v[56:59], s[4:5] offset:32
    global_store_dwordx4 v5, v[60:63], s[4:5] offset:48
    global_store_dwordx4 v5, v[64:67], s[4:5] offset:64
    global_store_dwordx4 v5, v[68:71], s[4:5] offset:80
    global_store_dwordx4 v5, v[72:75], s[4:5] offset:96
    global_store_dwordx4 v5, v[76:79], s[4:5] offset:112
    s_branch L_prep_kernel_4
L_prep_kernel_1:
    s_sub_u32 s23, s2, 384
    s_lshl_b32 s24, s23, 8
    v_add_u32 v1, s24, v0
    v_and_b32 v2, 63, v1
    v_lshrrev_b32 v3, 6, v1
    v_lshrrev_b32 v4, 2, v3
    v_lshlrev_b32 v4, 5, v4
    v_and_b32 v6, 3, v3
    v_lshl_add_u32 v4, v6, 2, v4
    v_lshlrev_b32 v4, 10, v4
    v_lshl_add_u32 v4, v2, 4, v4
    v_mov_b32 v8, v4
    v_add_u32 v9, 1024, v4
    v_add_u32 v10, 2048, v4
    v_add_u32 v11, 3072, v4
    v_add_u32 v12, 16384, v4
    v_add_u32 v13, 17408, v4
    v_add_u32 v14, 18432, v4
    v_add_u32 v15, 19456, v4
    global_load_dwordx4 v[16:19], v8, s[14:15]
    global_load_dwordx4 v[20:23], v9, s[14:15]
    global_load_dwordx4 v[24:27], v10, s[14:15]
    global_load_dwordx4 v[28:31], v11, s[14:15]
    global_load_dwordx4 v[32:35], v12, s[14:15]
    global_load_dwordx4 v[36:39], v13, s[14:15]
    global_load_dwordx4 v[40:43], v14, s[14:15]
    global_load_dwordx4 v[44:47], v15, s[14:15]
    s_waitcnt vmcnt(0)
    v_lshrrev_b32 v5, 1, v2
    v_lshlrev_b32 v5, 7, v5
    v_lshrrev_b32 v6, 2, v3
    v_add_u32 v5, v5, v6
    v_lshlrev_b32 v5, 6, v5
    v_and_b32 v6, 3, v3
    v_lshl_add_u32 v5, v6, 4, v5
    v_and_b32 v6, 1, v2
    v_lshl_add_u32 v5, v6, 3, v5
    v_lshlrev_b32 v5, 4, v5
    v_add_u32 v5, 12582912, v5
    s_mov_b32 s20, 0x05040100
    s_mov_b32 s21, 0x07060302
    v_perm_b32 v48, v20, v16, s20
    v_perm_b32 v52, v20, v16, s21
    v_perm_b32 v49, v28, v24, s20
    v_perm_b32 v53, v28, v24, s21
    v_perm_b32 v50, v36, v32, s20
    v_perm_b32 v54, v36, v32, s21
    v_perm_b32 v51, v44, v40, s20
    v_perm_b32 v55, v44, v40, s21
    v_perm_b32 v56, v21, v17, s20
    v_perm_b32 v60, v21, v17, s21
    v_perm_b32 v57, v29, v25, s20
    v_perm_b32 v61, v29, v25, s21
    v_perm_b32 v58, v37, v33, s20
    v_perm_b32 v62, v37, v33, s21
    v_perm_b32 v59, v45, v41, s20
    v_perm_b32 v63, v45, v41, s21
    v_perm_b32 v64, v22, v18, s20
    v_perm_b32 v68, v22, v18, s21
    v_perm_b32 v65, v30, v26, s20
    v_perm_b32 v69, v30, v26, s21
    v_perm_b32 v66, v38, v34, s20
    v_perm_b32 v70, v38, v34, s21
    v_perm_b32 v67, v46, v42, s20
    v_perm_b32 v71, v46, v42, s21
    v_perm_b32 v72, v23, v19, s20
    v_perm_b32 v76, v23, v19, s21
    v_perm_b32 v73, v31, v27, s20
    v_perm_b32 v77, v31, v27, s21
    v_perm_b32 v74, v39, v35, s20
    v_perm_b32 v78, v39, v35, s21
    v_perm_b32 v75, v47, v43, s20
    v_perm_b32 v79, v47, v43, s21
    global_store_dwordx4 v5, v[48:51], s[4:5] offset:0
    global_store_dwordx4 v5, v[52:55], s[4:5] offset:16
    global_store_dwordx4 v5, v[56:59], s[4:5] offset:32
    global_store_dwordx4 v5, v[60:63], s[4:5] offset:48
    global_store_dwordx4 v5, v[64:67], s[4:5] offset:64
    global_store_dwordx4 v5, v[68:71], s[4:5] offset:80
    global_store_dwordx4 v5, v[72:75], s[4:5] offset:96
    global_store_dwordx4 v5, v[76:79], s[4:5] offset:112
    s_branch L_prep_kernel_4
L_prep_kernel_2:
    s_sub_u32 s23, s2, 512
    v_cmp_gt_u32 vcc, 192, v0
    s_and_saveexec_b64 s[26:27], vcc
    s_cbranch_execz L_prep_kernel_4
    s_mul_i32 s24, s23, 24576
    v_lshlrev_b32 v4, 4, v0
    v_add_u32 v4, s24, v4
    v_mov_b32 v8, v4
    v_add_u32 v9, 3072, v4
    v_add_u32 v10, 6144, v4
    v_add_u32 v11, 9216, v4
    v_add_u32 v12, 12288, v4
    v_add_u32 v13, 15360, v4
    v_add_u32 v14, 18432, v4
    v_add_u32 v15, 21504, v4
    global_load_dwordx4 v[16:19], v8, s[16:17]
    global_load_dwordx4 v[20:23], v9, s[16:17]
    global_load_dwordx4 v[24:27], v10, s[16:17]
    global_load_dwordx4 v[28:31], v11, s[16:17]
    global_load_dwordx4 v[32:35], v12, s[16:17]
    global_load_dwordx4 v[36:39], v13, s[16:17]
    global_load_dwordx4 v[40:43], v14, s[16:17]
    global_load_dwordx4 v[44:47], v15, s[16:17]
    s_waitcnt vmcnt(0)
    v_lshrrev_b32 v5, 1, v0
    v_lshlrev_b32 v5, 4, v5
    s_lshr_b32 s25, s23, 2
    v_add_u32 v5, s25, v5
    v_lshlrev_b32 v5, 6, v5
    s_and_b32 s25, s23, 3
    s_lshl_b32 s25, s25, 4
    v_add_u32 v5, s25, v5
    v_and_b32 v6, 1, v0
    v_lshl_add_u32 v5, v6, 3, v5
    v_lshlrev_b32 v5, 4, v5
    v_add_u32 v5, 16777216, v5
    s_mov_b32 s20, 0x05040100
    s_mov_b32 s21, 0x07060302
    v_perm_b32 v48, v20, v16, s20
    v_perm_b32 v52, v20, v16, s21
    v_perm_b32 v49, v28, v24, s20
    v_perm_b32 v53, v28, v24, s21
    v_perm_b32 v50, v36, v32, s20
    v_perm_b32 v54, v36, v32, s21
    v_perm_b32 v51, v44, v40, s20
    v_perm_b32 v55, v44, v40, s21
    v_perm_b32 v56, v21, v17, s20
    v_perm_b32 v60, v21, v17, s21
    v_perm_b32 v57, v29, v25, s20
    v_perm_b32 v61, v29, v25, s21
    v_perm_b32 v58, v37, v33, s20
    v_perm_b32 v62, v37, v33, s21
    v_perm_b32 v59, v45, v41, s20
    v_perm_b32 v63, v45, v41, s21
    v_perm_b32 v64, v22, v18, s20
    v_perm_b32 v68, v22, v18, s21
    v_perm_b32 v65, v30, v26, s20
    v_perm_b32 v69, v30, v26, s21
    v_perm_b32 v66, v38, v34, s20
    v_perm_b32 v70, v38, v34, s21
    v_perm_b32 v67, v46, v42, s20
    v_perm_b32 v71, v46, v42, s21
    v_perm_b32 v72, v23, v19, s20
    v_perm_b32 v76, v23, v19, s21
    v_perm_b32 v73, v31, v27, s20
    v_perm_b32 v77, v31, v27, s21
    v_perm_b32 v74, v39, v35, s20
    v_perm_b32 v78, v39, v35, s21
    v_perm_b32 v75, v47, v43, s20
    v_perm_b32 v79, v47, v43, s21
    global_store_dwordx4 v5, v[48:51], s[4:5] offset:0
    global_store_dwordx4 v5, v[52:55], s[4:5] offset:16
    global_store_dwordx4 v5, v[56:59], s[4:5] offset:32
    global_store_dwordx4 v5, v[60:63], s[4:5] offset:48
    global_store_dwordx4 v5, v[64:67], s[4:5] offset:64
    global_store_dwordx4 v5, v[68:71], s[4:5] offset:80
    global_store_dwordx4 v5, v[72:75], s[4:5] offset:96
    global_store_dwordx4 v5, v[76:79], s[4:5] offset:112
    s_branch L_prep_kernel_4
L_prep_kernel_3:
    s_sub_u32 s23, s2, 576
    s_lshl_b32 s24, s23, 8
    v_add_u32 v1, s24, v0
    v_and_b32 v2, 63, v1
    v_lshrrev_b32 v3, 6, v1
    v_lshrrev_b32 v4, 2, v3
    v_lshlrev_b32 v4, 5, v4
    v_and_b32 v6, 3, v3
    v_lshl_add_u32 v4, v6, 2, v4
    v_lshlrev_b32 v4, 10, v4
    v_lshl_add_u32 v4, v2, 4, v4
    v_mov_b32 v8, v4
    v_add_u32 v9, 1024, v4
    v_add_u32 v10, 2048, v4
    v_add_u32 v11, 3072, v4
    v_add_u32 v12, 16384, v4
    v_add_u32 v13, 17408, v4
    v_add_u32 v14, 18432, v4
    v_add_u32 v15, 19456, v4
    global_load_dwordx4 v[16:19], v8, s[18:19]
    global_load_dwordx4 v[20:23], v9, s[18:19]
    global_load_dwordx4 v[24:27], v10, s[18:19]
    global_load_dwordx4 v[28:31], v11, s[18:19]
    global_load_dwordx4 v[32:35], v12, s[18:19]
    global_load_dwordx4 v[36:39], v13, s[18:19]
    global_load_dwordx4 v[40:43], v14, s[18:19]
    global_load_dwordx4 v[44:47], v15, s[18:19]
    s_waitcnt vmcnt(0)
    v_lshrrev_b32 v5, 1, v2
    v_lshlrev_b32 v5, 4, v5
    v_lshrrev_b32 v6, 2, v3
    v_add_u32 v5, v5, v6
    v_lshlrev_b32 v5, 6, v5
    v_and_b32 v6, 3, v3
    v_lshl_add_u32 v5, v6, 4, v5
    v_and_b32 v6, 1, v2
    v_lshl_add_u32 v5, v6, 3, v5
    v_lshlrev_b32 v5, 4, v5
    v_add_u32 v5, 18350080, v5
    s_mov_b32 s20, 0x05040100
    s_mov_b32 s21, 0x07060302
    v_perm_b32 v48, v20, v16, s20
    v_perm_b32 v52, v20, v16, s21
    v_perm_b32 v49, v28, v24, s20
    v_perm_b32 v53, v28, v24, s21
    v_perm_b32 v50, v36, v32, s20
    v_perm_b32 v54, v36, v32, s21
    v_perm_b32 v51, v44, v40, s20
    v_perm_b32 v55, v44, v40, s21
    v_perm_b32 v56, v21, v17, s20
    v_perm_b32 v60, v21, v17, s21
    v_perm_b32 v57, v29, v25, s20
    v_perm_b32 v61, v29, v25, s21
    v_perm_b32 v58, v37, v33, s20
    v_perm_b32 v62, v37, v33, s21
    v_perm_b32 v59, v45, v41, s20
    v_perm_b32 v63, v45, v41, s21
    v_perm_b32 v64, v22, v18, s20
    v_perm_b32 v68, v22, v18, s21
    v_perm_b32 v65, v30, v26, s20
    v_perm_b32 v69, v30, v26, s21
    v_perm_b32 v66, v38, v34, s20
    v_perm_b32 v70, v38, v34, s21
    v_perm_b32 v67, v46, v42, s20
    v_perm_b32 v71, v46, v42, s21
    v_perm_b32 v72, v23, v19, s20
    v_perm_b32 v76, v23, v19, s21
    v_perm_b32 v73, v31, v27, s20
    v_perm_b32 v77, v31, v27, s21
    v_perm_b32 v74, v39, v35, s20
    v_perm_b32 v78, v39, v35, s21
    v_perm_b32 v75, v47, v43, s20
    v_perm_b32 v79, v47, v43, s21
    global_store_dwordx4 v5, v[48:51], s[4:5] offset:0
    global_store_dwordx4 v5, v[52:55], s[4:5] offset:16
    global_store_dwordx4 v5, v[56:59], s[4:5] offset:32
    global_store_dwordx4 v5, v[60:63], s[4:5] offset:48
    global_store_dwordx4 v5, v[64:67], s[4:5] offset:64
    global_store_dwordx4 v5, v[68:71], s[4:5] offset:80
    global_store_dwordx4 v5, v[72:75], s[4:5] offset:96
    global_store_dwordx4 v5, v[76:79], s[4:5] offset:112
    s_branch L_prep_kernel_4
L_prep_kernel_6:
    s_sub_u32 s26, s2, 592
    s_lshr_b32 s22, s26, 7
    s_and_b32 s23, s26, 127
    s_mov_b32 s6, s8
    s_mov_b32 s7, s9
    s_cmp_eq_u32 s22, 1
    s_cselect_b32 s6, s10, s6
    s_cselect_b32 s7, s11, s7
    s_cmp_eq_u32 s22, 2
    s_cselect_b32 s6, s12, s6
    s_cselect_b32 s7, s13, s7
    s_lshl_b32 s24, s23, 8
    v_add_u32 v1, s24, v0
    v_and_b32 v2, 511, v1
    v_lshrrev_b32 v3, 9, v1
    v_lshrrev_b32 v4, 1, v3
    v_lshlrev_b32 v4, 4, v4
    v_and_b32 v6, 1, v3
    v_lshl_add_u32 v4, v6, 2, v4
    v_lshlrev_b32 v4, 13, v4
    v_lshl_add_u32 v4, v2, 4, v4
    v_mov_b32 v8, v4
    v_add_u32 v9, 8192, v4
    v_add_u32 v10, 65536, v4
    v_add_u32 v11, 73728, v4
    v_add_u32 v12, 16384, v4
    v_add_u32 v13, 24576, v4
    v_add_u32 v14, 81920, v4
    v_add_u32 v15, 90112, v4
    global_load_dwordx4 v[16:19], v8, s[6:7]
    global_load_dwordx4 v[20:23], v9, s[6:7]
    global_load_dwordx4 v[24:27], v10, s[6:7]
    global_load_dwordx4 v[28:31], v11, s[6:7]
    global_load_dwordx4 v[32:35], v12, s[6:7]
    global_load_dwordx4 v[36:39], v13, s[6:7]
    global_load_dwordx4 v[40:43], v14, s[6:7]
    global_load_dwordx4 v[44:47], v15, s[6:7]
    s_waitcnt vmcnt(0)
    v_lshrrev_b32 v5, 4, v2
    v_mul_u32_u24 v5, 24, v5
    v_bfe_u32 v6, v2, 1, 3
    v_add_u32 v5, v5, v6
    s_lshl_b32 s25, s22, 3
    v_add_u32 v5, s25, v5
    v_lshlrev_b32 v5, 4, v5
    v_lshrrev_b32 v6, 2, v3
    v_add_u32 v5, v5, v6
    v_lshlrev_b32 v5, 6, v5
    v_and_b32 v6, 3, v3
    v_lshl_add_u32 v5, v6, 4, v5
    v_and_b32 v6, 1, v2
    v_lshl_add_u32 v5, v6, 3, v5
    v_lshlrev_b32 v5, 4, v5
    v_add_u32 v5, 142606336, v5
    s_mov_b32 s20, 0x05040100
    s_mov_b32 s21, 0x07060302
    v_perm_b32 v48, v20, v16, s20
    v_perm_b32 v52, v20, v16, s21
    v_perm_b32 v49, v28, v24, s20
    v_perm_b32 v53, v28, v24, s21
    v_perm_b32 v50, v36, v32, s20
    v_perm_b32 v54, v36, v32, s21
    v_perm_b32 v51, v44, v40, s20
    v_perm_b32 v55, v44, v40, s21
    v_perm_b32 v56, v21, v17, s20
    v_perm_b32 v60, v21, v17, s21
    v_perm_b32 v57, v29, v25, s20
    v_perm_b32 v61, v29, v25, s21
    v_perm_b32 v58, v37, v33, s20
    v_perm_b32 v62, v37, v33, s21
    v_perm_b32 v59, v45, v41, s20
    v_perm_b32 v63, v45, v41, s21
    v_perm_b32 v64, v22, v18, s20
    v_perm_b32 v68, v22, v18, s21
    v_perm_b32 v65, v30, v26, s20
    v_perm_b32 v69, v30, v26, s21
    v_perm_b32 v66, v38, v34, s20
    v_perm_b32 v70, v38, v34, s21
    v_perm_b32 v67, v46, v42, s20
    v_perm_b32 v71, v46, v42, s21
    v_perm_b32 v72, v23, v19, s20
    v_perm_b32 v76, v23, v19, s21
    v_perm_b32 v73, v31, v27, s20
    v_perm_b32 v77, v31, v27, s21
    v_perm_b32 v74, v39, v35, s20
    v_perm_b32 v78, v39, v35, s21
    v_perm_b32 v75, v47, v43, s20
    v_perm_b32 v79, v47, v43, s21
    global_store_dwordx4 v5, v[48:51], s[4:5] offset:0
    global_store_dwordx4 v5, v[52:55], s[4:5] offset:16
    global_store_dwordx4 v5, v[56:59], s[4:5] offset:32
    global_store_dwordx4 v5, v[60:63], s[4:5] offset:48
    global_store_dwordx4 v5, v[64:67], s[4:5] offset:64
    global_store_dwordx4 v5, v[68:71], s[4:5] offset:80
    global_store_dwordx4 v5, v[72:75], s[4:5] offset:96
    global_store_dwordx4 v5, v[76:79], s[4:5] offset:112
L_prep_kernel_4:
    s_endpgm
M_pre_kernel_end:
    s_endpgm
.globl ln1_kernel
.p2align 8
.type ln1_kernel,@function
ln1_kernel:
    s_load_dwordx2 s[4:5], s[0:1], 96
    s_load_dwordx2 s[6:7], s[0:1], 0
    s_cmp_ge_u32 s2, 128
    s_cbranch_scc1 L_ln1_kernel_1
    v_and_b32 v1, 15, v0
    v_bfe_u32 v2, v0, 4, 2
    v_lshrrev_b32 v3, 6, v0
    s_lshl_b32 s8, s2, 4
    v_add_u32 v4, s8, v1
    v_lshlrev_b32 v5, 10, v4
    v_lshl_add_u32 v5, v3, 8, v5
    v_lshl_add_u32 v5, v2, 4, v5
    s_waitcnt lgkmcnt(0)
    global_load_dwordx4 v[16:19], v5, s[6:7] offset:0
    global_load_dwordx4 v[20:23], v5, s[6:7] offset:64
    global_load_dwordx4 v[24:27], v5, s[6:7] offset:128
    global_load_dwordx4 v[28:31], v5, s[6:7] offset:192
    v_lshlrev_b32 v6, 11, v4
    v_lshl_add_u32 v6, v3, 9, v6
    v_lshl_add_u32 v6, v2, 5, v6
    v_add_u32 v6, 104857600, v6
    global_load_dwordx4 v[64:67], v6, s[4:5] offset:0
    global_load_dwordx4 v[68:71], v6, s[4:5] offset:16
    global_load_dwordx4 v[72:75], v6, s[4:5] offset:128
    global_load_dwordx4 v[76:79], v6, s[4:5] offset:144
    global_load_dwordx4 v[80:83], v6, s[4:5] offset:256
    global_load_dwordx4 v[84:87], v6, s[4:5] offset:272
    global_load_dwordx4 v[88:91], v6, s[4:5] offset:384
    global_load_dwordx4 v[92:95], v6, s[4:5] offset:400
    v_add_u32 v6, 4194304, v6
    global_load_dwordx4 v[96:99], v6, s[4:5] offset:0
    global_load_dwordx4 v[100:103], v6, s[4:5] offset:16
    global_load_dwordx4 v[104:107], v6, s[4:5] offset:128
    global_load_dwordx4 v[108:111], v6, s[4:5] offset:144
    global_load_dwordx4 v[112:115], v6, s[4:5] offset:256
    global_load_dwordx4 v[116:119], v6, s[4:5] offset:272
    global_load_dwordx4 v[120:123], v6, s[4:5] offset:384
    global_load_dwordx4 v[124:127], v6, s[4:5] offset:400
    v_add_u32 v6, 4194304, v6
    global_load_dwordx4 v[128:131], v6, s[4:5] offset:0
    global_load_dwordx4 v[132:135], v6, s[4:5] offset:16
    global_load_dwordx4 v[136:139], v6, s[4:5] offset:128
    global_load_dwordx4 v[140:143], v6, s[4:5] offset:144
    global_load_dwordx4 v[144:147], v6, s[4:5] offset:256
    global_load_dwordx4 v[148:151], v6, s[4:5] offset:272
    global_load_dwordx4 v[152:155], v6, s[4:5] offset:384
    global_load_dwordx4 v[156:159], v6, s[4:5] offset:400
    v_add_u32 v6, 4194304, v6
    global_load_dwordx4 v[160:163], v6, s[4:5] offset:0
    global_load_dwordx4 v[164:167], v6, s[4:5] offset:16
    global_load_dwordx4 v[168:171], v6, s[4:5] offset:128
    global_load_dwordx4 v[172:175], v6, s[4:5] offset:144
    global_load_dwordx4 v[176:179], v6, s[4:5] offset:256
    global_load_dwordx4 v[180:183], v6, s[4:5] offset:272
    global_load_dwordx4 v[184:187], v6, s[4:5] offset:384
    global_load_dwordx4 v[188:191], v6, s[4:5] offset:400
    s_waitcnt vmcnt(0)
    v_pk_add_f32 v[64:65], v[64:65], v[96:97]
    v_pk_add_f32 v[128:129], v[128:129], v[160:161]
    v_pk_add_f32 v[66:67], v[66:67], v[98:99]
    v_pk_add_f32 v[130:131], v[130:131], v[162:163]
    v_pk_add_f32 v[68:69], v[68:69], v[100:101]
    v_pk_add_f32 v[132:133], v[132:133], v[164:165]
    v_pk_add_f32 v[70:71], v[70:71], v[102:103]
    v_pk_add_f32 v[134:135], v[134:135], v[166:167]
    v_pk_add_f32 v[72:73], v[72:73], v[104:105]
    v_pk_add_f32 v[136:137], v[136:137], v[168:169]
    v_pk_add_f32 v[74:75], v[74:75], v[106:107]
    v_pk_add_f32 v[138:139], v[138:139], v[170:171]
    v_pk_add_f32 v[76:77], v[76:77], v[108:109]
    v_pk_add_f32 v[140:141], v[140:141], v[172:173]
    v_pk_add_f32 v[78:79], v[78:79], v[110:111]
    v_pk_add_f32 v[142:143], v[142:143], v[174:175]
    v_pk_add_f32 v[80:81], v[80:81], v[112:113]
    v_pk_add_f32 v[144:145], v[144:145], v[176:177]
    v_pk_add_f32 v[82:83], v[82:83], v[114:115]
    v_pk_add_f32 v[146:147], v[146:147], v[178:179]
    v_pk_add_f32 v[84:85], v[84:85], v[116:117]
    v_pk_add_f32 v[148:149], v[148:149], v[180:181]
    v_pk_add_f32 v[86:87], v[86:87], v[118:119]
    v_pk_add_f32 v[150:151], v[150:151], v[182:183]
    v_pk_add_f32 v[88:89], v[88:89], v[120:121]
    v_pk_add_f32 v[152:153], v[152:153], v[184:185]
    v_pk_add_f32 v[90:91], v[90:91], v[122:123]
    v_pk_add_f32 v[154:155], v[154:155], v[186:187]
    v_pk_add_f32 v[92:93], v[92:93], v[124:125]
    v_pk_add_f32 v[156:157], v[156:157], v[188:189]
    v_pk_add_f32 v[94:95], v[94:95], v[126:127]
    v_pk_add_f32 v[158:159], v[158:159], v[190:191]
    v_pk_add_f32 v[64:65], v[64:65], v[128:129]
    v_pk_add_f32 v[66:67], v[66:67], v[130:131]
    v_pk_add_f32 v[68:69], v[68:69], v[132:133]
    v_pk_add_f32 v[70:71], v[70:71], v[134:135]
    v_pk_add_f32 v[72:73], v[72:73], v[136:137]
    v_pk_add_f32 v[74:75], v[74:75], v[138:139]
    v_pk_add_f32 v[76:77], v[76:77], v[140:141]
    v_pk_add_f32 v[78:79], v[78:79], v[142:143]
    v_pk_add_f32 v[80:81], v[80:81], v[144:145]
    v_pk_add_f32 v[82:83], v[82:83], v[146:147]
    v_pk_add_f32 v[84:85], v[84:85], v[148:149]
    v_pk_add_f32 v[86:87], v[86:87], v[150:151]
    v_pk_add_f32 v[88:89], v[88:89], v[152:153]
    v_pk_add_f32 v[90:91], v[90:91], v[154:155]
    v_pk_add_f32 v[92:93], v[92:93], v[156:157]
    v_pk_add_f32 v[94:95], v[94:95], v[158:159]
    s_waitcnt vmcnt(0)
    v_lshlrev_b32 v32, 16, v16
    v_and_b32 v33, 0xffff0000, v16
    v_lshlrev_b32 v34, 16, v17
    v_and_b32 v35, 0xffff0000, v17
    v_lshlrev_b32 v36, 16, v18
    v_and_b32 v37, 0xffff0000, v18
    v_lshlrev_b32 v38, 16, v19
    v_and_b32 v39, 0xffff0000, v19
    v_lshlrev_b32 v40, 16, v20
    v_and_b32 v41, 0xffff0000, v20
    v_lshlrev_b32 v42, 16, v21
    v_and_b32 v43, 0xffff0000, v21
    v_lshlrev_b32 v44, 16, v22
    v_and_b32 v45, 0xffff0000, v22
    v_lshlrev_b32 v46, 16, v23
    v_and_b32 v47, 0xffff0000, v23
    v_lshlrev_b32 v48, 16, v24
    v_and_b32 v49, 0xffff0000, v24
    v_lshlrev_b32 v50, 16, v25
    v_and_b32 v51, 0xffff0000, v25
    v_lshlrev_b32 v52, 16, v26
    v_and_b32 v53, 0xffff0000, v26
    v_lshlrev_b32 v54, 16, v27
    v_and_b32 v55, 0xffff0000, v27
    v_lshlrev_b32 v56, 16, v28
    v_and_b32 v57, 0xffff0000, v28
    v_lshlrev_b32 v58, 16, v29
    v_and_b32 v59, 0xffff0000, v29
    v_lshlrev_b32 v60, 16, v30
    v_and_b32 v61, 0xffff0000, v30
    v_lshlrev_b32 v62, 16, v31
    v_and_b32 v63, 0xffff0000, v31
    v_cvt_pk_bf16_f32 v8, v64, v65
    v_lshlrev_b32 v64, 16, v8
    v_and_b32 v65, 0xffff0000, v8
    v_add_f32 v32, v32, v64
    v_add_f32 v33, v33, v65
    v_cvt_pk_bf16_f32 v16, v32, v33
    v_lshlrev_b32 v32, 16, v16
    v_and_b32 v33, 0xffff0000, v16
    v_cvt_pk_bf16_f32 v8, v66, v67
    v_lshlrev_b32 v66, 16, v8
    v_and_b32 v67, 0xffff0000, v8
    v_add_f32 v34, v34, v66
    v_add_f32 v35, v35, v67
    v_cvt_pk_bf16_f32 v17, v34, v35
    v_lshlrev_b32 v34, 16, v17
    v_and_b32 v35, 0xffff0000, v17
    v_cvt_pk_bf16_f32 v8, v68, v69
    v_lshlrev_b32 v68, 16, v8
    v_and_b32 v69, 0xffff0000, v8
    v_add_f32 v36, v36, v68
    v_add_f32 v37, v37, v69
    v_cvt_pk_bf16_f32 v18, v36, v37
    v_lshlrev_b32 v36, 16, v18
    v_and_b32 v37, 0xffff0000, v18
    v_cvt_pk_bf16_f32 v8, v70, v71
    v_lshlrev_b32 v70, 16, v8
    v_and_b32 v71, 0xffff0000, v8
    v_add_f32 v38, v38, v70
    v_add_f32 v39, v39, v71
    v_cvt_pk_bf16_f32 v19, v38, v39
    v_lshlrev_b32 v38, 16, v19
    v_and_b32 v39, 0xffff0000, v19
    v_cvt_pk_bf16_f32 v8, v72, v73
    v_lshlrev_b32 v72, 16, v8
    v_and_b32 v73, 0xffff0000, v8
    v_add_f32 v40, v40, v72
    v_add_f32 v41, v41, v73
    v_cvt_pk_bf16_f32 v20, v40, v41
    v_lshlrev_b32 v40, 16, v20
    v_and_b32 v41, 0xffff0000, v20
    v_cvt_pk_bf16_f32 v8, v74, v75
    v_lshlrev_b32 v74, 16, v8
    v_and_b32 v75, 0xffff0000, v8
    v_add_f32 v42, v42, v74
    v_add_f32 v43, v43, v75
    v_cvt_pk_bf16_f32 v21, v42, v43
    v_lshlrev_b32 v42, 16, v21
    v_and_b32 v43, 0xffff0000, v21
    v_cvt_pk_bf16_f32 v8, v76, v77
    v_lshlrev_b32 v76, 16, v8
    v_and_b32 v77, 0xffff0000, v8
    v_add_f32 v44, v44, v76
    v_add_f32 v45, v45, v77
    v_cvt_pk_bf16_f32 v22, v44, v45
    v_lshlrev_b32 v44, 16, v22
    v_and_b32 v45, 0xffff0000, v22
    v_cvt_pk_bf16_f32 v8, v78, v79
    v_lshlrev_b32 v78, 16, v8
    v_and_b32 v79, 0xffff0000, v8
    v_add_f32 v46, v46, v78
    v_add_f32 v47, v47, v79
    v_cvt_pk_bf16_f32 v23, v46, v47
    v_lshlrev_b32 v46, 16, v23
    v_and_b32 v47, 0xffff0000, v23
    v_cvt_pk_bf16_f32 v8, v80, v81
    v_lshlrev_b32 v80, 16, v8
    v_and_b32 v81, 0xffff0000, v8
    v_add_f32 v48, v48, v80
    v_add_f32 v49, v49, v81
    v_cvt_pk_bf16_f32 v24, v48, v49
    v_lshlrev_b32 v48, 16, v24
    v_and_b32 v49, 0xffff0000, v24
    v_cvt_pk_bf16_f32 v8, v82, v83
    v_lshlrev_b32 v82, 16, v8
    v_and_b32 v83, 0xffff0000, v8
    v_add_f32 v50, v50, v82
    v_add_f32 v51, v51, v83
    v_cvt_pk_bf16_f32 v25, v50, v51
    v_lshlrev_b32 v50, 16, v25
    v_and_b32 v51, 0xffff0000, v25
    v_cvt_pk_bf16_f32 v8, v84, v85
    v_lshlrev_b32 v84, 16, v8
    v_and_b32 v85, 0xffff0000, v8
    v_add_f32 v52, v52, v84
    v_add_f32 v53, v53, v85
    v_cvt_pk_bf16_f32 v26, v52, v53
    v_lshlrev_b32 v52, 16, v26
    v_and_b32 v53, 0xffff0000, v26
    v_cvt_pk_bf16_f32 v8, v86, v87
    v_lshlrev_b32 v86, 16, v8
    v_and_b32 v87, 0xffff0000, v8
    v_add_f32 v54, v54, v86
    v_add_f32 v55, v55, v87
    v_cvt_pk_bf16_f32 v27, v54, v55
    v_lshlrev_b32 v54, 16, v27
    v_and_b32 v55, 0xffff0000, v27
    v_cvt_pk_bf16_f32 v8, v88, v89
    v_lshlrev_b32 v88, 16, v8
    v_and_b32 v89, 0xffff0000, v8
    v_add_f32 v56, v56, v88
    v_add_f32 v57, v57, v89
    v_cvt_pk_bf16_f32 v28, v56, v57
    v_lshlrev_b32 v56, 16, v28
    v_and_b32 v57, 0xffff0000, v28
    v_cvt_pk_bf16_f32 v8, v90, v91
    v_lshlrev_b32 v90, 16, v8
    v_and_b32 v91, 0xffff0000, v8
    v_add_f32 v58, v58, v90
    v_add_f32 v59, v59, v91
    v_cvt_pk_bf16_f32 v29, v58, v59
    v_lshlrev_b32 v58, 16, v29
    v_and_b32 v59, 0xffff0000, v29
    v_cvt_pk_bf16_f32 v8, v92, v93
    v_lshlrev_b32 v92, 16, v8
    v_and_b32 v93, 0xffff0000, v8
    v_add_f32 v60, v60, v92
    v_add_f32 v61, v61, v93
    v_cvt_pk_bf16_f32 v30, v60, v61
    v_lshlrev_b32 v60, 16, v30
    v_and_b32 v61, 0xffff0000, v30
    v_cvt_pk_bf16_f32 v8, v94, v95
    v_lshlrev_b32 v94, 16, v8
    v_and_b32 v95, 0xffff0000, v8
    v_add_f32 v62, v62, v94
    v_add_f32 v63, v63, v95
    v_cvt_pk_bf16_f32 v31, v62, v63
    v_lshlrev_b32 v62, 16, v31
    v_and_b32 v63, 0xffff0000, v31
    v_add_u32 v7, 121634816, v5
    global_store_dwordx4 v7, v[16:19], s[4:5] offset:0
    global_store_dwordx4 v7, v[20:23], s[4:5] offset:64
    global_store_dwordx4 v7, v[24:27], s[4:5] offset:128
    global_store_dwordx4 v7, v[28:31], s[4:5] offset:192
    v_add_f32 v8, v32, v33
    v_add_f32 v8, v8, v34
    v_add_f32 v8, v8, v35
    v_add_f32 v8, v8, v36
    v_add_f32 v8, v8, v37
    v_add_f32 v8, v8, v38
    v_add_f32 v8, v8, v39
    v_add_f32 v8, v8, v40
    v_add_f32 v8, v8, v41
    v_add_f32 v8, v8, v42
    v_add_f32 v8, v8, v43
    v_add_f32 v8, v8, v44
    v_add_f32 v8, v8, v45
    v_add_f32 v8, v8, v46
    v_add_f32 v8, v8, v47
    v_add_f32 v8, v8, v48
    v_add_f32 v8, v8, v49
    v_add_f32 v8, v8, v50
    v_add_f32 v8, v8, v51
    v_add_f32 v8, v8, v52
    v_add_f32 v8, v8, v53
    v_add_f32 v8, v8, v54
    v_add_f32 v8, v8, v55
    v_add_f32 v8, v8, v56
    v_add_f32 v8, v8, v57
    v_add_f32 v8, v8, v58
    v_add_f32 v8, v8, v59
    v_add_f32 v8, v8, v60
    v_add_f32 v8, v8, v61
    v_add_f32 v8, v8, v62
    v_add_f32 v8, v8, v63
    v_mov_b32 v9, v8
    v_mov_b32 v10, v8
    s_nop 1
    v_permlane32_swap_b32 v9, v10
    s_nop 1
    v_add_f32 v8, v9, v10
    v_mov_b32 v9, v8
    v_mov_b32 v10, v8
    s_nop 1
    v_permlane16_swap_b32 v9, v10
    s_nop 1
    v_add_f32 v8, v9, v10
    v_lshlrev_b32 v11, 2, v1
    v_lshl_add_u32 v12, v3, 6, v11
    ds_write_b32 v12, v8
    s_waitcnt lgkmcnt(0)
    s_barrier
    ds_read_b32 v8, v11
    ds_read_b32 v9, v11 offset:64
    ds_read_b32 v10, v11 offset:128
    ds_read_b32 v13, v11 offset:192
    s_waitcnt lgkmcnt(0)
    v_add_f32 v8, v8, v9
    v_add_f32 v10, v10, v13
    v_add_f32 v8, v8, v10
    v_mul_f32 v8, 0x3b000000, v8
    v_mov_b32 v14, 0
    v_sub_f32 v9, v32, v8
    v_fmac_f32 v14, v9, v9
    v_sub_f32 v9, v33, v8
    v_fmac_f32 v14, v9, v9
    v_sub_f32 v9, v34, v8
    v_fmac_f32 v14, v9, v9
    v_sub_f32 v9, v35, v8
    v_fmac_f32 v14, v9, v9
    v_sub_f32 v9, v36, v8
    v_fmac_f32 v14, v9, v9
    v_sub_f32 v9, v37, v8
    v_fmac_f32 v14, v9, v9
    v_sub_f32 v9, v38, v8
    v_fmac_f32 v14, v9, v9
    v_sub_f32 v9, v39, v8
    v_fmac_f32 v14, v9, v9
    v_sub_f32 v9, v40, v8
    v_fmac_f32 v14, v9, v9
    v_sub_f32 v9, v41, v8
    v_fmac_f32 v14, v9, v9
    v_sub_f32 v9, v42, v8
    v_fmac_f32 v14, v9, v9
    v_sub_f32 v9, v43, v8
    v_fmac_f32 v14, v9, v9
    v_sub_f32 v9, v44, v8
    v_fmac_f32 v14, v9, v9
    v_sub_f32 v9, v45, v8
    v_fmac_f32 v14, v9, v9
    v_sub_f32 v9, v46, v8
    v_fmac_f32 v14, v9, v9
    v_sub_f32 v9, v47, v8
    v_fmac_f32 v14, v9, v9
    v_sub_f32 v9, v48, v8
    v_fmac_f32 v14, v9, v9
    v_sub_f32 v9, v49, v8
    v_fmac_f32 v14, v9, v9
    v_sub_f32 v9, v50, v8
    v_fmac_f32 v14, v9, v9
    v_sub_f32 v9, v51, v8
    v_fmac_f32 v14, v9, v9
    v_sub_f32 v9, v52, v8
    v_fmac_f32 v14, v9, v9
    v_sub_f32 v9, v53, v8
    v_fmac_f32 v14, v9, v9
    v_sub_f32 v9, v54, v8
    v_fmac_f32 v14, v9, v9
    v_sub_f32 v9, v55, v8
    v_fmac_f32 v14, v9, v9
    v_sub_f32 v9, v56, v8
    v_fmac_f32 v14, v9, v9
    v_sub_f32 v9, v57, v8
    v_fmac_f32 v14, v9, v9
    v_sub_f32 v9, v58, v8
    v_fmac_f32 v14, v9, v9
    v_sub_f32 v9, v59, v8
    v_fmac_f32 v14, v9, v9
    v_sub_f32 v9, v60, v8
    v_fmac_f32 v14, v9, v9
    v_sub_f32 v9, v61, v8
    v_fmac_f32 v14, v9, v9
    v_sub_f32 v9, v62, v8
    v_fmac_f32 v14, v9, v9
    v_sub_f32 v9, v63, v8
    v_fmac_f32 v14, v9, v9
    v_mov_b32 v9, v14
    v_mov_b32 v10, v14
    s_nop 1
    v_permlane32_swap_b32 v9, v10
    s_nop 1
    v_add_f32 v14, v9, v10
    v_mov_b32 v9, v14
    v_mov_b32 v10, v14
    s_nop 1
    v_permlane16_swap_b32 v9, v10
    s_nop 1
    v_add_f32 v14, v9, v10
    ds_write_b32 v12, v14 offset:256
    s_waitcnt lgkmcnt(0)
    s_barrier
    ds_read_b32 v14, v11 offset:256
    ds_read_b32 v9, v11 offset:320
    ds_read_b32 v10, v11 offset:384
    ds_read_b32 v13, v11 offset:448
    s_waitcnt lgkmcnt(0)
    v_add_f32 v14, v14, v9
    v_add_f32 v10, v10, v13
    v_add_f32 v14, v14, v10
    v_mul_f32 v14, 0x3b000000, v14
    v_cvt_pk_bf16_f32 v9, v8, v14
    v_lshlrev_b32 v8, 16, v9
    v_and_b32 v14, 0xffff0000, v9
    v_add_f32 v14, 0x3727c5ac, v14
    v_cvt_pk_bf16_f32 v9, v14, v14
    v_lshlrev_b32 v14, 16, v9
    v_sqrt_f32 v14, v14
    s_nop 0
    v_cvt_pk_bf16_f32 v9, v14, v14
    v_lshlrev_b32 v14, 16, v9
    v_rcp_f32 v15, v14
    s_nop 0
    v_sub_f32 v32, v32, v8
    v_sub_f32 v33, v33, v8
    v_cvt_pk_bf16_f32 v9, v32, v33
    v_lshlrev_b32 v32, 16, v9
    v_and_b32 v33, 0xffff0000, v9
    v_mul_f32 v9, v32, v15
    v_fma_f32 v10, -v9, v14, v32
    v_fma_f32 v32, v10, v15, v9
    v_mul_f32 v9, v33, v15
    v_fma_f32 v10, -v9, v14, v33
    v_fma_f32 v33, v10, v15, v9
    v_cvt_pk_bf16_f32 v16, v32, v33
    v_sub_f32 v34, v34, v8
    v_sub_f32 v35, v35, v8
    v_cvt_pk_bf16_f32 v9, v34, v35
    v_lshlrev_b32 v34, 16, v9
    v_and_b32 v35, 0xffff0000, v9
    v_mul_f32 v9, v34, v15
    v_fma_f32 v10, -v9, v14, v34
    v_fma_f32 v34, v10, v15, v9
    v_mul_f32 v9, v35, v15
    v_fma_f32 v10, -v9, v14, v35
    v_fma_f32 v35, v10, v15, v9
    v_cvt_pk_bf16_f32 v17, v34, v35
    v_sub_f32 v36, v36, v8
    v_sub_f32 v37, v37, v8
    v_cvt_pk_bf16_f32 v9, v36, v37
    v_lshlrev_b32 v36, 16, v9
    v_and_b32 v37, 0xffff0000, v9
    v_mul_f32 v9, v36, v15
    v_fma_f32 v10, -v9, v14, v36
    v_fma_f32 v36, v10, v15, v9
    v_mul_f32 v9, v37, v15
    v_fma_f32 v10, -v9, v14, v37
    v_fma_f32 v37, v10, v15, v9
    v_cvt_pk_bf16_f32 v18, v36, v37
    v_sub_f32 v38, v38, v8
    v_sub_f32 v39, v39, v8
    v_cvt_pk_bf16_f32 v9, v38, v39
    v_lshlrev_b32 v38, 16, v9
    v_and_b32 v39, 0xffff0000, v9
    v_mul_f32 v9, v38, v15
    v_fma_f32 v10, -v9, v14, v38
    v_fma_f32 v38, v10, v15, v9
    v_mul_f32 v9, v39, v15
    v_fma_f32 v10, -v9, v14, v39
    v_fma_f32 v39, v10, v15, v9
    v_cvt_pk_bf16_f32 v19, v38, v39
    v_sub_f32 v40, v40, v8
    v_sub_f32 v41, v41, v8
    v_cvt_pk_bf16_f32 v9, v40, v41
    v_lshlrev_b32 v40, 16, v9
    v_and_b32 v41, 0xffff0000, v9
    v_mul_f32 v9, v40, v15
    v_fma_f32 v10, -v9, v14, v40
    v_fma_f32 v40, v10, v15, v9
    v_mul_f32 v9, v41, v15
    v_fma_f32 v10, -v9, v14, v41
    v_fma_f32 v41, v10, v15, v9
    v_cvt_pk_bf16_f32 v20, v40, v41
    v_sub_f32 v42, v42, v8
    v_sub_f32 v43, v43, v8
    v_cvt_pk_bf16_f32 v9, v42, v43
    v_lshlrev_b32 v42, 16, v9
    v_and_b32 v43, 0xffff0000, v9
    v_mul_f32 v9, v42, v15
    v_fma_f32 v10, -v9, v14, v42
    v_fma_f32 v42, v10, v15, v9
    v_mul_f32 v9, v43, v15
    v_fma_f32 v10, -v9, v14, v43
    v_fma_f32 v43, v10, v15, v9
    v_cvt_pk_bf16_f32 v21, v42, v43
    v_sub_f32 v44, v44, v8
    v_sub_f32 v45, v45, v8
    v_cvt_pk_bf16_f32 v9, v44, v45
    v_lshlrev_b32 v44, 16, v9
    v_and_b32 v45, 0xffff0000, v9
    v_mul_f32 v9, v44, v15
    v_fma_f32 v10, -v9, v14, v44
    v_fma_f32 v44, v10, v15, v9
    v_mul_f32 v9, v45, v15
    v_fma_f32 v10, -v9, v14, v45
    v_fma_f32 v45, v10, v15, v9
    v_cvt_pk_bf16_f32 v22, v44, v45
    v_sub_f32 v46, v46, v8
    v_sub_f32 v47, v47, v8
    v_cvt_pk_bf16_f32 v9, v46, v47
    v_lshlrev_b32 v46, 16, v9
    v_and_b32 v47, 0xffff0000, v9
    v_mul_f32 v9, v46, v15
    v_fma_f32 v10, -v9, v14, v46
    v_fma_f32 v46, v10, v15, v9
    v_mul_f32 v9, v47, v15
    v_fma_f32 v10, -v9, v14, v47
    v_fma_f32 v47, v10, v15, v9
    v_cvt_pk_bf16_f32 v23, v46, v47
    v_sub_f32 v48, v48, v8
    v_sub_f32 v49, v49, v8
    v_cvt_pk_bf16_f32 v9, v48, v49
    v_lshlrev_b32 v48, 16, v9
    v_and_b32 v49, 0xffff0000, v9
    v_mul_f32 v9, v48, v15
    v_fma_f32 v10, -v9, v14, v48
    v_fma_f32 v48, v10, v15, v9
    v_mul_f32 v9, v49, v15
    v_fma_f32 v10, -v9, v14, v49
    v_fma_f32 v49, v10, v15, v9
    v_cvt_pk_bf16_f32 v24, v48, v49
    v_sub_f32 v50, v50, v8
    v_sub_f32 v51, v51, v8
    v_cvt_pk_bf16_f32 v9, v50, v51
    v_lshlrev_b32 v50, 16, v9
    v_and_b32 v51, 0xffff0000, v9
    v_mul_f32 v9, v50, v15
    v_fma_f32 v10, -v9, v14, v50
    v_fma_f32 v50, v10, v15, v9
    v_mul_f32 v9, v51, v15
    v_fma_f32 v10, -v9, v14, v51
    v_fma_f32 v51, v10, v15, v9
    v_cvt_pk_bf16_f32 v25, v50, v51
    v_sub_f32 v52, v52, v8
    v_sub_f32 v53, v53, v8
    v_cvt_pk_bf16_f32 v9, v52, v53
    v_lshlrev_b32 v52, 16, v9
    v_and_b32 v53, 0xffff0000, v9
    v_mul_f32 v9, v52, v15
    v_fma_f32 v10, -v9, v14, v52
    v_fma_f32 v52, v10, v15, v9
    v_mul_f32 v9, v53, v15
    v_fma_f32 v10, -v9, v14, v53
    v_fma_f32 v53, v10, v15, v9
    v_cvt_pk_bf16_f32 v26, v52, v53
    v_sub_f32 v54, v54, v8
    v_sub_f32 v55, v55, v8
    v_cvt_pk_bf16_f32 v9, v54, v55
    v_lshlrev_b32 v54, 16, v9
    v_and_b32 v55, 0xffff0000, v9
    v_mul_f32 v9, v54, v15
    v_fma_f32 v10, -v9, v14, v54
    v_fma_f32 v54, v10, v15, v9
    v_mul_f32 v9, v55, v15
    v_fma_f32 v10, -v9, v14, v55
    v_fma_f32 v55, v10, v15, v9
    v_cvt_pk_bf16_f32 v27, v54, v55
    v_sub_f32 v56, v56, v8
    v_sub_f32 v57, v57, v8
    v_cvt_pk_bf16_f32 v9, v56, v57
    v_lshlrev_b32 v56, 16, v9
    v_and_b32 v57, 0xffff0000, v9
    v_mul_f32 v9, v56, v15
    v_fma_f32 v10, -v9, v14, v56
    v_fma_f32 v56, v10, v15, v9
    v_mul_f32 v9, v57, v15
    v_fma_f32 v10, -v9, v14, v57
    v_fma_f32 v57, v10, v15, v9
    v_cvt_pk_bf16_f32 v28, v56, v57
    v_sub_f32 v58, v58, v8
    v_sub_f32 v59, v59, v8
    v_cvt_pk_bf16_f32 v9, v58, v59
    v_lshlrev_b32 v58, 16, v9
    v_and_b32 v59, 0xffff0000, v9
    v_mul_f32 v9, v58, v15
    v_fma_f32 v10, -v9, v14, v58
    v_fma_f32 v58, v10, v15, v9
    v_mul_f32 v9, v59, v15
    v_fma_f32 v10, -v9, v14, v59
    v_fma_f32 v59, v10, v15, v9
    v_cvt_pk_bf16_f32 v29, v58, v59
    v_sub_f32 v60, v60, v8
    v_sub_f32 v61, v61, v8
    v_cvt_pk_bf16_f32 v9, v60, v61
    v_lshlrev_b32 v60, 16, v9
    v_and_b32 v61, 0xffff0000, v9
    v_mul_f32 v9, v60, v15
    v_fma_f32 v10, -v9, v14, v60
    v_fma_f32 v60, v10, v15, v9
    v_mul_f32 v9, v61, v15
    v_fma_f32 v10, -v9, v14, v61
    v_fma_f32 v61, v10, v15, v9
    v_cvt_pk_bf16_f32 v30, v60, v61
    v_sub_f32 v62, v62, v8
    v_sub_f32 v63, v63, v8
    v_cvt_pk_bf16_f32 v9, v62, v63
    v_lshlrev_b32 v62, 16, v9
    v_and_b32 v63, 0xffff0000, v9
    v_mul_f32 v9, v62, v15
    v_fma_f32 v10, -v9, v14, v62
    v_fma_f32 v62, v10, v15, v9
    v_mul_f32 v9, v63, v15
    v_fma_f32 v10, -v9, v14, v63
    v_fma_f32 v63, v10, v15, v9
    v_cvt_pk_bf16_f32 v31, v62, v63
    v_and_b32 v6, 63, v0
    v_lshlrev_b32 v6, 4, v6
    v_lshl_add_u32 v6, v3, 12, v6
    s_lshl_b32 s8, s2, 14
    v_add_u32 v6, s8, v6
    v_add_u32 v6, 18874368, v6
    global_store_dwordx4 v6, v[16:19], s[4:5] offset:0
    global_store_dwordx4 v6, v[20:23], s[4:5] offset:1024
    global_store_dwordx4 v6, v[24:27], s[4:5] offset:2048
    global_store_dwordx4 v6, v[28:31], s[4:5] offset:3072
L_ln1_kernel_1:
    s_endpgm
.globl ln3_kernel
.p2align 8
.type ln3_kernel,@function
ln3_kernel:
    s_load_dwordx2 s[4:5], s[0:1], 96
    s_load_dwordx2 s[6:7], s[0:1], 0
    s_cmp_ge_u32 s2, 128
    s_cbranch_scc1 L_ln3_kernel_1
    v_and_b32 v1, 15, v0
    v_bfe_u32 v2, v0, 4, 2
    v_lshrrev_b32 v3, 6, v0
    s_lshl_b32 s8, s2, 4
    v_add_u32 v4, s8, v1
    v_lshlrev_b32 v5, 10, v4
    v_lshl_add_u32 v5, v3, 8, v5
    v_lshl_add_u32 v5, v2, 4, v5
    s_waitcnt lgkmcnt(0)
    s_add_u32 s6, s4, 123731968
    s_addc_u32 s7, s5, 0
    global_load_dwordx4 v[16:19], v5, s[6:7] offset:0
    global_load_dwordx4 v[20:23], v5, s[6:7] offset:64
    global_load_dwordx4 v[24:27], v5, s[6:7] offset:128
    global_load_dwordx4 v[28:31], v5, s[6:7] offset:192
    v_lshlrev_b32 v6, 11, v4
    v_lshl_add_u32 v6, v3, 9, v6
    v_lshl_add_u32 v6, v2, 5, v6
    v_add_u32 v6, 104857600, v6
    global_load_dwordx4 v[64:67], v6, s[4:5] offset:0
    global_load_dwordx4 v[68:71], v6, s[4:5] offset:16
    global_load_dwordx4 v[72:75], v6, s[4:5] offset:128
    global_load_dwordx4 v[76:79], v6, s[4:5] offset:144
    global_load_dwordx4 v[80:83], v6, s[4:5] offset:256
    global_load_dwordx4 v[84:87], v6, s[4:5] offset:272
    global_load_dwordx4 v[88:91], v6, s[4:5] offset:384
    global_load_dwordx4 v[92:95], v6, s[4:5] offset:400
    v_add_u32 v6, 4194304, v6
    global_load_dwordx4 v[96:99], v6, s[4:5] offset:0
    global_load_dwordx4 v[100:103], v6, s[4:5] offset:16
    global_load_dwordx4 v[104:107], v6, s[4:5] offset:128
    global_load_dwordx4 v[108:111], v6, s[4:5] offset:144
    global_load_dwordx4 v[112:115], v6, s[4:5] offset:256
    global_load_dwordx4 v[116:119], v6, s[4:5] offset:272
    global_load_dwordx4 v[120:123], v6, s[4:5] offset:384
    global_load_dwordx4 v[124:127], v6, s[4:5] offset:400
    v_add_u32 v6, 4194304, v6
    global_load_dwordx4 v[128:131], v6, s[4:5] offset:0
    global_load_dwordx4 v[132:135], v6, s[4:5] offset:16
    global_load_dwordx4 v[136:139], v6, s[4:5] offset:128
    global_load_dwordx4 v[140:143], v6, s[4:5] offset:144
    global_load_dwordx4 v[144:147], v6, s[4:5] offset:256
    global_load_dwordx4 v[148:151], v6, s[4:5] offset:272
    global_load_dwordx4 v[152:155], v6, s[4:5] offset:384
    global_load_dwordx4 v[156:159], v6, s[4:5] offset:400
    v_add_u32 v6, 4194304, v6
    global_load_dwordx4 v[160:163], v6, s[4:5] offset:0
    global_load_dwordx4 v[164:167], v6, s[4:5] offset:16
    global_load_dwordx4 v[168:171], v6, s[4:5] offset:128
    global_load_dwordx4 v[172:175], v6, s[4:5] offset:144
    global_load_dwordx4 v[176:179], v6, s[4:5] offset:256
    global_load_dwordx4 v[180:183], v6, s[4:5] offset:272
    global_load_dwordx4 v[184:187], v6, s[4:5] offset:384
    global_load_dwordx4 v[188:191], v6, s[4:5] offset:400
    s_waitcnt vmcnt(0)
    v_pk_add_f32 v[64:65], v[64:65], v[96:97]
    v_pk_add_f32 v[128:129], v[128:129], v[160:161]
    v_pk_add_f32 v[66:67], v[66:67], v[98:99]
    v_pk_add_f32 v[130:131], v[130:131], v[162:163]
    v_pk_add_f32 v[68:69], v[68:69], v[100:101]
    v_pk_add_f32 v[132:133], v[132:133], v[164:165]
    v_pk_add_f32 v[70:71], v[70:71], v[102:103]
    v_pk_add_f32 v[134:135], v[134:135], v[166:167]
    v_pk_add_f32 v[72:73], v[72:73], v[104:105]
    v_pk_add_f32 v[136:137], v[136:137], v[168:169]
    v_pk_add_f32 v[74:75], v[74:75], v[106:107]
    v_pk_add_f32 v[138:139], v[138:139], v[170:171]
    v_pk_add_f32 v[76:77], v[76:77], v[108:109]
    v_pk_add_f32 v[140:141], v[140:141], v[172:173]
    v_pk_add_f32 v[78:79], v[78:79], v[110:111]
    v_pk_add_f32 v[142:143], v[142:143], v[174:175]
    v_pk_add_f32 v[80:81], v[80:81], v[112:113]
    v_pk_add_f32 v[144:145], v[144:145], v[176:177]
    v_pk_add_f32 v[82:83], v[82:83], v[114:115]
    v_pk_add_f32 v[146:147], v[146:147], v[178:179]
    v_pk_add_f32 v[84:85], v[84:85], v[116:117]
    v_pk_add_f32 v[148:149], v[148:149], v[180:181]
    v_pk_add_f32 v[86:87], v[86:87], v[118:119]
    v_pk_add_f32 v[150:151], v[150:151], v[182:183]
    v_pk_add_f32 v[88:89], v[88:89], v[120:121]
    v_pk_add_f32 v[152:153], v[152:153], v[184:185]
    v_pk_add_f32 v[90:91], v[90:91], v[122:123]
    v_pk_add_f32 v[154:155], v[154:155], v[186:187]
    v_pk_add_f32 v[92:93], v[92:93], v[124:125]
    v_pk_add_f32 v[156:157], v[156:157], v[188:189]
    v_pk_add_f32 v[94:95], v[94:95], v[126:127]
    v_pk_add_f32 v[158:159], v[158:159], v[190:191]
    v_pk_add_f32 v[64:65], v[64:65], v[128:129]
    v_pk_add_f32 v[66:67], v[66:67], v[130:131]
    v_pk_add_f32 v[68:69], v[68:69], v[132:133]
    v_pk_add_f32 v[70:71], v[70:71], v[134:135]
    v_pk_add_f32 v[72:73], v[72:73], v[136:137]
    v_pk_add_f32 v[74:75], v[74:75], v[138:139]
    v_pk_add_f32 v[76:77], v[76:77], v[140:141]
    v_pk_add_f32 v[78:79], v[78:79], v[142:143]
    v_pk_add_f32 v[80:81], v[80:81], v[144:145]
    v_pk_add_f32 v[82:83], v[82:83], v[146:147]
    v_pk_add_f32 v[84:85], v[84:85], v[148:149]
    v_pk_add_f32 v[86:87], v[86:87], v[150:151]
    v_pk_add_f32 v[88:89], v[88:89], v[152:153]
    v_pk_add_f32 v[90:91], v[90:91], v[154:155]
    v_pk_add_f32 v[92:93], v[92:93], v[156:157]
    v_pk_add_f32 v[94:95], v[94:95], v[158:159]
    s_waitcnt vmcnt(0)
    v_lshlrev_b32 v32, 16, v16
    v_and_b32 v33, 0xffff0000, v16
    v_lshlrev_b32 v34, 16, v17
    v_and_b32 v35, 0xffff0000, v17
    v_lshlrev_b32 v36, 16, v18
    v_and_b32 v37, 0xffff0000, v18
    v_lshlrev_b32 v38, 16, v19
    v_and_b32 v39, 0xffff0000, v19
    v_lshlrev_b32 v40, 16, v20
    v_and_b32 v41, 0xffff0000, v20
    v_lshlrev_b32 v42, 16, v21
    v_and_b32 v43, 0xffff0000, v21
    v_lshlrev_b32 v44, 16, v22
    v_and_b32 v45, 0xffff0000, v22
    v_lshlrev_b32 v46, 16, v23
    v_and_b32 v47, 0xffff0000, v23
    v_lshlrev_b32 v48, 16, v24
    v_and_b32 v49, 0xffff0000, v24
    v_lshlrev_b32 v50, 16, v25
    v_and_b32 v51, 0xffff0000, v25
    v_lshlrev_b32 v52, 16, v26
    v_and_b32 v53, 0xffff0000, v26
    v_lshlrev_b32 v54, 16, v27
    v_and_b32 v55, 0xffff0000, v27
    v_lshlrev_b32 v56, 16, v28
    v_and_b32 v57, 0xffff0000, v28
    v_lshlrev_b32 v58, 16, v29
    v_and_b32 v59, 0xffff0000, v29
    v_lshlrev_b32 v60, 16, v30
    v_and_b32 v61, 0xffff0000, v30
    v_lshlrev_b32 v62, 16, v31
    v_and_b32 v63, 0xffff0000, v31
    v_cvt_pk_bf16_f32 v8, v64, v65
    v_lshlrev_b32 v64, 16, v8
    v_and_b32 v65, 0xffff0000, v8
    v_add_f32 v32, v32, v64
    v_add_f32 v33, v33, v65
    v_cvt_pk_bf16_f32 v16, v32, v33
    v_lshlrev_b32 v32, 16, v16
    v_and_b32 v33, 0xffff0000, v16
    v_cvt_pk_bf16_f32 v8, v66, v67
    v_lshlrev_b32 v66, 16, v8
    v_and_b32 v67, 0xffff0000, v8
    v_add_f32 v34, v34, v66
    v_add_f32 v35, v35, v67
    v_cvt_pk_bf16_f32 v17, v34, v35
    v_lshlrev_b32 v34, 16, v17
    v_and_b32 v35, 0xffff0000, v17
    v_cvt_pk_bf16_f32 v8, v68, v69
    v_lshlrev_b32 v68, 16, v8
    v_and_b32 v69, 0xffff0000, v8
    v_add_f32 v36, v36, v68
    v_add_f32 v37, v37, v69
    v_cvt_pk_bf16_f32 v18, v36, v37
    v_lshlrev_b32 v36, 16, v18
    v_and_b32 v37, 0xffff0000, v18
    v_cvt_pk_bf16_f32 v8, v70, v71
    v_lshlrev_b32 v70, 16, v8
    v_and_b32 v71, 0xffff0000, v8
    v_add_f32 v38, v38, v70
    v_add_f32 v39, v39, v71
    v_cvt_pk_bf16_f32 v19, v38, v39
    v_lshlrev_b32 v38, 16, v19
    v_and_b32 v39, 0xffff0000, v19
    v_cvt_pk_bf16_f32 v8, v72, v73
    v_lshlrev_b32 v72, 16, v8
    v_and_b32 v73, 0xffff0000, v8
    v_add_f32 v40, v40, v72
    v_add_f32 v41, v41, v73
    v_cvt_pk_bf16_f32 v20, v40, v41
    v_lshlrev_b32 v40, 16, v20
    v_and_b32 v41, 0xffff0000, v20
    v_cvt_pk_bf16_f32 v8, v74, v75
    v_lshlrev_b32 v74, 16, v8
    v_and_b32 v75, 0xffff0000, v8
    v_add_f32 v42, v42, v74
    v_add_f32 v43, v43, v75
    v_cvt_pk_bf16_f32 v21, v42, v43
    v_lshlrev_b32 v42, 16, v21
    v_and_b32 v43, 0xffff0000, v21
    v_cvt_pk_bf16_f32 v8, v76, v77
    v_lshlrev_b32 v76, 16, v8
    v_and_b32 v77, 0xffff0000, v8
    v_add_f32 v44, v44, v76
    v_add_f32 v45, v45, v77
    v_cvt_pk_bf16_f32 v22, v44, v45
    v_lshlrev_b32 v44, 16, v22
    v_and_b32 v45, 0xffff0000, v22
    v_cvt_pk_bf16_f32 v8, v78, v79
    v_lshlrev_b32 v78, 16, v8
    v_and_b32 v79, 0xffff0000, v8
    v_add_f32 v46, v46, v78
    v_add_f32 v47, v47, v79
    v_cvt_pk_bf16_f32 v23, v46, v47
    v_lshlrev_b32 v46, 16, v23
    v_and_b32 v47, 0xffff0000, v23
    v_cvt_pk_bf16_f32 v8, v80, v81
    v_lshlrev_b32 v80, 16, v8
    v_and_b32 v81, 0xffff0000, v8
    v_add_f32 v48, v48, v80
    v_add_f32 v49, v49, v81
    v_cvt_pk_bf16_f32 v24, v48, v49
    v_lshlrev_b32 v48, 16, v24
    v_and_b32 v49, 0xffff0000, v24
    v_cvt_pk_bf16_f32 v8, v82, v83
    v_lshlrev_b32 v82, 16, v8
    v_and_b32 v83, 0xffff0000, v8
    v_add_f32 v50, v50, v82
    v_add_f32 v51, v51, v83
    v_cvt_pk_bf16_f32 v25, v50, v51
    v_lshlrev_b32 v50, 16, v25
    v_and_b32 v51, 0xffff0000, v25
    v_cvt_pk_bf16_f32 v8, v84, v85
    v_lshlrev_b32 v84, 16, v8
    v_and_b32 v85, 0xffff0000, v8
    v_add_f32 v52, v52, v84
    v_add_f32 v53, v53, v85
    v_cvt_pk_bf16_f32 v26, v52, v53
    v_lshlrev_b32 v52, 16, v26
    v_and_b32 v53, 0xffff0000, v26
    v_cvt_pk_bf16_f32 v8, v86, v87
    v_lshlrev_b32 v86, 16, v8
    v_and_b32 v87, 0xffff0000, v8
    v_add_f32 v54, v54, v86
    v_add_f32 v55, v55, v87
    v_cvt_pk_bf16_f32 v27, v54, v55
    v_lshlrev_b32 v54, 16, v27
    v_and_b32 v55, 0xffff0000, v27
    v_cvt_pk_bf16_f32 v8, v88, v89
    v_lshlrev_b32 v88, 16, v8
    v_and_b32 v89, 0xffff0000, v8
    v_add_f32 v56, v56, v88
    v_add_f32 v57, v57, v89
    v_cvt_pk_bf16_f32 v28, v56, v57
    v_lshlrev_b32 v56, 16, v28
    v_and_b32 v57, 0xffff0000, v28
    v_cvt_pk_bf16_f32 v8, v90, v91
    v_lshlrev_b32 v90, 16, v8
    v_and_b32 v91, 0xffff0000, v8
    v_add_f32 v58, v58, v90
    v_add_f32 v59, v59, v91
    v_cvt_pk_bf16_f32 v29, v58, v59
    v_lshlrev_b32 v58, 16, v29
    v_and_b32 v59, 0xffff0000, v29
    v_cvt_pk_bf16_f32 v8, v92, v93
    v_lshlrev_b32 v92, 16, v8
    v_and_b32 v93, 0xffff0000, v8
    v_add_f32 v60, v60, v92
    v_add_f32 v61, v61, v93
    v_cvt_pk_bf16_f32 v30, v60, v61
    v_lshlrev_b32 v60, 16, v30
    v_and_b32 v61, 0xffff0000, v30
    v_cvt_pk_bf16_f32 v8, v94, v95
    v_lshlrev_b32 v94, 16, v8
    v_and_b32 v95, 0xffff0000, v8
    v_add_f32 v62, v62, v94
    v_add_f32 v63, v63, v95
    v_cvt_pk_bf16_f32 v31, v62, v63
    v_lshlrev_b32 v62, 16, v31
    v_and_b32 v63, 0xffff0000, v31
    v_add_u32 v7, 125829120, v5
    global_store_dwordx4 v7, v[16:19], s[4:5] offset:0
    global_store_dwordx4 v7, v[20:23], s[4:5] offset:64
    global_store_dwordx4 v7, v[24:27], s[4:5] offset:128
    global_store_dwordx4 v7, v[28:31], s[4:5] offset:192
    v_add_f32 v8, v32, v33
    v_add_f32 v8, v8, v34
    v_add_f32 v8, v8, v35
    v_add_f32 v8, v8, v36
    v_add_f32 v8, v8, v37
    v_add_f32 v8, v8, v38
    v_add_f32 v8, v8, v39
    v_add_f32 v8, v8, v40
    v_add_f32 v8, v8, v41
    v_add_f32 v8, v8, v42
    v_add_f32 v8, v8, v43
    v_add_f32 v8, v8, v44
    v_add_f32 v8, v8, v45
    v_add_f32 v8, v8, v46
    v_add_f32 v8, v8, v47
    v_add_f32 v8, v8, v48
    v_add_f32 v8, v8, v49
    v_add_f32 v8, v8, v50
    v_add_f32 v8, v8, v51
    v_add_f32 v8, v8, v52
    v_add_f32 v8, v8, v53
    v_add_f32 v8, v8, v54
    v_add_f32 v8, v8, v55
    v_add_f32 v8, v8, v56
    v_add_f32 v8, v8, v57
    v_add_f32 v8, v8, v58
    v_add_f32 v8, v8, v59
    v_add_f32 v8, v8, v60
    v_add_f32 v8, v8, v61
    v_add_f32 v8, v8, v62
    v_add_f32 v8, v8, v63
    v_mov_b32 v9, v8
    v_mov_b32 v10, v8
    s_nop 1
    v_permlane32_swap_b32 v9, v10
    s_nop 1
    v_add_f32 v8, v9, v10
    v_mov_b32 v9, v8
    v_mov_b32 v10, v8
    s_nop 1
    v_permlane16_swap_b32 v9, v10
    s_nop 1
    v_add_f32 v8, v9, v10
    v_lshlrev_b32 v11, 2, v1
    v_lshl_add_u32 v12, v3, 6, v11
    ds_write_b32 v12, v8
    s_waitcnt lgkmcnt(0)
    s_barrier
    ds_read_b32 v8, v11
    ds_read_b32 v9, v11 offset:64
    ds_read_b32 v10, v11 offset:128
    ds_read_b32 v13, v11 offset:192
    s_waitcnt lgkmcnt(0)
    v_add_f32 v8, v8, v9
    v_add_f32 v10, v10, v13
    v_add_f32 v8, v8, v10
    v_mul_f32 v8, 0x3b000000, v8
    v_mov_b32 v14, 0
    v_sub_f32 v9, v32, v8
    v_fmac_f32 v14, v9, v9
    v_sub_f32 v9, v33, v8
    v_fmac_f32 v14, v9, v9
    v_sub_f32 v9, v34, v8
    v_fmac_f32 v14, v9, v9
    v_sub_f32 v9, v35, v8
    v_fmac_f32 v14, v9, v9
    v_sub_f32 v9, v36, v8
    v_fmac_f32 v14, v9, v9
    v_sub_f32 v9, v37, v8
    v_fmac_f32 v14, v9, v9
    v_sub_f32 v9, v38, v8
    v_fmac_f32 v14, v9, v9
    v_sub_f32 v9, v39, v8
    v_fmac_f32 v14, v9, v9
    v_sub_f32 v9, v40, v8
    v_fmac_f32 v14, v9, v9
    v_sub_f32 v9, v41, v8
    v_fmac_f32 v14, v9, v9
    v_sub_f32 v9, v42, v8
    v_fmac_f32 v14, v9, v9
    v_sub_f32 v9, v43, v8
    v_fmac_f32 v14, v9, v9
    v_sub_f32 v9, v44, v8
    v_fmac_f32 v14, v9, v9
    v_sub_f32 v9, v45, v8
    v_fmac_f32 v14, v9, v9
    v_sub_f32 v9, v46, v8
    v_fmac_f32 v14, v9, v9
    v_sub_f32 v9, v47, v8
    v_fmac_f32 v14, v9, v9
    v_sub_f32 v9, v48, v8
    v_fmac_f32 v14, v9, v9
    v_sub_f32 v9, v49, v8
    v_fmac_f32 v14, v9, v9
    v_sub_f32 v9, v50, v8
    v_fmac_f32 v14, v9, v9
    v_sub_f32 v9, v51, v8
    v_fmac_f32 v14, v9, v9
    v_sub_f32 v9, v52, v8
    v_fmac_f32 v14, v9, v9
    v_sub_f32 v9, v53, v8
    v_fmac_f32 v14, v9, v9
    v_sub_f32 v9, v54, v8
    v_fmac_f32 v14, v9, v9
    v_sub_f32 v9, v55, v8
    v_fmac_f32 v14, v9, v9
    v_sub_f32 v9, v56, v8
    v_fmac_f32 v14, v9, v9
    v_sub_f32 v9, v57, v8
    v_fmac_f32 v14, v9, v9
    v_sub_f32 v9, v58, v8
    v_fmac_f32 v14, v9, v9
    v_sub_f32 v9, v59, v8
    v_fmac_f32 v14, v9, v9
    v_sub_f32 v9, v60, v8
    v_fmac_f32 v14, v9, v9
    v_sub_f32 v9, v61, v8
    v_fmac_f32 v14, v9, v9
    v_sub_f32 v9, v62, v8
    v_fmac_f32 v14, v9, v9
    v_sub_f32 v9, v63, v8
    v_fmac_f32 v14, v9, v9
    v_mov_b32 v9, v14
    v_mov_b32 v10, v14
    s_nop 1
    v_permlane32_swap_b32 v9, v10
    s_nop 1
    v_add_f32 v14, v9, v10
    v_mov_b32 v9, v14
    v_mov_b32 v10, v14
    s_nop 1
    v_permlane16_swap_b32 v9, v10
    s_nop 1
    v_add_f32 v14, v9, v10
    ds_write_b32 v12, v14 offset:256
    s_waitcnt lgkmcnt(0)
    s_barrier
    ds_read_b32 v14, v11 offset:256
    ds_read_b32 v9, v11 offset:320
    ds_read_b32 v10, v11 offset:384
    ds_read_b32 v13, v11 offset:448
    s_waitcnt lgkmcnt(0)
    v_add_f32 v14, v14, v9
    v_add_f32 v10, v10, v13
    v_add_f32 v14, v14, v10
    v_mul_f32 v14, 0x3b000000, v14
    v_cvt_pk_bf16_f32 v9, v8, v14
    v_lshlrev_b32 v8, 16, v9
    v_and_b32 v14, 0xffff0000, v9
    v_add_f32 v14, 0x3727c5ac, v14
    v_cvt_pk_bf16_f32 v9, v14, v14
    v_lshlrev_b32 v14, 16, v9
    v_sqrt_f32 v14, v14
    s_nop 0
    v_cvt_pk_bf16_f32 v9, v14, v14
    v_lshlrev_b32 v14, 16, v9
    v_rcp_f32 v15, v14
    s_nop 0
    v_sub_f32 v32, v32, v8
    v_sub_f32 v33, v33, v8
    v_cvt_pk_bf16_f32 v9, v32, v33
    v_lshlrev_b32 v32, 16, v9
    v_and_b32 v33, 0xffff0000, v9
    v_mul_f32 v9, v32, v15
    v_fma_f32 v10, -v9, v14, v32
    v_fma_f32 v32, v10, v15, v9
    v_mul_f32 v9, v33, v15
    v_fma_f32 v10, -v9, v14, v33
    v_fma_f32 v33, v10, v15, v9
    v_cvt_pk_bf16_f32 v16, v32, v33
    v_sub_f32 v34, v34, v8
    v_sub_f32 v35, v35, v8
    v_cvt_pk_bf16_f32 v9, v34, v35
    v_lshlrev_b32 v34, 16, v9
    v_and_b32 v35, 0xffff0000, v9
    v_mul_f32 v9, v34, v15
    v_fma_f32 v10, -v9, v14, v34
    v_fma_f32 v34, v10, v15, v9
    v_mul_f32 v9, v35, v15
    v_fma_f32 v10, -v9, v14, v35
    v_fma_f32 v35, v10, v15, v9
    v_cvt_pk_bf16_f32 v17, v34, v35
    v_sub_f32 v36, v36, v8
    v_sub_f32 v37, v37, v8
    v_cvt_pk_bf16_f32 v9, v36, v37
    v_lshlrev_b32 v36, 16, v9
    v_and_b32 v37, 0xffff0000, v9
    v_mul_f32 v9, v36, v15
    v_fma_f32 v10, -v9, v14, v36
    v_fma_f32 v36, v10, v15, v9
    v_mul_f32 v9, v37, v15
    v_fma_f32 v10, -v9, v14, v37
    v_fma_f32 v37, v10, v15, v9
    v_cvt_pk_bf16_f32 v18, v36, v37
    v_sub_f32 v38, v38, v8
    v_sub_f32 v39, v39, v8
    v_cvt_pk_bf16_f32 v9, v38, v39
    v_lshlrev_b32 v38, 16, v9
    v_and_b32 v39, 0xffff0000, v9
    v_mul_f32 v9, v38, v15
    v_fma_f32 v10, -v9, v14, v38
    v_fma_f32 v38, v10, v15, v9
    v_mul_f32 v9, v39, v15
    v_fma_f32 v10, -v9, v14, v39
    v_fma_f32 v39, v10, v15, v9
    v_cvt_pk_bf16_f32 v19, v38, v39
    v_sub_f32 v40, v40, v8
    v_sub_f32 v41, v41, v8
    v_cvt_pk_bf16_f32 v9, v40, v41
    v_lshlrev_b32 v40, 16, v9
    v_and_b32 v41, 0xffff0000, v9
    v_mul_f32 v9, v40, v15
    v_fma_f32 v10, -v9, v14, v40
    v_fma_f32 v40, v10, v15, v9
    v_mul_f32 v9, v41, v15
    v_fma_f32 v10, -v9, v14, v41
    v_fma_f32 v41, v10, v15, v9
    v_cvt_pk_bf16_f32 v20, v40, v41
    v_sub_f32 v42, v42, v8
    v_sub_f32 v43, v43, v8
    v_cvt_pk_bf16_f32 v9, v42, v43
    v_lshlrev_b32 v42, 16, v9
    v_and_b32 v43, 0xffff0000, v9
    v_mul_f32 v9, v42, v15
    v_fma_f32 v10, -v9, v14, v42
    v_fma_f32 v42, v10, v15, v9
    v_mul_f32 v9, v43, v15
    v_fma_f32 v10, -v9, v14, v43
    v_fma_f32 v43, v10, v15, v9
    v_cvt_pk_bf16_f32 v21, v42, v43
    v_sub_f32 v44, v44, v8
    v_sub_f32 v45, v45, v8
    v_cvt_pk_bf16_f32 v9, v44, v45
    v_lshlrev_b32 v44, 16, v9
    v_and_b32 v45, 0xffff0000, v9
    v_mul_f32 v9, v44, v15
    v_fma_f32 v10, -v9, v14, v44
    v_fma_f32 v44, v10, v15, v9
    v_mul_f32 v9, v45, v15
    v_fma_f32 v10, -v9, v14, v45
    v_fma_f32 v45, v10, v15, v9
    v_cvt_pk_bf16_f32 v22, v44, v45
    v_sub_f32 v46, v46, v8
    v_sub_f32 v47, v47, v8
    v_cvt_pk_bf16_f32 v9, v46, v47
    v_lshlrev_b32 v46, 16, v9
    v_and_b32 v47, 0xffff0000, v9
    v_mul_f32 v9, v46, v15
    v_fma_f32 v10, -v9, v14, v46
    v_fma_f32 v46, v10, v15, v9
    v_mul_f32 v9, v47, v15
    v_fma_f32 v10, -v9, v14, v47
    v_fma_f32 v47, v10, v15, v9
    v_cvt_pk_bf16_f32 v23, v46, v47
    v_sub_f32 v48, v48, v8
    v_sub_f32 v49, v49, v8
    v_cvt_pk_bf16_f32 v9, v48, v49
    v_lshlrev_b32 v48, 16, v9
    v_and_b32 v49, 0xffff0000, v9
    v_mul_f32 v9, v48, v15
    v_fma_f32 v10, -v9, v14, v48
    v_fma_f32 v48, v10, v15, v9
    v_mul_f32 v9, v49, v15
    v_fma_f32 v10, -v9, v14, v49
    v_fma_f32 v49, v10, v15, v9
    v_cvt_pk_bf16_f32 v24, v48, v49
    v_sub_f32 v50, v50, v8
    v_sub_f32 v51, v51, v8
    v_cvt_pk_bf16_f32 v9, v50, v51
    v_lshlrev_b32 v50, 16, v9
    v_and_b32 v51, 0xffff0000, v9
    v_mul_f32 v9, v50, v15
    v_fma_f32 v10, -v9, v14, v50
    v_fma_f32 v50, v10, v15, v9
    v_mul_f32 v9, v51, v15
    v_fma_f32 v10, -v9, v14, v51
    v_fma_f32 v51, v10, v15, v9
    v_cvt_pk_bf16_f32 v25, v50, v51
    v_sub_f32 v52, v52, v8
    v_sub_f32 v53, v53, v8
    v_cvt_pk_bf16_f32 v9, v52, v53
    v_lshlrev_b32 v52, 16, v9
    v_and_b32 v53, 0xffff0000, v9
    v_mul_f32 v9, v52, v15
    v_fma_f32 v10, -v9, v14, v52
    v_fma_f32 v52, v10, v15, v9
    v_mul_f32 v9, v53, v15
    v_fma_f32 v10, -v9, v14, v53
    v_fma_f32 v53, v10, v15, v9
    v_cvt_pk_bf16_f32 v26, v52, v53
    v_sub_f32 v54, v54, v8
    v_sub_f32 v55, v55, v8
    v_cvt_pk_bf16_f32 v9, v54, v55
    v_lshlrev_b32 v54, 16, v9
    v_and_b32 v55, 0xffff0000, v9
    v_mul_f32 v9, v54, v15
    v_fma_f32 v10, -v9, v14, v54
    v_fma_f32 v54, v10, v15, v9
    v_mul_f32 v9, v55, v15
    v_fma_f32 v10, -v9, v14, v55
    v_fma_f32 v55, v10, v15, v9
    v_cvt_pk_bf16_f32 v27, v54, v55
    v_sub_f32 v56, v56, v8
    v_sub_f32 v57, v57, v8
    v_cvt_pk_bf16_f32 v9, v56, v57
    v_lshlrev_b32 v56, 16, v9
    v_and_b32 v57, 0xffff0000, v9
    v_mul_f32 v9, v56, v15
    v_fma_f32 v10, -v9, v14, v56
    v_fma_f32 v56, v10, v15, v9
    v_mul_f32 v9, v57, v15
    v_fma_f32 v10, -v9, v14, v57
    v_fma_f32 v57, v10, v15, v9
    v_cvt_pk_bf16_f32 v28, v56, v57
    v_sub_f32 v58, v58, v8
    v_sub_f32 v59, v59, v8
    v_cvt_pk_bf16_f32 v9, v58, v59
    v_lshlrev_b32 v58, 16, v9
    v_and_b32 v59, 0xffff0000, v9
    v_mul_f32 v9, v58, v15
    v_fma_f32 v10, -v9, v14, v58
    v_fma_f32 v58, v10, v15, v9
    v_mul_f32 v9, v59, v15
    v_fma_f32 v10, -v9, v14, v59
    v_fma_f32 v59, v10, v15, v9
    v_cvt_pk_bf16_f32 v29, v58, v59
    v_sub_f32 v60, v60, v8
    v_sub_f32 v61, v61, v8
    v_cvt_pk_bf16_f32 v9, v60, v61
    v_lshlrev_b32 v60, 16, v9
    v_and_b32 v61, 0xffff0000, v9
    v_mul_f32 v9, v60, v15
    v_fma_f32 v10, -v9, v14, v60
    v_fma_f32 v60, v10, v15, v9
    v_mul_f32 v9, v61, v15
    v_fma_f32 v10, -v9, v14, v61
    v_fma_f32 v61, v10, v15, v9
    v_cvt_pk_bf16_f32 v30, v60, v61
    v_sub_f32 v62, v62, v8
    v_sub_f32 v63, v63, v8
    v_cvt_pk_bf16_f32 v9, v62, v63
    v_lshlrev_b32 v62, 16, v9
    v_and_b32 v63, 0xffff0000, v9
    v_mul_f32 v9, v62, v15
    v_fma_f32 v10, -v9, v14, v62
    v_fma_f32 v62, v10, v15, v9
    v_mul_f32 v9, v63, v15
    v_fma_f32 v10, -v9, v14, v63
    v_fma_f32 v63, v10, v15, v9
    v_cvt_pk_bf16_f32 v31, v62, v63
    v_and_b32 v6, 63, v0
    v_lshlrev_b32 v6, 4, v6
    v_lshl_add_u32 v6, v3, 12, v6
    s_lshl_b32 s8, s2, 14
    v_add_u32 v6, s8, v6
    v_add_u32 v6, 18874368, v6
    global_store_dwordx4 v6, v[16:19], s[4:5] offset:0
    global_store_dwordx4 v6, v[20:23], s[4:5] offset:1024
    global_store_dwordx4 v6, v[24:27], s[4:5] offset:2048
    global_store_dwordx4 v6, v[28:31], s[4:5] offset:3072
L_ln3_kernel_1:
    s_endpgm
.globl chain_kernel
.p2align 8
.type chain_kernel,@function
chain_kernel:
    s_cmp_ge_u32 s2, 256
    s_cbranch_scc1 L_chain_kernel_1
    s_load_dwordx2 s[4:5], s[0:1], 96
    s_load_dwordx2 s[6:7], s[0:1], 8
    s_load_dwordx2 s[8:9], s[0:1], 88
    s_nop 0
    s_getreg_b32 s14, hwreg(HW_REG_XCC_ID)
    s_and_b32 s14, s14, 7
    v_lshrrev_b32 v1, 6, v0
    s_nop 0
    v_readfirstlane_b32 s12, v1
    v_mov_b32 v10, 16384
    s_waitcnt lgkmcnt(0)
    s_cmp_lg_u32 s12, 0
    s_cbranch_scc1 L_chain_kernel_2
    s_mov_b64 exec, 1
    s_lshl_b32 s15, s14, 2
    v_mov_b32 v1, s15
    v_mov_b32 v2, 1
    v_mov_b32 v3, 68
    global_atomic_add v4, v1, v2, s[8:9] sc0
    global_atomic_add v5, v3, v2, s[8:9] sc0
    s_waitcnt vmcnt(0)
    v_readfirstlane_b32 s16, v4
    v_readfirstlane_b32 s17, v5
    v_mov_b32 v3, 64
    s_add_u32 s18, s14, 1
    s_cmp_lg_u32 s16, 31
    s_cbranch_scc1 L_chain_kernel_5
    v_mov_b32 v6, s18
    v_mov_b32 v7, 0
    global_atomic_cmpswap v3, v[6:7], s[8:9]
    s_waitcnt vmcnt(0)
L_chain_kernel_5:
    s_mov_b32 s10, -1
    s_mov_b32 s11, 0
    s_cmp_lt_u32 s16, 32
    s_cbranch_scc1 L_chain_kernel_8
    s_cmp_lt_u32 s17, 32
    s_cbranch_scc0 L_chain_kernel_7
L_chain_kernel_8:
    s_mov_b32 s19, 0
L_chain_kernel_3:
    global_load_dword v4, v3, s[8:9] sc1
    s_waitcnt vmcnt(0)
    v_readfirstlane_b32 s15, v4
    s_cmp_lg_u32 s15, 0
    s_cbranch_scc1 L_chain_kernel_4
    s_add_u32 s19, s19, 1
    s_cmp_lt_u32 s19, 20000
    s_cbranch_scc1 L_chain_kernel_3
    v_mov_b32 v6, 0x100
    v_mov_b32 v7, 0
    global_atomic_cmpswap v3, v[6:7], s[8:9]
    s_waitcnt vmcnt(0)
    s_mov_b32 s19, 0
    s_branch L_chain_kernel_3
L_chain_kernel_4:
    s_cmp_eq_u32 s15, s18
    s_cbranch_scc0 L_chain_kernel_9
    s_cmp_lt_u32 s16, 32
    s_cbranch_scc0 L_chain_kernel_7
    s_mov_b32 s10, s16
    s_mov_b32 s11, 1
    s_branch L_chain_kernel_7
L_chain_kernel_9:
    s_cmp_eq_u32 s15, 0x100
    s_cbranch_scc0 L_chain_kernel_7
    s_cmp_lt_u32 s17, 32
    s_cbranch_scc0 L_chain_kernel_7
    s_mov_b32 s10, s17
L_chain_kernel_7:
    v_mov_b32 v6, s10
    v_mov_b32 v7, s11
    ds_write_b64 v10, v[6:7]
    s_mov_b64 exec, -1
L_chain_kernel_2:
    s_waitcnt lgkmcnt(0)
    s_barrier
    ds_read_b64 v[6:7], v10
    s_waitcnt lgkmcnt(0)
    v_readfirstlane_b32 s10, v6
    v_readfirstlane_b32 s11, v7
    s_nop 3
    s_cmp_eq_u32 s10, -1
    s_cbranch_scc1 L_chain_kernel_11
    v_and_b32 v1, 63, v0
    v_lshlrev_b32 v5, 4, v1
    v_bfe_u32 v6, v0, 4, 2
    v_and_b32 v7, 15, v0
    v_add_u32 v4, 4096, v5
    v_and_b32 v8, 7, v7
    v_mul_u32_u24 v9, 1040, v8
    v_lshl_add_u32 v9, v6, 5, v9
    v_lshrrev_b32 v10, 3, v7
    v_lshl_add_u32 v9, v10, 4, v9
    v_mul_u32_u24 v21, 272, v8
    v_lshl_add_u32 v21, v6, 4, v21
    s_lshl_b32 s22, s12, 6
    s_add_u32 s23, s22, 2176
    v_add_u32 v17, s23, v21
    v_mov_b32 v16, 0x4444
    v_mov_b32 v11, 0xeeee
    v_cmp_lt_u32 vcc, 7, v7
    s_nop 1
    v_cndmask_b32 v16, v16, v11, vcc
    v_lshrrev_b32 v10, 5, v1
    v_mul_u32_u24 v20, 2176, v10
    v_bfe_u32 v10, v1, 4, 1
    v_mul_u32_u24 v10, 1088, v10
    v_add_u32 v20, v20, v10
    v_lshl_add_u32 v20, v7, 2, v20
    v_add_u32 v20, s22, v20
    s_mov_b32 s30, 0x00ff00ff
    s_mov_b32 s31, 0x00ff00ff
    s_mov_b32 s32, 0
    s_mov_b32 s33, -1
    v_and_b32 v2, 1, v7
    v_lshlrev_b32 v2, 2, v2
    v_add_u32 v2, v2, v6
    v_lshlrev_b32 v2, 4, v2
    v_bfe_u32 v10, v7, 1, 2
    v_lshl_add_u32 v2, v10, 12, v2
    v_bfe_u32 v3, v1, 2, 1
    s_lshl_b32 s22, s12, 1
    v_add_u32 v3, s22, v3
    v_lshlrev_b32 v3, 10, v3
    v_and_b32 v8, 3, v1
    v_lshl_add_u32 v3, v8, 3, v3
    v_bfe_u32 v8, v1, 4, 1
    v_lshl_add_u32 v3, v8, 2, v3
    s_lshl_b32 s22, s10, 5
    v_add_u32 v3, s22, v3
    s_lshl_b32 s22, s12, 11
    v_add_u32 v4, s22, v5
    s_lshl_b32 s22, s10, 7
    s_lshl_b32 s23, s12, 2
    s_add_u32 s22, s22, s23
    s_add_u32 s36, s22, 129007616
    s_mul_i32 s22, s12, 2080
    s_add_u32 s22, s22, 17408
    v_add_u32 v0, s22, v5
    v_mov_b32 v1, v9
    s_lshl_b32 s22, s12, 10
    s_add_u32 s22, s22, 12288
    v_add_u32 v22, s22, v5
    s_lshl_b32 s22, s12, 15
    s_add_u32 s22, s22, 25792
    v_add_u32 v23, s22, v5
    s_mov_b32 s13, 0
    s_lshl_b32 s24, s10, 12
    s_lshl_b32 s25, s10, 13
    s_lshl_b32 s27, s12, 17
    s_lshl_b32 s22, s10, 7
    s_add_u32 s27, s27, s22
    s_add_u32 s27, s27, 127926272
    s_lshl_b32 s28, s10, 14
    s_lshl_b32 s22, s12, 12
    s_add_u32 s28, s28, s22
    s_add_u32 s28, s28, 127926272
    s_mov_b32 s29, 128983040
    s_mov_b32 s34, 128974848
    s_mov_b32 s20, s6
    s_mov_b32 s21, s7
    s_mov_b32 s40, 0x200000
    s_mov_b32 s16, s4
    s_and_b32 s17, s5, 0xffff
    s_mov_b32 s18, 0x10000000
    s_mov_b32 s19, 0x00020000
    s_lshl_b32 s22, s12, 20
    s_lshl_b32 s23, s10, 12
    s_add_u32 s22, s22, s23
    s_add_u32 s22, s22, 12582912
    v_add_u32 v8, s22, v5
    s_lshl_b32 s23, s12, 15
    s_add_u32 s26, s23, 25792
    s_mov_b32 m0, s26
    s_mov_b32 s26, 0
    buffer_load_dwordx4 v8, s[16:19], s26 offen offset:0 lds
    buffer_load_dwordx4 v8, s[16:19], s26 offen offset:1024 lds
    buffer_load_dwordx4 v8, s[16:19], s26 offen offset:2048 lds
    buffer_load_dwordx4 v8, s[16:19], s26 offen offset:3072 lds
    s_add_u32 s26, s23, 29888
    s_mov_b32 m0, s26
    s_mov_b32 s26, 131072
    buffer_load_dwordx4 v8, s[16:19], s26 offen offset:0 lds
    buffer_load_dwordx4 v8, s[16:19], s26 offen offset:1024 lds
    buffer_load_dwordx4 v8, s[16:19], s26 offen offset:2048 lds
    buffer_load_dwordx4 v8, s[16:19], s26 offen offset:3072 lds
    s_add_u32 s26, s23, 33984
    s_mov_b32 m0, s26
    s_mov_b32 s26, 262144
    buffer_load_dwordx4 v8, s[16:19], s26 offen offset:0 lds
    buffer_load_dwordx4 v8, s[16:19], s26 offen offset:1024 lds
    buffer_load_dwordx4 v8, s[16:19], s26 offen offset:2048 lds
    buffer_load_dwordx4 v8, s[16:19], s26 offen offset:3072 lds
    s_add_u32 s26, s23, 38080
    s_mov_b32 m0, s26
    s_mov_b32 s26, 393216
    buffer_load_dwordx4 v8, s[16:19], s26 offen offset:0 lds
    buffer_load_dwordx4 v8, s[16:19], s26 offen offset:1024 lds
    buffer_load_dwordx4 v8, s[16:19], s26 offen offset:2048 lds
    buffer_load_dwordx4 v8, s[16:19], s26 offen offset:3072 lds
    s_add_u32 s26, s23, 42176
    s_mov_b32 m0, s26
    s_mov_b32 s26, 524288
    buffer_load_dwordx4 v8, s[16:19], s26 offen offset:0 lds
    buffer_load_dwordx4 v8, s[16:19], s26 offen offset:1024 lds
    buffer_load_dwordx4 v8, s[16:19], s26 offen offset:2048 lds
    buffer_load_dwordx4 v8, s[16:19], s26 offen offset:3072 lds
    s_add_u32 s26, s23, 46272
    s_mov_b32 m0, s26
    s_mov_b32 s26, 655360
    buffer_load_dwordx4 v8, s[16:19], s26 offen offset:0 lds
    buffer_load_dwordx4 v8, s[16:19], s26 offen offset:1024 lds
    buffer_load_dwordx4 v8, s[16:19], s26 offen offset:2048 lds
    buffer_load_dwordx4 v8, s[16:19], s26 offen offset:3072 lds
    s_add_u32 s26, s23, 50368
    s_mov_b32 m0, s26
    s_mov_b32 s26, 786432
    buffer_load_dwordx4 v8, s[16:19], s26 offen offset:0 lds
    buffer_load_dwordx4 v8, s[16:19], s26 offen offset:1024 lds
    buffer_load_dwordx4 v8, s[16:19], s26 offen offset:2048 lds
    buffer_load_dwordx4 v8, s[16:19], s26 offen offset:3072 lds
    s_add_u32 s26, s23, 54464
    s_mov_b32 m0, s26
    s_mov_b32 s26, 917504
    buffer_load_dwordx4 v8, s[16:19], s26 offen offset:0 lds
    buffer_load_dwordx4 v8, s[16:19], s26 offen offset:1024 lds
    buffer_load_dwordx4 v8, s[16:19], s26 offen offset:2048 lds
    buffer_load_dwordx4 v8, s[16:19], s26 offen offset:3072 lds
    s_mul_i32 s22, s10, 393216
    s_lshl_b32 s23, s12, 15
    s_add_u32 s22, s22, s23
    v_add_u32 v8, s22, v5
    v_add_u32 v9, 142606336, v8
    global_load_dwordx4 a[0:3], v9, s[4:5] offset:0
    global_load_dwordx4 a[4:7], v9, s[4:5] offset:1024
    global_load_dwordx4 a[8:11], v9, s[4:5] offset:2048
    global_load_dwordx4 a[12:15], v9, s[4:5] offset:3072
    v_add_u32 v9, 142610432, v8
    global_load_dwordx4 a[16:19], v9, s[4:5] offset:0
    global_load_dwordx4 a[20:23], v9, s[4:5] offset:1024
    global_load_dwordx4 a[24:27], v9, s[4:5] offset:2048
    global_load_dwordx4 a[28:31], v9, s[4:5] offset:3072
    v_add_u32 v9, 142614528, v8
    global_load_dwordx4 a[32:35], v9, s[4:5] offset:0
    global_load_dwordx4 a[36:39], v9, s[4:5] offset:1024
    global_load_dwordx4 a[40:43], v9, s[4:5] offset:2048
    global_load_dwordx4 a[44:47], v9, s[4:5] offset:3072
    v_add_u32 v9, 142618624, v8
    global_load_dwordx4 a[48:51], v9, s[4:5] offset:0
    global_load_dwordx4 a[52:55], v9, s[4:5] offset:1024
    global_load_dwordx4 a[56:59], v9, s[4:5] offset:2048
    global_load_dwordx4 a[60:63], v9, s[4:5] offset:3072
    v_add_u32 v9, 142622720, v8
    global_load_dwordx4 a[64:67], v9, s[4:5] offset:0
    global_load_dwordx4 a[68:71], v9, s[4:5] offset:1024
    global_load_dwordx4 a[72:75], v9, s[4:5] offset:2048
    global_load_dwordx4 a[76:79], v9, s[4:5] offset:3072
    v_add_u32 v9, 142626816, v8
    global_load_dwordx4 a[80:83], v9, s[4:5] offset:0
    global_load_dwordx4 a[84:87], v9, s[4:5] offset:1024
    global_load_dwordx4 a[88:91], v9, s[4:5] offset:2048
    global_load_dwordx4 a[92:95], v9, s[4:5] offset:3072
    v_add_u32 v9, 142630912, v8
    global_load_dwordx4 a[96:99], v9, s[4:5] offset:0
    global_load_dwordx4 a[100:103], v9, s[4:5] offset:1024
    global_load_dwordx4 a[104:107], v9, s[4:5] offset:2048
    global_load_dwordx4 a[108:111], v9, s[4:5] offset:3072
    v_add_u32 v9, 142635008, v8
    global_load_dwordx4 a[112:115], v9, s[4:5] offset:0
    global_load_dwordx4 a[116:119], v9, s[4:5] offset:1024
    global_load_dwordx4 a[120:123], v9, s[4:5] offset:2048
    global_load_dwordx4 a[124:127], v9, s[4:5] offset:3072
    v_add_u32 v9, 142737408, v8
    global_load_dwordx4 a[128:131], v9, s[4:5] offset:0
    global_load_dwordx4 a[132:135], v9, s[4:5] offset:1024
    global_load_dwordx4 a[136:139], v9, s[4:5] offset:2048
    global_load_dwordx4 a[140:143], v9, s[4:5] offset:3072
    v_add_u32 v9, 142741504, v8
    global_load_dwordx4 a[144:147], v9, s[4:5] offset:0
    global_load_dwordx4 a[148:151], v9, s[4:5] offset:1024
    global_load_dwordx4 a[152:155], v9, s[4:5] offset:2048
    global_load_dwordx4 a[156:159], v9, s[4:5] offset:3072
    v_add_u32 v9, 142745600, v8
    global_load_dwordx4 a[160:163], v9, s[4:5] offset:0
    global_load_dwordx4 a[164:167], v9, s[4:5] offset:1024
    global_load_dwordx4 a[168:171], v9, s[4:5] offset:2048
    global_load_dwordx4 a[172:175], v9, s[4:5] offset:3072
    v_add_u32 v9, 142749696, v8
    global_load_dwordx4 a[176:179], v9, s[4:5] offset:0
    global_load_dwordx4 a[180:183], v9, s[4:5] offset:1024
    global_load_dwordx4 a[184:187], v9, s[4:5] offset:2048
    global_load_dwordx4 a[188:191], v9, s[4:5] offset:3072
    v_add_u32 v9, 142753792, v8
    global_load_dwordx4 a[192:195], v9, s[4:5] offset:0
    global_load_dwordx4 a[196:199], v9, s[4:5] offset:1024
    global_load_dwordx4 a[200:203], v9, s[4:5] offset:2048
    global_load_dwordx4 a[204:207], v9, s[4:5] offset:3072
    v_add_u32 v9, 142757888, v8
    global_load_dwordx4 a[208:211], v9, s[4:5] offset:0
    global_load_dwordx4 a[212:215], v9, s[4:5] offset:1024
    global_load_dwordx4 a[216:219], v9, s[4:5] offset:2048
    global_load_dwordx4 a[220:223], v9, s[4:5] offset:3072
    v_add_u32 v9, 142761984, v8
    global_load_dwordx4 a[224:227], v9, s[4:5] offset:0
    global_load_dwordx4 a[228:231], v9, s[4:5] offset:1024
    global_load_dwordx4 a[232:235], v9, s[4:5] offset:2048
    global_load_dwordx4 a[236:239], v9, s[4:5] offset:3072
    v_add_u32 v9, 142766080, v8
    global_load_dwordx4 a[240:243], v9, s[4:5] offset:0
    global_load_dwordx4 a[244:247], v9, s[4:5] offset:1024
    global_load_dwordx4 a[248:251], v9, s[4:5] offset:2048
    global_load_dwordx4 a[252:255], v9, s[4:5] offset:3072
    v_add_u32 v9, 142868480, v8
    global_load_dwordx4 v[128:131], v9, s[4:5] offset:0
    global_load_dwordx4 v[132:135], v9, s[4:5] offset:1024
    global_load_dwordx4 v[136:139], v9, s[4:5] offset:2048
    global_load_dwordx4 v[140:143], v9, s[4:5] offset:3072
    v_add_u32 v9, 142872576, v8
    global_load_dwordx4 v[144:147], v9, s[4:5] offset:0
    global_load_dwordx4 v[148:151], v9, s[4:5] offset:1024
    global_load_dwordx4 v[152:155], v9, s[4:5] offset:2048
    global_load_dwordx4 v[156:159], v9, s[4:5] offset:3072
    v_add_u32 v9, 142876672, v8
    global_load_dwordx4 v[160:163], v9, s[4:5] offset:0
    global_load_dwordx4 v[164:167], v9, s[4:5] offset:1024
    global_load_dwordx4 v[168:171], v9, s[4:5] offset:2048
    global_load_dwordx4 v[172:175], v9, s[4:5] offset:3072
    v_add_u32 v9, 142880768, v8
    global_load_dwordx4 v[176:179], v9, s[4:5] offset:0
    global_load_dwordx4 v[180:183], v9, s[4:5] offset:1024
    global_load_dwordx4 v[184:187], v9, s[4:5] offset:2048
    global_load_dwordx4 v[188:191], v9, s[4:5] offset:3072
    v_add_u32 v9, 142884864, v8
    global_load_dwordx4 v[192:195], v9, s[4:5] offset:0
    global_load_dwordx4 v[196:199], v9, s[4:5] offset:1024
    global_load_dwordx4 v[200:203], v9, s[4:5] offset:2048
    global_load_dwordx4 v[204:207], v9, s[4:5] offset:3072
    v_add_u32 v9, 142888960, v8
    global_load_dwordx4 v[208:211], v9, s[4:5] offset:0
    global_load_dwordx4 v[212:215], v9, s[4:5] offset:1024
    global_load_dwordx4 v[216:219], v9, s[4:5] offset:2048
    global_load_dwordx4 v[220:223], v9, s[4:5] offset:3072
    v_add_u32 v9, 142893056, v8
    global_load_dwordx4 v[224:227], v9, s[4:5] offset:0
    global_load_dwordx4 v[228:231], v9, s[4:5] offset:1024
    global_load_dwordx4 v[232:235], v9, s[4:5] offset:2048
    global_load_dwordx4 v[236:239], v9, s[4:5] offset:3072
    v_add_u32 v9, 142897152, v8
    global_load_dwordx4 v[240:243], v9, s[4:5] offset:0
    global_load_dwordx4 v[244:247], v9, s[4:5] offset:1024
    global_load_dwordx4 v[248:251], v9, s[4:5] offset:2048
    global_load_dwordx4 v[252:255], v9, s[4:5] offset:3072
    s_lshl_b32 s35, s10, 2
    s_add_u32 s35, s35, 129015808
    s_and_b32 s22, s12, 1
    s_lshl_b32 s22, s22, 12
    s_mov_b32 s37, 38273024
    s_mov_b32 s23, 55050240
    s_cmp_lt_u32 s12, 2
    s_cselect_b32 s37, s37, s23
    s_add_u32 s37, s37, s22
    v_mov_b32 v6, s35
kvw_chain_kernel_12:
    global_load_dword v7, v6, s[4:5] sc1
    s_waitcnt vmcnt(0)
    v_readfirstlane_b32 s22, v7
    s_sub_u32 s40, s40, 1
    s_cbranch_scc1 L_chain_kernel_1
    s_cmp_lt_u32 s22, 2
    s_cbranch_scc1 kvw_chain_kernel_12
    s_add_u32 s35, s35, 128
    s_waitcnt vmcnt(0)
    s_barrier
    s_nop 0
    s_cmp_eq_u32 s11, 0
    s_cbranch_scc1 L_chain_kernel_6
loop_chain_kernel_13:
    v_add_u32 v18, s25, v5
    v_add_u32 v19, 37748736, v18
    v_add_u32 v6, 4096, v19
    s_lshl_b32 s22, s12, 11
    v_add_u32 v18, s22, v18
    v_add_u32 v18, 54525952, v18
    global_load_dwordx4 v[24:27], v19, s[4:5] offset:0
    global_load_dwordx4 v[28:31], v19, s[4:5] offset:1024
    global_load_dwordx4 v[32:35], v19, s[4:5] offset:2048
    global_load_dwordx4 v[36:39], v19, s[4:5] offset:3072
    global_load_dwordx4 v[40:43], v6, s[4:5] offset:0
    global_load_dwordx4 v[44:47], v6, s[4:5] offset:1024
    global_load_dwordx4 v[48:51], v6, s[4:5] offset:2048
    global_load_dwordx4 v[52:55], v6, s[4:5] offset:3072
    global_load_dwordx4 v[56:59], v18, s[4:5]
    global_load_dwordx4 v[60:63], v18, s[4:5] offset:1024
    v_mov_b32 v64, 0
    v_mov_b32 v65, 0
    v_mov_b32 v66, 0
    v_mov_b32 v67, 0
    v_mov_b32 v68, 0
    v_mov_b32 v69, 0
    v_mov_b32 v70, 0
    v_mov_b32 v71, 0
    v_mov_b32 v72, 0
    v_mov_b32 v73, 0
    v_mov_b32 v74, 0
    v_mov_b32 v75, 0
    v_mov_b32 v76, 0
    v_mov_b32 v77, 0
    v_mov_b32 v78, 0
    v_mov_b32 v79, 0
    v_mov_b32 v80, 0
    v_mov_b32 v81, 0
    v_mov_b32 v82, 0
    v_mov_b32 v83, 0
    v_mov_b32 v84, 0
    v_mov_b32 v85, 0
    v_mov_b32 v86, 0
    v_mov_b32 v87, 0
gpoll_chain_kernel_17:
    global_load_dwordx4 v[120:123], v4, s[20:21] sc1
    global_load_dwordx4 v[124:127], v4, s[20:21] offset:1024 sc1
    s_waitcnt vmcnt(0)
    v_max3_u32 v6, v120, v121, v122
    v_max3_u32 v7, v123, v124, v125
    v_max3_u32 v6, v6, v126, v127
    v_max_u32 v6, v6, v7
    v_cmp_eq_u32 vcc, -1, v6
    s_cbranch_vccz gA_chain_kernel_18
    s_sub_u32 s40, s40, 1
    s_cbranch_scc1 dead_chain_kernel_16
    s_branch gpoll_chain_kernel_17
gokB_chain_kernel_19:
    ds_write_b128 v0, v[8:11]
    ds_write_b128 v0, v[12:15] offset:1040
    s_branch gdone_chain_kernel_20
gA_chain_kernel_18:
    ds_write_b128 v0, v[120:123]
    ds_write_b128 v0, v[124:127] offset:1040
gdone_chain_kernel_20:
    s_waitcnt lgkmcnt(0)
    s_barrier
    ds_read_b128 v[88:91], v1 offset:17408
    ds_read_b128 v[92:95], v1 offset:17536
    ds_read_b128 v[96:99], v1 offset:17664
    ds_read_b128 v[100:103], v1 offset:17792
    ds_read_b128 v[104:107], v1 offset:17920
    ds_read_b128 v[108:111], v1 offset:18048
    ds_read_b128 v[112:115], v1 offset:18176
    ds_read_b128 v[116:119], v1 offset:18304
    s_waitcnt lgkmcnt(7)
    v_smfmac_f32_16x16x64_bf16 v[64:67], v[88:91], a[0:7], v16
    v_smfmac_f32_16x16x64_bf16 v[68:71], v[88:91], a[64:71], v16
    v_smfmac_f32_16x16x64_bf16 v[72:75], v[88:91], a[128:135], v16
    v_smfmac_f32_16x16x64_bf16 v[76:79], v[88:91], a[192:199], v16
    s_waitcnt lgkmcnt(6)
    v_smfmac_f32_16x16x64_bf16 v[64:67], v[92:95], a[8:15], v16
    v_smfmac_f32_16x16x64_bf16 v[68:71], v[92:95], a[72:79], v16
    v_smfmac_f32_16x16x64_bf16 v[72:75], v[92:95], a[136:143], v16
    v_smfmac_f32_16x16x64_bf16 v[76:79], v[92:95], a[200:207], v16
    s_waitcnt lgkmcnt(5)
    v_smfmac_f32_16x16x64_bf16 v[64:67], v[96:99], a[16:23], v16
    v_smfmac_f32_16x16x64_bf16 v[68:71], v[96:99], a[80:87], v16
    v_smfmac_f32_16x16x64_bf16 v[72:75], v[96:99], a[144:151], v16
    v_smfmac_f32_16x16x64_bf16 v[76:79], v[96:99], a[208:215], v16
    s_waitcnt lgkmcnt(4)
    v_smfmac_f32_16x16x64_bf16 v[64:67], v[100:103], a[24:31], v16
    v_smfmac_f32_16x16x64_bf16 v[68:71], v[100:103], a[88:95], v16
    v_smfmac_f32_16x16x64_bf16 v[72:75], v[100:103], a[152:159], v16
    v_smfmac_f32_16x16x64_bf16 v[76:79], v[100:103], a[216:223], v16
    s_waitcnt vmcnt(0)
    s_cmp_ge_u32 s13, 62
    s_cbranch_scc1 tno_chain_kernel_21
    s_and_b32 s22, s13, 3
    s_cmp_lg_u32 s22, 2
    s_cbranch_scc1 tnf_chain_kernel_22
    v_mov_b32 v6, s35
kvw_chain_kernel_23:
    global_load_dword v7, v6, s[4:5] sc1
    s_waitcnt vmcnt(0)
    v_readfirstlane_b32 s22, v7
    s_sub_u32 s40, s40, 1
    s_cbranch_scc1 dead_chain_kernel_16
    s_cmp_lt_u32 s22, 2
    s_cbranch_scc1 kvw_chain_kernel_23
    s_add_u32 s35, s35, 128
tnf_chain_kernel_22:
    s_add_u32 s22, s25, s37
    v_lshlrev_b32 v6, 2, v5
    v_add_u32 v6, s22, v6
    global_load_dword v12, v6, s[4:5]
tno_chain_kernel_21:
    s_waitcnt lgkmcnt(3)
    v_smfmac_f32_16x16x64_bf16 v[64:67], v[104:107], a[32:39], v16
    v_smfmac_f32_16x16x64_bf16 v[68:71], v[104:107], a[96:103], v16
    v_smfmac_f32_16x16x64_bf16 v[72:75], v[104:107], a[160:167], v16
    v_smfmac_f32_16x16x64_bf16 v[76:79], v[104:107], a[224:231], v16
    s_waitcnt lgkmcnt(2)
    v_smfmac_f32_16x16x64_bf16 v[64:67], v[108:111], a[40:47], v16
    v_smfmac_f32_16x16x64_bf16 v[68:71], v[108:111], a[104:111], v16
    v_smfmac_f32_16x16x64_bf16 v[72:75], v[108:111], a[168:175], v16
    v_smfmac_f32_16x16x64_bf16 v[76:79], v[108:111], a[232:239], v16
    s_waitcnt lgkmcnt(1)
    v_smfmac_f32_16x16x64_bf16 v[64:67], v[112:115], a[48:55], v16
    v_smfmac_f32_16x16x64_bf16 v[68:71], v[112:115], a[112:119], v16
    v_smfmac_f32_16x16x64_bf16 v[72:75], v[112:115], a[176:183], v16
    v_smfmac_f32_16x16x64_bf16 v[76:79], v[112:115], a[240:247], v16
    s_waitcnt lgkmcnt(0)
    v_smfmac_f32_16x16x64_bf16 v[64:67], v[116:119], a[56:63], v16
    v_smfmac_f32_16x16x64_bf16 v[68:71], v[116:119], a[120:127], v16
    v_smfmac_f32_16x16x64_bf16 v[72:75], v[116:119], a[184:191], v16
    v_smfmac_f32_16x16x64_bf16 v[76:79], v[116:119], a[248:255], v16
    v_smfmac_f32_16x16x64_bf16 v[80:83], v[88:91], v[128:135], v16
    v_smfmac_f32_16x16x64_bf16 v[84:87], v[88:91], v[192:199], v16
    v_smfmac_f32_16x16x64_bf16 v[80:83], v[92:95], v[136:143], v16
    v_smfmac_f32_16x16x64_bf16 v[84:87], v[92:95], v[200:207], v16
    v_smfmac_f32_16x16x64_bf16 v[80:83], v[96:99], v[144:151], v16
    v_smfmac_f32_16x16x64_bf16 v[84:87], v[96:99], v[208:215], v16
    s_lshl_b32 s22, s12, 9
    s_lshr_b32 s23, s24, 1
    s_add_u32 s23, s23, s22
    v_lshrrev_b32 v19, 1, v5
    v_add_u32 v19, s23, v19
    v_add_u32 v19, 79691776, v19
    s_nop 1
    v_permlane32_swap_b32 v64, v72
    v_permlane32_swap_b32 v68, v76
    v_smfmac_f32_16x16x64_bf16 v[80:83], v[100:103], v[152:159], v16
    v_permlane32_swap_b32 v65, v73
    v_permlane32_swap_b32 v69, v77
    v_smfmac_f32_16x16x64_bf16 v[84:87], v[100:103], v[216:223], v16
    v_permlane32_swap_b32 v66, v74
    v_permlane32_swap_b32 v70, v78
    v_smfmac_f32_16x16x64_bf16 v[80:83], v[104:107], v[160:167], v16
    v_permlane32_swap_b32 v67, v75
    v_permlane32_swap_b32 v71, v79
    v_smfmac_f32_16x16x64_bf16 v[84:87], v[104:107], v[224:231], v16
    v_pk_add_f32 v[64:65], v[64:65], v[72:73]
    v_pk_add_f32 v[68:69], v[68:69], v[76:77]
    v_smfmac_f32_16x16x64_bf16 v[80:83], v[108:111], v[168:175], v16
    v_pk_add_f32 v[66:67], v[66:67], v[74:75]
    v_pk_add_f32 v[70:71], v[70:71], v[78:79]
    v_smfmac_f32_16x16x64_bf16 v[84:87], v[108:111], v[232:239], v16
    v_cvt_pk_bf16_f32 v6, v64, v68
    ds_write_b32 v20, v6 offset:0
    v_smfmac_f32_16x16x64_bf16 v[80:83], v[112:115], v[176:183], v16
    v_cvt_pk_bf16_f32 v7, v65, v69
    ds_write_b32 v20, v7 offset:272
    v_smfmac_f32_16x16x64_bf16 v[84:87], v[112:115], v[240:247], v16
    v_cvt_pk_bf16_f32 v8, v66, v70
    ds_write_b32 v20, v8 offset:544
    v_smfmac_f32_16x16x64_bf16 v[80:83], v[116:119], v[184:191], v16
    v_cvt_pk_bf16_f32 v9, v67, v71
    ds_write_b32 v20, v9 offset:816
    v_smfmac_f32_16x16x64_bf16 v[84:87], v[116:119], v[248:255], v16
    s_waitcnt lgkmcnt(0)
    s_barrier
    s_cmp_eq_u32 s13, 63
    s_cbranch_scc1 last_chain_kernel_24
    ds_read_b128 v[88:91], v21 offset:0
    ds_read_b128 v[104:107], v21 offset:2176
    ds_read_b128 v[92:95], v21 offset:64
    ds_read_b128 v[108:111], v21 offset:2240
    ds_read_b128 v[96:99], v21 offset:128
    ds_read_b128 v[112:115], v21 offset:2304
    ds_read_b128 v[100:103], v21 offset:192
    ds_read_b128 v[116:119], v21 offset:2368
    ds_read_b128 v[120:123], v17
    s_waitcnt lgkmcnt(7)
    v_mfma_f32_16x16x32_bf16 v[68:71], v[24:27], v[88:91], 0
    v_mfma_f32_16x16x32_bf16 v[72:75], v[40:43], v[88:91], 0
    v_mfma_f32_16x16x32_bf16 v[64:67], v[104:107], v[88:91], 0
    s_waitcnt lgkmcnt(5)
    v_mfma_f32_16x16x32_bf16 v[68:71], v[28:31], v[92:95], v[68:71]
    v_mfma_f32_16x16x32_bf16 v[72:75], v[44:47], v[92:95], v[72:75]
    v_mfma_f32_16x16x32_bf16 v[64:67], v[108:111], v[92:95], v[64:67]
    s_waitcnt lgkmcnt(3)
    v_mfma_f32_16x16x32_bf16 v[68:71], v[32:35], v[96:99], v[68:71]
    v_mfma_f32_16x16x32_bf16 v[72:75], v[48:51], v[96:99], v[72:75]
    v_mfma_f32_16x16x32_bf16 v[64:67], v[112:115], v[96:99], v[64:67]
    s_waitcnt lgkmcnt(1)
    v_mfma_f32_16x16x32_bf16 v[68:71], v[36:39], v[100:103], v[68:71]
    v_mfma_f32_16x16x32_bf16 v[72:75], v[52:55], v[100:103], v[72:75]
    v_mfma_f32_16x16x32_bf16 v[64:67], v[116:119], v[100:103], v[64:67]
    v_permlane32_swap_b32 v80, v84
    v_permlane32_swap_b32 v81, v85
    v_permlane32_swap_b32 v82, v86
    v_permlane32_swap_b32 v83, v87
    s_nop 0
    v_pk_add_f32 v[80:81], v[80:81], v[84:85]
    v_pk_add_f32 v[82:83], v[82:83], v[86:87]
    v_cvt_pk_bf16_f32 v14, v80, v81
    v_cvt_pk_bf16_f32 v15, v82, v83
    global_store_dwordx2 v19, v[14:15], s[4:5] sc1
    s_lshl_b32 s22, s12, 10
    s_add_u32 s22, s22, s24
    v_add_u32 v18, s22, v5
    v_add_u32 v18, 71303168, v18
    s_waitcnt lgkmcnt(0)
    global_store_dwordx4 v18, v[120:123], s[4:5] sc1
    ds_read_b128 v[76:79], v23 offset:0
    ds_read_b128 v[80:83], v23 offset:1024
    ds_read_b128 v[84:87], v23 offset:2048
    ds_read_b128 v[88:91], v23 offset:3072
    ds_read_b128 v[92:95], v23 offset:4096
    ds_read_b128 v[96:99], v23 offset:5120
    ds_read_b128 v[100:103], v23 offset:6144
    ds_read_b128 v[104:107], v23 offset:7168
    v_mov_b32 v7, 0xff800000
    v_cndmask_b32 v64, v64, v7, s[32:33]
    v_cndmask_b32 v65, v65, v7, s[32:33]
    v_cndmask_b32 v66, v66, v7, s[32:33]
    v_cndmask_b32 v67, v67, v7, s[32:33]
    v_max3_f32 v6, v64, v65, v66
    v_max3_f32 v8, v67, v68, v69
    v_max3_f32 v9, v70, v71, v72
    v_max3_f32 v10, v73, v74, v75
    v_max_f32 v6, v6, v8
    v_max_f32 v9, v9, v10
    v_max_f32 v6, v6, v9
    v_mov_b32 v7, v6
    v_mov_b32 v8, v6
    s_nop 1
    v_permlane32_swap_b32 v7, v8
    s_nop 1
    v_max_f32 v6, v7, v8
    v_mov_b32 v7, v6
    v_mov_b32 v8, v6
    s_nop 1
    v_permlane16_swap_b32 v7, v8
    s_nop 1
    v_max_f32 v6, v7, v8
    s_mov_b32 s22, 1040356334
    v_mul_f32 v6, s22, v6
    v_fma_f32 v64, v64, s22, -v6
    v_fma_f32 v65, v65, s22, -v6
    v_fma_f32 v66, v66, s22, -v6
    v_fma_f32 v67, v67, s22, -v6
    v_fma_f32 v68, v68, s22, -v6
    v_fma_f32 v69, v69, s22, -v6
    v_fma_f32 v70, v70, s22, -v6
    v_fma_f32 v71, v71, s22, -v6
    v_fma_f32 v72, v72, s22, -v6
    v_fma_f32 v73, v73, s22, -v6
    v_fma_f32 v74, v74, s22, -v6
    v_fma_f32 v75, v75, s22, -v6
    v_exp_f32 v64, v64
    ds_read_b128 v[108:111], v23 offset:8192
    v_exp_f32 v65, v65
    ds_read_b128 v[112:115], v23 offset:9216
    v_exp_f32 v66, v66
    ds_read_b128 v[116:119], v23 offset:10240
    v_exp_f32 v67, v67
    ds_read_b128 v[24:27], v23 offset:11264
    v_exp_f32 v68, v68
    ds_read_b128 v[28:31], v23 offset:12288
    v_exp_f32 v69, v69
    ds_read_b128 v[32:35], v23 offset:13312
    v_exp_f32 v70, v70
    ds_read_b128 v[36:39], v23 offset:14336
    v_exp_f32 v71, v71
    ds_read_b128 v[40:43], v23 offset:15360
    v_exp_f32 v72, v72
    ds_read_b128 v[44:47], v23 offset:16384
    v_exp_f32 v73, v73
    ds_read_b128 v[48:51], v23 offset:17408
    v_exp_f32 v74, v74
    ds_read_b128 v[52:55], v23 offset:18432
    v_exp_f32 v75, v75
    s_nop 0
    v_pk_add_f32 v[6:7], v[64:65], v[66:67]
    v_pk_add_f32 v[8:9], v[68:69], v[70:71]
    v_pk_add_f32 v[10:11], v[72:73], v[74:75]
    v_pk_add_f32 v[6:7], v[6:7], v[8:9]
    v_pk_add_f32 v[6:7], v[6:7], v[10:11]
    v_add_f32 v6, v6, v7
    v_mov_b32 v7, v6
    v_mov_b32 v8, v6
    s_nop 1
    v_permlane32_swap_b32 v7, v8
    s_nop 1
    v_add_f32 v6, v7, v8
    v_mov_b32 v7, v6
    v_mov_b32 v8, v6
    s_nop 1
    v_permlane16_swap_b32 v7, v8
    s_nop 1
    v_add_f32 v6, v7, v8
    v_rcp_f32 v6, v6
    s_nop 0
    v_mov_b32 v7, v6
    v_pk_mul_f32 v[64:65], v[64:65], v[6:7]
    v_pk_mul_f32 v[66:67], v[66:67], v[6:7]
    v_pk_mul_f32 v[68:69], v[68:69], v[6:7]
    v_pk_mul_f32 v[70:71], v[70:71], v[6:7]
    v_pk_mul_f32 v[72:73], v[72:73], v[6:7]
    v_pk_mul_f32 v[74:75], v[74:75], v[6:7]
    v_cvt_pk_bf16_f32 v120, v64, v65
    v_cvt_pk_bf16_f32 v121, v66, v67
    v_mov_b32 v122, 0
    v_mov_b32 v123, 0
    v_mov_b32 v8, v120
    v_mov_b32 v9, v121
    v_cvt_pk_bf16_f32 v124, v68, v69
    v_cvt_pk_bf16_f32 v125, v70, v71
    v_cvt_pk_bf16_f32 v126, v72, v73
    v_cvt_pk_bf16_f32 v127, v74, v75
    v_permlane32_swap_b32 v122, v8
    v_permlane32_swap_b32 v123, v9
    s_nop 1
    v_mfma_f32_16x16x32_bf16 v[64:67], v[56:59], v[124:127], 0
    v_mfma_f32_16x16x32_bf16 v[68:71], v[60:63], v[124:127], 0
    v_mfma_f32_16x16x16_bf16 v[64:67], v[14:15], v[120:121], v[64:67]
    v_mfma_f32_16x16x16_bf16 v[68:71], v[14:15], v[122:123], v[68:71]
    v_mov_b32 v7, s13
    v_mov_b32 v6, s36
    s_mov_b64 exec, 1
    global_store_dword v6, v7, s[4:5] sc1
    s_mov_b64 exec, -1
    s_bfe_u32 s41, s13, 0x10001
    s_and_b32 s22, s13, 1
    s_lshl_b32 s22, s22, 19
    s_add_u32 s22, s22, s27
    v_add_u32 v18, s22, v2
    s_nop 4
    v_cvt_pk_bf16_f32 v72, v64, v65
    v_cvt_pk_bf16_f32 v73, v66, v67
    v_cvt_pk_bf16_f32 v74, v68, v69
    v_cvt_pk_bf16_f32 v75, v70, v71
    ds_write_b128 v22, v[72:75]
    s_waitcnt lgkmcnt(0)
    s_barrier
    ds_read_b128 v[56:59], v5 offset:12288
    ds_read_b128 v[60:63], v5 offset:13312
    ds_read_b128 v[64:67], v5 offset:14336
    ds_read_b128 v[68:71], v5 offset:15360
    s_waitcnt lgkmcnt(0)
    v_mfma_f32_16x16x32_bf16 v[8:11], v[76:79], v[56:59], 0
    ds_read_b128 v[76:79], v23 offset:19456
    v_mfma_f32_16x16x32_bf16 v[8:11], v[80:83], v[60:63], v[8:11]
    ds_read_b128 v[80:83], v23 offset:20480
    v_mfma_f32_16x16x32_bf16 v[8:11], v[84:87], v[64:67], v[8:11]
    ds_read_b128 v[84:87], v23 offset:21504
    v_mfma_f32_16x16x32_bf16 v[8:11], v[88:91], v[68:71], v[8:11]
    ds_read_b128 v[88:91], v23 offset:22528
    v_mfma_f32_16x16x32_bf16 v[120:123], v[92:95], v[56:59], 0
    ds_read_b128 v[92:95], v23 offset:23552
    v_mfma_f32_16x16x32_bf16 v[120:123], v[96:99], v[60:63], v[120:123]
    ds_read_b128 v[96:99], v23 offset:24576
    v_mfma_f32_16x16x32_bf16 v[120:123], v[100:103], v[64:67], v[120:123]
    ds_read_b128 v[100:103], v23 offset:25600
    v_mfma_f32_16x16x32_bf16 v[120:123], v[104:107], v[68:71], v[120:123]
    ds_read_b128 v[104:107], v23 offset:26624
    v_bfi_b32 v8, 1, s41, v8
    s_mov_b64 exec, s[30:31]
    global_store_dwordx4 v18, v[8:11], s[4:5]
    s_mov_b64 exec, -1
    v_add_u32 v18, 16384, v18
    v_mfma_f32_16x16x32_bf16 v[124:127], v[108:111], v[56:59], 0
    ds_read_b128 v[108:111], v23 offset:27648
    v_mfma_f32_16x16x32_bf16 v[124:127], v[112:115], v[60:63], v[124:127]
    ds_read_b128 v[112:115], v23 offset:28672
    v_mfma_f32_16x16x32_bf16 v[124:127], v[116:119], v[64:67], v[124:127]
    ds_read_b128 v[116:119], v23 offset:29696
    v_mfma_f32_16x16x32_bf16 v[124:127], v[24:27], v[68:71], v[124:127]
    ds_read_b128 v[24:27], v23 offset:30720
    v_bfi_b32 v120, 1, s41, v120
    s_mov_b64 exec, s[30:31]
    global_store_dwordx4 v18, v[120:123], s[4:5]
    s_mov_b64 exec, -1
    v_add_u32 v18, 16384, v18
    v_mfma_f32_16x16x32_bf16 v[72:75], v[28:31], v[56:59], 0
    ds_read_b128 v[28:31], v23 offset:31744
    v_mfma_f32_16x16x32_bf16 v[72:75], v[32:35], v[60:63], v[72:75]
    v_mfma_f32_16x16x32_bf16 v[72:75], v[36:39], v[64:67], v[72:75]
    v_mfma_f32_16x16x32_bf16 v[72:75], v[40:43], v[68:71], v[72:75]
    v_bfi_b32 v124, 1, s41, v124
    s_mov_b64 exec, s[30:31]
    global_store_dwordx4 v18, v[124:127], s[4:5]
    s_mov_b64 exec, -1
    v_add_u32 v18, 16384, v18
    v_mfma_f32_16x16x32_bf16 v[8:11], v[44:47], v[56:59], 0
    v_mfma_f32_16x16x32_bf16 v[8:11], v[48:51], v[60:63], v[8:11]
    v_mfma_f32_16x16x32_bf16 v[8:11], v[52:55], v[64:67], v[8:11]
    s_waitcnt lgkmcnt(12)
    v_mfma_f32_16x16x32_bf16 v[8:11], v[76:79], v[68:71], v[8:11]
    v_bfi_b32 v72, 1, s41, v72
    s_mov_b64 exec, s[30:31]
    global_store_dwordx4 v18, v[72:75], s[4:5]
    s_mov_b64 exec, -1
    v_add_u32 v18, 16384, v18
    s_waitcnt lgkmcnt(11)
    v_mfma_f32_16x16x32_bf16 v[120:123], v[80:83], v[56:59], 0
    s_waitcnt lgkmcnt(10)
    v_mfma_f32_16x16x32_bf16 v[120:123], v[84:87], v[60:63], v[120:123]
    s_waitcnt lgkmcnt(9)
    v_mfma_f32_16x16x32_bf16 v[120:123], v[88:91], v[64:67], v[120:123]
    s_waitcnt lgkmcnt(8)
    v_mfma_f32_16x16x32_bf16 v[120:123], v[92:95], v[68:71], v[120:123]
    v_bfi_b32 v8, 1, s41, v8
    s_mov_b64 exec, s[30:31]
    global_store_dwordx4 v18, v[8:11], s[4:5]
    s_mov_b64 exec, -1
    v_add_u32 v18, 16384, v18
    s_waitcnt lgkmcnt(7)
    v_mfma_f32_16x16x32_bf16 v[124:127], v[96:99], v[56:59], 0
    s_waitcnt lgkmcnt(6)
    v_mfma_f32_16x16x32_bf16 v[124:127], v[100:103], v[60:63], v[124:127]
    s_waitcnt lgkmcnt(5)
    v_mfma_f32_16x16x32_bf16 v[124:127], v[104:107], v[64:67], v[124:127]
    s_waitcnt lgkmcnt(4)
    v_mfma_f32_16x16x32_bf16 v[124:127], v[108:111], v[68:71], v[124:127]
    v_bfi_b32 v120, 1, s41, v120
    s_mov_b64 exec, s[30:31]
    global_store_dwordx4 v18, v[120:123], s[4:5]
    s_mov_b64 exec, -1
    v_add_u32 v18, 16384, v18
    s_waitcnt lgkmcnt(3)
    v_mfma_f32_16x16x32_bf16 v[72:75], v[112:115], v[56:59], 0
    s_waitcnt lgkmcnt(2)
    v_mfma_f32_16x16x32_bf16 v[72:75], v[116:119], v[60:63], v[72:75]
    s_waitcnt lgkmcnt(1)
    v_mfma_f32_16x16x32_bf16 v[72:75], v[24:27], v[64:67], v[72:75]
    s_waitcnt lgkmcnt(0)
    v_mfma_f32_16x16x32_bf16 v[72:75], v[28:31], v[68:71], v[72:75]
    v_bfi_b32 v124, 1, s41, v124
    s_mov_b64 exec, s[30:31]
    global_store_dwordx4 v18, v[124:127], s[4:5]
    s_mov_b64 exec, -1
    v_add_u32 v18, 16384, v18
    s_nop 7
    v_bfi_b32 v72, 1, s41, v72
    s_mov_b64 exec, s[30:31]
    global_store_dwordx4 v18, v[72:75], s[4:5]
    s_mov_b64 exec, -1
    v_add_u32 v18, 16384, v18
    s_add_u32 s25, s25, 262144
    s_and_b32 s22, s13, 1
    s_lshl_b32 s22, s22, 19
    s_add_u32 s22, s22, s28
    v_add_u32 v18, s22, v5
redpoll_chain_kernel_25:
    global_load_dwordx4 v[64:67], v18, s[4:5] offset:0 sc1
    global_load_dwordx4 v[68:71], v18, s[4:5] offset:1024 sc1
    global_load_dwordx4 v[72:75], v18, s[4:5] offset:2048 sc1
    global_load_dwordx4 v[76:79], v18, s[4:5] offset:3072 sc1
    s_waitcnt vmcnt(0)
    v_xor_b32 v6, s41, v64
    v_xor_b32 v7, s41, v68
    v_xor_b32 v112, s41, v72
    v_xor_b32 v113, s41, v76
    v_or3_b32 v6, v6, v7, v112
    v_or_b32 v6, v6, v113
    v_and_b32 v6, 1, v6
    v_cmp_ne_u32 vcc, 0, v6
    s_cbranch_vccz rA_chain_kernel_26
    s_sub_u32 s40, s40, 1
    s_cbranch_scc1 dead_chain_kernel_16
    s_branch redpoll_chain_kernel_25
rB_chain_kernel_27:
    v_pk_add_f32 v[96:97], v[80:81], v[84:85]
    v_pk_add_f32 v[98:99], v[82:83], v[86:87]
    v_pk_add_f32 v[100:101], v[88:89], v[92:93]
    v_pk_add_f32 v[102:103], v[90:91], v[94:95]
    s_branch rj_chain_kernel_28
rA_chain_kernel_26:
    v_pk_add_f32 v[96:97], v[64:65], v[68:69]
    v_pk_add_f32 v[98:99], v[66:67], v[70:71]
    v_pk_add_f32 v[100:101], v[72:73], v[76:77]
    v_pk_add_f32 v[102:103], v[74:75], v[78:79]
rj_chain_kernel_28:
    v_pk_add_f32 v[96:97], v[96:97], v[100:101]
    v_pk_add_f32 v[98:99], v[98:99], v[102:103]
    s_nop 1
    v_add_f32_dpp v100, v96, v96 row_ror:8 row_mask:0xf bank_mask:0xf
    v_add_f32_dpp v101, v97, v97 row_ror:8 row_mask:0xf bank_mask:0xf
    v_add_f32_dpp v102, v98, v98 row_ror:8 row_mask:0xf bank_mask:0xf
    v_add_f32_dpp v103, v99, v99 row_ror:8 row_mask:0xf bank_mask:0xf
    s_nop 1
    v_permlane16_swap_b32 v100, v102
    v_permlane16_swap_b32 v101, v103
    s_nop 0
    v_add_f32 v96, v100, v102
    v_add_f32 v97, v101, v103
    v_mov_b32 v98, v96
    v_mov_b32 v99, v97
    s_nop 1
    v_permlane32_swap_b32 v96, v98
    v_permlane32_swap_b32 v97, v99
    s_nop 0
    v_add_f32 v96, v96, v98
    v_add_f32 v97, v97, v99
    v_cvt_pk_bf16_f32 v104, v96, v97
    v_min_u32 v104, 0xfffffffe, v104
    v_add_u32 v7, s29, v3
    s_mov_b32 exec_lo, 0x00ff00ff
    s_mov_b32 exec_hi, 0
    global_store_dword v7, v104, s[4:5]
    v_mov_b32 v106, -1
    v_add_u32 v7, s34, v3
    global_store_dword v7, v106, s[4:5]
    s_mov_b64 exec, -1
    s_waitcnt vmcnt(2)
    s_cmp_lg_u32 s12, 0
    s_cbranch_scc1 nored_chain_kernel_15
nored_chain_kernel_15:
    s_add_u32 s13, s13, 1
    s_add_u32 s24, s24, 131072
    s_mov_b32 s34, s29
    s_add_u32 s20, s4, s29
    s_addc_u32 s21, s5, 0
    s_add_u32 s29, s29, 8192
    s_cmp_eq_u32 s29, 128999424
    s_cselect_b32 s29, 128974848, s29
    s_branch loop_chain_kernel_13
last_chain_kernel_24:
    s_nop 7
    s_nop 3
    v_permlane32_swap_b32 v80, v84
    v_permlane32_swap_b32 v81, v85
    v_permlane32_swap_b32 v82, v86
    v_permlane32_swap_b32 v83, v87
    s_nop 0
    v_pk_add_f32 v[80:81], v[80:81], v[84:85]
    v_pk_add_f32 v[82:83], v[82:83], v[86:87]
    v_cvt_pk_bf16_f32 v14, v80, v81
    v_cvt_pk_bf16_f32 v15, v82, v83
    ds_read_b128 v[120:123], v17
    global_store_dwordx2 v19, v[14:15], s[4:5] sc1
    s_lshl_b32 s22, s12, 10
    s_add_u32 s22, s22, s24
    v_add_u32 v18, s22, v5
    v_add_u32 v18, 71303168, v18
    s_waitcnt lgkmcnt(0)
    global_store_dwordx4 v18, v[120:123], s[4:5] sc1
    v_mov_b32 v7, 64
    v_mov_b32 v6, s36
    s_waitcnt vmcnt(0)
    s_mov_b64 exec, 1
    global_store_dword v6, v7, s[4:5] sc1
    s_mov_b64 exec, -1
done_chain_kernel_14:
dead_chain_kernel_16:
    s_endpgm
L_chain_kernel_6:
loop_chain_kernel_29:
    v_add_u32 v18, s25, v5
    v_add_u32 v19, 37748736, v18
    v_add_u32 v6, 4096, v19
    s_lshl_b32 s22, s12, 11
    v_add_u32 v18, s22, v18
    v_add_u32 v18, 54525952, v18
    global_load_dwordx4 v[24:27], v19, s[4:5] offset:0
    global_load_dwordx4 v[28:31], v19, s[4:5] offset:1024
    global_load_dwordx4 v[32:35], v19, s[4:5] offset:2048
    global_load_dwordx4 v[36:39], v19, s[4:5] offset:3072
    global_load_dwordx4 v[40:43], v6, s[4:5] offset:0
    global_load_dwordx4 v[44:47], v6, s[4:5] offset:1024
    global_load_dwordx4 v[48:51], v6, s[4:5] offset:2048
    global_load_dwordx4 v[52:55], v6, s[4:5] offset:3072
    global_load_dwordx4 v[56:59], v18, s[4:5]
    global_load_dwordx4 v[60:63], v18, s[4:5] offset:1024
    v_mov_b32 v64, 0
    v_mov_b32 v65, 0
    v_mov_b32 v66, 0
    v_mov_b32 v67, 0
    v_mov_b32 v68, 0
    v_mov_b32 v69, 0
    v_mov_b32 v70, 0
    v_mov_b32 v71, 0
    v_mov_b32 v72, 0
    v_mov_b32 v73, 0
    v_mov_b32 v74, 0
    v_mov_b32 v75, 0
    v_mov_b32 v76, 0
    v_mov_b32 v77, 0
    v_mov_b32 v78, 0
    v_mov_b32 v79, 0
    v_mov_b32 v80, 0
    v_mov_b32 v81, 0
    v_mov_b32 v82, 0
    v_mov_b32 v83, 0
    v_mov_b32 v84, 0
    v_mov_b32 v85, 0
    v_mov_b32 v86, 0
    v_mov_b32 v87, 0
gpoll_chain_kernel_33:
    global_load_dwordx4 v[120:123], v4, s[20:21] sc1
    global_load_dwordx4 v[124:127], v4, s[20:21] offset:1024 sc1
    s_waitcnt vmcnt(0)
    v_max3_u32 v6, v120, v121, v122
    v_max3_u32 v7, v123, v124, v125
    v_max3_u32 v6, v6, v126, v127
    v_max_u32 v6, v6, v7
    v_cmp_eq_u32 vcc, -1, v6
    s_cbranch_vccz gA_chain_kernel_34
    s_sub_u32 s40, s40, 1
    s_cbranch_scc1 dead_chain_kernel_32
    s_branch gpoll_chain_kernel_33
gokB_chain_kernel_35:
    ds_write_b128 v0, v[8:11]
    ds_write_b128 v0, v[12:15] offset:1040
    s_branch gdone_chain_kernel_36
gA_chain_kernel_34:
    ds_write_b128 v0, v[120:123]
    ds_write_b128 v0, v[124:127] offset:1040
gdone_chain_kernel_36:
    s_waitcnt lgkmcnt(0)
    s_barrier
    ds_read_b128 v[88:91], v1 offset:17408
    ds_read_b128 v[92:95], v1 offset:17536
    ds_read_b128 v[96:99], v1 offset:17664
    ds_read_b128 v[100:103], v1 offset:17792
    ds_read_b128 v[104:107], v1 offset:17920
    ds_read_b128 v[108:111], v1 offset:18048
    ds_read_b128 v[112:115], v1 offset:18176
    ds_read_b128 v[116:119], v1 offset:18304
    s_waitcnt lgkmcnt(7)
    v_smfmac_f32_16x16x64_bf16 v[64:67], v[88:91], a[0:7], v16
    v_smfmac_f32_16x16x64_bf16 v[68:71], v[88:91], a[64:71], v16
    v_smfmac_f32_16x16x64_bf16 v[72:75], v[88:91], a[128:135], v16
    v_smfmac_f32_16x16x64_bf16 v[76:79], v[88:91], a[192:199], v16
    s_waitcnt lgkmcnt(6)
    v_smfmac_f32_16x16x64_bf16 v[64:67], v[92:95], a[8:15], v16
    v_smfmac_f32_16x16x64_bf16 v[68:71], v[92:95], a[72:79], v16
    v_smfmac_f32_16x16x64_bf16 v[72:75], v[92:95], a[136:143], v16
    v_smfmac_f32_16x16x64_bf16 v[76:79], v[92:95], a[200:207], v16
    s_waitcnt lgkmcnt(5)
    v_smfmac_f32_16x16x64_bf16 v[64:67], v[96:99], a[16:23], v16
    v_smfmac_f32_16x16x64_bf16 v[68:71], v[96:99], a[80:87], v16
    v_smfmac_f32_16x16x64_bf16 v[72:75], v[96:99], a[144:151], v16
    v_smfmac_f32_16x16x64_bf16 v[76:79], v[96:99], a[208:215], v16
    s_waitcnt lgkmcnt(4)
    v_smfmac_f32_16x16x64_bf16 v[64:67], v[100:103], a[24:31], v16
    v_smfmac_f32_16x16x64_bf16 v[68:71], v[100:103], a[88:95], v16
    v_smfmac_f32_16x16x64_bf16 v[72:75], v[100:103], a[152:159], v16
    v_smfmac_f32_16x16x64_bf16 v[76:79], v[100:103], a[216:223], v16
    s_waitcnt vmcnt(0)
    s_cmp_ge_u32 s13, 62
    s_cbranch_scc1 tno_chain_kernel_37
    s_and_b32 s22, s13, 3
    s_cmp_lg_u32 s22, 2
    s_cbranch_scc1 tnf_chain_kernel_38
    v_mov_b32 v6, s35
kvw_chain_kernel_39:
    global_load_dword v7, v6, s[4:5] sc1
    s_waitcnt vmcnt(0)
    v_readfirstlane_b32 s22, v7
    s_sub_u32 s40, s40, 1
    s_cbranch_scc1 dead_chain_kernel_32
    s_cmp_lt_u32 s22, 2
    s_cbranch_scc1 kvw_chain_kernel_39
    s_add_u32 s35, s35, 128
tnf_chain_kernel_38:
    s_add_u32 s22, s25, s37
    v_lshlrev_b32 v6, 2, v5
    v_add_u32 v6, s22, v6
    global_load_dword v12, v6, s[4:5]
tno_chain_kernel_37:
    s_waitcnt lgkmcnt(3)
    v_smfmac_f32_16x16x64_bf16 v[64:67], v[104:107], a[32:39], v16
    v_smfmac_f32_16x16x64_bf16 v[68:71], v[104:107], a[96:103], v16
    v_smfmac_f32_16x16x64_bf16 v[72:75], v[104:107], a[160:167], v16
    v_smfmac_f32_16x16x64_bf16 v[76:79], v[104:107], a[224:231], v16
    s_waitcnt lgkmcnt(2)
    v_smfmac_f32_16x16x64_bf16 v[64:67], v[108:111], a[40:47], v16
    v_smfmac_f32_16x16x64_bf16 v[68:71], v[108:111], a[104:111], v16
    v_smfmac_f32_16x16x64_bf16 v[72:75], v[108:111], a[168:175], v16
    v_smfmac_f32_16x16x64_bf16 v[76:79], v[108:111], a[232:239], v16
    s_waitcnt lgkmcnt(1)
    v_smfmac_f32_16x16x64_bf16 v[64:67], v[112:115], a[48:55], v16
    v_smfmac_f32_16x16x64_bf16 v[68:71], v[112:115], a[112:119], v16
    v_smfmac_f32_16x16x64_bf16 v[72:75], v[112:115], a[176:183], v16
    v_smfmac_f32_16x16x64_bf16 v[76:79], v[112:115], a[240:247], v16
    s_waitcnt lgkmcnt(0)
    v_smfmac_f32_16x16x64_bf16 v[64:67], v[116:119], a[56:63], v16
    v_smfmac_f32_16x16x64_bf16 v[68:71], v[116:119], a[120:127], v16
    v_smfmac_f32_16x16x64_bf16 v[72:75], v[116:119], a[184:191], v16
    v_smfmac_f32_16x16x64_bf16 v[76:79], v[116:119], a[248:255], v16
    v_smfmac_f32_16x16x64_bf16 v[80:83], v[88:91], v[128:135], v16
    v_smfmac_f32_16x16x64_bf16 v[84:87], v[88:91], v[192:199], v16
    v_smfmac_f32_16x16x64_bf16 v[80:83], v[92:95], v[136:143], v16
    v_smfmac_f32_16x16x64_bf16 v[84:87], v[92:95], v[200:207], v16
    v_smfmac_f32_16x16x64_bf16 v[80:83], v[96:99], v[144:151], v16
    v_smfmac_f32_16x16x64_bf16 v[84:87], v[96:99], v[208:215], v16
    s_lshl_b32 s22, s12, 9
    s_lshr_b32 s23, s24, 1
    s_add_u32 s23, s23, s22
    v_lshrrev_b32 v19, 1, v5
    v_add_u32 v19, s23, v19
    v_add_u32 v19, 79691776, v19
    s_nop 1
    v_permlane32_swap_b32 v64, v72
    v_permlane32_swap_b32 v68, v76
    v_smfmac_f32_16x16x64_bf16 v[80:83], v[100:103], v[152:159], v16
    v_permlane32_swap_b32 v65, v73
    v_permlane32_swap_b32 v69, v77
    v_smfmac_f32_16x16x64_bf16 v[84:87], v[100:103], v[216:223], v16
    v_permlane32_swap_b32 v66, v74
    v_permlane32_swap_b32 v70, v78
    v_smfmac_f32_16x16x64_bf16 v[80:83], v[104:107], v[160:167], v16
    v_permlane32_swap_b32 v67, v75
    v_permlane32_swap_b32 v71, v79
    v_smfmac_f32_16x16x64_bf16 v[84:87], v[104:107], v[224:231], v16
    v_pk_add_f32 v[64:65], v[64:65], v[72:73]
    v_pk_add_f32 v[68:69], v[68:69], v[76:77]
    v_smfmac_f32_16x16x64_bf16 v[80:83], v[108:111], v[168:175], v16
    v_pk_add_f32 v[66:67], v[66:67], v[74:75]
    v_pk_add_f32 v[70:71], v[70:71], v[78:79]
    v_smfmac_f32_16x16x64_bf16 v[84:87], v[108:111], v[232:239], v16
    v_cvt_pk_bf16_f32 v6, v64, v68
    ds_write_b32 v20, v6 offset:0
    v_smfmac_f32_16x16x64_bf16 v[80:83], v[112:115], v[176:183], v16
    v_cvt_pk_bf16_f32 v7, v65, v69
    ds_write_b32 v20, v7 offset:272
    v_smfmac_f32_16x16x64_bf16 v[84:87], v[112:115], v[240:247], v16
    v_cvt_pk_bf16_f32 v8, v66, v70
    ds_write_b32 v20, v8 offset:544
    v_smfmac_f32_16x16x64_bf16 v[80:83], v[116:119], v[184:191], v16
    v_cvt_pk_bf16_f32 v9, v67, v71
    ds_write_b32 v20, v9 offset:816
    v_smfmac_f32_16x16x64_bf16 v[84:87], v[116:119], v[248:255], v16
    s_waitcnt lgkmcnt(0)
    s_barrier
    s_cmp_eq_u32 s13, 63
    s_cbranch_scc1 last_chain_kernel_40
    ds_read_b128 v[88:91], v21 offset:0
    ds_read_b128 v[104:107], v21 offset:2176
    ds_read_b128 v[92:95], v21 offset:64
    ds_read_b128 v[108:111], v21 offset:2240
    ds_read_b128 v[96:99], v21 offset:128
    ds_read_b128 v[112:115], v21 offset:2304
    ds_read_b128 v[100:103], v21 offset:192
    ds_read_b128 v[116:119], v21 offset:2368
    ds_read_b128 v[120:123], v17
    s_waitcnt lgkmcnt(7)
    v_mfma_f32_16x16x32_bf16 v[68:71], v[24:27], v[88:91], 0
    v_mfma_f32_16x16x32_bf16 v[72:75], v[40:43], v[88:91], 0
    v_mfma_f32_16x16x32_bf16 v[64:67], v[104:107], v[88:91], 0
    s_waitcnt lgkmcnt(5)
    v_mfma_f32_16x16x32_bf16 v[68:71], v[28:31], v[92:95], v[68:71]
    v_mfma_f32_16x16x32_bf16 v[72:75], v[44:47], v[92:95], v[72:75]
    v_mfma_f32_16x16x32_bf16 v[64:67], v[108:111], v[92:95], v[64:67]
    s_waitcnt lgkmcnt(3)
    v_mfma_f32_16x16x32_bf16 v[68:71], v[32:35], v[96:99], v[68:71]
    v_mfma_f32_16x16x32_bf16 v[72:75], v[48:51], v[96:99], v[72:75]
    v_mfma_f32_16x16x32_bf16 v[64:67], v[112:115], v[96:99], v[64:67]
    s_waitcnt lgkmcnt(1)
    v_mfma_f32_16x16x32_bf16 v[68:71], v[36:39], v[100:103], v[68:71]
    v_mfma_f32_16x16x32_bf16 v[72:75], v[52:55], v[100:103], v[72:75]
    v_mfma_f32_16x16x32_bf16 v[64:67], v[116:119], v[100:103], v[64:67]
    v_permlane32_swap_b32 v80, v84
    v_permlane32_swap_b32 v81, v85
    v_permlane32_swap_b32 v82, v86
    v_permlane32_swap_b32 v83, v87
    s_nop 0
    v_pk_add_f32 v[80:81], v[80:81], v[84:85]
    v_pk_add_f32 v[82:83], v[82:83], v[86:87]
    v_cvt_pk_bf16_f32 v14, v80, v81
    v_cvt_pk_bf16_f32 v15, v82, v83
    global_store_dwordx2 v19, v[14:15], s[4:5] sc1
    s_lshl_b32 s22, s12, 10
    s_add_u32 s22, s22, s24
    v_add_u32 v18, s22, v5
    v_add_u32 v18, 71303168, v18
    s_waitcnt lgkmcnt(0)
    global_store_dwordx4 v18, v[120:123], s[4:5] sc1
    ds_read_b128 v[76:79], v23 offset:0
    ds_read_b128 v[80:83], v23 offset:1024
    ds_read_b128 v[84:87], v23 offset:2048
    ds_read_b128 v[88:91], v23 offset:3072
    ds_read_b128 v[92:95], v23 offset:4096
    ds_read_b128 v[96:99], v23 offset:5120
    ds_read_b128 v[100:103], v23 offset:6144
    ds_read_b128 v[104:107], v23 offset:7168
    v_mov_b32 v7, 0xff800000
    v_cndmask_b32 v64, v64, v7, s[32:33]
    v_cndmask_b32 v65, v65, v7, s[32:33]
    v_cndmask_b32 v66, v66, v7, s[32:33]
    v_cndmask_b32 v67, v67, v7, s[32:33]
    v_max3_f32 v6, v64, v65, v66
    v_max3_f32 v8, v67, v68, v69
    v_max3_f32 v9, v70, v71, v72
    v_max3_f32 v10, v73, v74, v75
    v_max_f32 v6, v6, v8
    v_max_f32 v9, v9, v10
    v_max_f32 v6, v6, v9
    v_mov_b32 v7, v6
    v_mov_b32 v8, v6
    s_nop 1
    v_permlane32_swap_b32 v7, v8
    s_nop 1
    v_max_f32 v6, v7, v8
    v_mov_b32 v7, v6
    v_mov_b32 v8, v6
    s_nop 1
    v_permlane16_swap_b32 v7, v8
    s_nop 1
    v_max_f32 v6, v7, v8
    s_mov_b32 s22, 1040356334
    v_mul_f32 v6, s22, v6
    v_fma_f32 v64, v64, s22, -v6
    v_fma_f32 v65, v65, s22, -v6
    v_fma_f32 v66, v66, s22, -v6
    v_fma_f32 v67, v67, s22, -v6
    v_fma_f32 v68, v68, s22, -v6
    v_fma_f32 v69, v69, s22, -v6
    v_fma_f32 v70, v70, s22, -v6
    v_fma_f32 v71, v71, s22, -v6
    v_fma_f32 v72, v72, s22, -v6
    v_fma_f32 v73, v73, s22, -v6
    v_fma_f32 v74, v74, s22, -v6
    v_fma_f32 v75, v75, s22, -v6
    v_exp_f32 v64, v64
    ds_read_b128 v[108:111], v23 offset:8192
    v_exp_f32 v65, v65
    ds_read_b128 v[112:115], v23 offset:9216
    v_exp_f32 v66, v66
    ds_read_b128 v[116:119], v23 offset:10240
    v_exp_f32 v67, v67
    ds_read_b128 v[24:27], v23 offset:11264
    v_exp_f32 v68, v68
    ds_read_b128 v[28:31], v23 offset:12288
    v_exp_f32 v69, v69
    ds_read_b128 v[32:35], v23 offset:13312
    v_exp_f32 v70, v70
    ds_read_b128 v[36:39], v23 offset:14336
    v_exp_f32 v71, v71
    ds_read_b128 v[40:43], v23 offset:15360
    v_exp_f32 v72, v72
    ds_read_b128 v[44:47], v23 offset:16384
    v_exp_f32 v73, v73
    ds_read_b128 v[48:51], v23 offset:17408
    v_exp_f32 v74, v74
    ds_read_b128 v[52:55], v23 offset:18432
    v_exp_f32 v75, v75
    s_nop 0
    v_pk_add_f32 v[6:7], v[64:65], v[66:67]
    v_pk_add_f32 v[8:9], v[68:69], v[70:71]
    v_pk_add_f32 v[10:11], v[72:73], v[74:75]
    v_pk_add_f32 v[6:7], v[6:7], v[8:9]
    v_pk_add_f32 v[6:7], v[6:7], v[10:11]
    v_add_f32 v6, v6, v7
    v_mov_b32 v7, v6
    v_mov_b32 v8, v6
    s_nop 1
    v_permlane32_swap_b32 v7, v8
    s_nop 1
    v_add_f32 v6, v7, v8
    v_mov_b32 v7, v6
    v_mov_b32 v8, v6
    s_nop 1
    v_permlane16_swap_b32 v7, v8
    s_nop 1
    v_add_f32 v6, v7, v8
    v_rcp_f32 v6, v6
    s_nop 0
    v_mov_b32 v7, v6
    v_pk_mul_f32 v[64:65], v[64:65], v[6:7]
    v_pk_mul_f32 v[66:67], v[66:67], v[6:7]
    v_pk_mul_f32 v[68:69], v[68:69], v[6:7]
    v_pk_mul_f32 v[70:71], v[70:71], v[6:7]
    v_pk_mul_f32 v[72:73], v[72:73], v[6:7]
    v_pk_mul_f32 v[74:75], v[74:75], v[6:7]
    v_cvt_pk_bf16_f32 v120, v64, v65
    v_cvt_pk_bf16_f32 v121, v66, v67
    v_mov_b32 v122, 0
    v_mov_b32 v123, 0
    v_mov_b32 v8, v120
    v_mov_b32 v9, v121
    v_cvt_pk_bf16_f32 v124, v68, v69
    v_cvt_pk_bf16_f32 v125, v70, v71
    v_cvt_pk_bf16_f32 v126, v72, v73
    v_cvt_pk_bf16_f32 v127, v74, v75
    v_permlane32_swap_b32 v122, v8
    v_permlane32_swap_b32 v123, v9
    s_nop 1
    v_mfma_f32_16x16x32_bf16 v[64:67], v[56:59], v[124:127], 0
    v_mfma_f32_16x16x32_bf16 v[68:71], v[60:63], v[124:127], 0
    v_mfma_f32_16x16x16_bf16 v[64:67], v[14:15], v[120:121], v[64:67]
    v_mfma_f32_16x16x16_bf16 v[68:71], v[14:15], v[122:123], v[68:71]
    v_mov_b32 v7, s13
    v_mov_b32 v6, s36
    s_mov_b64 exec, 1
    global_store_dword v6, v7, s[4:5] sc1
    s_mov_b64 exec, -1
    s_bfe_u32 s41, s13, 0x10001
    s_and_b32 s22, s13, 1
    s_lshl_b32 s22, s22, 19
    s_add_u32 s22, s22, s27
    v_add_u32 v18, s22, v2
    s_nop 4
    v_cvt_pk_bf16_f32 v72, v64, v65
    v_cvt_pk_bf16_f32 v73, v66, v67
    v_cvt_pk_bf16_f32 v74, v68, v69
    v_cvt_pk_bf16_f32 v75, v70, v71
    ds_write_b128 v22, v[72:75]
    s_waitcnt lgkmcnt(0)
    s_barrier
    ds_read_b128 v[56:59], v5 offset:12288
    ds_read_b128 v[60:63], v5 offset:13312
    ds_read_b128 v[64:67], v5 offset:14336
    ds_read_b128 v[68:71], v5 offset:15360
    s_waitcnt lgkmcnt(0)
    v_mfma_f32_16x16x32_bf16 v[8:11], v[76:79], v[56:59], 0
    ds_read_b128 v[76:79], v23 offset:19456
    v_mfma_f32_16x16x32_bf16 v[8:11], v[80:83], v[60:63], v[8:11]
    ds_read_b128 v[80:83], v23 offset:20480
    v_mfma_f32_16x16x32_bf16 v[8:11], v[84:87], v[64:67], v[8:11]
    ds_read_b128 v[84:87], v23 offset:21504
    v_mfma_f32_16x16x32_bf16 v[8:11], v[88:91], v[68:71], v[8:11]
    ds_read_b128 v[88:91], v23 offset:22528
    v_mfma_f32_16x16x32_bf16 v[120:123], v[92:95], v[56:59], 0
    ds_read_b128 v[92:95], v23 offset:23552
    v_mfma_f32_16x16x32_bf16 v[120:123], v[96:99], v[60:63], v[120:123]
    ds_read_b128 v[96:99], v23 offset:24576
    v_mfma_f32_16x16x32_bf16 v[120:123], v[100:103], v[64:67], v[120:123]
    ds_read_b128 v[100:103], v23 offset:25600
    v_mfma_f32_16x16x32_bf16 v[120:123], v[104:107], v[68:71], v[120:123]
    ds_read_b128 v[104:107], v23 offset:26624
    v_bfi_b32 v8, 1, s41, v8
    s_mov_b64 exec, s[30:31]
    global_store_dwordx4 v18, v[8:11], s[4:5] sc1
    s_mov_b64 exec, -1
    v_add_u32 v18, 16384, v18
    v_mfma_f32_16x16x32_bf16 v[124:127], v[108:111], v[56:59], 0
    ds_read_b128 v[108:111], v23 offset:27648
    v_mfma_f32_16x16x32_bf16 v[124:127], v[112:115], v[60:63], v[124:127]
    ds_read_b128 v[112:115], v23 offset:28672
    v_mfma_f32_16x16x32_bf16 v[124:127], v[116:119], v[64:67], v[124:127]
    ds_read_b128 v[116:119], v23 offset:29696
    v_mfma_f32_16x16x32_bf16 v[124:127], v[24:27], v[68:71], v[124:127]
    ds_read_b128 v[24:27], v23 offset:30720
    v_bfi_b32 v120, 1, s41, v120
    s_mov_b64 exec, s[30:31]
    global_store_dwordx4 v18, v[120:123], s[4:5] sc1
    s_mov_b64 exec, -1
    v_add_u32 v18, 16384, v18
    v_mfma_f32_16x16x32_bf16 v[72:75], v[28:31], v[56:59], 0
    ds_read_b128 v[28:31], v23 offset:31744
    v_mfma_f32_16x16x32_bf16 v[72:75], v[32:35], v[60:63], v[72:75]
    v_mfma_f32_16x16x32_bf16 v[72:75], v[36:39], v[64:67], v[72:75]
    v_mfma_f32_16x16x32_bf16 v[72:75], v[40:43], v[68:71], v[72:75]
    v_bfi_b32 v124, 1, s41, v124
    s_mov_b64 exec, s[30:31]
    global_store_dwordx4 v18, v[124:127], s[4:5] sc1
    s_mov_b64 exec, -1
    v_add_u32 v18, 16384, v18
    v_mfma_f32_16x16x32_bf16 v[8:11], v[44:47], v[56:59], 0
    v_mfma_f32_16x16x32_bf16 v[8:11], v[48:51], v[60:63], v[8:11]
    v_mfma_f32_16x16x32_bf16 v[8:11], v[52:55], v[64:67], v[8:11]
    s_waitcnt lgkmcnt(12)
    v_mfma_f32_16x16x32_bf16 v[8:11], v[76:79], v[68:71], v[8:11]
    v_bfi_b32 v72, 1, s41, v72
    s_mov_b64 exec, s[30:31]
    global_store_dwordx4 v18, v[72:75], s[4:5] sc1
    s_mov_b64 exec, -1
    v_add_u32 v18, 16384, v18
    s_waitcnt lgkmcnt(11)
    v_mfma_f32_16x16x32_bf16 v[120:123], v[80:83], v[56:59], 0
    s_waitcnt lgkmcnt(10)
    v_mfma_f32_16x16x32_bf16 v[120:123], v[84:87], v[60:63], v[120:123]
    s_waitcnt lgkmcnt(9)
    v_mfma_f32_16x16x32_bf16 v[120:123], v[88:91], v[64:67], v[120:123]
    s_waitcnt lgkmcnt(8)
    v_mfma_f32_16x16x32_bf16 v[120:123], v[92:95], v[68:71], v[120:123]
    v_bfi_b32 v8, 1, s41, v8
    s_mov_b64 exec, s[30:31]
    global_store_dwordx4 v18, v[8:11], s[4:5] sc1
    s_mov_b64 exec, -1
    v_add_u32 v18, 16384, v18
    s_waitcnt lgkmcnt(7)
    v_mfma_f32_16x16x32_bf16 v[124:127], v[96:99], v[56:59], 0
    s_waitcnt lgkmcnt(6)
    v_mfma_f32_16x16x32_bf16 v[124:127], v[100:103], v[60:63], v[124:127]
    s_waitcnt lgkmcnt(5)
    v_mfma_f32_16x16x32_bf16 v[124:127], v[104:107], v[64:67], v[124:127]
    s_waitcnt lgkmcnt(4)
    v_mfma_f32_16x16x32_bf16 v[124:127], v[108:111], v[68:71], v[124:127]
    v_bfi_b32 v120, 1, s41, v120
    s_mov_b64 exec, s[30:31]
    global_store_dwordx4 v18, v[120:123], s[4:5] sc1
    s_mov_b64 exec, -1
    v_add_u32 v18, 16384, v18
    s_waitcnt lgkmcnt(3)
    v_mfma_f32_16x16x32_bf16 v[72:75], v[112:115], v[56:59], 0
    s_waitcnt lgkmcnt(2)
    v_mfma_f32_16x16x32_bf16 v[72:75], v[116:119], v[60:63], v[72:75]
    s_waitcnt lgkmcnt(1)
    v_mfma_f32_16x16x32_bf16 v[72:75], v[24:27], v[64:67], v[72:75]
    s_waitcnt lgkmcnt(0)
    v_mfma_f32_16x16x32_bf16 v[72:75], v[28:31], v[68:71], v[72:75]
    v_bfi_b32 v124, 1, s41, v124
    s_mov_b64 exec, s[30:31]
    global_store_dwordx4 v18, v[124:127], s[4:5] sc1
    s_mov_b64 exec, -1
    v_add_u32 v18, 16384, v18
    s_nop 7
    v_bfi_b32 v72, 1, s41, v72
    s_mov_b64 exec, s[30:31]
    global_store_dwordx4 v18, v[72:75], s[4:5] sc1
    s_mov_b64 exec, -1
    v_add_u32 v18, 16384, v18
    s_add_u32 s25, s25, 262144
    s_and_b32 s22, s13, 1
    s_lshl_b32 s22, s22, 19
    s_add_u32 s22, s22, s28
    v_add_u32 v18, s22, v5
redpoll_chain_kernel_41:
    global_load_dwordx4 v[64:67], v18, s[4:5] offset:0 sc1
    global_load_dwordx4 v[68:71], v18, s[4:5] offset:1024 sc1
    global_load_dwordx4 v[72:75], v18, s[4:5] offset:2048 sc1
    global_load_dwordx4 v[76:79], v18, s[4:5] offset:3072 sc1
    s_waitcnt vmcnt(0)
    v_xor_b32 v6, s41, v64
    v_xor_b32 v7, s41, v68
    v_xor_b32 v112, s41, v72
    v_xor_b32 v113, s41, v76
    v_or3_b32 v6, v6, v7, v112
    v_or_b32 v6, v6, v113
    v_and_b32 v6, 1, v6
    v_cmp_ne_u32 vcc, 0, v6
    s_cbranch_vccz rA_chain_kernel_42
    s_sub_u32 s40, s40, 1
    s_cbranch_scc1 dead_chain_kernel_32
    s_branch redpoll_chain_kernel_41
rB_chain_kernel_43:
    v_pk_add_f32 v[96:97], v[80:81], v[84:85]
    v_pk_add_f32 v[98:99], v[82:83], v[86:87]
    v_pk_add_f32 v[100:101], v[88:89], v[92:93]
    v_pk_add_f32 v[102:103], v[90:91], v[94:95]
    s_branch rj_chain_kernel_44
rA_chain_kernel_42:
    v_pk_add_f32 v[96:97], v[64:65], v[68:69]
    v_pk_add_f32 v[98:99], v[66:67], v[70:71]
    v_pk_add_f32 v[100:101], v[72:73], v[76:77]
    v_pk_add_f32 v[102:103], v[74:75], v[78:79]
rj_chain_kernel_44:
    v_pk_add_f32 v[96:97], v[96:97], v[100:101]
    v_pk_add_f32 v[98:99], v[98:99], v[102:103]
    s_nop 1
    v_add_f32_dpp v100, v96, v96 row_ror:8 row_mask:0xf bank_mask:0xf
    v_add_f32_dpp v101, v97, v97 row_ror:8 row_mask:0xf bank_mask:0xf
    v_add_f32_dpp v102, v98, v98 row_ror:8 row_mask:0xf bank_mask:0xf
    v_add_f32_dpp v103, v99, v99 row_ror:8 row_mask:0xf bank_mask:0xf
    s_nop 1
    v_permlane16_swap_b32 v100, v102
    v_permlane16_swap_b32 v101, v103
    s_nop 0
    v_add_f32 v96, v100, v102
    v_add_f32 v97, v101, v103
    v_mov_b32 v98, v96
    v_mov_b32 v99, v97
    s_nop 1
    v_permlane32_swap_b32 v96, v98
    v_permlane32_swap_b32 v97, v99
    s_nop 0
    v_add_f32 v96, v96, v98
    v_add_f32 v97, v97, v99
    v_cvt_pk_bf16_f32 v104, v96, v97
    v_min_u32 v104, 0xfffffffe, v104
    v_add_u32 v7, s29, v3
    s_mov_b32 exec_lo, 0x00ff00ff
    s_mov_b32 exec_hi, 0
    global_store_dword v7, v104, s[4:5] sc1
    v_mov_b32 v106, -1
    v_add_u32 v7, s34, v3
    global_store_dword v7, v106, s[4:5] sc1
    s_mov_b64 exec, -1
    s_waitcnt vmcnt(2)
    s_cmp_lg_u32 s12, 0
    s_cbranch_scc1 nored_chain_kernel_31
nored_chain_kernel_31:
    s_add_u32 s13, s13, 1
    s_add_u32 s24, s24, 131072
    s_mov_b32 s34, s29
    s_add_u32 s20, s4, s29
    s_addc_u32 s21, s5, 0
    s_add_u32 s29, s29, 8192
    s_cmp_eq_u32 s29, 128999424
    s_cselect_b32 s29, 128974848, s29
    s_branch loop_chain_kernel_29
last_chain_kernel_40:
    s_nop 7
    s_nop 3
    v_permlane32_swap_b32 v80, v84
    v_permlane32_swap_b32 v81, v85
    v_permlane32_swap_b32 v82, v86
    v_permlane32_swap_b32 v83, v87
    s_nop 0
    v_pk_add_f32 v[80:81], v[80:81], v[84:85]
    v_pk_add_f32 v[82:83], v[82:83], v[86:87]
    v_cvt_pk_bf16_f32 v14, v80, v81
    v_cvt_pk_bf16_f32 v15, v82, v83
    ds_read_b128 v[120:123], v17
    global_store_dwordx2 v19, v[14:15], s[4:5] sc1
    s_lshl_b32 s22, s12, 10
    s_add_u32 s22, s22, s24
    v_add_u32 v18, s22, v5
    v_add_u32 v18, 71303168, v18
    s_waitcnt lgkmcnt(0)
    global_store_dwordx4 v18, v[120:123], s[4:5] sc1
    v_mov_b32 v7, 64
    v_mov_b32 v6, s36
    s_waitcnt vmcnt(0)
    s_mov_b64 exec, 1
    global_store_dword v6, v7, s[4:5] sc1
    s_mov_b64 exec, -1
done_chain_kernel_30:
dead_chain_kernel_32:
    s_endpgm
L_chain_kernel_1:
    s_endpgm
L_chain_kernel_11:
    s_mov_b32 s36, s8
    s_mov_b32 s37, s9
    v_and_b32 v1, 63, v0
    v_bfe_u32 v2, v0, 4, 2
    v_and_b32 v3, 15, v0
    s_mov_b32 s8, s4
    s_and_b32 s9, s5, 0xffff
    s_mov_b32 s10, 0x10000000
    s_mov_b32 s11, 0x00020000
    v_mov_b32 v200, 131136
    s_mov_b32 s51, 2047
w_chain_kernel_45:
    s_barrier
    s_cmp_lg_u32 s12, 0
    s_cbranch_scc1 w_chain_kernel_48
    s_mov_b64 exec, 1
    v_mov_b32 v6, 128
    v_mov_b32 v7, 1
    global_atomic_add v6, v6, v7, s[36:37] sc0
    s_waitcnt vmcnt(0)
    ds_write_b32 v200, v6
    s_mov_b64 exec, -1
w_chain_kernel_48:
    s_waitcnt lgkmcnt(0)
    s_barrier
    ds_read_b32 v6, v200
    s_waitcnt lgkmcnt(0)
    v_readfirstlane_b32 s38, v6
    s_nop 3
    s_mov_b32 s51, s38
    s_cmp_ge_u32 s38, 1792
    s_cbranch_scc1 w_chain_kernel_46
    s_cmp_lt_u32 s38, 1024
    s_cbranch_scc1 w_chain_kernel_53
    s_sub_u32 s38, s38, 1024
    s_mul_i32 s20, s38, 43691
    s_lshr_b32 s20, s20, 21
    s_mov_b32 s41, s20
    s_mov_b32 s43, 0
    s_mul_i32 s21, s20, 48
    s_sub_u32 s39, s38, s21
    s_cmp_ge_u32 s39, 32
    s_cbranch_scc1 w_chain_kernel_47
    s_lshl_b32 s24, s20, 17
    s_add_u32 s24, s24, 18874368
    s_mul_i32 s25, s39, 393216
    s_add_u32 s25, s25, 0
    s_and_b32 s13, s12, 1
    s_mul_i32 s14, s13, 65536
    s_add_u32 s14, s14, s24
    s_mul_i32 s15, s13, 65536
    s_add_u32 s15, s15, s25
    s_cmp_lt_u32 s12, 2
    s_cselect_b32 s14, s14, s15
    v_lshlrev_b32 v8, 4, v1
    v_add_u32 v4, s14, v8
    s_mov_b32 s16, 15360
    s_mov_b32 s17, 15360
    s_cselect_b32 s16, s16, s17
    v_add_u32 v5, s16, v4
    s_mov_b32 s16, 30720
    s_mov_b32 s17, 30720
    s_cselect_b32 s16, s16, s17
    v_add_u32 v6, s16, v4
    s_mov_b32 s16, 46080
    s_mov_b32 s17, 46080
    s_cselect_b32 s16, s16, s17
    v_add_u32 v7, s16, v4
    s_lshl_b32 s17, s12, 12
    s_lshr_b32 s18, s12, 1
    s_lshl_b32 s18, s18, 12
    v_add_u32 v9, s18, v8
    s_lshl_b32 s19, s13, 12
    v_add_u32 v10, s19, v8
    v_add_u32 v10, 8192, v10
    s_lshl_b32 s18, s12, 11
    v_add_u32 v9, s18, v8
    v_add_u32 v10, 8192, v8
    v_add_u32 v11, 65536, v9
    v_add_u32 v12, 65536, v10
    v_mov_b32 v64, 0
    v_mov_b32 v65, 0
    v_mov_b32 v66, 0
    v_mov_b32 v67, 0
    v_mov_b32 v68, 0
    v_mov_b32 v69, 0
    v_mov_b32 v70, 0
    v_mov_b32 v71, 0
    v_mov_b32 v72, 0
    v_mov_b32 v73, 0
    v_mov_b32 v74, 0
    v_mov_b32 v75, 0
    v_mov_b32 v76, 0
    v_mov_b32 v77, 0
    v_mov_b32 v78, 0
    v_mov_b32 v79, 0
    v_mov_b32 v80, 0
    v_mov_b32 v81, 0
    v_mov_b32 v82, 0
    v_mov_b32 v83, 0
    v_mov_b32 v84, 0
    v_mov_b32 v85, 0
    v_mov_b32 v86, 0
    v_mov_b32 v87, 0
    v_mov_b32 v88, 0
    v_mov_b32 v89, 0
    v_mov_b32 v90, 0
    v_mov_b32 v91, 0
    v_mov_b32 v92, 0
    v_mov_b32 v93, 0
    v_mov_b32 v94, 0
    v_mov_b32 v95, 0
    v_mov_b32 v96, 0
    v_mov_b32 v97, 0
    v_mov_b32 v98, 0
    v_mov_b32 v99, 0
    v_mov_b32 v100, 0
    v_mov_b32 v101, 0
    v_mov_b32 v102, 0
    v_mov_b32 v103, 0
    v_mov_b32 v104, 0
    v_mov_b32 v105, 0
    v_mov_b32 v106, 0
    v_mov_b32 v107, 0
    v_mov_b32 v108, 0
    v_mov_b32 v109, 0
    v_mov_b32 v110, 0
    v_mov_b32 v111, 0
    v_mov_b32 v112, 0
    v_mov_b32 v113, 0
    v_mov_b32 v114, 0
    v_mov_b32 v115, 0
    v_mov_b32 v116, 0
    v_mov_b32 v117, 0
    v_mov_b32 v118, 0
    v_mov_b32 v119, 0
    v_mov_b32 v120, 0
    v_mov_b32 v121, 0
    v_mov_b32 v122, 0
    v_mov_b32 v123, 0
    v_mov_b32 v124, 0
    v_mov_b32 v125, 0
    v_mov_b32 v126, 0
    v_mov_b32 v127, 0
    s_add_u32 s13, s17, 0
    s_mov_b32 m0, s13
    s_mov_b32 s13, 0
    buffer_load_dwordx4 v4, s[8:11], s13 offen offset:0 lds
    buffer_load_dwordx4 v5, s[8:11], s13 offen offset:1024 lds
    buffer_load_dwordx4 v6, s[8:11], s13 offen offset:2048 lds
    buffer_load_dwordx4 v7, s[8:11], s13 offen offset:3072 lds
    s_add_u32 s13, s17, 16384
    s_mov_b32 m0, s13
    s_mov_b32 s13, 1024
    buffer_load_dwordx4 v4, s[8:11], s13 offen offset:0 lds
    buffer_load_dwordx4 v5, s[8:11], s13 offen offset:1024 lds
    buffer_load_dwordx4 v6, s[8:11], s13 offen offset:2048 lds
    buffer_load_dwordx4 v7, s[8:11], s13 offen offset:3072 lds
    s_add_u32 s13, s17, 32768
    s_mov_b32 m0, s13
    s_mov_b32 s13, 2048
    buffer_load_dwordx4 v4, s[8:11], s13 offen offset:0 lds
    buffer_load_dwordx4 v5, s[8:11], s13 offen offset:1024 lds
    buffer_load_dwordx4 v6, s[8:11], s13 offen offset:2048 lds
    buffer_load_dwordx4 v7, s[8:11], s13 offen offset:3072 lds
    s_add_u32 s13, s17, 49152
    s_mov_b32 m0, s13
    s_mov_b32 s13, 3072
    buffer_load_dwordx4 v4, s[8:11], s13 offen offset:0 lds
    buffer_load_dwordx4 v5, s[8:11], s13 offen offset:1024 lds
    buffer_load_dwordx4 v6, s[8:11], s13 offen offset:2048 lds
    buffer_load_dwordx4 v7, s[8:11], s13 offen offset:3072 lds
    s_add_u32 s13, s17, 65536
    s_mov_b32 m0, s13
    s_mov_b32 s13, 4096
    buffer_load_dwordx4 v4, s[8:11], s13 offen offset:0 lds
    buffer_load_dwordx4 v5, s[8:11], s13 offen offset:1024 lds
    buffer_load_dwordx4 v6, s[8:11], s13 offen offset:2048 lds
    buffer_load_dwordx4 v7, s[8:11], s13 offen offset:3072 lds
    s_add_u32 s13, s17, 81920
    s_mov_b32 m0, s13
    s_mov_b32 s13, 5120
    buffer_load_dwordx4 v4, s[8:11], s13 offen offset:0 lds
    buffer_load_dwordx4 v5, s[8:11], s13 offen offset:1024 lds
    buffer_load_dwordx4 v6, s[8:11], s13 offen offset:2048 lds
    buffer_load_dwordx4 v7, s[8:11], s13 offen offset:3072 lds
    s_add_u32 s13, s17, 98304
    s_mov_b32 m0, s13
    s_mov_b32 s13, 6144
    buffer_load_dwordx4 v4, s[8:11], s13 offen offset:0 lds
    buffer_load_dwordx4 v5, s[8:11], s13 offen offset:1024 lds
    buffer_load_dwordx4 v6, s[8:11], s13 offen offset:2048 lds
    buffer_load_dwordx4 v7, s[8:11], s13 offen offset:3072 lds
    s_waitcnt vmcnt(24)
    s_barrier
    ds_read_b128 v[24:27], v9 offset:0
    ds_read_b128 v[28:31], v9 offset:1024
    ds_read_b128 v[32:35], v10 offset:0
    ds_read_b128 v[36:39], v10 offset:1024
    ds_read_b128 v[40:43], v10 offset:2048
    ds_read_b128 v[44:47], v10 offset:3072
    ds_read_b128 v[48:51], v10 offset:4096
    ds_read_b128 v[52:55], v10 offset:5120
    ds_read_b128 v[56:59], v10 offset:6144
    ds_read_b128 v[60:63], v10 offset:7168
    s_waitcnt vmcnt(20)
    s_barrier
    s_add_u32 s13, s17, 114688
    s_mov_b32 m0, s13
    s_mov_b32 s13, 7168
    buffer_load_dwordx4 v4, s[8:11], s13 offen offset:0 lds
    buffer_load_dwordx4 v5, s[8:11], s13 offen offset:1024 lds
    buffer_load_dwordx4 v6, s[8:11], s13 offen offset:2048 lds
    buffer_load_dwordx4 v7, s[8:11], s13 offen offset:3072 lds
    ds_read_b128 v[128:131], v9 offset:16384
    ds_read_b128 v[132:135], v9 offset:17408
    ds_read_b128 v[136:139], v10 offset:16384
    ds_read_b128 v[140:143], v10 offset:17408
    ds_read_b128 v[144:147], v10 offset:18432
    ds_read_b128 v[148:151], v10 offset:19456
    ds_read_b128 v[152:155], v10 offset:20480
    ds_read_b128 v[156:159], v10 offset:21504
    ds_read_b128 v[160:163], v10 offset:22528
    ds_read_b128 v[164:167], v10 offset:23552
    s_waitcnt lgkmcnt(10)
    v_mfma_f32_16x16x32_bf16 v[64:67], v[32:35], v[24:27], v[64:67]
    v_mfma_f32_16x16x32_bf16 v[68:71], v[36:39], v[24:27], v[68:71]
    v_mfma_f32_16x16x32_bf16 v[72:75], v[40:43], v[24:27], v[72:75]
    v_mfma_f32_16x16x32_bf16 v[76:79], v[44:47], v[24:27], v[76:79]
    v_mfma_f32_16x16x32_bf16 v[80:83], v[48:51], v[24:27], v[80:83]
    v_mfma_f32_16x16x32_bf16 v[84:87], v[52:55], v[24:27], v[84:87]
    v_mfma_f32_16x16x32_bf16 v[88:91], v[56:59], v[24:27], v[88:91]
    v_mfma_f32_16x16x32_bf16 v[92:95], v[60:63], v[24:27], v[92:95]
    v_mfma_f32_16x16x32_bf16 v[96:99], v[32:35], v[28:31], v[96:99]
    v_mfma_f32_16x16x32_bf16 v[100:103], v[36:39], v[28:31], v[100:103]
    v_mfma_f32_16x16x32_bf16 v[104:107], v[40:43], v[28:31], v[104:107]
    v_mfma_f32_16x16x32_bf16 v[108:111], v[44:47], v[28:31], v[108:111]
    v_mfma_f32_16x16x32_bf16 v[112:115], v[48:51], v[28:31], v[112:115]
    v_mfma_f32_16x16x32_bf16 v[116:119], v[52:55], v[28:31], v[116:119]
    v_mfma_f32_16x16x32_bf16 v[120:123], v[56:59], v[28:31], v[120:123]
    v_mfma_f32_16x16x32_bf16 v[124:127], v[60:63], v[28:31], v[124:127]
    s_waitcnt vmcnt(20)
    s_barrier
    s_add_u32 s13, s17, 0
    s_mov_b32 m0, s13
    s_mov_b32 s13, 8192
    buffer_load_dwordx4 v4, s[8:11], s13 offen offset:0 lds
    buffer_load_dwordx4 v5, s[8:11], s13 offen offset:1024 lds
    buffer_load_dwordx4 v6, s[8:11], s13 offen offset:2048 lds
    buffer_load_dwordx4 v7, s[8:11], s13 offen offset:3072 lds
    ds_read_b128 v[24:27], v9 offset:32768
    ds_read_b128 v[28:31], v9 offset:33792
    ds_read_b128 v[32:35], v10 offset:32768
    ds_read_b128 v[36:39], v10 offset:33792
    ds_read_b128 v[40:43], v10 offset:34816
    ds_read_b128 v[44:47], v10 offset:35840
    ds_read_b128 v[48:51], v10 offset:36864
    ds_read_b128 v[52:55], v10 offset:37888
    ds_read_b128 v[56:59], v10 offset:38912
    ds_read_b128 v[60:63], v10 offset:39936
    s_waitcnt lgkmcnt(10)
    v_mfma_f32_16x16x32_bf16 v[64:67], v[136:139], v[128:131], v[64:67]
    v_mfma_f32_16x16x32_bf16 v[68:71], v[140:143], v[128:131], v[68:71]
    v_mfma_f32_16x16x32_bf16 v[72:75], v[144:147], v[128:131], v[72:75]
    v_mfma_f32_16x16x32_bf16 v[76:79], v[148:151], v[128:131], v[76:79]
    v_mfma_f32_16x16x32_bf16 v[80:83], v[152:155], v[128:131], v[80:83]
    v_mfma_f32_16x16x32_bf16 v[84:87], v[156:159], v[128:131], v[84:87]
    v_mfma_f32_16x16x32_bf16 v[88:91], v[160:163], v[128:131], v[88:91]
    v_mfma_f32_16x16x32_bf16 v[92:95], v[164:167], v[128:131], v[92:95]
    v_mfma_f32_16x16x32_bf16 v[96:99], v[136:139], v[132:135], v[96:99]
    v_mfma_f32_16x16x32_bf16 v[100:103], v[140:143], v[132:135], v[100:103]
    v_mfma_f32_16x16x32_bf16 v[104:107], v[144:147], v[132:135], v[104:107]
    v_mfma_f32_16x16x32_bf16 v[108:111], v[148:151], v[132:135], v[108:111]
    v_mfma_f32_16x16x32_bf16 v[112:115], v[152:155], v[132:135], v[112:115]
    v_mfma_f32_16x16x32_bf16 v[116:119], v[156:159], v[132:135], v[116:119]
    v_mfma_f32_16x16x32_bf16 v[120:123], v[160:163], v[132:135], v[120:123]
    v_mfma_f32_16x16x32_bf16 v[124:127], v[164:167], v[132:135], v[124:127]
    s_waitcnt vmcnt(20)
    s_barrier
    s_add_u32 s13, s17, 16384
    s_mov_b32 m0, s13
    s_mov_b32 s13, 9216
    buffer_load_dwordx4 v4, s[8:11], s13 offen offset:0 lds
    buffer_load_dwordx4 v5, s[8:11], s13 offen offset:1024 lds
    buffer_load_dwordx4 v6, s[8:11], s13 offen offset:2048 lds
    buffer_load_dwordx4 v7, s[8:11], s13 offen offset:3072 lds
    ds_read_b128 v[128:131], v9 offset:49152
    ds_read_b128 v[132:135], v9 offset:50176
    ds_read_b128 v[136:139], v10 offset:49152
    ds_read_b128 v[140:143], v10 offset:50176
    ds_read_b128 v[144:147], v10 offset:51200
    ds_read_b128 v[148:151], v10 offset:52224
    ds_read_b128 v[152:155], v10 offset:53248
    ds_read_b128 v[156:159], v10 offset:54272
    ds_read_b128 v[160:163], v10 offset:55296
    ds_read_b128 v[164:167], v10 offset:56320
    s_waitcnt lgkmcnt(10)
    v_mfma_f32_16x16x32_bf16 v[64:67], v[32:35], v[24:27], v[64:67]
    v_mfma_f32_16x16x32_bf16 v[68:71], v[36:39], v[24:27], v[68:71]
    v_mfma_f32_16x16x32_bf16 v[72:75], v[40:43], v[24:27], v[72:75]
    v_mfma_f32_16x16x32_bf16 v[76:79], v[44:47], v[24:27], v[76:79]
    v_mfma_f32_16x16x32_bf16 v[80:83], v[48:51], v[24:27], v[80:83]
    v_mfma_f32_16x16x32_bf16 v[84:87], v[52:55], v[24:27], v[84:87]
    v_mfma_f32_16x16x32_bf16 v[88:91], v[56:59], v[24:27], v[88:91]
    v_mfma_f32_16x16x32_bf16 v[92:95], v[60:63], v[24:27], v[92:95]
    v_mfma_f32_16x16x32_bf16 v[96:99], v[32:35], v[28:31], v[96:99]
    v_mfma_f32_16x16x32_bf16 v[100:103], v[36:39], v[28:31], v[100:103]
    v_mfma_f32_16x16x32_bf16 v[104:107], v[40:43], v[28:31], v[104:107]
    v_mfma_f32_16x16x32_bf16 v[108:111], v[44:47], v[28:31], v[108:111]
    v_mfma_f32_16x16x32_bf16 v[112:115], v[48:51], v[28:31], v[112:115]
    v_mfma_f32_16x16x32_bf16 v[116:119], v[52:55], v[28:31], v[116:119]
    v_mfma_f32_16x16x32_bf16 v[120:123], v[56:59], v[28:31], v[120:123]
    v_mfma_f32_16x16x32_bf16 v[124:127], v[60:63], v[28:31], v[124:127]
    s_waitcnt vmcnt(20)
    s_barrier
    s_add_u32 s13, s17, 32768
    s_mov_b32 m0, s13
    s_mov_b32 s13, 10240
    buffer_load_dwordx4 v4, s[8:11], s13 offen offset:0 lds
    buffer_load_dwordx4 v5, s[8:11], s13 offen offset:1024 lds
    buffer_load_dwordx4 v6, s[8:11], s13 offen offset:2048 lds
    buffer_load_dwordx4 v7, s[8:11], s13 offen offset:3072 lds
    ds_read_b128 v[24:27], v11 offset:0
    ds_read_b128 v[28:31], v11 offset:1024
    ds_read_b128 v[32:35], v12 offset:0
    ds_read_b128 v[36:39], v12 offset:1024
    ds_read_b128 v[40:43], v12 offset:2048
    ds_read_b128 v[44:47], v12 offset:3072
    ds_read_b128 v[48:51], v12 offset:4096
    ds_read_b128 v[52:55], v12 offset:5120
    ds_read_b128 v[56:59], v12 offset:6144
    ds_read_b128 v[60:63], v12 offset:7168
    s_waitcnt lgkmcnt(10)
    v_mfma_f32_16x16x32_bf16 v[64:67], v[136:139], v[128:131], v[64:67]
    v_mfma_f32_16x16x32_bf16 v[68:71], v[140:143], v[128:131], v[68:71]
    v_mfma_f32_16x16x32_bf16 v[72:75], v[144:147], v[128:131], v[72:75]
    v_mfma_f32_16x16x32_bf16 v[76:79], v[148:151], v[128:131], v[76:79]
    v_mfma_f32_16x16x32_bf16 v[80:83], v[152:155], v[128:131], v[80:83]
    v_mfma_f32_16x16x32_bf16 v[84:87], v[156:159], v[128:131], v[84:87]
    v_mfma_f32_16x16x32_bf16 v[88:91], v[160:163], v[128:131], v[88:91]
    v_mfma_f32_16x16x32_bf16 v[92:95], v[164:167], v[128:131], v[92:95]
    v_mfma_f32_16x16x32_bf16 v[96:99], v[136:139], v[132:135], v[96:99]
    v_mfma_f32_16x16x32_bf16 v[100:103], v[140:143], v[132:135], v[100:103]
    v_mfma_f32_16x16x32_bf16 v[104:107], v[144:147], v[132:135], v[104:107]
    v_mfma_f32_16x16x32_bf16 v[108:111], v[148:151], v[132:135], v[108:111]
    v_mfma_f32_16x16x32_bf16 v[112:115], v[152:155], v[132:135], v[112:115]
    v_mfma_f32_16x16x32_bf16 v[116:119], v[156:159], v[132:135], v[116:119]
    v_mfma_f32_16x16x32_bf16 v[120:123], v[160:163], v[132:135], v[120:123]
    v_mfma_f32_16x16x32_bf16 v[124:127], v[164:167], v[132:135], v[124:127]
    s_waitcnt vmcnt(20)
    s_barrier
    s_add_u32 s13, s17, 49152
    s_mov_b32 m0, s13
    s_mov_b32 s13, 11264
    buffer_load_dwordx4 v4, s[8:11], s13 offen offset:0 lds
    buffer_load_dwordx4 v5, s[8:11], s13 offen offset:1024 lds
    buffer_load_dwordx4 v6, s[8:11], s13 offen offset:2048 lds
    buffer_load_dwordx4 v7, s[8:11], s13 offen offset:3072 lds
    ds_read_b128 v[128:131], v11 offset:16384
    ds_read_b128 v[132:135], v11 offset:17408
    ds_read_b128 v[136:139], v12 offset:16384
    ds_read_b128 v[140:143], v12 offset:17408
    ds_read_b128 v[144:147], v12 offset:18432
    ds_read_b128 v[148:151], v12 offset:19456
    ds_read_b128 v[152:155], v12 offset:20480
    ds_read_b128 v[156:159], v12 offset:21504
    ds_read_b128 v[160:163], v12 offset:22528
    ds_read_b128 v[164:167], v12 offset:23552
    s_waitcnt lgkmcnt(10)
    v_mfma_f32_16x16x32_bf16 v[64:67], v[32:35], v[24:27], v[64:67]
    v_mfma_f32_16x16x32_bf16 v[68:71], v[36:39], v[24:27], v[68:71]
    v_mfma_f32_16x16x32_bf16 v[72:75], v[40:43], v[24:27], v[72:75]
    v_mfma_f32_16x16x32_bf16 v[76:79], v[44:47], v[24:27], v[76:79]
    v_mfma_f32_16x16x32_bf16 v[80:83], v[48:51], v[24:27], v[80:83]
    v_mfma_f32_16x16x32_bf16 v[84:87], v[52:55], v[24:27], v[84:87]
    v_mfma_f32_16x16x32_bf16 v[88:91], v[56:59], v[24:27], v[88:91]
    v_mfma_f32_16x16x32_bf16 v[92:95], v[60:63], v[24:27], v[92:95]
    v_mfma_f32_16x16x32_bf16 v[96:99], v[32:35], v[28:31], v[96:99]
    v_mfma_f32_16x16x32_bf16 v[100:103], v[36:39], v[28:31], v[100:103]
    v_mfma_f32_16x16x32_bf16 v[104:107], v[40:43], v[28:31], v[104:107]
    v_mfma_f32_16x16x32_bf16 v[108:111], v[44:47], v[28:31], v[108:111]
    v_mfma_f32_16x16x32_bf16 v[112:115], v[48:51], v[28:31], v[112:115]
    v_mfma_f32_16x16x32_bf16 v[116:119], v[52:55], v[28:31], v[116:119]
    v_mfma_f32_16x16x32_bf16 v[120:123], v[56:59], v[28:31], v[120:123]
    v_mfma_f32_16x16x32_bf16 v[124:127], v[60:63], v[28:31], v[124:127]
    s_waitcnt vmcnt(20)
    s_barrier
    s_add_u32 s13, s17, 65536
    s_mov_b32 m0, s13
    s_mov_b32 s13, 12288
    buffer_load_dwordx4 v4, s[8:11], s13 offen offset:0 lds
    buffer_load_dwordx4 v5, s[8:11], s13 offen offset:1024 lds
    buffer_load_dwordx4 v6, s[8:11], s13 offen offset:2048 lds
    buffer_load_dwordx4 v7, s[8:11], s13 offen offset:3072 lds
    ds_read_b128 v[24:27], v11 offset:32768
    ds_read_b128 v[28:31], v11 offset:33792
    ds_read_b128 v[32:35], v12 offset:32768
    ds_read_b128 v[36:39], v12 offset:33792
    ds_read_b128 v[40:43], v12 offset:34816
    ds_read_b128 v[44:47], v12 offset:35840
    ds_read_b128 v[48:51], v12 offset:36864
    ds_read_b128 v[52:55], v12 offset:37888
    ds_read_b128 v[56:59], v12 offset:38912
    ds_read_b128 v[60:63], v12 offset:39936
    s_waitcnt lgkmcnt(10)
    v_mfma_f32_16x16x32_bf16 v[64:67], v[136:139], v[128:131], v[64:67]
    v_mfma_f32_16x16x32_bf16 v[68:71], v[140:143], v[128:131], v[68:71]
    v_mfma_f32_16x16x32_bf16 v[72:75], v[144:147], v[128:131], v[72:75]
    v_mfma_f32_16x16x32_bf16 v[76:79], v[148:151], v[128:131], v[76:79]
    v_mfma_f32_16x16x32_bf16 v[80:83], v[152:155], v[128:131], v[80:83]
    v_mfma_f32_16x16x32_bf16 v[84:87], v[156:159], v[128:131], v[84:87]
    v_mfma_f32_16x16x32_bf16 v[88:91], v[160:163], v[128:131], v[88:91]
    v_mfma_f32_16x16x32_bf16 v[92:95], v[164:167], v[128:131], v[92:95]
    v_mfma_f32_16x16x32_bf16 v[96:99], v[136:139], v[132:135], v[96:99]
    v_mfma_f32_16x16x32_bf16 v[100:103], v[140:143], v[132:135], v[100:103]
    v_mfma_f32_16x16x32_bf16 v[104:107], v[144:147], v[132:135], v[104:107]
    v_mfma_f32_16x16x32_bf16 v[108:111], v[148:151], v[132:135], v[108:111]
    v_mfma_f32_16x16x32_bf16 v[112:115], v[152:155], v[132:135], v[112:115]
    v_mfma_f32_16x16x32_bf16 v[116:119], v[156:159], v[132:135], v[116:119]
    v_mfma_f32_16x16x32_bf16 v[120:123], v[160:163], v[132:135], v[120:123]
    v_mfma_f32_16x16x32_bf16 v[124:127], v[164:167], v[132:135], v[124:127]
    s_waitcnt vmcnt(20)
    s_barrier
    s_add_u32 s13, s17, 81920
    s_mov_b32 m0, s13
    s_mov_b32 s13, 13312
    buffer_load_dwordx4 v4, s[8:11], s13 offen offset:0 lds
    buffer_load_dwordx4 v5, s[8:11], s13 offen offset:1024 lds
    buffer_load_dwordx4 v6, s[8:11], s13 offen offset:2048 lds
    buffer_load_dwordx4 v7, s[8:11], s13 offen offset:3072 lds
    ds_read_b128 v[128:131], v11 offset:49152
    ds_read_b128 v[132:135], v11 offset:50176
    ds_read_b128 v[136:139], v12 offset:49152
    ds_read_b128 v[140:143], v12 offset:50176
    ds_read_b128 v[144:147], v12 offset:51200
    ds_read_b128 v[148:151], v12 offset:52224
    ds_read_b128 v[152:155], v12 offset:53248
    ds_read_b128 v[156:159], v12 offset:54272
    ds_read_b128 v[160:163], v12 offset:55296
    ds_read_b128 v[164:167], v12 offset:56320
    s_waitcnt lgkmcnt(10)
    v_mfma_f32_16x16x32_bf16 v[64:67], v[32:35], v[24:27], v[64:67]
    v_mfma_f32_16x16x32_bf16 v[68:71], v[36:39], v[24:27], v[68:71]
    v_mfma_f32_16x16x32_bf16 v[72:75], v[40:43], v[24:27], v[72:75]
    v_mfma_f32_16x16x32_bf16 v[76:79], v[44:47], v[24:27], v[76:79]
    v_mfma_f32_16x16x32_bf16 v[80:83], v[48:51], v[24:27], v[80:83]
    v_mfma_f32_16x16x32_bf16 v[84:87], v[52:55], v[24:27], v[84:87]
    v_mfma_f32_16x16x32_bf16 v[88:91], v[56:59], v[24:27], v[88:91]
    v_mfma_f32_16x16x32_bf16 v[92:95], v[60:63], v[24:27], v[92:95]
    v_mfma_f32_16x16x32_bf16 v[96:99], v[32:35], v[28:31], v[96:99]
    v_mfma_f32_16x16x32_bf16 v[100:103], v[36:39], v[28:31], v[100:103]
    v_mfma_f32_16x16x32_bf16 v[104:107], v[40:43], v[28:31], v[104:107]
    v_mfma_f32_16x16x32_bf16 v[108:111], v[44:47], v[28:31], v[108:111]
    v_mfma_f32_16x16x32_bf16 v[112:115], v[48:51], v[28:31], v[112:115]
    v_mfma_f32_16x16x32_bf16 v[116:119], v[52:55], v[28:31], v[116:119]
    v_mfma_f32_16x16x32_bf16 v[120:123], v[56:59], v[28:31], v[120:123]
    v_mfma_f32_16x16x32_bf16 v[124:127], v[60:63], v[28:31], v[124:127]
    s_waitcnt vmcnt(20)
    s_barrier
    s_add_u32 s13, s17, 98304
    s_mov_b32 m0, s13
    s_mov_b32 s13, 14336
    buffer_load_dwordx4 v4, s[8:11], s13 offen offset:0 lds
    buffer_load_dwordx4 v5, s[8:11], s13 offen offset:1024 lds
    buffer_load_dwordx4 v6, s[8:11], s13 offen offset:2048 lds
    buffer_load_dwordx4 v7, s[8:11], s13 offen offset:3072 lds
    ds_read_b128 v[24:27], v9 offset:0
    ds_read_b128 v[28:31], v9 offset:1024
    ds_read_b128 v[32:35], v10 offset:0
    ds_read_b128 v[36:39], v10 offset:1024
    ds_read_b128 v[40:43], v10 offset:2048
    ds_read_b128 v[44:47], v10 offset:3072
    ds_read_b128 v[48:51], v10 offset:4096
    ds_read_b128 v[52:55], v10 offset:5120
    ds_read_b128 v[56:59], v10 offset:6144
    ds_read_b128 v[60:63], v10 offset:7168
    s_waitcnt lgkmcnt(10)
    v_mfma_f32_16x16x32_bf16 v[64:67], v[136:139], v[128:131], v[64:67]
    v_mfma_f32_16x16x32_bf16 v[68:71], v[140:143], v[128:131], v[68:71]
    v_mfma_f32_16x16x32_bf16 v[72:75], v[144:147], v[128:131], v[72:75]
    v_mfma_f32_16x16x32_bf16 v[76:79], v[148:151], v[128:131], v[76:79]
    v_mfma_f32_16x16x32_bf16 v[80:83], v[152:155], v[128:131], v[80:83]
    v_mfma_f32_16x16x32_bf16 v[84:87], v[156:159], v[128:131], v[84:87]
    v_mfma_f32_16x16x32_bf16 v[88:91], v[160:163], v[128:131], v[88:91]
    v_mfma_f32_16x16x32_bf16 v[92:95], v[164:167], v[128:131], v[92:95]
    v_mfma_f32_16x16x32_bf16 v[96:99], v[136:139], v[132:135], v[96:99]
    v_mfma_f32_16x16x32_bf16 v[100:103], v[140:143], v[132:135], v[100:103]
    v_mfma_f32_16x16x32_bf16 v[104:107], v[144:147], v[132:135], v[104:107]
    v_mfma_f32_16x16x32_bf16 v[108:111], v[148:151], v[132:135], v[108:111]
    v_mfma_f32_16x16x32_bf16 v[112:115], v[152:155], v[132:135], v[112:115]
    v_mfma_f32_16x16x32_bf16 v[116:119], v[156:159], v[132:135], v[116:119]
    v_mfma_f32_16x16x32_bf16 v[120:123], v[160:163], v[132:135], v[120:123]
    v_mfma_f32_16x16x32_bf16 v[124:127], v[164:167], v[132:135], v[124:127]
    s_waitcnt vmcnt(20)
    s_barrier
    s_add_u32 s13, s17, 114688
    s_mov_b32 m0, s13
    s_mov_b32 s13, 15360
    buffer_load_dwordx4 v4, s[8:11], s13 offen offset:0 lds
    buffer_load_dwordx4 v5, s[8:11], s13 offen offset:1024 lds
    buffer_load_dwordx4 v6, s[8:11], s13 offen offset:2048 lds
    buffer_load_dwordx4 v7, s[8:11], s13 offen offset:3072 lds
    ds_read_b128 v[128:131], v9 offset:16384
    ds_read_b128 v[132:135], v9 offset:17408
    ds_read_b128 v[136:139], v10 offset:16384
    ds_read_b128 v[140:143], v10 offset:17408
    ds_read_b128 v[144:147], v10 offset:18432
    ds_read_b128 v[148:151], v10 offset:19456
    ds_read_b128 v[152:155], v10 offset:20480
    ds_read_b128 v[156:159], v10 offset:21504
    ds_read_b128 v[160:163], v10 offset:22528
    ds_read_b128 v[164:167], v10 offset:23552
    s_waitcnt lgkmcnt(10)
    v_mfma_f32_16x16x32_bf16 v[64:67], v[32:35], v[24:27], v[64:67]
    v_mfma_f32_16x16x32_bf16 v[68:71], v[36:39], v[24:27], v[68:71]
    v_mfma_f32_16x16x32_bf16 v[72:75], v[40:43], v[24:27], v[72:75]
    v_mfma_f32_16x16x32_bf16 v[76:79], v[44:47], v[24:27], v[76:79]
    v_mfma_f32_16x16x32_bf16 v[80:83], v[48:51], v[24:27], v[80:83]
    v_mfma_f32_16x16x32_bf16 v[84:87], v[52:55], v[24:27], v[84:87]
    v_mfma_f32_16x16x32_bf16 v[88:91], v[56:59], v[24:27], v[88:91]
    v_mfma_f32_16x16x32_bf16 v[92:95], v[60:63], v[24:27], v[92:95]
    v_mfma_f32_16x16x32_bf16 v[96:99], v[32:35], v[28:31], v[96:99]
    v_mfma_f32_16x16x32_bf16 v[100:103], v[36:39], v[28:31], v[100:103]
    v_mfma_f32_16x16x32_bf16 v[104:107], v[40:43], v[28:31], v[104:107]
    v_mfma_f32_16x16x32_bf16 v[108:111], v[44:47], v[28:31], v[108:111]
    v_mfma_f32_16x16x32_bf16 v[112:115], v[48:51], v[28:31], v[112:115]
    v_mfma_f32_16x16x32_bf16 v[116:119], v[52:55], v[28:31], v[116:119]
    v_mfma_f32_16x16x32_bf16 v[120:123], v[56:59], v[28:31], v[120:123]
    v_mfma_f32_16x16x32_bf16 v[124:127], v[60:63], v[28:31], v[124:127]
    s_waitcnt vmcnt(20)
    s_barrier
    ds_read_b128 v[24:27], v9 offset:32768
    ds_read_b128 v[28:31], v9 offset:33792
    ds_read_b128 v[32:35], v10 offset:32768
    ds_read_b128 v[36:39], v10 offset:33792
    ds_read_b128 v[40:43], v10 offset:34816
    ds_read_b128 v[44:47], v10 offset:35840
    ds_read_b128 v[48:51], v10 offset:36864
    ds_read_b128 v[52:55], v10 offset:37888
    ds_read_b128 v[56:59], v10 offset:38912
    ds_read_b128 v[60:63], v10 offset:39936
    s_waitcnt lgkmcnt(10)
    v_mfma_f32_16x16x32_bf16 v[64:67], v[136:139], v[128:131], v[64:67]
    v_mfma_f32_16x16x32_bf16 v[68:71], v[140:143], v[128:131], v[68:71]
    v_mfma_f32_16x16x32_bf16 v[72:75], v[144:147], v[128:131], v[72:75]
    v_mfma_f32_16x16x32_bf16 v[76:79], v[148:151], v[128:131], v[76:79]
    v_mfma_f32_16x16x32_bf16 v[80:83], v[152:155], v[128:131], v[80:83]
    v_mfma_f32_16x16x32_bf16 v[84:87], v[156:159], v[128:131], v[84:87]
    v_mfma_f32_16x16x32_bf16 v[88:91], v[160:163], v[128:131], v[88:91]
    v_mfma_f32_16x16x32_bf16 v[92:95], v[164:167], v[128:131], v[92:95]
    v_mfma_f32_16x16x32_bf16 v[96:99], v[136:139], v[132:135], v[96:99]
    v_mfma_f32_16x16x32_bf16 v[100:103], v[140:143], v[132:135], v[100:103]
    v_mfma_f32_16x16x32_bf16 v[104:107], v[144:147], v[132:135], v[104:107]
    v_mfma_f32_16x16x32_bf16 v[108:111], v[148:151], v[132:135], v[108:111]
    v_mfma_f32_16x16x32_bf16 v[112:115], v[152:155], v[132:135], v[112:115]
    v_mfma_f32_16x16x32_bf16 v[116:119], v[156:159], v[132:135], v[116:119]
    v_mfma_f32_16x16x32_bf16 v[120:123], v[160:163], v[132:135], v[120:123]
    v_mfma_f32_16x16x32_bf16 v[124:127], v[164:167], v[132:135], v[124:127]
    s_waitcnt vmcnt(16)
    s_barrier
    ds_read_b128 v[128:131], v9 offset:49152
    ds_read_b128 v[132:135], v9 offset:50176
    ds_read_b128 v[136:139], v10 offset:49152
    ds_read_b128 v[140:143], v10 offset:50176
    ds_read_b128 v[144:147], v10 offset:51200
    ds_read_b128 v[148:151], v10 offset:52224
    ds_read_b128 v[152:155], v10 offset:53248
    ds_read_b128 v[156:159], v10 offset:54272
    ds_read_b128 v[160:163], v10 offset:55296
    ds_read_b128 v[164:167], v10 offset:56320
    s_waitcnt lgkmcnt(10)
    v_mfma_f32_16x16x32_bf16 v[64:67], v[32:35], v[24:27], v[64:67]
    v_mfma_f32_16x16x32_bf16 v[68:71], v[36:39], v[24:27], v[68:71]
    v_mfma_f32_16x16x32_bf16 v[72:75], v[40:43], v[24:27], v[72:75]
    v_mfma_f32_16x16x32_bf16 v[76:79], v[44:47], v[24:27], v[76:79]
    v_mfma_f32_16x16x32_bf16 v[80:83], v[48:51], v[24:27], v[80:83]
    v_mfma_f32_16x16x32_bf16 v[84:87], v[52:55], v[24:27], v[84:87]
    v_mfma_f32_16x16x32_bf16 v[88:91], v[56:59], v[24:27], v[88:91]
    v_mfma_f32_16x16x32_bf16 v[92:95], v[60:63], v[24:27], v[92:95]
    v_mfma_f32_16x16x32_bf16 v[96:99], v[32:35], v[28:31], v[96:99]
    v_mfma_f32_16x16x32_bf16 v[100:103], v[36:39], v[28:31], v[100:103]
    v_mfma_f32_16x16x32_bf16 v[104:107], v[40:43], v[28:31], v[104:107]
    v_mfma_f32_16x16x32_bf16 v[108:111], v[44:47], v[28:31], v[108:111]
    v_mfma_f32_16x16x32_bf16 v[112:115], v[48:51], v[28:31], v[112:115]
    v_mfma_f32_16x16x32_bf16 v[116:119], v[52:55], v[28:31], v[116:119]
    v_mfma_f32_16x16x32_bf16 v[120:123], v[56:59], v[28:31], v[120:123]
    v_mfma_f32_16x16x32_bf16 v[124:127], v[60:63], v[28:31], v[124:127]
    s_waitcnt vmcnt(12)
    s_barrier
    ds_read_b128 v[24:27], v11 offset:0
    ds_read_b128 v[28:31], v11 offset:1024
    ds_read_b128 v[32:35], v12 offset:0
    ds_read_b128 v[36:39], v12 offset:1024
    ds_read_b128 v[40:43], v12 offset:2048
    ds_read_b128 v[44:47], v12 offset:3072
    ds_read_b128 v[48:51], v12 offset:4096
    ds_read_b128 v[52:55], v12 offset:5120
    ds_read_b128 v[56:59], v12 offset:6144
    ds_read_b128 v[60:63], v12 offset:7168
    s_waitcnt lgkmcnt(10)
    v_mfma_f32_16x16x32_bf16 v[64:67], v[136:139], v[128:131], v[64:67]
    v_mfma_f32_16x16x32_bf16 v[68:71], v[140:143], v[128:131], v[68:71]
    v_mfma_f32_16x16x32_bf16 v[72:75], v[144:147], v[128:131], v[72:75]
    v_mfma_f32_16x16x32_bf16 v[76:79], v[148:151], v[128:131], v[76:79]
    v_mfma_f32_16x16x32_bf16 v[80:83], v[152:155], v[128:131], v[80:83]
    v_mfma_f32_16x16x32_bf16 v[84:87], v[156:159], v[128:131], v[84:87]
    v_mfma_f32_16x16x32_bf16 v[88:91], v[160:163], v[128:131], v[88:91]
    v_mfma_f32_16x16x32_bf16 v[92:95], v[164:167], v[128:131], v[92:95]
    v_mfma_f32_16x16x32_bf16 v[96:99], v[136:139], v[132:135], v[96:99]
    v_mfma_f32_16x16x32_bf16 v[100:103], v[140:143], v[132:135], v[100:103]
    v_mfma_f32_16x16x32_bf16 v[104:107], v[144:147], v[132:135], v[104:107]
    v_mfma_f32_16x16x32_bf16 v[108:111], v[148:151], v[132:135], v[108:111]
    v_mfma_f32_16x16x32_bf16 v[112:115], v[152:155], v[132:135], v[112:115]
    v_mfma_f32_16x16x32_bf16 v[116:119], v[156:159], v[132:135], v[116:119]
    v_mfma_f32_16x16x32_bf16 v[120:123], v[160:163], v[132:135], v[120:123]
    v_mfma_f32_16x16x32_bf16 v[124:127], v[164:167], v[132:135], v[124:127]
    s_waitcnt vmcnt(8)
    s_barrier
    ds_read_b128 v[128:131], v11 offset:16384
    ds_read_b128 v[132:135], v11 offset:17408
    ds_read_b128 v[136:139], v12 offset:16384
    ds_read_b128 v[140:143], v12 offset:17408
    ds_read_b128 v[144:147], v12 offset:18432
    ds_read_b128 v[148:151], v12 offset:19456
    ds_read_b128 v[152:155], v12 offset:20480
    ds_read_b128 v[156:159], v12 offset:21504
    ds_read_b128 v[160:163], v12 offset:22528
    ds_read_b128 v[164:167], v12 offset:23552
    s_waitcnt lgkmcnt(10)
    v_mfma_f32_16x16x32_bf16 v[64:67], v[32:35], v[24:27], v[64:67]
    v_mfma_f32_16x16x32_bf16 v[68:71], v[36:39], v[24:27], v[68:71]
    v_mfma_f32_16x16x32_bf16 v[72:75], v[40:43], v[24:27], v[72:75]
    v_mfma_f32_16x16x32_bf16 v[76:79], v[44:47], v[24:27], v[76:79]
    v_mfma_f32_16x16x32_bf16 v[80:83], v[48:51], v[24:27], v[80:83]
    v_mfma_f32_16x16x32_bf16 v[84:87], v[52:55], v[24:27], v[84:87]
    v_mfma_f32_16x16x32_bf16 v[88:91], v[56:59], v[24:27], v[88:91]
    v_mfma_f32_16x16x32_bf16 v[92:95], v[60:63], v[24:27], v[92:95]
    v_mfma_f32_16x16x32_bf16 v[96:99], v[32:35], v[28:31], v[96:99]
    v_mfma_f32_16x16x32_bf16 v[100:103], v[36:39], v[28:31], v[100:103]
    v_mfma_f32_16x16x32_bf16 v[104:107], v[40:43], v[28:31], v[104:107]
    v_mfma_f32_16x16x32_bf16 v[108:111], v[44:47], v[28:31], v[108:111]
    v_mfma_f32_16x16x32_bf16 v[112:115], v[48:51], v[28:31], v[112:115]
    v_mfma_f32_16x16x32_bf16 v[116:119], v[52:55], v[28:31], v[116:119]
    v_mfma_f32_16x16x32_bf16 v[120:123], v[56:59], v[28:31], v[120:123]
    v_mfma_f32_16x16x32_bf16 v[124:127], v[60:63], v[28:31], v[124:127]
    s_waitcnt vmcnt(4)
    s_barrier
    ds_read_b128 v[24:27], v11 offset:32768
    ds_read_b128 v[28:31], v11 offset:33792
    ds_read_b128 v[32:35], v12 offset:32768
    ds_read_b128 v[36:39], v12 offset:33792
    ds_read_b128 v[40:43], v12 offset:34816
    ds_read_b128 v[44:47], v12 offset:35840
    ds_read_b128 v[48:51], v12 offset:36864
    ds_read_b128 v[52:55], v12 offset:37888
    ds_read_b128 v[56:59], v12 offset:38912
    ds_read_b128 v[60:63], v12 offset:39936
    s_waitcnt lgkmcnt(10)
    v_mfma_f32_16x16x32_bf16 v[64:67], v[136:139], v[128:131], v[64:67]
    v_mfma_f32_16x16x32_bf16 v[68:71], v[140:143], v[128:131], v[68:71]
    v_mfma_f32_16x16x32_bf16 v[72:75], v[144:147], v[128:131], v[72:75]
    v_mfma_f32_16x16x32_bf16 v[76:79], v[148:151], v[128:131], v[76:79]
    v_mfma_f32_16x16x32_bf16 v[80:83], v[152:155], v[128:131], v[80:83]
    v_mfma_f32_16x16x32_bf16 v[84:87], v[156:159], v[128:131], v[84:87]
    v_mfma_f32_16x16x32_bf16 v[88:91], v[160:163], v[128:131], v[88:91]
    v_mfma_f32_16x16x32_bf16 v[92:95], v[164:167], v[128:131], v[92:95]
    v_mfma_f32_16x16x32_bf16 v[96:99], v[136:139], v[132:135], v[96:99]
    v_mfma_f32_16x16x32_bf16 v[100:103], v[140:143], v[132:135], v[100:103]
    v_mfma_f32_16x16x32_bf16 v[104:107], v[144:147], v[132:135], v[104:107]
    v_mfma_f32_16x16x32_bf16 v[108:111], v[148:151], v[132:135], v[108:111]
    v_mfma_f32_16x16x32_bf16 v[112:115], v[152:155], v[132:135], v[112:115]
    v_mfma_f32_16x16x32_bf16 v[116:119], v[156:159], v[132:135], v[116:119]
    v_mfma_f32_16x16x32_bf16 v[120:123], v[160:163], v[132:135], v[120:123]
    v_mfma_f32_16x16x32_bf16 v[124:127], v[164:167], v[132:135], v[124:127]
    s_waitcnt vmcnt(0)
    s_barrier
    ds_read_b128 v[128:131], v11 offset:49152
    ds_read_b128 v[132:135], v11 offset:50176
    ds_read_b128 v[136:139], v12 offset:49152
    ds_read_b128 v[140:143], v12 offset:50176
    ds_read_b128 v[144:147], v12 offset:51200
    ds_read_b128 v[148:151], v12 offset:52224
    ds_read_b128 v[152:155], v12 offset:53248
    ds_read_b128 v[156:159], v12 offset:54272
    ds_read_b128 v[160:163], v12 offset:55296
    ds_read_b128 v[164:167], v12 offset:56320
    s_waitcnt lgkmcnt(10)
    v_mfma_f32_16x16x32_bf16 v[64:67], v[32:35], v[24:27], v[64:67]
    v_mfma_f32_16x16x32_bf16 v[68:71], v[36:39], v[24:27], v[68:71]
    v_mfma_f32_16x16x32_bf16 v[72:75], v[40:43], v[24:27], v[72:75]
    v_mfma_f32_16x16x32_bf16 v[76:79], v[44:47], v[24:27], v[76:79]
    v_mfma_f32_16x16x32_bf16 v[80:83], v[48:51], v[24:27], v[80:83]
    v_mfma_f32_16x16x32_bf16 v[84:87], v[52:55], v[24:27], v[84:87]
    v_mfma_f32_16x16x32_bf16 v[88:91], v[56:59], v[24:27], v[88:91]
    v_mfma_f32_16x16x32_bf16 v[92:95], v[60:63], v[24:27], v[92:95]
    v_mfma_f32_16x16x32_bf16 v[96:99], v[32:35], v[28:31], v[96:99]
    v_mfma_f32_16x16x32_bf16 v[100:103], v[36:39], v[28:31], v[100:103]
    v_mfma_f32_16x16x32_bf16 v[104:107], v[40:43], v[28:31], v[104:107]
    v_mfma_f32_16x16x32_bf16 v[108:111], v[44:47], v[28:31], v[108:111]
    v_mfma_f32_16x16x32_bf16 v[112:115], v[48:51], v[28:31], v[112:115]
    v_mfma_f32_16x16x32_bf16 v[116:119], v[52:55], v[28:31], v[116:119]
    v_mfma_f32_16x16x32_bf16 v[120:123], v[56:59], v[28:31], v[120:123]
    v_mfma_f32_16x16x32_bf16 v[124:127], v[60:63], v[28:31], v[124:127]
    s_waitcnt lgkmcnt(0)
    v_mfma_f32_16x16x32_bf16 v[64:67], v[136:139], v[128:131], v[64:67]
    v_mfma_f32_16x16x32_bf16 v[68:71], v[140:143], v[128:131], v[68:71]
    v_mfma_f32_16x16x32_bf16 v[72:75], v[144:147], v[128:131], v[72:75]
    v_mfma_f32_16x16x32_bf16 v[76:79], v[148:151], v[128:131], v[76:79]
    v_mfma_f32_16x16x32_bf16 v[80:83], v[152:155], v[128:131], v[80:83]
    v_mfma_f32_16x16x32_bf16 v[84:87], v[156:159], v[128:131], v[84:87]
    v_mfma_f32_16x16x32_bf16 v[88:91], v[160:163], v[128:131], v[88:91]
    v_mfma_f32_16x16x32_bf16 v[92:95], v[164:167], v[128:131], v[92:95]
    v_mfma_f32_16x16x32_bf16 v[96:99], v[136:139], v[132:135], v[96:99]
    v_mfma_f32_16x16x32_bf16 v[100:103], v[140:143], v[132:135], v[100:103]
    v_mfma_f32_16x16x32_bf16 v[104:107], v[144:147], v[132:135], v[104:107]
    v_mfma_f32_16x16x32_bf16 v[108:111], v[148:151], v[132:135], v[108:111]
    v_mfma_f32_16x16x32_bf16 v[112:115], v[152:155], v[132:135], v[112:115]
    v_mfma_f32_16x16x32_bf16 v[116:119], v[156:159], v[132:135], v[116:119]
    v_mfma_f32_16x16x32_bf16 v[120:123], v[160:163], v[132:135], v[120:123]
    v_mfma_f32_16x16x32_bf16 v[124:127], v[164:167], v[132:135], v[124:127]
    s_nop 7
    s_nop 1
    v_cvt_pk_bf16_f32 v16, v64, v68
    v_cvt_pk_bf16_f32 v17, v65, v69
    v_cvt_pk_bf16_f32 v18, v66, v70
    v_cvt_pk_bf16_f32 v19, v67, v71
    v_cvt_pk_bf16_f32 v20, v72, v76
    v_cvt_pk_bf16_f32 v21, v73, v77
    v_cvt_pk_bf16_f32 v22, v74, v78
    v_cvt_pk_bf16_f32 v23, v75, v79
    v_cvt_pk_bf16_f32 v24, v80, v84
    v_cvt_pk_bf16_f32 v25, v81, v85
    v_cvt_pk_bf16_f32 v26, v82, v86
    v_cvt_pk_bf16_f32 v27, v83, v87
    v_cvt_pk_bf16_f32 v28, v88, v92
    v_cvt_pk_bf16_f32 v29, v89, v93
    v_cvt_pk_bf16_f32 v30, v90, v94
    v_cvt_pk_bf16_f32 v31, v91, v95
    v_cvt_pk_bf16_f32 v32, v96, v100
    v_cvt_pk_bf16_f32 v33, v97, v101
    v_cvt_pk_bf16_f32 v34, v98, v102
    v_cvt_pk_bf16_f32 v35, v99, v103
    v_cvt_pk_bf16_f32 v36, v104, v108
    v_cvt_pk_bf16_f32 v37, v105, v109
    v_cvt_pk_bf16_f32 v38, v106, v110
    v_cvt_pk_bf16_f32 v39, v107, v111
    v_cvt_pk_bf16_f32 v40, v112, v116
    v_cvt_pk_bf16_f32 v41, v113, v117
    v_cvt_pk_bf16_f32 v42, v114, v118
    v_cvt_pk_bf16_f32 v43, v115, v119
    v_cvt_pk_bf16_f32 v44, v120, v124
    v_cvt_pk_bf16_f32 v45, v121, v125
    v_cvt_pk_bf16_f32 v46, v122, v126
    v_cvt_pk_bf16_f32 v47, v123, v127
    s_lshl_b32 s13, s20, 2
    s_add_u32 s13, s13, s12
    s_lshl_b32 s14, s39, 7
    s_add_u32 s14, s14, 129007616
    v_mov_b32 v6, s14
w_chain_kernel_49:
    global_load_dwordx4 v[8:11], v6, s[4:5] sc1
    s_waitcnt vmcnt(0)
    v_min3_u32 v8, v8, v9, v10
    v_min_u32 v8, v8, v11
    s_nop 0
    v_readfirstlane_b32 s15, v8
    s_nop 3
    s_cmp_gt_u32 s15, s13
    s_cbranch_scc1 w_chain_kernel_51
    s_add_u32 s43, s43, 1
    s_cmp_gt_u32 s43, 0x80000
    s_cbranch_scc1 w_chain_kernel_51
    s_sleep 12
    s_sub_u32 s15, s13, s15
    s_cmp_lt_u32 s15, 3
    s_cbranch_scc1 w_chain_kernel_49
    s_sleep 60
    s_branch w_chain_kernel_49
w_chain_kernel_51:
    s_lshl_b32 s13, s13, 5
    s_add_u32 s13, s13, s39
    v_lshlrev_b32 v5, 4, v1
    s_lshl_b32 s14, s13, 13
    s_lshl_b32 s15, s13, 12
    v_add_u32 v6, s14, v5
    v_add_u32 v7, 20971520, v6
    v_add_u32 v8, 4096, v7
    v_add_u32 v9, 37748736, v6
    v_add_u32 v10, 4096, v9
    v_add_u32 v11, 54525952, v6
    v_add_u32 v12, 4096, v11
    v_add_u32 v13, s15, v5
    v_add_u32 v13, 71303168, v13
    v_lshrrev_b32 v14, 1, v5
    s_lshr_b32 s16, s15, 1
    v_add_u32 v14, s16, v14
    v_add_u32 v14, 79691776, v14
    global_load_dwordx4 v[80:83], v13, s[4:5] offset:0 sc1
    global_load_dwordx4 v[84:87], v13, s[4:5] offset:1024 sc1
    global_load_dwordx4 v[88:91], v13, s[4:5] offset:2048 sc1
    global_load_dwordx4 v[92:95], v13, s[4:5] offset:3072 sc1
    global_load_dwordx4 v[48:51], v9, s[4:5] offset:0 sc1
    global_load_dwordx4 v[52:55], v9, s[4:5] offset:1024 sc1
    global_load_dwordx4 v[56:59], v9, s[4:5] offset:2048 sc1
    global_load_dwordx4 v[60:63], v9, s[4:5] offset:3072 sc1
    global_load_dwordx4 v[64:67], v10, s[4:5] offset:0 sc1
    global_load_dwordx4 v[68:71], v10, s[4:5] offset:1024 sc1
    global_load_dwordx4 v[72:75], v10, s[4:5] offset:2048 sc1
    global_load_dwordx4 v[76:79], v10, s[4:5] offset:3072 sc1
    global_load_dwordx4 v[96:99], v11, s[4:5] offset:0 sc1
    global_load_dwordx4 v[100:103], v11, s[4:5] offset:1024 sc1
    global_load_dwordx4 v[104:107], v11, s[4:5] offset:2048 sc1
    global_load_dwordx4 v[108:111], v11, s[4:5] offset:3072 sc1
    global_load_dwordx4 v[112:115], v12, s[4:5] offset:0 sc1
    global_load_dwordx4 v[116:119], v12, s[4:5] offset:1024 sc1
    global_load_dwordx4 v[120:123], v12, s[4:5] offset:2048 sc1
    global_load_dwordx4 v[124:127], v12, s[4:5] offset:3072 sc1
    global_load_dwordx2 v[128:129], v14, s[4:5] offset:0 sc1
    global_load_dwordx2 v[130:131], v14, s[4:5] offset:512 sc1
    global_load_dwordx2 v[132:133], v14, s[4:5] offset:1024 sc1
    global_load_dwordx2 v[134:135], v14, s[4:5] offset:1536 sc1
    s_waitcnt vmcnt(12)
    v_mfma_f32_16x16x32_bf16 v[144:147], v[80:83], v[16:19], 0
    v_mfma_f32_16x16x32_bf16 v[144:147], v[84:87], v[20:23], v[144:147]
    v_mfma_f32_16x16x32_bf16 v[144:147], v[88:91], v[24:27], v[144:147]
    v_mfma_f32_16x16x32_bf16 v[144:147], v[92:95], v[28:31], v[144:147]
    v_mfma_f32_16x16x32_bf16 v[148:151], v[48:51], v[16:19], 0
    v_mfma_f32_16x16x32_bf16 v[148:151], v[52:55], v[20:23], v[148:151]
    v_mfma_f32_16x16x32_bf16 v[148:151], v[56:59], v[24:27], v[148:151]
    v_mfma_f32_16x16x32_bf16 v[148:151], v[60:63], v[28:31], v[148:151]
    v_mfma_f32_16x16x32_bf16 v[156:159], v[80:83], v[32:35], 0
    v_mfma_f32_16x16x32_bf16 v[156:159], v[84:87], v[36:39], v[156:159]
    v_mfma_f32_16x16x32_bf16 v[156:159], v[88:91], v[40:43], v[156:159]
    v_mfma_f32_16x16x32_bf16 v[156:159], v[92:95], v[44:47], v[156:159]
    v_mfma_f32_16x16x32_bf16 v[160:163], v[48:51], v[32:35], 0
    v_mfma_f32_16x16x32_bf16 v[160:163], v[52:55], v[36:39], v[160:163]
    v_mfma_f32_16x16x32_bf16 v[160:163], v[56:59], v[40:43], v[160:163]
    v_mfma_f32_16x16x32_bf16 v[160:163], v[60:63], v[44:47], v[160:163]
    v_mfma_f32_16x16x32_bf16 v[164:167], v[64:67], v[32:35], 0
    v_mfma_f32_16x16x32_bf16 v[164:167], v[68:71], v[36:39], v[164:167]
    v_mfma_f32_16x16x32_bf16 v[164:167], v[72:75], v[40:43], v[164:167]
    v_mfma_f32_16x16x32_bf16 v[164:167], v[76:79], v[44:47], v[164:167]
    v_lshlrev_b32 v15, 2, v2
    s_mov_b32 s32, 0
    s_mov_b32 s33, -1
    v_add_u32 v6, 0, v15
    v_cmp_gt_u32 s[20:21], v6, v3
    v_add_u32 v6, 1, v15
    v_cmp_gt_u32 s[22:23], v6, v3
    v_add_u32 v6, 2, v15
    v_cmp_gt_u32 s[24:25], v6, v3
    v_add_u32 v6, 3, v15
    v_cmp_gt_u32 s[26:27], v6, v3
    s_mov_b32 s30, 1035273459
    s_mov_b32 s31, 1069066811
    v_mov_b32 v15, 0xff800000
    s_nop 4
    v_cvt_pk_bf16_f32 v6, v144, v145
    v_lshlrev_b32 v144, 16, v6
    v_and_b32 v145, 0xffff0000, v6
    v_mul_f32 v144, s30, v144
    v_mul_f32 v145, s30, v145
    v_cvt_pk_bf16_f32 v6, v144, v145
    v_lshlrev_b32 v144, 16, v6
    v_and_b32 v145, 0xffff0000, v6
    v_cvt_pk_bf16_f32 v6, v146, v147
    v_lshlrev_b32 v146, 16, v6
    v_and_b32 v147, 0xffff0000, v6
    v_mul_f32 v146, s30, v146
    v_mul_f32 v147, s30, v147
    v_cvt_pk_bf16_f32 v6, v146, v147
    v_lshlrev_b32 v146, 16, v6
    v_and_b32 v147, 0xffff0000, v6
    v_cvt_pk_bf16_f32 v6, v148, v149
    v_lshlrev_b32 v148, 16, v6
    v_and_b32 v149, 0xffff0000, v6
    v_mul_f32 v148, s30, v148
    v_mul_f32 v149, s30, v149
    v_cvt_pk_bf16_f32 v6, v148, v149
    v_lshlrev_b32 v148, 16, v6
    v_and_b32 v149, 0xffff0000, v6
    v_cvt_pk_bf16_f32 v6, v150, v151
    v_lshlrev_b32 v150, 16, v6
    v_and_b32 v151, 0xffff0000, v6
    v_mul_f32 v150, s30, v150
    v_mul_f32 v151, s30, v151
    v_cvt_pk_bf16_f32 v6, v150, v151
    v_lshlrev_b32 v150, 16, v6
    v_and_b32 v151, 0xffff0000, v6
    v_cndmask_b32 v144, v144, v15, s[32:33]
    v_cndmask_b32 v148, v148, v15, s[20:21]
    v_cndmask_b32 v145, v145, v15, s[32:33]
    v_cndmask_b32 v149, v149, v15, s[22:23]
    v_cndmask_b32 v146, v146, v15, s[32:33]
    v_cndmask_b32 v150, v150, v15, s[24:25]
    v_cndmask_b32 v147, v147, v15, s[32:33]
    v_cndmask_b32 v151, v151, v15, s[26:27]
    v_max_f32 v6, v144, v145
    v_max3_f32 v6, v6, v146, v147
    v_max3_f32 v6, v6, v148, v149
    v_max3_f32 v6, v6, v150, v151
    v_mov_b32 v7, v6
    v_mov_b32 v8, v6
    s_nop 1
    v_permlane32_swap_b32 v7, v8
    s_nop 1
    v_max_f32 v6, v7, v8
    v_mov_b32 v7, v6
    v_mov_b32 v8, v6
    s_nop 1
    v_permlane16_swap_b32 v7, v8
    s_nop 1
    v_max_f32 v6, v7, v8
    v_sub_f32 v144, v144, v6
    v_mul_f32 v144, s31, v144
    v_exp_f32 v144, v144
    v_sub_f32 v145, v145, v6
    v_mul_f32 v145, s31, v145
    v_exp_f32 v145, v145
    v_sub_f32 v146, v146, v6
    v_mul_f32 v146, s31, v146
    v_exp_f32 v146, v146
    v_sub_f32 v147, v147, v6
    v_mul_f32 v147, s31, v147
    v_exp_f32 v147, v147
    v_sub_f32 v148, v148, v6
    v_mul_f32 v148, s31, v148
    v_exp_f32 v148, v148
    v_sub_f32 v149, v149, v6
    v_mul_f32 v149, s31, v149
    v_exp_f32 v149, v149
    v_sub_f32 v150, v150, v6
    v_mul_f32 v150, s31, v150
    v_exp_f32 v150, v150
    v_sub_f32 v151, v151, v6
    v_mul_f32 v151, s31, v151
    v_exp_f32 v151, v151
    s_nop 0
    v_add_f32 v6, v144, v145
    v_add_f32 v6, v6, v146
    v_add_f32 v6, v6, v147
    v_add_f32 v6, v6, v148
    v_add_f32 v6, v6, v149
    v_add_f32 v6, v6, v150
    v_add_f32 v6, v6, v151
    v_mov_b32 v7, v6
    v_mov_b32 v8, v6
    s_nop 1
    v_permlane32_swap_b32 v7, v8
    s_nop 1
    v_add_f32 v6, v7, v8
    v_mov_b32 v7, v6
    v_mov_b32 v8, v6
    s_nop 1
    v_permlane16_swap_b32 v7, v8
    s_nop 1
    v_add_f32 v6, v7, v8
    v_rcp_f32 v6, v6
    s_nop 0
    v_mul_f32 v144, v144, v6
    v_mul_f32 v145, v145, v6
    v_mul_f32 v146, v146, v6
    v_mul_f32 v147, v147, v6
    v_mul_f32 v148, v148, v6
    v_mul_f32 v149, v149, v6
    v_mul_f32 v150, v150, v6
    v_mul_f32 v151, v151, v6
    v_cvt_pk_bf16_f32 v168, v144, v145
    v_cvt_pk_bf16_f32 v169, v146, v147
    v_mov_b32 v170, 0
    v_mov_b32 v171, 0
    v_mov_b32 v7, v168
    v_mov_b32 v8, v169
    s_nop 1
    v_permlane32_swap_b32 v170, v7
    v_permlane32_swap_b32 v171, v8
    v_cvt_pk_bf16_f32 v172, v148, v149
    v_cvt_pk_bf16_f32 v173, v150, v151
    v_mov_b32 v174, 0
    v_mov_b32 v175, 0
    v_cvt_pk_bf16_f32 v6, v156, v157
    v_lshlrev_b32 v156, 16, v6
    v_and_b32 v157, 0xffff0000, v6
    v_mul_f32 v156, s30, v156
    v_mul_f32 v157, s30, v157
    v_cvt_pk_bf16_f32 v6, v156, v157
    v_lshlrev_b32 v156, 16, v6
    v_and_b32 v157, 0xffff0000, v6
    v_cvt_pk_bf16_f32 v6, v158, v159
    v_lshlrev_b32 v158, 16, v6
    v_and_b32 v159, 0xffff0000, v6
    v_mul_f32 v158, s30, v158
    v_mul_f32 v159, s30, v159
    v_cvt_pk_bf16_f32 v6, v158, v159
    v_lshlrev_b32 v158, 16, v6
    v_and_b32 v159, 0xffff0000, v6
    v_cvt_pk_bf16_f32 v6, v160, v161
    v_lshlrev_b32 v160, 16, v6
    v_and_b32 v161, 0xffff0000, v6
    v_mul_f32 v160, s30, v160
    v_mul_f32 v161, s30, v161
    v_cvt_pk_bf16_f32 v6, v160, v161
    v_lshlrev_b32 v160, 16, v6
    v_and_b32 v161, 0xffff0000, v6
    v_cvt_pk_bf16_f32 v6, v162, v163
    v_lshlrev_b32 v162, 16, v6
    v_and_b32 v163, 0xffff0000, v6
    v_mul_f32 v162, s30, v162
    v_mul_f32 v163, s30, v163
    v_cvt_pk_bf16_f32 v6, v162, v163
    v_lshlrev_b32 v162, 16, v6
    v_and_b32 v163, 0xffff0000, v6
    v_cvt_pk_bf16_f32 v6, v164, v165
    v_lshlrev_b32 v164, 16, v6
    v_and_b32 v165, 0xffff0000, v6
    v_mul_f32 v164, s30, v164
    v_mul_f32 v165, s30, v165
    v_cvt_pk_bf16_f32 v6, v164, v165
    v_lshlrev_b32 v164, 16, v6
    v_and_b32 v165, 0xffff0000, v6
    v_cvt_pk_bf16_f32 v6, v166, v167
    v_lshlrev_b32 v166, 16, v6
    v_and_b32 v167, 0xffff0000, v6
    v_mul_f32 v166, s30, v166
    v_mul_f32 v167, s30, v167
    v_cvt_pk_bf16_f32 v6, v166, v167
    v_lshlrev_b32 v166, 16, v6
    v_and_b32 v167, 0xffff0000, v6
    v_cndmask_b32 v156, v156, v15, s[32:33]
    v_cndmask_b32 v164, v164, v15, s[20:21]
    v_cndmask_b32 v157, v157, v15, s[32:33]
    v_cndmask_b32 v165, v165, v15, s[22:23]
    v_cndmask_b32 v158, v158, v15, s[32:33]
    v_cndmask_b32 v166, v166, v15, s[24:25]
    v_cndmask_b32 v159, v159, v15, s[32:33]
    v_cndmask_b32 v167, v167, v15, s[26:27]
    v_max_f32 v6, v156, v157
    v_max3_f32 v6, v6, v158, v159
    v_max3_f32 v6, v6, v160, v161
    v_max3_f32 v6, v6, v162, v163
    v_max3_f32 v6, v6, v164, v165
    v_max3_f32 v6, v6, v166, v167
    v_mov_b32 v7, v6
    v_mov_b32 v8, v6
    s_nop 1
    v_permlane32_swap_b32 v7, v8
    s_nop 1
    v_max_f32 v6, v7, v8
    v_mov_b32 v7, v6
    v_mov_b32 v8, v6
    s_nop 1
    v_permlane16_swap_b32 v7, v8
    s_nop 1
    v_max_f32 v6, v7, v8
    v_sub_f32 v156, v156, v6
    v_mul_f32 v156, s31, v156
    v_exp_f32 v156, v156
    v_sub_f32 v157, v157, v6
    v_mul_f32 v157, s31, v157
    v_exp_f32 v157, v157
    v_sub_f32 v158, v158, v6
    v_mul_f32 v158, s31, v158
    v_exp_f32 v158, v158
    v_sub_f32 v159, v159, v6
    v_mul_f32 v159, s31, v159
    v_exp_f32 v159, v159
    v_sub_f32 v160, v160, v6
    v_mul_f32 v160, s31, v160
    v_exp_f32 v160, v160
    v_sub_f32 v161, v161, v6
    v_mul_f32 v161, s31, v161
    v_exp_f32 v161, v161
    v_sub_f32 v162, v162, v6
    v_mul_f32 v162, s31, v162
    v_exp_f32 v162, v162
    v_sub_f32 v163, v163, v6
    v_mul_f32 v163, s31, v163
    v_exp_f32 v163, v163
    v_sub_f32 v164, v164, v6
    v_mul_f32 v164, s31, v164
    v_exp_f32 v164, v164
    v_sub_f32 v165, v165, v6
    v_mul_f32 v165, s31, v165
    v_exp_f32 v165, v165
    v_sub_f32 v166, v166, v6
    v_mul_f32 v166, s31, v166
    v_exp_f32 v166, v166
    v_sub_f32 v167, v167, v6
    v_mul_f32 v167, s31, v167
    v_exp_f32 v167, v167
    s_nop 0
    v_add_f32 v6, v156, v157
    v_add_f32 v6, v6, v158
    v_add_f32 v6, v6, v159
    v_add_f32 v6, v6, v160
    v_add_f32 v6, v6, v161
    v_add_f32 v6, v6, v162
    v_add_f32 v6, v6, v163
    v_add_f32 v6, v6, v164
    v_add_f32 v6, v6, v165
    v_add_f32 v6, v6, v166
    v_add_f32 v6, v6, v167
    v_mov_b32 v7, v6
    v_mov_b32 v8, v6
    s_nop 1
    v_permlane32_swap_b32 v7, v8
    s_nop 1
    v_add_f32 v6, v7, v8
    v_mov_b32 v7, v6
    v_mov_b32 v8, v6
    s_nop 1
    v_permlane16_swap_b32 v7, v8
    s_nop 1
    v_add_f32 v6, v7, v8
    v_rcp_f32 v6, v6
    s_nop 0
    v_mul_f32 v156, v156, v6
    v_mul_f32 v157, v157, v6
    v_mul_f32 v158, v158, v6
    v_mul_f32 v159, v159, v6
    v_mul_f32 v160, v160, v6
    v_mul_f32 v161, v161, v6
    v_mul_f32 v162, v162, v6
    v_mul_f32 v163, v163, v6
    v_mul_f32 v164, v164, v6
    v_mul_f32 v165, v165, v6
    v_mul_f32 v166, v166, v6
    v_mul_f32 v167, v167, v6
    v_cvt_pk_bf16_f32 v176, v156, v157
    v_cvt_pk_bf16_f32 v177, v158, v159
    v_mov_b32 v178, 0
    v_mov_b32 v179, 0
    v_mov_b32 v7, v176
    v_mov_b32 v8, v177
    s_nop 1
    v_permlane32_swap_b32 v178, v7
    v_permlane32_swap_b32 v179, v8
    v_cvt_pk_bf16_f32 v180, v160, v161
    v_cvt_pk_bf16_f32 v181, v162, v163
    v_cvt_pk_bf16_f32 v182, v164, v165
    v_cvt_pk_bf16_f32 v183, v166, v167
    s_waitcnt vmcnt(0)
    s_nop 1
    v_mfma_f32_16x16x32_bf16 v[16:19], v[96:99], v[172:175], 0
    v_mfma_f32_16x16x32_bf16 v[20:23], v[100:103], v[172:175], 0
    v_mfma_f32_16x16x32_bf16 v[24:27], v[104:107], v[172:175], 0
    v_mfma_f32_16x16x32_bf16 v[28:31], v[108:111], v[172:175], 0
    v_mfma_f32_16x16x32_bf16 v[32:35], v[112:115], v[172:175], 0
    v_mfma_f32_16x16x32_bf16 v[36:39], v[116:119], v[172:175], 0
    v_mfma_f32_16x16x32_bf16 v[40:43], v[120:123], v[172:175], 0
    v_mfma_f32_16x16x32_bf16 v[44:47], v[124:127], v[172:175], 0
    v_mfma_f32_16x16x16_bf16 v[16:19], v[128:129], v[168:169], v[16:19]
    v_mfma_f32_16x16x16_bf16 v[20:23], v[128:129], v[170:171], v[20:23]
    v_mfma_f32_16x16x16_bf16 v[24:27], v[130:131], v[168:169], v[24:27]
    v_mfma_f32_16x16x16_bf16 v[28:31], v[130:131], v[170:171], v[28:31]
    v_mfma_f32_16x16x16_bf16 v[32:35], v[132:133], v[168:169], v[32:35]
    v_mfma_f32_16x16x16_bf16 v[36:39], v[132:133], v[170:171], v[36:39]
    v_mfma_f32_16x16x16_bf16 v[40:43], v[134:135], v[168:169], v[40:43]
    v_mfma_f32_16x16x16_bf16 v[44:47], v[134:135], v[170:171], v[44:47]
    v_mfma_f32_16x16x32_bf16 v[48:51], v[96:99], v[180:183], 0
    v_mfma_f32_16x16x32_bf16 v[52:55], v[100:103], v[180:183], 0
    v_mfma_f32_16x16x32_bf16 v[56:59], v[104:107], v[180:183], 0
    v_mfma_f32_16x16x32_bf16 v[60:63], v[108:111], v[180:183], 0
    v_mfma_f32_16x16x32_bf16 v[64:67], v[112:115], v[180:183], 0
    v_mfma_f32_16x16x32_bf16 v[68:71], v[116:119], v[180:183], 0
    v_mfma_f32_16x16x32_bf16 v[72:75], v[120:123], v[180:183], 0
    v_mfma_f32_16x16x32_bf16 v[76:79], v[124:127], v[180:183], 0
    v_mfma_f32_16x16x16_bf16 v[48:51], v[128:129], v[176:177], v[48:51]
    v_mfma_f32_16x16x16_bf16 v[52:55], v[128:129], v[178:179], v[52:55]
    v_mfma_f32_16x16x16_bf16 v[56:59], v[130:131], v[176:177], v[56:59]
    v_mfma_f32_16x16x16_bf16 v[60:63], v[130:131], v[178:179], v[60:63]
    v_mfma_f32_16x16x16_bf16 v[64:67], v[132:133], v[176:177], v[64:67]
    v_mfma_f32_16x16x16_bf16 v[68:71], v[132:133], v[178:179], v[68:71]
    v_mfma_f32_16x16x16_bf16 v[72:75], v[134:135], v[176:177], v[72:75]
    v_mfma_f32_16x16x16_bf16 v[76:79], v[134:135], v[178:179], v[76:79]
    s_lshr_b32 s16, s13, 5
    s_and_b32 s17, s13, 31
    s_lshl_b32 s16, s16, 18
    s_lshl_b32 s17, s17, 12
    s_add_u32 s16, s16, s17
    s_add_u32 s16, s16, 88080384
    v_add_u32 v6, s16, v5
    v_add_u32 v7, 131072, v6
    s_nop 7
    v_cvt_pk_bf16_f32 v144, v16, v17
    v_cvt_pk_bf16_f32 v145, v18, v19
    v_cvt_pk_bf16_f32 v146, v20, v21
    v_cvt_pk_bf16_f32 v147, v22, v23
    global_store_dwordx4 v6, v[144:147], s[4:5] offset:0 sc1
    v_cvt_pk_bf16_f32 v148, v24, v25
    v_cvt_pk_bf16_f32 v149, v26, v27
    v_cvt_pk_bf16_f32 v150, v28, v29
    v_cvt_pk_bf16_f32 v151, v30, v31
    global_store_dwordx4 v6, v[148:151], s[4:5] offset:1024 sc1
    v_cvt_pk_bf16_f32 v152, v32, v33
    v_cvt_pk_bf16_f32 v153, v34, v35
    v_cvt_pk_bf16_f32 v154, v36, v37
    v_cvt_pk_bf16_f32 v155, v38, v39
    global_store_dwordx4 v6, v[152:155], s[4:5] offset:2048 sc1
    v_cvt_pk_bf16_f32 v156, v40, v41
    v_cvt_pk_bf16_f32 v157, v42, v43
    v_cvt_pk_bf16_f32 v158, v44, v45
    v_cvt_pk_bf16_f32 v159, v46, v47
    global_store_dwordx4 v6, v[156:159], s[4:5] offset:3072 sc1
    v_cvt_pk_bf16_f32 v144, v48, v49
    v_cvt_pk_bf16_f32 v145, v50, v51
    v_cvt_pk_bf16_f32 v146, v52, v53
    v_cvt_pk_bf16_f32 v147, v54, v55
    global_store_dwordx4 v7, v[144:147], s[4:5] offset:0 sc1
    v_cvt_pk_bf16_f32 v148, v56, v57
    v_cvt_pk_bf16_f32 v149, v58, v59
    v_cvt_pk_bf16_f32 v150, v60, v61
    v_cvt_pk_bf16_f32 v151, v62, v63
    global_store_dwordx4 v7, v[148:151], s[4:5] offset:1024 sc1
    v_cvt_pk_bf16_f32 v152, v64, v65
    v_cvt_pk_bf16_f32 v153, v66, v67
    v_cvt_pk_bf16_f32 v154, v68, v69
    v_cvt_pk_bf16_f32 v155, v70, v71
    global_store_dwordx4 v7, v[152:155], s[4:5] offset:2048 sc1
    v_cvt_pk_bf16_f32 v156, v72, v73
    v_cvt_pk_bf16_f32 v157, v74, v75
    v_cvt_pk_bf16_f32 v158, v76, v77
    v_cvt_pk_bf16_f32 v159, v78, v79
    global_store_dwordx4 v7, v[156:159], s[4:5] offset:3072 sc1
    s_waitcnt vmcnt(0)
    s_barrier
    s_cmp_lg_u32 s12, 0
    s_cbranch_scc1 w_chain_kernel_45
    s_lshl_b32 s14, s41, 2
    s_lshr_b32 s15, s39, 3
    s_add_u32 s14, s14, s15
    s_lshl_b32 s14, s14, 6
    s_add_u32 s14, s14, 129011712
    s_mov_b64 exec, 1
    v_mov_b32 v6, s14
    v_mov_b32 v7, 1
    global_atomic_add v6, v7, s[4:5] sc1
    s_mov_b64 exec, -1
    s_branch w_chain_kernel_45
w_chain_kernel_47:
    s_sub_u32 s39, s39, 32
    s_and_b32 s21, s39, 3
    s_lshr_b32 s22, s39, 2
    s_lshl_b32 s14, s20, 2
    s_add_u32 s14, s14, s22
    s_lshl_b32 s14, s14, 6
    s_add_u32 s14, s14, 129011712
    v_mov_b32 v6, s14
w_chain_kernel_50:
    global_load_dword v8, v6, s[4:5] sc1
    s_waitcnt vmcnt(0)
    v_readfirstlane_b32 s15, v8
    s_nop 3
    s_cmp_ge_u32 s15, 8
    s_cbranch_scc1 w_chain_kernel_52
    s_add_u32 s43, s43, 1
    s_cmp_gt_u32 s43, 0x80000
    s_cbranch_scc1 w_chain_kernel_52
    s_sleep 8
    s_branch w_chain_kernel_50
w_chain_kernel_52:
    s_barrier
    s_lshl_b32 s24, s20, 20
    s_lshl_b32 s26, s22, 15
    s_add_u32 s24, s24, s26
    s_add_u32 s24, s24, 88080384
    s_lshl_b32 s25, s21, 20
    s_add_u32 s25, s25, s26
    s_add_u32 s25, s25, 12582912
    s_and_b32 s13, s12, 1
    s_mul_i32 s14, s13, 524288
    s_add_u32 s14, s14, s24
    s_mul_i32 s15, s13, 524288
    s_add_u32 s15, s15, s25
    s_cmp_lt_u32 s12, 2
    s_cselect_b32 s14, s14, s15
    v_lshlrev_b32 v8, 4, v1
    v_add_u32 v4, s14, v8
    s_mov_b32 s16, 130048
    s_mov_b32 s17, 130048
    s_cselect_b32 s16, s16, s17
    v_add_u32 v5, s16, v4
    s_mov_b32 s16, 260096
    s_mov_b32 s17, 260096
    s_cselect_b32 s16, s16, s17
    v_add_u32 v6, s16, v4
    s_mov_b32 s16, 390144
    s_mov_b32 s17, 390144
    s_cselect_b32 s16, s16, s17
    v_add_u32 v7, s16, v4
    s_lshl_b32 s17, s12, 12
    s_lshr_b32 s18, s12, 1
    s_lshl_b32 s18, s18, 12
    v_add_u32 v9, s18, v8
    s_lshl_b32 s19, s13, 12
    v_add_u32 v10, s19, v8
    v_add_u32 v10, 8192, v10
    v_add_u32 v11, 65536, v9
    v_add_u32 v12, 65536, v10
    v_mov_b32 v64, 0
    v_mov_b32 v65, 0
    v_mov_b32 v66, 0
    v_mov_b32 v67, 0
    v_mov_b32 v68, 0
    v_mov_b32 v69, 0
    v_mov_b32 v70, 0
    v_mov_b32 v71, 0
    v_mov_b32 v72, 0
    v_mov_b32 v73, 0
    v_mov_b32 v74, 0
    v_mov_b32 v75, 0
    v_mov_b32 v76, 0
    v_mov_b32 v77, 0
    v_mov_b32 v78, 0
    v_mov_b32 v79, 0
    v_mov_b32 v80, 0
    v_mov_b32 v81, 0
    v_mov_b32 v82, 0
    v_mov_b32 v83, 0
    v_mov_b32 v84, 0
    v_mov_b32 v85, 0
    v_mov_b32 v86, 0
    v_mov_b32 v87, 0
    v_mov_b32 v88, 0
    v_mov_b32 v89, 0
    v_mov_b32 v90, 0
    v_mov_b32 v91, 0
    v_mov_b32 v92, 0
    v_mov_b32 v93, 0
    v_mov_b32 v94, 0
    v_mov_b32 v95, 0
    v_mov_b32 v96, 0
    v_mov_b32 v97, 0
    v_mov_b32 v98, 0
    v_mov_b32 v99, 0
    v_mov_b32 v100, 0
    v_mov_b32 v101, 0
    v_mov_b32 v102, 0
    v_mov_b32 v103, 0
    v_mov_b32 v104, 0
    v_mov_b32 v105, 0
    v_mov_b32 v106, 0
    v_mov_b32 v107, 0
    v_mov_b32 v108, 0
    v_mov_b32 v109, 0
    v_mov_b32 v110, 0
    v_mov_b32 v111, 0
    v_mov_b32 v112, 0
    v_mov_b32 v113, 0
    v_mov_b32 v114, 0
    v_mov_b32 v115, 0
    v_mov_b32 v116, 0
    v_mov_b32 v117, 0
    v_mov_b32 v118, 0
    v_mov_b32 v119, 0
    v_mov_b32 v120, 0
    v_mov_b32 v121, 0
    v_mov_b32 v122, 0
    v_mov_b32 v123, 0
    v_mov_b32 v124, 0
    v_mov_b32 v125, 0
    v_mov_b32 v126, 0
    v_mov_b32 v127, 0
    s_add_u32 s13, s17, 0
    s_mov_b32 m0, s13
    s_mov_b32 s13, 0
    buffer_load_dwordx4 v4, s[8:11], s13 offen offset:0 sc1 lds
    buffer_load_dwordx4 v5, s[8:11], s13 offen offset:1024 sc1 lds
    buffer_load_dwordx4 v6, s[8:11], s13 offen offset:2048 sc1 lds
    buffer_load_dwordx4 v7, s[8:11], s13 offen offset:3072 sc1 lds
    s_add_u32 s13, s17, 16384
    s_mov_b32 m0, s13
    s_mov_b32 s13, 1024
    buffer_load_dwordx4 v4, s[8:11], s13 offen offset:0 sc1 lds
    buffer_load_dwordx4 v5, s[8:11], s13 offen offset:1024 sc1 lds
    buffer_load_dwordx4 v6, s[8:11], s13 offen offset:2048 sc1 lds
    buffer_load_dwordx4 v7, s[8:11], s13 offen offset:3072 sc1 lds
    s_add_u32 s13, s17, 32768
    s_mov_b32 m0, s13
    s_mov_b32 s13, 2048
    buffer_load_dwordx4 v4, s[8:11], s13 offen offset:0 sc1 lds
    buffer_load_dwordx4 v5, s[8:11], s13 offen offset:1024 sc1 lds
    buffer_load_dwordx4 v6, s[8:11], s13 offen offset:2048 sc1 lds
    buffer_load_dwordx4 v7, s[8:11], s13 offen offset:3072 sc1 lds
    s_add_u32 s13, s17, 49152
    s_mov_b32 m0, s13
    s_mov_b32 s13, 3072
    buffer_load_dwordx4 v4, s[8:11], s13 offen offset:0 sc1 lds
    buffer_load_dwordx4 v5, s[8:11], s13 offen offset:1024 sc1 lds
    buffer_load_dwordx4 v6, s[8:11], s13 offen offset:2048 sc1 lds
    buffer_load_dwordx4 v7, s[8:11], s13 offen offset:3072 sc1 lds
    s_add_u32 s13, s17, 65536
    s_mov_b32 m0, s13
    s_mov_b32 s13, 4096
    buffer_load_dwordx4 v4, s[8:11], s13 offen offset:0 sc1 lds
    buffer_load_dwordx4 v5, s[8:11], s13 offen offset:1024 sc1 lds
    buffer_load_dwordx4 v6, s[8:11], s13 offen offset:2048 sc1 lds
    buffer_load_dwordx4 v7, s[8:11], s13 offen offset:3072 sc1 lds
    s_add_u32 s13, s17, 81920
    s_mov_b32 m0, s13
    s_mov_b32 s13, 5120
    buffer_load_dwordx4 v4, s[8:11], s13 offen offset:0 sc1 lds
    buffer_load_dwordx4 v5, s[8:11], s13 offen offset:1024 sc1 lds
    buffer_load_dwordx4 v6, s[8:11], s13 offen offset:2048 sc1 lds
    buffer_load_dwordx4 v7, s[8:11], s13 offen offset:3072 sc1 lds
    s_add_u32 s13, s17, 98304
    s_mov_b32 m0, s13
    s_mov_b32 s13, 6144
    buffer_load_dwordx4 v4, s[8:11], s13 offen offset:0 sc1 lds
    buffer_load_dwordx4 v5, s[8:11], s13 offen offset:1024 sc1 lds
    buffer_load_dwordx4 v6, s[8:11], s13 offen offset:2048 sc1 lds
    buffer_load_dwordx4 v7, s[8:11], s13 offen offset:3072 sc1 lds
    s_waitcnt vmcnt(24)
    s_barrier
    ds_read_b128 v[24:27], v9 offset:0
    ds_read_b128 v[28:31], v9 offset:1024
    ds_read_b128 v[32:35], v9 offset:2048
    ds_read_b128 v[36:39], v9 offset:3072
    ds_read_b128 v[40:43], v10 offset:0
    ds_read_b128 v[44:47], v10 offset:1024
    ds_read_b128 v[48:51], v10 offset:2048
    ds_read_b128 v[52:55], v10 offset:3072
    s_waitcnt vmcnt(20)
    s_barrier
    s_add_u32 s13, s17, 114688
    s_mov_b32 m0, s13
    s_mov_b32 s13, 7168
    buffer_load_dwordx4 v4, s[8:11], s13 offen offset:0 sc1 lds
    buffer_load_dwordx4 v5, s[8:11], s13 offen offset:1024 sc1 lds
    buffer_load_dwordx4 v6, s[8:11], s13 offen offset:2048 sc1 lds
    buffer_load_dwordx4 v7, s[8:11], s13 offen offset:3072 sc1 lds
    ds_read_b128 v[128:131], v9 offset:16384
    ds_read_b128 v[132:135], v9 offset:17408
    ds_read_b128 v[136:139], v9 offset:18432
    ds_read_b128 v[140:143], v9 offset:19456
    ds_read_b128 v[144:147], v10 offset:16384
    ds_read_b128 v[148:151], v10 offset:17408
    ds_read_b128 v[152:155], v10 offset:18432
    ds_read_b128 v[156:159], v10 offset:19456
    s_waitcnt lgkmcnt(8)
    v_mfma_f32_16x16x32_bf16 v[64:67], v[40:43], v[24:27], v[64:67]
    v_mfma_f32_16x16x32_bf16 v[68:71], v[44:47], v[24:27], v[68:71]
    v_mfma_f32_16x16x32_bf16 v[72:75], v[48:51], v[24:27], v[72:75]
    v_mfma_f32_16x16x32_bf16 v[76:79], v[52:55], v[24:27], v[76:79]
    v_mfma_f32_16x16x32_bf16 v[80:83], v[40:43], v[28:31], v[80:83]
    v_mfma_f32_16x16x32_bf16 v[84:87], v[44:47], v[28:31], v[84:87]
    v_mfma_f32_16x16x32_bf16 v[88:91], v[48:51], v[28:31], v[88:91]
    v_mfma_f32_16x16x32_bf16 v[92:95], v[52:55], v[28:31], v[92:95]
    v_mfma_f32_16x16x32_bf16 v[96:99], v[40:43], v[32:35], v[96:99]
    v_mfma_f32_16x16x32_bf16 v[100:103], v[44:47], v[32:35], v[100:103]
    v_mfma_f32_16x16x32_bf16 v[104:107], v[48:51], v[32:35], v[104:107]
    v_mfma_f32_16x16x32_bf16 v[108:111], v[52:55], v[32:35], v[108:111]
    v_mfma_f32_16x16x32_bf16 v[112:115], v[40:43], v[36:39], v[112:115]
    v_mfma_f32_16x16x32_bf16 v[116:119], v[44:47], v[36:39], v[116:119]
    v_mfma_f32_16x16x32_bf16 v[120:123], v[48:51], v[36:39], v[120:123]
    v_mfma_f32_16x16x32_bf16 v[124:127], v[52:55], v[36:39], v[124:127]
    s_waitcnt vmcnt(20)
    s_barrier
    s_add_u32 s13, s17, 0
    s_mov_b32 m0, s13
    s_mov_b32 s13, 8192
    buffer_load_dwordx4 v4, s[8:11], s13 offen offset:0 sc1 lds
    buffer_load_dwordx4 v5, s[8:11], s13 offen offset:1024 sc1 lds
    buffer_load_dwordx4 v6, s[8:11], s13 offen offset:2048 sc1 lds
    buffer_load_dwordx4 v7, s[8:11], s13 offen offset:3072 sc1 lds
    ds_read_b128 v[24:27], v9 offset:32768
    ds_read_b128 v[28:31], v9 offset:33792
    ds_read_b128 v[32:35], v9 offset:34816
    ds_read_b128 v[36:39], v9 offset:35840
    ds_read_b128 v[40:43], v10 offset:32768
    ds_read_b128 v[44:47], v10 offset:33792
    ds_read_b128 v[48:51], v10 offset:34816
    ds_read_b128 v[52:55], v10 offset:35840
    s_waitcnt lgkmcnt(8)
    v_mfma_f32_16x16x32_bf16 v[64:67], v[144:147], v[128:131], v[64:67]
    v_mfma_f32_16x16x32_bf16 v[68:71], v[148:151], v[128:131], v[68:71]
    v_mfma_f32_16x16x32_bf16 v[72:75], v[152:155], v[128:131], v[72:75]
    v_mfma_f32_16x16x32_bf16 v[76:79], v[156:159], v[128:131], v[76:79]
    v_mfma_f32_16x16x32_bf16 v[80:83], v[144:147], v[132:135], v[80:83]
    v_mfma_f32_16x16x32_bf16 v[84:87], v[148:151], v[132:135], v[84:87]
    v_mfma_f32_16x16x32_bf16 v[88:91], v[152:155], v[132:135], v[88:91]
    v_mfma_f32_16x16x32_bf16 v[92:95], v[156:159], v[132:135], v[92:95]
    v_mfma_f32_16x16x32_bf16 v[96:99], v[144:147], v[136:139], v[96:99]
    v_mfma_f32_16x16x32_bf16 v[100:103], v[148:151], v[136:139], v[100:103]
    v_mfma_f32_16x16x32_bf16 v[104:107], v[152:155], v[136:139], v[104:107]
    v_mfma_f32_16x16x32_bf16 v[108:111], v[156:159], v[136:139], v[108:111]
    v_mfma_f32_16x16x32_bf16 v[112:115], v[144:147], v[140:143], v[112:115]
    v_mfma_f32_16x16x32_bf16 v[116:119], v[148:151], v[140:143], v[116:119]
    v_mfma_f32_16x16x32_bf16 v[120:123], v[152:155], v[140:143], v[120:123]
    v_mfma_f32_16x16x32_bf16 v[124:127], v[156:159], v[140:143], v[124:127]
    s_waitcnt vmcnt(20)
    s_barrier
    s_add_u32 s13, s17, 16384
    s_mov_b32 m0, s13
    s_mov_b32 s13, 9216
    buffer_load_dwordx4 v4, s[8:11], s13 offen offset:0 sc1 lds
    buffer_load_dwordx4 v5, s[8:11], s13 offen offset:1024 sc1 lds
    buffer_load_dwordx4 v6, s[8:11], s13 offen offset:2048 sc1 lds
    buffer_load_dwordx4 v7, s[8:11], s13 offen offset:3072 sc1 lds
    ds_read_b128 v[128:131], v9 offset:49152
    ds_read_b128 v[132:135], v9 offset:50176
    ds_read_b128 v[136:139], v9 offset:51200
    ds_read_b128 v[140:143], v9 offset:52224
    ds_read_b128 v[144:147], v10 offset:49152
    ds_read_b128 v[148:151], v10 offset:50176
    ds_read_b128 v[152:155], v10 offset:51200
    ds_read_b128 v[156:159], v10 offset:52224
    s_waitcnt lgkmcnt(8)
    v_mfma_f32_16x16x32_bf16 v[64:67], v[40:43], v[24:27], v[64:67]
    v_mfma_f32_16x16x32_bf16 v[68:71], v[44:47], v[24:27], v[68:71]
    v_mfma_f32_16x16x32_bf16 v[72:75], v[48:51], v[24:27], v[72:75]
    v_mfma_f32_16x16x32_bf16 v[76:79], v[52:55], v[24:27], v[76:79]
    v_mfma_f32_16x16x32_bf16 v[80:83], v[40:43], v[28:31], v[80:83]
    v_mfma_f32_16x16x32_bf16 v[84:87], v[44:47], v[28:31], v[84:87]
    v_mfma_f32_16x16x32_bf16 v[88:91], v[48:51], v[28:31], v[88:91]
    v_mfma_f32_16x16x32_bf16 v[92:95], v[52:55], v[28:31], v[92:95]
    v_mfma_f32_16x16x32_bf16 v[96:99], v[40:43], v[32:35], v[96:99]
    v_mfma_f32_16x16x32_bf16 v[100:103], v[44:47], v[32:35], v[100:103]
    v_mfma_f32_16x16x32_bf16 v[104:107], v[48:51], v[32:35], v[104:107]
    v_mfma_f32_16x16x32_bf16 v[108:111], v[52:55], v[32:35], v[108:111]
    v_mfma_f32_16x16x32_bf16 v[112:115], v[40:43], v[36:39], v[112:115]
    v_mfma_f32_16x16x32_bf16 v[116:119], v[44:47], v[36:39], v[116:119]
    v_mfma_f32_16x16x32_bf16 v[120:123], v[48:51], v[36:39], v[120:123]
    v_mfma_f32_16x16x32_bf16 v[124:127], v[52:55], v[36:39], v[124:127]
    s_waitcnt vmcnt(20)
    s_barrier
    s_add_u32 s13, s17, 32768
    s_mov_b32 m0, s13
    s_mov_b32 s13, 10240
    buffer_load_dwordx4 v4, s[8:11], s13 offen offset:0 sc1 lds
    buffer_load_dwordx4 v5, s[8:11], s13 offen offset:1024 sc1 lds
    buffer_load_dwordx4 v6, s[8:11], s13 offen offset:2048 sc1 lds
    buffer_load_dwordx4 v7, s[8:11], s13 offen offset:3072 sc1 lds
    ds_read_b128 v[24:27], v11 offset:0
    ds_read_b128 v[28:31], v11 offset:1024
    ds_read_b128 v[32:35], v11 offset:2048
    ds_read_b128 v[36:39], v11 offset:3072
    ds_read_b128 v[40:43], v12 offset:0
    ds_read_b128 v[44:47], v12 offset:1024
    ds_read_b128 v[48:51], v12 offset:2048
    ds_read_b128 v[52:55], v12 offset:3072
    s_waitcnt lgkmcnt(8)
    v_mfma_f32_16x16x32_bf16 v[64:67], v[144:147], v[128:131], v[64:67]
    v_mfma_f32_16x16x32_bf16 v[68:71], v[148:151], v[128:131], v[68:71]
    v_mfma_f32_16x16x32_bf16 v[72:75], v[152:155], v[128:131], v[72:75]
    v_mfma_f32_16x16x32_bf16 v[76:79], v[156:159], v[128:131], v[76:79]
    v_mfma_f32_16x16x32_bf16 v[80:83], v[144:147], v[132:135], v[80:83]
    v_mfma_f32_16x16x32_bf16 v[84:87], v[148:151], v[132:135], v[84:87]
    v_mfma_f32_16x16x32_bf16 v[88:91], v[152:155], v[132:135], v[88:91]
    v_mfma_f32_16x16x32_bf16 v[92:95], v[156:159], v[132:135], v[92:95]
    v_mfma_f32_16x16x32_bf16 v[96:99], v[144:147], v[136:139], v[96:99]
    v_mfma_f32_16x16x32_bf16 v[100:103], v[148:151], v[136:139], v[100:103]
    v_mfma_f32_16x16x32_bf16 v[104:107], v[152:155], v[136:139], v[104:107]
    v_mfma_f32_16x16x32_bf16 v[108:111], v[156:159], v[136:139], v[108:111]
    v_mfma_f32_16x16x32_bf16 v[112:115], v[144:147], v[140:143], v[112:115]
    v_mfma_f32_16x16x32_bf16 v[116:119], v[148:151], v[140:143], v[116:119]
    v_mfma_f32_16x16x32_bf16 v[120:123], v[152:155], v[140:143], v[120:123]
    v_mfma_f32_16x16x32_bf16 v[124:127], v[156:159], v[140:143], v[124:127]
    s_waitcnt vmcnt(20)
    s_barrier
    s_add_u32 s13, s17, 49152
    s_mov_b32 m0, s13
    s_mov_b32 s13, 11264
    buffer_load_dwordx4 v4, s[8:11], s13 offen offset:0 sc1 lds
    buffer_load_dwordx4 v5, s[8:11], s13 offen offset:1024 sc1 lds
    buffer_load_dwordx4 v6, s[8:11], s13 offen offset:2048 sc1 lds
    buffer_load_dwordx4 v7, s[8:11], s13 offen offset:3072 sc1 lds
    ds_read_b128 v[128:131], v11 offset:16384
    ds_read_b128 v[132:135], v11 offset:17408
    ds_read_b128 v[136:139], v11 offset:18432
    ds_read_b128 v[140:143], v11 offset:19456
    ds_read_b128 v[144:147], v12 offset:16384
    ds_read_b128 v[148:151], v12 offset:17408
    ds_read_b128 v[152:155], v12 offset:18432
    ds_read_b128 v[156:159], v12 offset:19456
    s_waitcnt lgkmcnt(8)
    v_mfma_f32_16x16x32_bf16 v[64:67], v[40:43], v[24:27], v[64:67]
    v_mfma_f32_16x16x32_bf16 v[68:71], v[44:47], v[24:27], v[68:71]
    v_mfma_f32_16x16x32_bf16 v[72:75], v[48:51], v[24:27], v[72:75]
    v_mfma_f32_16x16x32_bf16 v[76:79], v[52:55], v[24:27], v[76:79]
    v_mfma_f32_16x16x32_bf16 v[80:83], v[40:43], v[28:31], v[80:83]
    v_mfma_f32_16x16x32_bf16 v[84:87], v[44:47], v[28:31], v[84:87]
    v_mfma_f32_16x16x32_bf16 v[88:91], v[48:51], v[28:31], v[88:91]
    v_mfma_f32_16x16x32_bf16 v[92:95], v[52:55], v[28:31], v[92:95]
    v_mfma_f32_16x16x32_bf16 v[96:99], v[40:43], v[32:35], v[96:99]
    v_mfma_f32_16x16x32_bf16 v[100:103], v[44:47], v[32:35], v[100:103]
    v_mfma_f32_16x16x32_bf16 v[104:107], v[48:51], v[32:35], v[104:107]
    v_mfma_f32_16x16x32_bf16 v[108:111], v[52:55], v[32:35], v[108:111]
    v_mfma_f32_16x16x32_bf16 v[112:115], v[40:43], v[36:39], v[112:115]
    v_mfma_f32_16x16x32_bf16 v[116:119], v[44:47], v[36:39], v[116:119]
    v_mfma_f32_16x16x32_bf16 v[120:123], v[48:51], v[36:39], v[120:123]
    v_mfma_f32_16x16x32_bf16 v[124:127], v[52:55], v[36:39], v[124:127]
    s_waitcnt vmcnt(20)
    s_barrier
    s_add_u32 s13, s17, 65536
    s_mov_b32 m0, s13
    s_mov_b32 s13, 12288
    buffer_load_dwordx4 v4, s[8:11], s13 offen offset:0 sc1 lds
    buffer_load_dwordx4 v5, s[8:11], s13 offen offset:1024 sc1 lds
    buffer_load_dwordx4 v6, s[8:11], s13 offen offset:2048 sc1 lds
    buffer_load_dwordx4 v7, s[8:11], s13 offen offset:3072 sc1 lds
    ds_read_b128 v[24:27], v11 offset:32768
    ds_read_b128 v[28:31], v11 offset:33792
    ds_read_b128 v[32:35], v11 offset:34816
    ds_read_b128 v[36:39], v11 offset:35840
    ds_read_b128 v[40:43], v12 offset:32768
    ds_read_b128 v[44:47], v12 offset:33792
    ds_read_b128 v[48:51], v12 offset:34816
    ds_read_b128 v[52:55], v12 offset:35840
    s_waitcnt lgkmcnt(8)
    v_mfma_f32_16x16x32_bf16 v[64:67], v[144:147], v[128:131], v[64:67]
    v_mfma_f32_16x16x32_bf16 v[68:71], v[148:151], v[128:131], v[68:71]
    v_mfma_f32_16x16x32_bf16 v[72:75], v[152:155], v[128:131], v[72:75]
    v_mfma_f32_16x16x32_bf16 v[76:79], v[156:159], v[128:131], v[76:79]
    v_mfma_f32_16x16x32_bf16 v[80:83], v[144:147], v[132:135], v[80:83]
    v_mfma_f32_16x16x32_bf16 v[84:87], v[148:151], v[132:135], v[84:87]
    v_mfma_f32_16x16x32_bf16 v[88:91], v[152:155], v[132:135], v[88:91]
    v_mfma_f32_16x16x32_bf16 v[92:95], v[156:159], v[132:135], v[92:95]
    v_mfma_f32_16x16x32_bf16 v[96:99], v[144:147], v[136:139], v[96:99]
    v_mfma_f32_16x16x32_bf16 v[100:103], v[148:151], v[136:139], v[100:103]
    v_mfma_f32_16x16x32_bf16 v[104:107], v[152:155], v[136:139], v[104:107]
    v_mfma_f32_16x16x32_bf16 v[108:111], v[156:159], v[136:139], v[108:111]
    v_mfma_f32_16x16x32_bf16 v[112:115], v[144:147], v[140:143], v[112:115]
    v_mfma_f32_16x16x32_bf16 v[116:119], v[148:151], v[140:143], v[116:119]
    v_mfma_f32_16x16x32_bf16 v[120:123], v[152:155], v[140:143], v[120:123]
    v_mfma_f32_16x16x32_bf16 v[124:127], v[156:159], v[140:143], v[124:127]
    s_waitcnt vmcnt(20)
    s_barrier
    s_add_u32 s13, s17, 81920
    s_mov_b32 m0, s13
    s_mov_b32 s13, 13312
    buffer_load_dwordx4 v4, s[8:11], s13 offen offset:0 sc1 lds
    buffer_load_dwordx4 v5, s[8:11], s13 offen offset:1024 sc1 lds
    buffer_load_dwordx4 v6, s[8:11], s13 offen offset:2048 sc1 lds
    buffer_load_dwordx4 v7, s[8:11], s13 offen offset:3072 sc1 lds
    ds_read_b128 v[128:131], v11 offset:49152
    ds_read_b128 v[132:135], v11 offset:50176
    ds_read_b128 v[136:139], v11 offset:51200
    ds_read_b128 v[140:143], v11 offset:52224
    ds_read_b128 v[144:147], v12 offset:49152
    ds_read_b128 v[148:151], v12 offset:50176
    ds_read_b128 v[152:155], v12 offset:51200
    ds_read_b128 v[156:159], v12 offset:52224
    s_waitcnt lgkmcnt(8)
    v_mfma_f32_16x16x32_bf16 v[64:67], v[40:43], v[24:27], v[64:67]
    v_mfma_f32_16x16x32_bf16 v[68:71], v[44:47], v[24:27], v[68:71]
    v_mfma_f32_16x16x32_bf16 v[72:75], v[48:51], v[24:27], v[72:75]
    v_mfma_f32_16x16x32_bf16 v[76:79], v[52:55], v[24:27], v[76:79]
    v_mfma_f32_16x16x32_bf16 v[80:83], v[40:43], v[28:31], v[80:83]
    v_mfma_f32_16x16x32_bf16 v[84:87], v[44:47], v[28:31], v[84:87]
    v_mfma_f32_16x16x32_bf16 v[88:91], v[48:51], v[28:31], v[88:91]
    v_mfma_f32_16x16x32_bf16 v[92:95], v[52:55], v[28:31], v[92:95]
    v_mfma_f32_16x16x32_bf16 v[96:99], v[40:43], v[32:35], v[96:99]
    v_mfma_f32_16x16x32_bf16 v[100:103], v[44:47], v[32:35], v[100:103]
    v_mfma_f32_16x16x32_bf16 v[104:107], v[48:51], v[32:35], v[104:107]
    v_mfma_f32_16x16x32_bf16 v[108:111], v[52:55], v[32:35], v[108:111]
    v_mfma_f32_16x16x32_bf16 v[112:115], v[40:43], v[36:39], v[112:115]
    v_mfma_f32_16x16x32_bf16 v[116:119], v[44:47], v[36:39], v[116:119]
    v_mfma_f32_16x16x32_bf16 v[120:123], v[48:51], v[36:39], v[120:123]
    v_mfma_f32_16x16x32_bf16 v[124:127], v[52:55], v[36:39], v[124:127]
    s_waitcnt vmcnt(20)
    s_barrier
    s_add_u32 s13, s17, 98304
    s_mov_b32 m0, s13
    s_mov_b32 s13, 14336
    buffer_load_dwordx4 v4, s[8:11], s13 offen offset:0 sc1 lds
    buffer_load_dwordx4 v5, s[8:11], s13 offen offset:1024 sc1 lds
    buffer_load_dwordx4 v6, s[8:11], s13 offen offset:2048 sc1 lds
    buffer_load_dwordx4 v7, s[8:11], s13 offen offset:3072 sc1 lds
    ds_read_b128 v[24:27], v9 offset:0
    ds_read_b128 v[28:31], v9 offset:1024
    ds_read_b128 v[32:35], v9 offset:2048
    ds_read_b128 v[36:39], v9 offset:3072
    ds_read_b128 v[40:43], v10 offset:0
    ds_read_b128 v[44:47], v10 offset:1024
    ds_read_b128 v[48:51], v10 offset:2048
    ds_read_b128 v[52:55], v10 offset:3072
    s_waitcnt lgkmcnt(8)
    v_mfma_f32_16x16x32_bf16 v[64:67], v[144:147], v[128:131], v[64:67]
    v_mfma_f32_16x16x32_bf16 v[68:71], v[148:151], v[128:131], v[68:71]
    v_mfma_f32_16x16x32_bf16 v[72:75], v[152:155], v[128:131], v[72:75]
    v_mfma_f32_16x16x32_bf16 v[76:79], v[156:159], v[128:131], v[76:79]
    v_mfma_f32_16x16x32_bf16 v[80:83], v[144:147], v[132:135], v[80:83]
    v_mfma_f32_16x16x32_bf16 v[84:87], v[148:151], v[132:135], v[84:87]
    v_mfma_f32_16x16x32_bf16 v[88:91], v[152:155], v[132:135], v[88:91]
    v_mfma_f32_16x16x32_bf16 v[92:95], v[156:159], v[132:135], v[92:95]
    v_mfma_f32_16x16x32_bf16 v[96:99], v[144:147], v[136:139], v[96:99]
    v_mfma_f32_16x16x32_bf16 v[100:103], v[148:151], v[136:139], v[100:103]
    v_mfma_f32_16x16x32_bf16 v[104:107], v[152:155], v[136:139], v[104:107]
    v_mfma_f32_16x16x32_bf16 v[108:111], v[156:159], v[136:139], v[108:111]
    v_mfma_f32_16x16x32_bf16 v[112:115], v[144:147], v[140:143], v[112:115]
    v_mfma_f32_16x16x32_bf16 v[116:119], v[148:151], v[140:143], v[116:119]
    v_mfma_f32_16x16x32_bf16 v[120:123], v[152:155], v[140:143], v[120:123]
    v_mfma_f32_16x16x32_bf16 v[124:127], v[156:159], v[140:143], v[124:127]
    s_waitcnt vmcnt(20)
    s_barrier
    s_add_u32 s13, s17, 114688
    s_mov_b32 m0, s13
    s_mov_b32 s13, 15360
    buffer_load_dwordx4 v4, s[8:11], s13 offen offset:0 sc1 lds
    buffer_load_dwordx4 v5, s[8:11], s13 offen offset:1024 sc1 lds
    buffer_load_dwordx4 v6, s[8:11], s13 offen offset:2048 sc1 lds
    buffer_load_dwordx4 v7, s[8:11], s13 offen offset:3072 sc1 lds
    ds_read_b128 v[128:131], v9 offset:16384
    ds_read_b128 v[132:135], v9 offset:17408
    ds_read_b128 v[136:139], v9 offset:18432
    ds_read_b128 v[140:143], v9 offset:19456
    ds_read_b128 v[144:147], v10 offset:16384
    ds_read_b128 v[148:151], v10 offset:17408
    ds_read_b128 v[152:155], v10 offset:18432
    ds_read_b128 v[156:159], v10 offset:19456
    s_waitcnt lgkmcnt(8)
    v_mfma_f32_16x16x32_bf16 v[64:67], v[40:43], v[24:27], v[64:67]
    v_mfma_f32_16x16x32_bf16 v[68:71], v[44:47], v[24:27], v[68:71]
    v_mfma_f32_16x16x32_bf16 v[72:75], v[48:51], v[24:27], v[72:75]
    v_mfma_f32_16x16x32_bf16 v[76:79], v[52:55], v[24:27], v[76:79]
    v_mfma_f32_16x16x32_bf16 v[80:83], v[40:43], v[28:31], v[80:83]
    v_mfma_f32_16x16x32_bf16 v[84:87], v[44:47], v[28:31], v[84:87]
    v_mfma_f32_16x16x32_bf16 v[88:91], v[48:51], v[28:31], v[88:91]
    v_mfma_f32_16x16x32_bf16 v[92:95], v[52:55], v[28:31], v[92:95]
    v_mfma_f32_16x16x32_bf16 v[96:99], v[40:43], v[32:35], v[96:99]
    v_mfma_f32_16x16x32_bf16 v[100:103], v[44:47], v[32:35], v[100:103]
    v_mfma_f32_16x16x32_bf16 v[104:107], v[48:51], v[32:35], v[104:107]
    v_mfma_f32_16x16x32_bf16 v[108:111], v[52:55], v[32:35], v[108:111]
    v_mfma_f32_16x16x32_bf16 v[112:115], v[40:43], v[36:39], v[112:115]
    v_mfma_f32_16x16x32_bf16 v[116:119], v[44:47], v[36:39], v[116:119]
    v_mfma_f32_16x16x32_bf16 v[120:123], v[48:51], v[36:39], v[120:123]
    v_mfma_f32_16x16x32_bf16 v[124:127], v[52:55], v[36:39], v[124:127]
    s_waitcnt vmcnt(20)
    s_barrier
    s_add_u32 s13, s17, 0
    s_mov_b32 m0, s13
    s_mov_b32 s13, 16384
    buffer_load_dwordx4 v4, s[8:11], s13 offen offset:0 sc1 lds
    buffer_load_dwordx4 v5, s[8:11], s13 offen offset:1024 sc1 lds
    buffer_load_dwordx4 v6, s[8:11], s13 offen offset:2048 sc1 lds
    buffer_load_dwordx4 v7, s[8:11], s13 offen offset:3072 sc1 lds
    ds_read_b128 v[24:27], v9 offset:32768
    ds_read_b128 v[28:31], v9 offset:33792
    ds_read_b128 v[32:35], v9 offset:34816
    ds_read_b128 v[36:39], v9 offset:35840
    ds_read_b128 v[40:43], v10 offset:32768
    ds_read_b128 v[44:47], v10 offset:33792
    ds_read_b128 v[48:51], v10 offset:34816
    ds_read_b128 v[52:55], v10 offset:35840
    s_waitcnt lgkmcnt(8)
    v_mfma_f32_16x16x32_bf16 v[64:67], v[144:147], v[128:131], v[64:67]
    v_mfma_f32_16x16x32_bf16 v[68:71], v[148:151], v[128:131], v[68:71]
    v_mfma_f32_16x16x32_bf16 v[72:75], v[152:155], v[128:131], v[72:75]
    v_mfma_f32_16x16x32_bf16 v[76:79], v[156:159], v[128:131], v[76:79]
    v_mfma_f32_16x16x32_bf16 v[80:83], v[144:147], v[132:135], v[80:83]
    v_mfma_f32_16x16x32_bf16 v[84:87], v[148:151], v[132:135], v[84:87]
    v_mfma_f32_16x16x32_bf16 v[88:91], v[152:155], v[132:135], v[88:91]
    v_mfma_f32_16x16x32_bf16 v[92:95], v[156:159], v[132:135], v[92:95]
    v_mfma_f32_16x16x32_bf16 v[96:99], v[144:147], v[136:139], v[96:99]
    v_mfma_f32_16x16x32_bf16 v[100:103], v[148:151], v[136:139], v[100:103]
    v_mfma_f32_16x16x32_bf16 v[104:107], v[152:155], v[136:139], v[104:107]
    v_mfma_f32_16x16x32_bf16 v[108:111], v[156:159], v[136:139], v[108:111]
    v_mfma_f32_16x16x32_bf16 v[112:115], v[144:147], v[140:143], v[112:115]
    v_mfma_f32_16x16x32_bf16 v[116:119], v[148:151], v[140:143], v[116:119]
    v_mfma_f32_16x16x32_bf16 v[120:123], v[152:155], v[140:143], v[120:123]
    v_mfma_f32_16x16x32_bf16 v[124:127], v[156:159], v[140:143], v[124:127]
    s_waitcnt vmcnt(20)
    s_barrier
    s_add_u32 s13, s17, 16384
    s_mov_b32 m0, s13
    s_mov_b32 s13, 17408
    buffer_load_dwordx4 v4, s[8:11], s13 offen offset:0 sc1 lds
    buffer_load_dwordx4 v5, s[8:11], s13 offen offset:1024 sc1 lds
    buffer_load_dwordx4 v6, s[8:11], s13 offen offset:2048 sc1 lds
    buffer_load_dwordx4 v7, s[8:11], s13 offen offset:3072 sc1 lds
    ds_read_b128 v[128:131], v9 offset:49152
    ds_read_b128 v[132:135], v9 offset:50176
    ds_read_b128 v[136:139], v9 offset:51200
    ds_read_b128 v[140:143], v9 offset:52224
    ds_read_b128 v[144:147], v10 offset:49152
    ds_read_b128 v[148:151], v10 offset:50176
    ds_read_b128 v[152:155], v10 offset:51200
    ds_read_b128 v[156:159], v10 offset:52224
    s_waitcnt lgkmcnt(8)
    v_mfma_f32_16x16x32_bf16 v[64:67], v[40:43], v[24:27], v[64:67]
    v_mfma_f32_16x16x32_bf16 v[68:71], v[44:47], v[24:27], v[68:71]
    v_mfma_f32_16x16x32_bf16 v[72:75], v[48:51], v[24:27], v[72:75]
    v_mfma_f32_16x16x32_bf16 v[76:79], v[52:55], v[24:27], v[76:79]
    v_mfma_f32_16x16x32_bf16 v[80:83], v[40:43], v[28:31], v[80:83]
    v_mfma_f32_16x16x32_bf16 v[84:87], v[44:47], v[28:31], v[84:87]
    v_mfma_f32_16x16x32_bf16 v[88:91], v[48:51], v[28:31], v[88:91]
    v_mfma_f32_16x16x32_bf16 v[92:95], v[52:55], v[28:31], v[92:95]
    v_mfma_f32_16x16x32_bf16 v[96:99], v[40:43], v[32:35], v[96:99]
    v_mfma_f32_16x16x32_bf16 v[100:103], v[44:47], v[32:35], v[100:103]
    v_mfma_f32_16x16x32_bf16 v[104:107], v[48:51], v[32:35], v[104:107]
    v_mfma_f32_16x16x32_bf16 v[108:111], v[52:55], v[32:35], v[108:111]
    v_mfma_f32_16x16x32_bf16 v[112:115], v[40:43], v[36:39], v[112:115]
    v_mfma_f32_16x16x32_bf16 v[116:119], v[44:47], v[36:39], v[116:119]
    v_mfma_f32_16x16x32_bf16 v[120:123], v[48:51], v[36:39], v[120:123]
    v_mfma_f32_16x16x32_bf16 v[124:127], v[52:55], v[36:39], v[124:127]
    s_waitcnt vmcnt(20)
    s_barrier
    s_add_u32 s13, s17, 32768
    s_mov_b32 m0, s13
    s_mov_b32 s13, 18432
    buffer_load_dwordx4 v4, s[8:11], s13 offen offset:0 sc1 lds
    buffer_load_dwordx4 v5, s[8:11], s13 offen offset:1024 sc1 lds
    buffer_load_dwordx4 v6, s[8:11], s13 offen offset:2048 sc1 lds
    buffer_load_dwordx4 v7, s[8:11], s13 offen offset:3072 sc1 lds
    ds_read_b128 v[24:27], v11 offset:0
    ds_read_b128 v[28:31], v11 offset:1024
    ds_read_b128 v[32:35], v11 offset:2048
    ds_read_b128 v[36:39], v11 offset:3072
    ds_read_b128 v[40:43], v12 offset:0
    ds_read_b128 v[44:47], v12 offset:1024
    ds_read_b128 v[48:51], v12 offset:2048
    ds_read_b128 v[52:55], v12 offset:3072
    s_waitcnt lgkmcnt(8)
    v_mfma_f32_16x16x32_bf16 v[64:67], v[144:147], v[128:131], v[64:67]
    v_mfma_f32_16x16x32_bf16 v[68:71], v[148:151], v[128:131], v[68:71]
    v_mfma_f32_16x16x32_bf16 v[72:75], v[152:155], v[128:131], v[72:75]
    v_mfma_f32_16x16x32_bf16 v[76:79], v[156:159], v[128:131], v[76:79]
    v_mfma_f32_16x16x32_bf16 v[80:83], v[144:147], v[132:135], v[80:83]
    v_mfma_f32_16x16x32_bf16 v[84:87], v[148:151], v[132:135], v[84:87]
    v_mfma_f32_16x16x32_bf16 v[88:91], v[152:155], v[132:135], v[88:91]
    v_mfma_f32_16x16x32_bf16 v[92:95], v[156:159], v[132:135], v[92:95]
    v_mfma_f32_16x16x32_bf16 v[96:99], v[144:147], v[136:139], v[96:99]
    v_mfma_f32_16x16x32_bf16 v[100:103], v[148:151], v[136:139], v[100:103]
    v_mfma_f32_16x16x32_bf16 v[104:107], v[152:155], v[136:139], v[104:107]
    v_mfma_f32_16x16x32_bf16 v[108:111], v[156:159], v[136:139], v[108:111]
    v_mfma_f32_16x16x32_bf16 v[112:115], v[144:147], v[140:143], v[112:115]
    v_mfma_f32_16x16x32_bf16 v[116:119], v[148:151], v[140:143], v[116:119]
    v_mfma_f32_16x16x32_bf16 v[120:123], v[152:155], v[140:143], v[120:123]
    v_mfma_f32_16x16x32_bf16 v[124:127], v[156:159], v[140:143], v[124:127]
    s_waitcnt vmcnt(20)
    s_barrier
    s_add_u32 s13, s17, 49152
    s_mov_b32 m0, s13
    s_mov_b32 s13, 19456
    buffer_load_dwordx4 v4, s[8:11], s13 offen offset:0 sc1 lds
    buffer_load_dwordx4 v5, s[8:11], s13 offen offset:1024 sc1 lds
    buffer_load_dwordx4 v6, s[8:11], s13 offen offset:2048 sc1 lds
    buffer_load_dwordx4 v7, s[8:11], s13 offen offset:3072 sc1 lds
    ds_read_b128 v[128:131], v11 offset:16384
    ds_read_b128 v[132:135], v11 offset:17408
    ds_read_b128 v[136:139], v11 offset:18432
    ds_read_b128 v[140:143], v11 offset:19456
    ds_read_b128 v[144:147], v12 offset:16384
    ds_read_b128 v[148:151], v12 offset:17408
    ds_read_b128 v[152:155], v12 offset:18432
    ds_read_b128 v[156:159], v12 offset:19456
    s_waitcnt lgkmcnt(8)
    v_mfma_f32_16x16x32_bf16 v[64:67], v[40:43], v[24:27], v[64:67]
    v_mfma_f32_16x16x32_bf16 v[68:71], v[44:47], v[24:27], v[68:71]
    v_mfma_f32_16x16x32_bf16 v[72:75], v[48:51], v[24:27], v[72:75]
    v_mfma_f32_16x16x32_bf16 v[76:79], v[52:55], v[24:27], v[76:79]
    v_mfma_f32_16x16x32_bf16 v[80:83], v[40:43], v[28:31], v[80:83]
    v_mfma_f32_16x16x32_bf16 v[84:87], v[44:47], v[28:31], v[84:87]
    v_mfma_f32_16x16x32_bf16 v[88:91], v[48:51], v[28:31], v[88:91]
    v_mfma_f32_16x16x32_bf16 v[92:95], v[52:55], v[28:31], v[92:95]
    v_mfma_f32_16x16x32_bf16 v[96:99], v[40:43], v[32:35], v[96:99]
    v_mfma_f32_16x16x32_bf16 v[100:103], v[44:47], v[32:35], v[100:103]
    v_mfma_f32_16x16x32_bf16 v[104:107], v[48:51], v[32:35], v[104:107]
    v_mfma_f32_16x16x32_bf16 v[108:111], v[52:55], v[32:35], v[108:111]
    v_mfma_f32_16x16x32_bf16 v[112:115], v[40:43], v[36:39], v[112:115]
    v_mfma_f32_16x16x32_bf16 v[116:119], v[44:47], v[36:39], v[116:119]
    v_mfma_f32_16x16x32_bf16 v[120:123], v[48:51], v[36:39], v[120:123]
    v_mfma_f32_16x16x32_bf16 v[124:127], v[52:55], v[36:39], v[124:127]
    s_waitcnt vmcnt(20)
    s_barrier
    s_add_u32 s13, s17, 65536
    s_mov_b32 m0, s13
    s_mov_b32 s13, 20480
    buffer_load_dwordx4 v4, s[8:11], s13 offen offset:0 sc1 lds
    buffer_load_dwordx4 v5, s[8:11], s13 offen offset:1024 sc1 lds
    buffer_load_dwordx4 v6, s[8:11], s13 offen offset:2048 sc1 lds
    buffer_load_dwordx4 v7, s[8:11], s13 offen offset:3072 sc1 lds
    ds_read_b128 v[24:27], v11 offset:32768
    ds_read_b128 v[28:31], v11 offset:33792
    ds_read_b128 v[32:35], v11 offset:34816
    ds_read_b128 v[36:39], v11 offset:35840
    ds_read_b128 v[40:43], v12 offset:32768
    ds_read_b128 v[44:47], v12 offset:33792
    ds_read_b128 v[48:51], v12 offset:34816
    ds_read_b128 v[52:55], v12 offset:35840
    s_waitcnt lgkmcnt(8)
    v_mfma_f32_16x16x32_bf16 v[64:67], v[144:147], v[128:131], v[64:67]
    v_mfma_f32_16x16x32_bf16 v[68:71], v[148:151], v[128:131], v[68:71]
    v_mfma_f32_16x16x32_bf16 v[72:75], v[152:155], v[128:131], v[72:75]
    v_mfma_f32_16x16x32_bf16 v[76:79], v[156:159], v[128:131], v[76:79]
    v_mfma_f32_16x16x32_bf16 v[80:83], v[144:147], v[132:135], v[80:83]
    v_mfma_f32_16x16x32_bf16 v[84:87], v[148:151], v[132:135], v[84:87]
    v_mfma_f32_16x16x32_bf16 v[88:91], v[152:155], v[132:135], v[88:91]
    v_mfma_f32_16x16x32_bf16 v[92:95], v[156:159], v[132:135], v[92:95]
    v_mfma_f32_16x16x32_bf16 v[96:99], v[144:147], v[136:139], v[96:99]
    v_mfma_f32_16x16x32_bf16 v[100:103], v[148:151], v[136:139], v[100:103]
    v_mfma_f32_16x16x32_bf16 v[104:107], v[152:155], v[136:139], v[104:107]
    v_mfma_f32_16x16x32_bf16 v[108:111], v[156:159], v[136:139], v[108:111]
    v_mfma_f32_16x16x32_bf16 v[112:115], v[144:147], v[140:143], v[112:115]
    v_mfma_f32_16x16x32_bf16 v[116:119], v[148:151], v[140:143], v[116:119]
    v_mfma_f32_16x16x32_bf16 v[120:123], v[152:155], v[140:143], v[120:123]
    v_mfma_f32_16x16x32_bf16 v[124:127], v[156:159], v[140:143], v[124:127]
    s_waitcnt vmcnt(20)
    s_barrier
    s_add_u32 s13, s17, 81920
    s_mov_b32 m0, s13
    s_mov_b32 s13, 21504
    buffer_load_dwordx4 v4, s[8:11], s13 offen offset:0 sc1 lds
    buffer_load_dwordx4 v5, s[8:11], s13 offen offset:1024 sc1 lds
    buffer_load_dwordx4 v6, s[8:11], s13 offen offset:2048 sc1 lds
    buffer_load_dwordx4 v7, s[8:11], s13 offen offset:3072 sc1 lds
    ds_read_b128 v[128:131], v11 offset:49152
    ds_read_b128 v[132:135], v11 offset:50176
    ds_read_b128 v[136:139], v11 offset:51200
    ds_read_b128 v[140:143], v11 offset:52224
    ds_read_b128 v[144:147], v12 offset:49152
    ds_read_b128 v[148:151], v12 offset:50176
    ds_read_b128 v[152:155], v12 offset:51200
    ds_read_b128 v[156:159], v12 offset:52224
    s_waitcnt lgkmcnt(8)
    v_mfma_f32_16x16x32_bf16 v[64:67], v[40:43], v[24:27], v[64:67]
    v_mfma_f32_16x16x32_bf16 v[68:71], v[44:47], v[24:27], v[68:71]
    v_mfma_f32_16x16x32_bf16 v[72:75], v[48:51], v[24:27], v[72:75]
    v_mfma_f32_16x16x32_bf16 v[76:79], v[52:55], v[24:27], v[76:79]
    v_mfma_f32_16x16x32_bf16 v[80:83], v[40:43], v[28:31], v[80:83]
    v_mfma_f32_16x16x32_bf16 v[84:87], v[44:47], v[28:31], v[84:87]
    v_mfma_f32_16x16x32_bf16 v[88:91], v[48:51], v[28:31], v[88:91]
    v_mfma_f32_16x16x32_bf16 v[92:95], v[52:55], v[28:31], v[92:95]
    v_mfma_f32_16x16x32_bf16 v[96:99], v[40:43], v[32:35], v[96:99]
    v_mfma_f32_16x16x32_bf16 v[100:103], v[44:47], v[32:35], v[100:103]
    v_mfma_f32_16x16x32_bf16 v[104:107], v[48:51], v[32:35], v[104:107]
    v_mfma_f32_16x16x32_bf16 v[108:111], v[52:55], v[32:35], v[108:111]
    v_mfma_f32_16x16x32_bf16 v[112:115], v[40:43], v[36:39], v[112:115]
    v_mfma_f32_16x16x32_bf16 v[116:119], v[44:47], v[36:39], v[116:119]
    v_mfma_f32_16x16x32_bf16 v[120:123], v[48:51], v[36:39], v[120:123]
    v_mfma_f32_16x16x32_bf16 v[124:127], v[52:55], v[36:39], v[124:127]
    s_waitcnt vmcnt(20)
    s_barrier
    s_add_u32 s13, s17, 98304
    s_mov_b32 m0, s13
    s_mov_b32 s13, 22528
    buffer_load_dwordx4 v4, s[8:11], s13 offen offset:0 sc1 lds
    buffer_load_dwordx4 v5, s[8:11], s13 offen offset:1024 sc1 lds
    buffer_load_dwordx4 v6, s[8:11], s13 offen offset:2048 sc1 lds
    buffer_load_dwordx4 v7, s[8:11], s13 offen offset:3072 sc1 lds
    ds_read_b128 v[24:27], v9 offset:0
    ds_read_b128 v[28:31], v9 offset:1024
    ds_read_b128 v[32:35], v9 offset:2048
    ds_read_b128 v[36:39], v9 offset:3072
    ds_read_b128 v[40:43], v10 offset:0
    ds_read_b128 v[44:47], v10 offset:1024
    ds_read_b128 v[48:51], v10 offset:2048
    ds_read_b128 v[52:55], v10 offset:3072
    s_waitcnt lgkmcnt(8)
    v_mfma_f32_16x16x32_bf16 v[64:67], v[144:147], v[128:131], v[64:67]
    v_mfma_f32_16x16x32_bf16 v[68:71], v[148:151], v[128:131], v[68:71]
    v_mfma_f32_16x16x32_bf16 v[72:75], v[152:155], v[128:131], v[72:75]
    v_mfma_f32_16x16x32_bf16 v[76:79], v[156:159], v[128:131], v[76:79]
    v_mfma_f32_16x16x32_bf16 v[80:83], v[144:147], v[132:135], v[80:83]
    v_mfma_f32_16x16x32_bf16 v[84:87], v[148:151], v[132:135], v[84:87]
    v_mfma_f32_16x16x32_bf16 v[88:91], v[152:155], v[132:135], v[88:91]
    v_mfma_f32_16x16x32_bf16 v[92:95], v[156:159], v[132:135], v[92:95]
    v_mfma_f32_16x16x32_bf16 v[96:99], v[144:147], v[136:139], v[96:99]
    v_mfma_f32_16x16x32_bf16 v[100:103], v[148:151], v[136:139], v[100:103]
    v_mfma_f32_16x16x32_bf16 v[104:107], v[152:155], v[136:139], v[104:107]
    v_mfma_f32_16x16x32_bf16 v[108:111], v[156:159], v[136:139], v[108:111]
    v_mfma_f32_16x16x32_bf16 v[112:115], v[144:147], v[140:143], v[112:115]
    v_mfma_f32_16x16x32_bf16 v[116:119], v[148:151], v[140:143], v[116:119]
    v_mfma_f32_16x16x32_bf16 v[120:123], v[152:155], v[140:143], v[120:123]
    v_mfma_f32_16x16x32_bf16 v[124:127], v[156:159], v[140:143], v[124:127]
    s_waitcnt vmcnt(20)
    s_barrier
    s_add_u32 s13, s17, 114688
    s_mov_b32 m0, s13
    s_mov_b32 s13, 23552
    buffer_load_dwordx4 v4, s[8:11], s13 offen offset:0 sc1 lds
    buffer_load_dwordx4 v5, s[8:11], s13 offen offset:1024 sc1 lds
    buffer_load_dwordx4 v6, s[8:11], s13 offen offset:2048 sc1 lds
    buffer_load_dwordx4 v7, s[8:11], s13 offen offset:3072 sc1 lds
    ds_read_b128 v[128:131], v9 offset:16384
    ds_read_b128 v[132:135], v9 offset:17408
    ds_read_b128 v[136:139], v9 offset:18432
    ds_read_b128 v[140:143], v9 offset:19456
    ds_read_b128 v[144:147], v10 offset:16384
    ds_read_b128 v[148:151], v10 offset:17408
    ds_read_b128 v[152:155], v10 offset:18432
    ds_read_b128 v[156:159], v10 offset:19456
    s_waitcnt lgkmcnt(8)
    v_mfma_f32_16x16x32_bf16 v[64:67], v[40:43], v[24:27], v[64:67]
    v_mfma_f32_16x16x32_bf16 v[68:71], v[44:47], v[24:27], v[68:71]
    v_mfma_f32_16x16x32_bf16 v[72:75], v[48:51], v[24:27], v[72:75]
    v_mfma_f32_16x16x32_bf16 v[76:79], v[52:55], v[24:27], v[76:79]
    v_mfma_f32_16x16x32_bf16 v[80:83], v[40:43], v[28:31], v[80:83]
    v_mfma_f32_16x16x32_bf16 v[84:87], v[44:47], v[28:31], v[84:87]
    v_mfma_f32_16x16x32_bf16 v[88:91], v[48:51], v[28:31], v[88:91]
    v_mfma_f32_16x16x32_bf16 v[92:95], v[52:55], v[28:31], v[92:95]
    v_mfma_f32_16x16x32_bf16 v[96:99], v[40:43], v[32:35], v[96:99]
    v_mfma_f32_16x16x32_bf16 v[100:103], v[44:47], v[32:35], v[100:103]
    v_mfma_f32_16x16x32_bf16 v[104:107], v[48:51], v[32:35], v[104:107]
    v_mfma_f32_16x16x32_bf16 v[108:111], v[52:55], v[32:35], v[108:111]
    v_mfma_f32_16x16x32_bf16 v[112:115], v[40:43], v[36:39], v[112:115]
    v_mfma_f32_16x16x32_bf16 v[116:119], v[44:47], v[36:39], v[116:119]
    v_mfma_f32_16x16x32_bf16 v[120:123], v[48:51], v[36:39], v[120:123]
    v_mfma_f32_16x16x32_bf16 v[124:127], v[52:55], v[36:39], v[124:127]
    s_waitcnt vmcnt(20)
    s_barrier
    s_add_u32 s13, s17, 0
    s_mov_b32 m0, s13
    s_mov_b32 s13, 24576
    buffer_load_dwordx4 v4, s[8:11], s13 offen offset:0 sc1 lds
    buffer_load_dwordx4 v5, s[8:11], s13 offen offset:1024 sc1 lds
    buffer_load_dwordx4 v6, s[8:11], s13 offen offset:2048 sc1 lds
    buffer_load_dwordx4 v7, s[8:11], s13 offen offset:3072 sc1 lds
    ds_read_b128 v[24:27], v9 offset:32768
    ds_read_b128 v[28:31], v9 offset:33792
    ds_read_b128 v[32:35], v9 offset:34816
    ds_read_b128 v[36:39], v9 offset:35840
    ds_read_b128 v[40:43], v10 offset:32768
    ds_read_b128 v[44:47], v10 offset:33792
    ds_read_b128 v[48:51], v10 offset:34816
    ds_read_b128 v[52:55], v10 offset:35840
    s_waitcnt lgkmcnt(8)
    v_mfma_f32_16x16x32_bf16 v[64:67], v[144:147], v[128:131], v[64:67]
    v_mfma_f32_16x16x32_bf16 v[68:71], v[148:151], v[128:131], v[68:71]
    v_mfma_f32_16x16x32_bf16 v[72:75], v[152:155], v[128:131], v[72:75]
    v_mfma_f32_16x16x32_bf16 v[76:79], v[156:159], v[128:131], v[76:79]
    v_mfma_f32_16x16x32_bf16 v[80:83], v[144:147], v[132:135], v[80:83]
    v_mfma_f32_16x16x32_bf16 v[84:87], v[148:151], v[132:135], v[84:87]
    v_mfma_f32_16x16x32_bf16 v[88:91], v[152:155], v[132:135], v[88:91]
    v_mfma_f32_16x16x32_bf16 v[92:95], v[156:159], v[132:135], v[92:95]
    v_mfma_f32_16x16x32_bf16 v[96:99], v[144:147], v[136:139], v[96:99]
    v_mfma_f32_16x16x32_bf16 v[100:103], v[148:151], v[136:139], v[100:103]
    v_mfma_f32_16x16x32_bf16 v[104:107], v[152:155], v[136:139], v[104:107]
    v_mfma_f32_16x16x32_bf16 v[108:111], v[156:159], v[136:139], v[108:111]
    v_mfma_f32_16x16x32_bf16 v[112:115], v[144:147], v[140:143], v[112:115]
    v_mfma_f32_16x16x32_bf16 v[116:119], v[148:151], v[140:143], v[116:119]
    v_mfma_f32_16x16x32_bf16 v[120:123], v[152:155], v[140:143], v[120:123]
    v_mfma_f32_16x16x32_bf16 v[124:127], v[156:159], v[140:143], v[124:127]
    s_waitcnt vmcnt(20)
    s_barrier
    s_add_u32 s13, s17, 16384
    s_mov_b32 m0, s13
    s_mov_b32 s13, 25600
    buffer_load_dwordx4 v4, s[8:11], s13 offen offset:0 sc1 lds
    buffer_load_dwordx4 v5, s[8:11], s13 offen offset:1024 sc1 lds
    buffer_load_dwordx4 v6, s[8:11], s13 offen offset:2048 sc1 lds
    buffer_load_dwordx4 v7, s[8:11], s13 offen offset:3072 sc1 lds
    ds_read_b128 v[128:131], v9 offset:49152
    ds_read_b128 v[132:135], v9 offset:50176
    ds_read_b128 v[136:139], v9 offset:51200
    ds_read_b128 v[140:143], v9 offset:52224
    ds_read_b128 v[144:147], v10 offset:49152
    ds_read_b128 v[148:151], v10 offset:50176
    ds_read_b128 v[152:155], v10 offset:51200
    ds_read_b128 v[156:159], v10 offset:52224
    s_waitcnt lgkmcnt(8)
    v_mfma_f32_16x16x32_bf16 v[64:67], v[40:43], v[24:27], v[64:67]
    v_mfma_f32_16x16x32_bf16 v[68:71], v[44:47], v[24:27], v[68:71]
    v_mfma_f32_16x16x32_bf16 v[72:75], v[48:51], v[24:27], v[72:75]
    v_mfma_f32_16x16x32_bf16 v[76:79], v[52:55], v[24:27], v[76:79]
    v_mfma_f32_16x16x32_bf16 v[80:83], v[40:43], v[28:31], v[80:83]
    v_mfma_f32_16x16x32_bf16 v[84:87], v[44:47], v[28:31], v[84:87]
    v_mfma_f32_16x16x32_bf16 v[88:91], v[48:51], v[28:31], v[88:91]
    v_mfma_f32_16x16x32_bf16 v[92:95], v[52:55], v[28:31], v[92:95]
    v_mfma_f32_16x16x32_bf16 v[96:99], v[40:43], v[32:35], v[96:99]
    v_mfma_f32_16x16x32_bf16 v[100:103], v[44:47], v[32:35], v[100:103]
    v_mfma_f32_16x16x32_bf16 v[104:107], v[48:51], v[32:35], v[104:107]
    v_mfma_f32_16x16x32_bf16 v[108:111], v[52:55], v[32:35], v[108:111]
    v_mfma_f32_16x16x32_bf16 v[112:115], v[40:43], v[36:39], v[112:115]
    v_mfma_f32_16x16x32_bf16 v[116:119], v[44:47], v[36:39], v[116:119]
    v_mfma_f32_16x16x32_bf16 v[120:123], v[48:51], v[36:39], v[120:123]
    v_mfma_f32_16x16x32_bf16 v[124:127], v[52:55], v[36:39], v[124:127]
    s_waitcnt vmcnt(20)
    s_barrier
    s_add_u32 s13, s17, 32768
    s_mov_b32 m0, s13
    s_mov_b32 s13, 26624
    buffer_load_dwordx4 v4, s[8:11], s13 offen offset:0 sc1 lds
    buffer_load_dwordx4 v5, s[8:11], s13 offen offset:1024 sc1 lds
    buffer_load_dwordx4 v6, s[8:11], s13 offen offset:2048 sc1 lds
    buffer_load_dwordx4 v7, s[8:11], s13 offen offset:3072 sc1 lds
    ds_read_b128 v[24:27], v11 offset:0
    ds_read_b128 v[28:31], v11 offset:1024
    ds_read_b128 v[32:35], v11 offset:2048
    ds_read_b128 v[36:39], v11 offset:3072
    ds_read_b128 v[40:43], v12 offset:0
    ds_read_b128 v[44:47], v12 offset:1024
    ds_read_b128 v[48:51], v12 offset:2048
    ds_read_b128 v[52:55], v12 offset:3072
    s_waitcnt lgkmcnt(8)
    v_mfma_f32_16x16x32_bf16 v[64:67], v[144:147], v[128:131], v[64:67]
    v_mfma_f32_16x16x32_bf16 v[68:71], v[148:151], v[128:131], v[68:71]
    v_mfma_f32_16x16x32_bf16 v[72:75], v[152:155], v[128:131], v[72:75]
    v_mfma_f32_16x16x32_bf16 v[76:79], v[156:159], v[128:131], v[76:79]
    v_mfma_f32_16x16x32_bf16 v[80:83], v[144:147], v[132:135], v[80:83]
    v_mfma_f32_16x16x32_bf16 v[84:87], v[148:151], v[132:135], v[84:87]
    v_mfma_f32_16x16x32_bf16 v[88:91], v[152:155], v[132:135], v[88:91]
    v_mfma_f32_16x16x32_bf16 v[92:95], v[156:159], v[132:135], v[92:95]
    v_mfma_f32_16x16x32_bf16 v[96:99], v[144:147], v[136:139], v[96:99]
    v_mfma_f32_16x16x32_bf16 v[100:103], v[148:151], v[136:139], v[100:103]
    v_mfma_f32_16x16x32_bf16 v[104:107], v[152:155], v[136:139], v[104:107]
    v_mfma_f32_16x16x32_bf16 v[108:111], v[156:159], v[136:139], v[108:111]
    v_mfma_f32_16x16x32_bf16 v[112:115], v[144:147], v[140:143], v[112:115]
    v_mfma_f32_16x16x32_bf16 v[116:119], v[148:151], v[140:143], v[116:119]
    v_mfma_f32_16x16x32_bf16 v[120:123], v[152:155], v[140:143], v[120:123]
    v_mfma_f32_16x16x32_bf16 v[124:127], v[156:159], v[140:143], v[124:127]
    s_waitcnt vmcnt(20)
    s_barrier
    s_add_u32 s13, s17, 49152
    s_mov_b32 m0, s13
    s_mov_b32 s13, 27648
    buffer_load_dwordx4 v4, s[8:11], s13 offen offset:0 sc1 lds
    buffer_load_dwordx4 v5, s[8:11], s13 offen offset:1024 sc1 lds
    buffer_load_dwordx4 v6, s[8:11], s13 offen offset:2048 sc1 lds
    buffer_load_dwordx4 v7, s[8:11], s13 offen offset:3072 sc1 lds
    ds_read_b128 v[128:131], v11 offset:16384
    ds_read_b128 v[132:135], v11 offset:17408
    ds_read_b128 v[136:139], v11 offset:18432
    ds_read_b128 v[140:143], v11 offset:19456
    ds_read_b128 v[144:147], v12 offset:16384
    ds_read_b128 v[148:151], v12 offset:17408
    ds_read_b128 v[152:155], v12 offset:18432
    ds_read_b128 v[156:159], v12 offset:19456
    s_waitcnt lgkmcnt(8)
    v_mfma_f32_16x16x32_bf16 v[64:67], v[40:43], v[24:27], v[64:67]
    v_mfma_f32_16x16x32_bf16 v[68:71], v[44:47], v[24:27], v[68:71]
    v_mfma_f32_16x16x32_bf16 v[72:75], v[48:51], v[24:27], v[72:75]
    v_mfma_f32_16x16x32_bf16 v[76:79], v[52:55], v[24:27], v[76:79]
    v_mfma_f32_16x16x32_bf16 v[80:83], v[40:43], v[28:31], v[80:83]
    v_mfma_f32_16x16x32_bf16 v[84:87], v[44:47], v[28:31], v[84:87]
    v_mfma_f32_16x16x32_bf16 v[88:91], v[48:51], v[28:31], v[88:91]
    v_mfma_f32_16x16x32_bf16 v[92:95], v[52:55], v[28:31], v[92:95]
    v_mfma_f32_16x16x32_bf16 v[96:99], v[40:43], v[32:35], v[96:99]
    v_mfma_f32_16x16x32_bf16 v[100:103], v[44:47], v[32:35], v[100:103]
    v_mfma_f32_16x16x32_bf16 v[104:107], v[48:51], v[32:35], v[104:107]
    v_mfma_f32_16x16x32_bf16 v[108:111], v[52:55], v[32:35], v[108:111]
    v_mfma_f32_16x16x32_bf16 v[112:115], v[40:43], v[36:39], v[112:115]
    v_mfma_f32_16x16x32_bf16 v[116:119], v[44:47], v[36:39], v[116:119]
    v_mfma_f32_16x16x32_bf16 v[120:123], v[48:51], v[36:39], v[120:123]
    v_mfma_f32_16x16x32_bf16 v[124:127], v[52:55], v[36:39], v[124:127]
    s_waitcnt vmcnt(20)
    s_barrier
    s_add_u32 s13, s17, 65536
    s_mov_b32 m0, s13
    s_mov_b32 s13, 28672
    buffer_load_dwordx4 v4, s[8:11], s13 offen offset:0 sc1 lds
    buffer_load_dwordx4 v5, s[8:11], s13 offen offset:1024 sc1 lds
    buffer_load_dwordx4 v6, s[8:11], s13 offen offset:2048 sc1 lds
    buffer_load_dwordx4 v7, s[8:11], s13 offen offset:3072 sc1 lds
    ds_read_b128 v[24:27], v11 offset:32768
    ds_read_b128 v[28:31], v11 offset:33792
    ds_read_b128 v[32:35], v11 offset:34816
    ds_read_b128 v[36:39], v11 offset:35840
    ds_read_b128 v[40:43], v12 offset:32768
    ds_read_b128 v[44:47], v12 offset:33792
    ds_read_b128 v[48:51], v12 offset:34816
    ds_read_b128 v[52:55], v12 offset:35840
    s_waitcnt lgkmcnt(8)
    v_mfma_f32_16x16x32_bf16 v[64:67], v[144:147], v[128:131], v[64:67]
    v_mfma_f32_16x16x32_bf16 v[68:71], v[148:151], v[128:131], v[68:71]
    v_mfma_f32_16x16x32_bf16 v[72:75], v[152:155], v[128:131], v[72:75]
    v_mfma_f32_16x16x32_bf16 v[76:79], v[156:159], v[128:131], v[76:79]
    v_mfma_f32_16x16x32_bf16 v[80:83], v[144:147], v[132:135], v[80:83]
    v_mfma_f32_16x16x32_bf16 v[84:87], v[148:151], v[132:135], v[84:87]
    v_mfma_f32_16x16x32_bf16 v[88:91], v[152:155], v[132:135], v[88:91]
    v_mfma_f32_16x16x32_bf16 v[92:95], v[156:159], v[132:135], v[92:95]
    v_mfma_f32_16x16x32_bf16 v[96:99], v[144:147], v[136:139], v[96:99]
    v_mfma_f32_16x16x32_bf16 v[100:103], v[148:151], v[136:139], v[100:103]
    v_mfma_f32_16x16x32_bf16 v[104:107], v[152:155], v[136:139], v[104:107]
    v_mfma_f32_16x16x32_bf16 v[108:111], v[156:159], v[136:139], v[108:111]
    v_mfma_f32_16x16x32_bf16 v[112:115], v[144:147], v[140:143], v[112:115]
    v_mfma_f32_16x16x32_bf16 v[116:119], v[148:151], v[140:143], v[116:119]
    v_mfma_f32_16x16x32_bf16 v[120:123], v[152:155], v[140:143], v[120:123]
    v_mfma_f32_16x16x32_bf16 v[124:127], v[156:159], v[140:143], v[124:127]
    s_waitcnt vmcnt(20)
    s_barrier
    s_add_u32 s13, s17, 81920
    s_mov_b32 m0, s13
    s_mov_b32 s13, 29696
    buffer_load_dwordx4 v4, s[8:11], s13 offen offset:0 sc1 lds
    buffer_load_dwordx4 v5, s[8:11], s13 offen offset:1024 sc1 lds
    buffer_load_dwordx4 v6, s[8:11], s13 offen offset:2048 sc1 lds
    buffer_load_dwordx4 v7, s[8:11], s13 offen offset:3072 sc1 lds
    ds_read_b128 v[128:131], v11 offset:49152
    ds_read_b128 v[132:135], v11 offset:50176
    ds_read_b128 v[136:139], v11 offset:51200
    ds_read_b128 v[140:143], v11 offset:52224
    ds_read_b128 v[144:147], v12 offset:49152
    ds_read_b128 v[148:151], v12 offset:50176
    ds_read_b128 v[152:155], v12 offset:51200
    ds_read_b128 v[156:159], v12 offset:52224
    s_waitcnt lgkmcnt(8)
    v_mfma_f32_16x16x32_bf16 v[64:67], v[40:43], v[24:27], v[64:67]
    v_mfma_f32_16x16x32_bf16 v[68:71], v[44:47], v[24:27], v[68:71]
    v_mfma_f32_16x16x32_bf16 v[72:75], v[48:51], v[24:27], v[72:75]
    v_mfma_f32_16x16x32_bf16 v[76:79], v[52:55], v[24:27], v[76:79]
    v_mfma_f32_16x16x32_bf16 v[80:83], v[40:43], v[28:31], v[80:83]
    v_mfma_f32_16x16x32_bf16 v[84:87], v[44:47], v[28:31], v[84:87]
    v_mfma_f32_16x16x32_bf16 v[88:91], v[48:51], v[28:31], v[88:91]
    v_mfma_f32_16x16x32_bf16 v[92:95], v[52:55], v[28:31], v[92:95]
    v_mfma_f32_16x16x32_bf16 v[96:99], v[40:43], v[32:35], v[96:99]
    v_mfma_f32_16x16x32_bf16 v[100:103], v[44:47], v[32:35], v[100:103]
    v_mfma_f32_16x16x32_bf16 v[104:107], v[48:51], v[32:35], v[104:107]
    v_mfma_f32_16x16x32_bf16 v[108:111], v[52:55], v[32:35], v[108:111]
    v_mfma_f32_16x16x32_bf16 v[112:115], v[40:43], v[36:39], v[112:115]
    v_mfma_f32_16x16x32_bf16 v[116:119], v[44:47], v[36:39], v[116:119]
    v_mfma_f32_16x16x32_bf16 v[120:123], v[48:51], v[36:39], v[120:123]
    v_mfma_f32_16x16x32_bf16 v[124:127], v[52:55], v[36:39], v[124:127]
    s_waitcnt vmcnt(20)
    s_barrier
    s_add_u32 s13, s17, 98304
    s_mov_b32 m0, s13
    s_mov_b32 s13, 30720
    buffer_load_dwordx4 v4, s[8:11], s13 offen offset:0 sc1 lds
    buffer_load_dwordx4 v5, s[8:11], s13 offen offset:1024 sc1 lds
    buffer_load_dwordx4 v6, s[8:11], s13 offen offset:2048 sc1 lds
    buffer_load_dwordx4 v7, s[8:11], s13 offen offset:3072 sc1 lds
    ds_read_b128 v[24:27], v9 offset:0
    ds_read_b128 v[28:31], v9 offset:1024
    ds_read_b128 v[32:35], v9 offset:2048
    ds_read_b128 v[36:39], v9 offset:3072
    ds_read_b128 v[40:43], v10 offset:0
    ds_read_b128 v[44:47], v10 offset:1024
    ds_read_b128 v[48:51], v10 offset:2048
    ds_read_b128 v[52:55], v10 offset:3072
    s_waitcnt lgkmcnt(8)
    v_mfma_f32_16x16x32_bf16 v[64:67], v[144:147], v[128:131], v[64:67]
    v_mfma_f32_16x16x32_bf16 v[68:71], v[148:151], v[128:131], v[68:71]
    v_mfma_f32_16x16x32_bf16 v[72:75], v[152:155], v[128:131], v[72:75]
    v_mfma_f32_16x16x32_bf16 v[76:79], v[156:159], v[128:131], v[76:79]
    v_mfma_f32_16x16x32_bf16 v[80:83], v[144:147], v[132:135], v[80:83]
    v_mfma_f32_16x16x32_bf16 v[84:87], v[148:151], v[132:135], v[84:87]
    v_mfma_f32_16x16x32_bf16 v[88:91], v[152:155], v[132:135], v[88:91]
    v_mfma_f32_16x16x32_bf16 v[92:95], v[156:159], v[132:135], v[92:95]
    v_mfma_f32_16x16x32_bf16 v[96:99], v[144:147], v[136:139], v[96:99]
    v_mfma_f32_16x16x32_bf16 v[100:103], v[148:151], v[136:139], v[100:103]
    v_mfma_f32_16x16x32_bf16 v[104:107], v[152:155], v[136:139], v[104:107]
    v_mfma_f32_16x16x32_bf16 v[108:111], v[156:159], v[136:139], v[108:111]
    v_mfma_f32_16x16x32_bf16 v[112:115], v[144:147], v[140:143], v[112:115]
    v_mfma_f32_16x16x32_bf16 v[116:119], v[148:151], v[140:143], v[116:119]
    v_mfma_f32_16x16x32_bf16 v[120:123], v[152:155], v[140:143], v[120:123]
    v_mfma_f32_16x16x32_bf16 v[124:127], v[156:159], v[140:143], v[124:127]
    s_waitcnt vmcnt(20)
    s_barrier
    s_add_u32 s13, s17, 114688
    s_mov_b32 m0, s13
    s_mov_b32 s13, 31744
    buffer_load_dwordx4 v4, s[8:11], s13 offen offset:0 sc1 lds
    buffer_load_dwordx4 v5, s[8:11], s13 offen offset:1024 sc1 lds
    buffer_load_dwordx4 v6, s[8:11], s13 offen offset:2048 sc1 lds
    buffer_load_dwordx4 v7, s[8:11], s13 offen offset:3072 sc1 lds
    ds_read_b128 v[128:131], v9 offset:16384
    ds_read_b128 v[132:135], v9 offset:17408
    ds_read_b128 v[136:139], v9 offset:18432
    ds_read_b128 v[140:143], v9 offset:19456
    ds_read_b128 v[144:147], v10 offset:16384
    ds_read_b128 v[148:151], v10 offset:17408
    ds_read_b128 v[152:155], v10 offset:18432
    ds_read_b128 v[156:159], v10 offset:19456
    s_waitcnt lgkmcnt(8)
    v_mfma_f32_16x16x32_bf16 v[64:67], v[40:43], v[24:27], v[64:67]
    v_mfma_f32_16x16x32_bf16 v[68:71], v[44:47], v[24:27], v[68:71]
    v_mfma_f32_16x16x32_bf16 v[72:75], v[48:51], v[24:27], v[72:75]
    v_mfma_f32_16x16x32_bf16 v[76:79], v[52:55], v[24:27], v[76:79]
    v_mfma_f32_16x16x32_bf16 v[80:83], v[40:43], v[28:31], v[80:83]
    v_mfma_f32_16x16x32_bf16 v[84:87], v[44:47], v[28:31], v[84:87]
    v_mfma_f32_16x16x32_bf16 v[88:91], v[48:51], v[28:31], v[88:91]
    v_mfma_f32_16x16x32_bf16 v[92:95], v[52:55], v[28:31], v[92:95]
    v_mfma_f32_16x16x32_bf16 v[96:99], v[40:43], v[32:35], v[96:99]
    v_mfma_f32_16x16x32_bf16 v[100:103], v[44:47], v[32:35], v[100:103]
    v_mfma_f32_16x16x32_bf16 v[104:107], v[48:51], v[32:35], v[104:107]
    v_mfma_f32_16x16x32_bf16 v[108:111], v[52:55], v[32:35], v[108:111]
    v_mfma_f32_16x16x32_bf16 v[112:115], v[40:43], v[36:39], v[112:115]
    v_mfma_f32_16x16x32_bf16 v[116:119], v[44:47], v[36:39], v[116:119]
    v_mfma_f32_16x16x32_bf16 v[120:123], v[48:51], v[36:39], v[120:123]
    v_mfma_f32_16x16x32_bf16 v[124:127], v[52:55], v[36:39], v[124:127]
    s_waitcnt vmcnt(20)
    s_barrier
    ds_read_b128 v[24:27], v9 offset:32768
    ds_read_b128 v[28:31], v9 offset:33792
    ds_read_b128 v[32:35], v9 offset:34816
    ds_read_b128 v[36:39], v9 offset:35840
    ds_read_b128 v[40:43], v10 offset:32768
    ds_read_b128 v[44:47], v10 offset:33792
    ds_read_b128 v[48:51], v10 offset:34816
    ds_read_b128 v[52:55], v10 offset:35840
    s_waitcnt lgkmcnt(8)
    v_mfma_f32_16x16x32_bf16 v[64:67], v[144:147], v[128:131], v[64:67]
    v_mfma_f32_16x16x32_bf16 v[68:71], v[148:151], v[128:131], v[68:71]
    v_mfma_f32_16x16x32_bf16 v[72:75], v[152:155], v[128:131], v[72:75]
    v_mfma_f32_16x16x32_bf16 v[76:79], v[156:159], v[128:131], v[76:79]
    v_mfma_f32_16x16x32_bf16 v[80:83], v[144:147], v[132:135], v[80:83]
    v_mfma_f32_16x16x32_bf16 v[84:87], v[148:151], v[132:135], v[84:87]
    v_mfma_f32_16x16x32_bf16 v[88:91], v[152:155], v[132:135], v[88:91]
    v_mfma_f32_16x16x32_bf16 v[92:95], v[156:159], v[132:135], v[92:95]
    v_mfma_f32_16x16x32_bf16 v[96:99], v[144:147], v[136:139], v[96:99]
    v_mfma_f32_16x16x32_bf16 v[100:103], v[148:151], v[136:139], v[100:103]
    v_mfma_f32_16x16x32_bf16 v[104:107], v[152:155], v[136:139], v[104:107]
    v_mfma_f32_16x16x32_bf16 v[108:111], v[156:159], v[136:139], v[108:111]
    v_mfma_f32_16x16x32_bf16 v[112:115], v[144:147], v[140:143], v[112:115]
    v_mfma_f32_16x16x32_bf16 v[116:119], v[148:151], v[140:143], v[116:119]
    v_mfma_f32_16x16x32_bf16 v[120:123], v[152:155], v[140:143], v[120:123]
    v_mfma_f32_16x16x32_bf16 v[124:127], v[156:159], v[140:143], v[124:127]
    s_waitcnt vmcnt(16)
    s_barrier
    ds_read_b128 v[128:131], v9 offset:49152
    ds_read_b128 v[132:135], v9 offset:50176
    ds_read_b128 v[136:139], v9 offset:51200
    ds_read_b128 v[140:143], v9 offset:52224
    ds_read_b128 v[144:147], v10 offset:49152
    ds_read_b128 v[148:151], v10 offset:50176
    ds_read_b128 v[152:155], v10 offset:51200
    ds_read_b128 v[156:159], v10 offset:52224
    s_waitcnt lgkmcnt(8)
    v_mfma_f32_16x16x32_bf16 v[64:67], v[40:43], v[24:27], v[64:67]
    v_mfma_f32_16x16x32_bf16 v[68:71], v[44:47], v[24:27], v[68:71]
    v_mfma_f32_16x16x32_bf16 v[72:75], v[48:51], v[24:27], v[72:75]
    v_mfma_f32_16x16x32_bf16 v[76:79], v[52:55], v[24:27], v[76:79]
    v_mfma_f32_16x16x32_bf16 v[80:83], v[40:43], v[28:31], v[80:83]
    v_mfma_f32_16x16x32_bf16 v[84:87], v[44:47], v[28:31], v[84:87]
    v_mfma_f32_16x16x32_bf16 v[88:91], v[48:51], v[28:31], v[88:91]
    v_mfma_f32_16x16x32_bf16 v[92:95], v[52:55], v[28:31], v[92:95]
    v_mfma_f32_16x16x32_bf16 v[96:99], v[40:43], v[32:35], v[96:99]
    v_mfma_f32_16x16x32_bf16 v[100:103], v[44:47], v[32:35], v[100:103]
    v_mfma_f32_16x16x32_bf16 v[104:107], v[48:51], v[32:35], v[104:107]
    v_mfma_f32_16x16x32_bf16 v[108:111], v[52:55], v[32:35], v[108:111]
    v_mfma_f32_16x16x32_bf16 v[112:115], v[40:43], v[36:39], v[112:115]
    v_mfma_f32_16x16x32_bf16 v[116:119], v[44:47], v[36:39], v[116:119]
    v_mfma_f32_16x16x32_bf16 v[120:123], v[48:51], v[36:39], v[120:123]
    v_mfma_f32_16x16x32_bf16 v[124:127], v[52:55], v[36:39], v[124:127]
    s_waitcnt vmcnt(12)
    s_barrier
    ds_read_b128 v[24:27], v11 offset:0
    ds_read_b128 v[28:31], v11 offset:1024
    ds_read_b128 v[32:35], v11 offset:2048
    ds_read_b128 v[36:39], v11 offset:3072
    ds_read_b128 v[40:43], v12 offset:0
    ds_read_b128 v[44:47], v12 offset:1024
    ds_read_b128 v[48:51], v12 offset:2048
    ds_read_b128 v[52:55], v12 offset:3072
    s_waitcnt lgkmcnt(8)
    v_mfma_f32_16x16x32_bf16 v[64:67], v[144:147], v[128:131], v[64:67]
    v_mfma_f32_16x16x32_bf16 v[68:71], v[148:151], v[128:131], v[68:71]
    v_mfma_f32_16x16x32_bf16 v[72:75], v[152:155], v[128:131], v[72:75]
    v_mfma_f32_16x16x32_bf16 v[76:79], v[156:159], v[128:131], v[76:79]
    v_mfma_f32_16x16x32_bf16 v[80:83], v[144:147], v[132:135], v[80:83]
    v_mfma_f32_16x16x32_bf16 v[84:87], v[148:151], v[132:135], v[84:87]
    v_mfma_f32_16x16x32_bf16 v[88:91], v[152:155], v[132:135], v[88:91]
    v_mfma_f32_16x16x32_bf16 v[92:95], v[156:159], v[132:135], v[92:95]
    v_mfma_f32_16x16x32_bf16 v[96:99], v[144:147], v[136:139], v[96:99]
    v_mfma_f32_16x16x32_bf16 v[100:103], v[148:151], v[136:139], v[100:103]
    v_mfma_f32_16x16x32_bf16 v[104:107], v[152:155], v[136:139], v[104:107]
    v_mfma_f32_16x16x32_bf16 v[108:111], v[156:159], v[136:139], v[108:111]
    v_mfma_f32_16x16x32_bf16 v[112:115], v[144:147], v[140:143], v[112:115]
    v_mfma_f32_16x16x32_bf16 v[116:119], v[148:151], v[140:143], v[116:119]
    v_mfma_f32_16x16x32_bf16 v[120:123], v[152:155], v[140:143], v[120:123]
    v_mfma_f32_16x16x32_bf16 v[124:127], v[156:159], v[140:143], v[124:127]
    s_waitcnt vmcnt(8)
    s_barrier
    ds_read_b128 v[128:131], v11 offset:16384
    ds_read_b128 v[132:135], v11 offset:17408
    ds_read_b128 v[136:139], v11 offset:18432
    ds_read_b128 v[140:143], v11 offset:19456
    ds_read_b128 v[144:147], v12 offset:16384
    ds_read_b128 v[148:151], v12 offset:17408
    ds_read_b128 v[152:155], v12 offset:18432
    ds_read_b128 v[156:159], v12 offset:19456
    s_waitcnt lgkmcnt(8)
    v_mfma_f32_16x16x32_bf16 v[64:67], v[40:43], v[24:27], v[64:67]
    v_mfma_f32_16x16x32_bf16 v[68:71], v[44:47], v[24:27], v[68:71]
    v_mfma_f32_16x16x32_bf16 v[72:75], v[48:51], v[24:27], v[72:75]
    v_mfma_f32_16x16x32_bf16 v[76:79], v[52:55], v[24:27], v[76:79]
    v_mfma_f32_16x16x32_bf16 v[80:83], v[40:43], v[28:31], v[80:83]
    v_mfma_f32_16x16x32_bf16 v[84:87], v[44:47], v[28:31], v[84:87]
    v_mfma_f32_16x16x32_bf16 v[88:91], v[48:51], v[28:31], v[88:91]
    v_mfma_f32_16x16x32_bf16 v[92:95], v[52:55], v[28:31], v[92:95]
    v_mfma_f32_16x16x32_bf16 v[96:99], v[40:43], v[32:35], v[96:99]
    v_mfma_f32_16x16x32_bf16 v[100:103], v[44:47], v[32:35], v[100:103]
    v_mfma_f32_16x16x32_bf16 v[104:107], v[48:51], v[32:35], v[104:107]
    v_mfma_f32_16x16x32_bf16 v[108:111], v[52:55], v[32:35], v[108:111]
    v_mfma_f32_16x16x32_bf16 v[112:115], v[40:43], v[36:39], v[112:115]
    v_mfma_f32_16x16x32_bf16 v[116:119], v[44:47], v[36:39], v[116:119]
    v_mfma_f32_16x16x32_bf16 v[120:123], v[48:51], v[36:39], v[120:123]
    v_mfma_f32_16x16x32_bf16 v[124:127], v[52:55], v[36:39], v[124:127]
    s_waitcnt vmcnt(4)
    s_barrier
    ds_read_b128 v[24:27], v11 offset:32768
    ds_read_b128 v[28:31], v11 offset:33792
    ds_read_b128 v[32:35], v11 offset:34816
    ds_read_b128 v[36:39], v11 offset:35840
    ds_read_b128 v[40:43], v12 offset:32768
    ds_read_b128 v[44:47], v12 offset:33792
    ds_read_b128 v[48:51], v12 offset:34816
    ds_read_b128 v[52:55], v12 offset:35840
    s_waitcnt lgkmcnt(8)
    v_mfma_f32_16x16x32_bf16 v[64:67], v[144:147], v[128:131], v[64:67]
    v_mfma_f32_16x16x32_bf16 v[68:71], v[148:151], v[128:131], v[68:71]
    v_mfma_f32_16x16x32_bf16 v[72:75], v[152:155], v[128:131], v[72:75]
    v_mfma_f32_16x16x32_bf16 v[76:79], v[156:159], v[128:131], v[76:79]
    v_mfma_f32_16x16x32_bf16 v[80:83], v[144:147], v[132:135], v[80:83]
    v_mfma_f32_16x16x32_bf16 v[84:87], v[148:151], v[132:135], v[84:87]
    v_mfma_f32_16x16x32_bf16 v[88:91], v[152:155], v[132:135], v[88:91]
    v_mfma_f32_16x16x32_bf16 v[92:95], v[156:159], v[132:135], v[92:95]
    v_mfma_f32_16x16x32_bf16 v[96:99], v[144:147], v[136:139], v[96:99]
    v_mfma_f32_16x16x32_bf16 v[100:103], v[148:151], v[136:139], v[100:103]
    v_mfma_f32_16x16x32_bf16 v[104:107], v[152:155], v[136:139], v[104:107]
    v_mfma_f32_16x16x32_bf16 v[108:111], v[156:159], v[136:139], v[108:111]
    v_mfma_f32_16x16x32_bf16 v[112:115], v[144:147], v[140:143], v[112:115]
    v_mfma_f32_16x16x32_bf16 v[116:119], v[148:151], v[140:143], v[116:119]
    v_mfma_f32_16x16x32_bf16 v[120:123], v[152:155], v[140:143], v[120:123]
    v_mfma_f32_16x16x32_bf16 v[124:127], v[156:159], v[140:143], v[124:127]
    s_waitcnt vmcnt(0)
    s_barrier
    ds_read_b128 v[128:131], v11 offset:49152
    ds_read_b128 v[132:135], v11 offset:50176
    ds_read_b128 v[136:139], v11 offset:51200
    ds_read_b128 v[140:143], v11 offset:52224
    ds_read_b128 v[144:147], v12 offset:49152
    ds_read_b128 v[148:151], v12 offset:50176
    ds_read_b128 v[152:155], v12 offset:51200
    ds_read_b128 v[156:159], v12 offset:52224
    s_waitcnt lgkmcnt(8)
    v_mfma_f32_16x16x32_bf16 v[64:67], v[40:43], v[24:27], v[64:67]
    v_mfma_f32_16x16x32_bf16 v[68:71], v[44:47], v[24:27], v[68:71]
    v_mfma_f32_16x16x32_bf16 v[72:75], v[48:51], v[24:27], v[72:75]
    v_mfma_f32_16x16x32_bf16 v[76:79], v[52:55], v[24:27], v[76:79]
    v_mfma_f32_16x16x32_bf16 v[80:83], v[40:43], v[28:31], v[80:83]
    v_mfma_f32_16x16x32_bf16 v[84:87], v[44:47], v[28:31], v[84:87]
    v_mfma_f32_16x16x32_bf16 v[88:91], v[48:51], v[28:31], v[88:91]
    v_mfma_f32_16x16x32_bf16 v[92:95], v[52:55], v[28:31], v[92:95]
    v_mfma_f32_16x16x32_bf16 v[96:99], v[40:43], v[32:35], v[96:99]
    v_mfma_f32_16x16x32_bf16 v[100:103], v[44:47], v[32:35], v[100:103]
    v_mfma_f32_16x16x32_bf16 v[104:107], v[48:51], v[32:35], v[104:107]
    v_mfma_f32_16x16x32_bf16 v[108:111], v[52:55], v[32:35], v[108:111]
    v_mfma_f32_16x16x32_bf16 v[112:115], v[40:43], v[36:39], v[112:115]
    v_mfma_f32_16x16x32_bf16 v[116:119], v[44:47], v[36:39], v[116:119]
    v_mfma_f32_16x16x32_bf16 v[120:123], v[48:51], v[36:39], v[120:123]
    v_mfma_f32_16x16x32_bf16 v[124:127], v[52:55], v[36:39], v[124:127]
    s_waitcnt lgkmcnt(0)
    v_mfma_f32_16x16x32_bf16 v[64:67], v[144:147], v[128:131], v[64:67]
    v_mfma_f32_16x16x32_bf16 v[68:71], v[148:151], v[128:131], v[68:71]
    v_mfma_f32_16x16x32_bf16 v[72:75], v[152:155], v[128:131], v[72:75]
    v_mfma_f32_16x16x32_bf16 v[76:79], v[156:159], v[128:131], v[76:79]
    v_mfma_f32_16x16x32_bf16 v[80:83], v[144:147], v[132:135], v[80:83]
    v_mfma_f32_16x16x32_bf16 v[84:87], v[148:151], v[132:135], v[84:87]
    v_mfma_f32_16x16x32_bf16 v[88:91], v[152:155], v[132:135], v[88:91]
    v_mfma_f32_16x16x32_bf16 v[92:95], v[156:159], v[132:135], v[92:95]
    v_mfma_f32_16x16x32_bf16 v[96:99], v[144:147], v[136:139], v[96:99]
    v_mfma_f32_16x16x32_bf16 v[100:103], v[148:151], v[136:139], v[100:103]
    v_mfma_f32_16x16x32_bf16 v[104:107], v[152:155], v[136:139], v[104:107]
    v_mfma_f32_16x16x32_bf16 v[108:111], v[156:159], v[136:139], v[108:111]
    v_mfma_f32_16x16x32_bf16 v[112:115], v[144:147], v[140:143], v[112:115]
    v_mfma_f32_16x16x32_bf16 v[116:119], v[148:151], v[140:143], v[116:119]
    v_mfma_f32_16x16x32_bf16 v[120:123], v[152:155], v[140:143], v[120:123]
    v_mfma_f32_16x16x32_bf16 v[124:127], v[156:159], v[140:143], v[124:127]
    s_nop 7
    s_nop 1
    s_lshr_b32 s27, s12, 1
    s_and_b32 s28, s12, 1
    s_lshl_b32 s29, s20, 7
    s_lshl_b32 s30, s27, 6
    s_add_u32 s29, s29, s30
    v_add_u32 v4, s29, v3
    v_lshlrev_b32 v4, 11, v4
    s_lshl_b32 s30, s21, 9
    s_lshl_b32 s31, s28, 8
    s_add_u32 s30, s30, s31
    s_lshl_b32 s31, s22, 22
    s_add_u32 s30, s30, s31
    s_add_u32 s30, s30, 104857600
    v_add_u32 v4, s30, v4
    v_lshl_add_u32 v4, v2, 4, v4
    global_store_dwordx4 v4, v[64:67], s[4:5] offset:0
    global_store_dwordx4 v4, v[68:71], s[4:5] offset:64
    global_store_dwordx4 v4, v[72:75], s[4:5] offset:128
    global_store_dwordx4 v4, v[76:79], s[4:5] offset:192
    v_add_u32 v4, 32768, v4
    global_store_dwordx4 v4, v[80:83], s[4:5] offset:0
    global_store_dwordx4 v4, v[84:87], s[4:5] offset:64
    global_store_dwordx4 v4, v[88:91], s[4:5] offset:128
    global_store_dwordx4 v4, v[92:95], s[4:5] offset:192
    v_add_u32 v4, 32768, v4
    global_store_dwordx4 v4, v[96:99], s[4:5] offset:0
    global_store_dwordx4 v4, v[100:103], s[4:5] offset:64
    global_store_dwordx4 v4, v[104:107], s[4:5] offset:128
    global_store_dwordx4 v4, v[108:111], s[4:5] offset:192
    v_add_u32 v4, 32768, v4
    global_store_dwordx4 v4, v[112:115], s[4:5] offset:0
    global_store_dwordx4 v4, v[116:119], s[4:5] offset:64
    global_store_dwordx4 v4, v[120:123], s[4:5] offset:128
    global_store_dwordx4 v4, v[124:127], s[4:5] offset:192
    s_branch w_chain_kernel_45
w_chain_kernel_53:
    s_lshr_b32 s20, s38, 6
    s_and_b32 s23, s38, 31
    s_bfe_u32 s22, s38, 0x10005
    s_add_u32 s22, s22, 1
    s_lshl_b32 s41, s20, 5
    s_add_u32 s41, s41, s23
    s_lshl_b32 s24, s20, 17
    s_add_u32 s24, s24, 18874368
    s_mul_i32 s25, s23, 24
    s_lshl_b32 s26, s22, 3
    s_add_u32 s25, s25, s26
    s_lshl_b32 s25, s25, 14
    s_add_u32 s25, s25, 0
    s_cmp_eq_u32 s22, 2
    s_cbranch_scc1 L_chain_kernel_55
    s_and_b32 s13, s12, 1
    s_mul_i32 s14, s13, 65536
    s_add_u32 s14, s14, s24
    s_mul_i32 s15, s13, 65536
    s_add_u32 s15, s15, s25
    s_cmp_lt_u32 s12, 2
    s_cselect_b32 s14, s14, s15
    v_lshlrev_b32 v8, 4, v1
    v_add_u32 v4, s14, v8
    s_mov_b32 s16, 15360
    s_mov_b32 s17, 15360
    s_cselect_b32 s16, s16, s17
    v_add_u32 v5, s16, v4
    s_mov_b32 s16, 30720
    s_mov_b32 s17, 30720
    s_cselect_b32 s16, s16, s17
    v_add_u32 v6, s16, v4
    s_mov_b32 s16, 46080
    s_mov_b32 s17, 46080
    s_cselect_b32 s16, s16, s17
    v_add_u32 v7, s16, v4
    s_lshl_b32 s17, s12, 12
    s_lshr_b32 s18, s12, 1
    s_lshl_b32 s18, s18, 12
    v_add_u32 v9, s18, v8
    s_lshl_b32 s19, s13, 12
    v_add_u32 v10, s19, v8
    v_add_u32 v10, 8192, v10
    v_add_u32 v11, 65536, v9
    v_add_u32 v12, 65536, v10
    v_mov_b32 v64, 0
    v_mov_b32 v65, 0
    v_mov_b32 v66, 0
    v_mov_b32 v67, 0
    v_mov_b32 v68, 0
    v_mov_b32 v69, 0
    v_mov_b32 v70, 0
    v_mov_b32 v71, 0
    v_mov_b32 v72, 0
    v_mov_b32 v73, 0
    v_mov_b32 v74, 0
    v_mov_b32 v75, 0
    v_mov_b32 v76, 0
    v_mov_b32 v77, 0
    v_mov_b32 v78, 0
    v_mov_b32 v79, 0
    v_mov_b32 v80, 0
    v_mov_b32 v81, 0
    v_mov_b32 v82, 0
    v_mov_b32 v83, 0
    v_mov_b32 v84, 0
    v_mov_b32 v85, 0
    v_mov_b32 v86, 0
    v_mov_b32 v87, 0
    v_mov_b32 v88, 0
    v_mov_b32 v89, 0
    v_mov_b32 v90, 0
    v_mov_b32 v91, 0
    v_mov_b32 v92, 0
    v_mov_b32 v93, 0
    v_mov_b32 v94, 0
    v_mov_b32 v95, 0
    v_mov_b32 v96, 0
    v_mov_b32 v97, 0
    v_mov_b32 v98, 0
    v_mov_b32 v99, 0
    v_mov_b32 v100, 0
    v_mov_b32 v101, 0
    v_mov_b32 v102, 0
    v_mov_b32 v103, 0
    v_mov_b32 v104, 0
    v_mov_b32 v105, 0
    v_mov_b32 v106, 0
    v_mov_b32 v107, 0
    v_mov_b32 v108, 0
    v_mov_b32 v109, 0
    v_mov_b32 v110, 0
    v_mov_b32 v111, 0
    v_mov_b32 v112, 0
    v_mov_b32 v113, 0
    v_mov_b32 v114, 0
    v_mov_b32 v115, 0
    v_mov_b32 v116, 0
    v_mov_b32 v117, 0
    v_mov_b32 v118, 0
    v_mov_b32 v119, 0
    v_mov_b32 v120, 0
    v_mov_b32 v121, 0
    v_mov_b32 v122, 0
    v_mov_b32 v123, 0
    v_mov_b32 v124, 0
    v_mov_b32 v125, 0
    v_mov_b32 v126, 0
    v_mov_b32 v127, 0
    s_add_u32 s13, s17, 0
    s_mov_b32 m0, s13
    s_mov_b32 s13, 0
    buffer_load_dwordx4 v4, s[8:11], s13 offen offset:0 lds
    buffer_load_dwordx4 v5, s[8:11], s13 offen offset:1024 lds
    buffer_load_dwordx4 v6, s[8:11], s13 offen offset:2048 lds
    buffer_load_dwordx4 v7, s[8:11], s13 offen offset:3072 lds
    s_add_u32 s13, s17, 16384
    s_mov_b32 m0, s13
    s_mov_b32 s13, 1024
    buffer_load_dwordx4 v4, s[8:11], s13 offen offset:0 lds
    buffer_load_dwordx4 v5, s[8:11], s13 offen offset:1024 lds
    buffer_load_dwordx4 v6, s[8:11], s13 offen offset:2048 lds
    buffer_load_dwordx4 v7, s[8:11], s13 offen offset:3072 lds
    s_add_u32 s13, s17, 32768
    s_mov_b32 m0, s13
    s_mov_b32 s13, 2048
    buffer_load_dwordx4 v4, s[8:11], s13 offen offset:0 lds
    buffer_load_dwordx4 v5, s[8:11], s13 offen offset:1024 lds
    buffer_load_dwordx4 v6, s[8:11], s13 offen offset:2048 lds
    buffer_load_dwordx4 v7, s[8:11], s13 offen offset:3072 lds
    s_add_u32 s13, s17, 49152
    s_mov_b32 m0, s13
    s_mov_b32 s13, 3072
    buffer_load_dwordx4 v4, s[8:11], s13 offen offset:0 lds
    buffer_load_dwordx4 v5, s[8:11], s13 offen offset:1024 lds
    buffer_load_dwordx4 v6, s[8:11], s13 offen offset:2048 lds
    buffer_load_dwordx4 v7, s[8:11], s13 offen offset:3072 lds
    s_add_u32 s13, s17, 65536
    s_mov_b32 m0, s13
    s_mov_b32 s13, 4096
    buffer_load_dwordx4 v4, s[8:11], s13 offen offset:0 lds
    buffer_load_dwordx4 v5, s[8:11], s13 offen offset:1024 lds
    buffer_load_dwordx4 v6, s[8:11], s13 offen offset:2048 lds
    buffer_load_dwordx4 v7, s[8:11], s13 offen offset:3072 lds
    s_add_u32 s13, s17, 81920
    s_mov_b32 m0, s13
    s_mov_b32 s13, 5120
    buffer_load_dwordx4 v4, s[8:11], s13 offen offset:0 lds
    buffer_load_dwordx4 v5, s[8:11], s13 offen offset:1024 lds
    buffer_load_dwordx4 v6, s[8:11], s13 offen offset:2048 lds
    buffer_load_dwordx4 v7, s[8:11], s13 offen offset:3072 lds
    s_add_u32 s13, s17, 98304
    s_mov_b32 m0, s13
    s_mov_b32 s13, 6144
    buffer_load_dwordx4 v4, s[8:11], s13 offen offset:0 lds
    buffer_load_dwordx4 v5, s[8:11], s13 offen offset:1024 lds
    buffer_load_dwordx4 v6, s[8:11], s13 offen offset:2048 lds
    buffer_load_dwordx4 v7, s[8:11], s13 offen offset:3072 lds
    s_waitcnt vmcnt(24)
    s_barrier
    ds_read_b128 v[24:27], v9 offset:0
    ds_read_b128 v[28:31], v9 offset:1024
    ds_read_b128 v[32:35], v9 offset:2048
    ds_read_b128 v[36:39], v9 offset:3072
    ds_read_b128 v[40:43], v10 offset:0
    ds_read_b128 v[44:47], v10 offset:1024
    ds_read_b128 v[48:51], v10 offset:2048
    ds_read_b128 v[52:55], v10 offset:3072
    s_waitcnt vmcnt(20)
    s_barrier
    s_add_u32 s13, s17, 114688
    s_mov_b32 m0, s13
    s_mov_b32 s13, 7168
    buffer_load_dwordx4 v4, s[8:11], s13 offen offset:0 lds
    buffer_load_dwordx4 v5, s[8:11], s13 offen offset:1024 lds
    buffer_load_dwordx4 v6, s[8:11], s13 offen offset:2048 lds
    buffer_load_dwordx4 v7, s[8:11], s13 offen offset:3072 lds
    ds_read_b128 v[128:131], v9 offset:16384
    ds_read_b128 v[132:135], v9 offset:17408
    ds_read_b128 v[136:139], v9 offset:18432
    ds_read_b128 v[140:143], v9 offset:19456
    ds_read_b128 v[144:147], v10 offset:16384
    ds_read_b128 v[148:151], v10 offset:17408
    ds_read_b128 v[152:155], v10 offset:18432
    ds_read_b128 v[156:159], v10 offset:19456
    s_waitcnt lgkmcnt(8)
    v_mfma_f32_16x16x32_bf16 v[64:67], v[40:43], v[24:27], v[64:67]
    v_mfma_f32_16x16x32_bf16 v[68:71], v[44:47], v[24:27], v[68:71]
    v_mfma_f32_16x16x32_bf16 v[72:75], v[48:51], v[24:27], v[72:75]
    v_mfma_f32_16x16x32_bf16 v[76:79], v[52:55], v[24:27], v[76:79]
    v_mfma_f32_16x16x32_bf16 v[80:83], v[40:43], v[28:31], v[80:83]
    v_mfma_f32_16x16x32_bf16 v[84:87], v[44:47], v[28:31], v[84:87]
    v_mfma_f32_16x16x32_bf16 v[88:91], v[48:51], v[28:31], v[88:91]
    v_mfma_f32_16x16x32_bf16 v[92:95], v[52:55], v[28:31], v[92:95]
    v_mfma_f32_16x16x32_bf16 v[96:99], v[40:43], v[32:35], v[96:99]
    v_mfma_f32_16x16x32_bf16 v[100:103], v[44:47], v[32:35], v[100:103]
    v_mfma_f32_16x16x32_bf16 v[104:107], v[48:51], v[32:35], v[104:107]
    v_mfma_f32_16x16x32_bf16 v[108:111], v[52:55], v[32:35], v[108:111]
    v_mfma_f32_16x16x32_bf16 v[112:115], v[40:43], v[36:39], v[112:115]
    v_mfma_f32_16x16x32_bf16 v[116:119], v[44:47], v[36:39], v[116:119]
    v_mfma_f32_16x16x32_bf16 v[120:123], v[48:51], v[36:39], v[120:123]
    v_mfma_f32_16x16x32_bf16 v[124:127], v[52:55], v[36:39], v[124:127]
    s_waitcnt vmcnt(20)
    s_barrier
    s_add_u32 s13, s17, 0
    s_mov_b32 m0, s13
    s_mov_b32 s13, 8192
    buffer_load_dwordx4 v4, s[8:11], s13 offen offset:0 lds
    buffer_load_dwordx4 v5, s[8:11], s13 offen offset:1024 lds
    buffer_load_dwordx4 v6, s[8:11], s13 offen offset:2048 lds
    buffer_load_dwordx4 v7, s[8:11], s13 offen offset:3072 lds
    ds_read_b128 v[24:27], v9 offset:32768
    ds_read_b128 v[28:31], v9 offset:33792
    ds_read_b128 v[32:35], v9 offset:34816
    ds_read_b128 v[36:39], v9 offset:35840
    ds_read_b128 v[40:43], v10 offset:32768
    ds_read_b128 v[44:47], v10 offset:33792
    ds_read_b128 v[48:51], v10 offset:34816
    ds_read_b128 v[52:55], v10 offset:35840
    s_waitcnt lgkmcnt(8)
    v_mfma_f32_16x16x32_bf16 v[64:67], v[144:147], v[128:131], v[64:67]
    v_mfma_f32_16x16x32_bf16 v[68:71], v[148:151], v[128:131], v[68:71]
    v_mfma_f32_16x16x32_bf16 v[72:75], v[152:155], v[128:131], v[72:75]
    v_mfma_f32_16x16x32_bf16 v[76:79], v[156:159], v[128:131], v[76:79]
    v_mfma_f32_16x16x32_bf16 v[80:83], v[144:147], v[132:135], v[80:83]
    v_mfma_f32_16x16x32_bf16 v[84:87], v[148:151], v[132:135], v[84:87]
    v_mfma_f32_16x16x32_bf16 v[88:91], v[152:155], v[132:135], v[88:91]
    v_mfma_f32_16x16x32_bf16 v[92:95], v[156:159], v[132:135], v[92:95]
    v_mfma_f32_16x16x32_bf16 v[96:99], v[144:147], v[136:139], v[96:99]
    v_mfma_f32_16x16x32_bf16 v[100:103], v[148:151], v[136:139], v[100:103]
    v_mfma_f32_16x16x32_bf16 v[104:107], v[152:155], v[136:139], v[104:107]
    v_mfma_f32_16x16x32_bf16 v[108:111], v[156:159], v[136:139], v[108:111]
    v_mfma_f32_16x16x32_bf16 v[112:115], v[144:147], v[140:143], v[112:115]
    v_mfma_f32_16x16x32_bf16 v[116:119], v[148:151], v[140:143], v[116:119]
    v_mfma_f32_16x16x32_bf16 v[120:123], v[152:155], v[140:143], v[120:123]
    v_mfma_f32_16x16x32_bf16 v[124:127], v[156:159], v[140:143], v[124:127]
    s_waitcnt vmcnt(20)
    s_barrier
    s_add_u32 s13, s17, 16384
    s_mov_b32 m0, s13
    s_mov_b32 s13, 9216
    buffer_load_dwordx4 v4, s[8:11], s13 offen offset:0 lds
    buffer_load_dwordx4 v5, s[8:11], s13 offen offset:1024 lds
    buffer_load_dwordx4 v6, s[8:11], s13 offen offset:2048 lds
    buffer_load_dwordx4 v7, s[8:11], s13 offen offset:3072 lds
    ds_read_b128 v[128:131], v9 offset:49152
    ds_read_b128 v[132:135], v9 offset:50176
    ds_read_b128 v[136:139], v9 offset:51200
    ds_read_b128 v[140:143], v9 offset:52224
    ds_read_b128 v[144:147], v10 offset:49152
    ds_read_b128 v[148:151], v10 offset:50176
    ds_read_b128 v[152:155], v10 offset:51200
    ds_read_b128 v[156:159], v10 offset:52224
    s_waitcnt lgkmcnt(8)
    v_mfma_f32_16x16x32_bf16 v[64:67], v[40:43], v[24:27], v[64:67]
    v_mfma_f32_16x16x32_bf16 v[68:71], v[44:47], v[24:27], v[68:71]
    v_mfma_f32_16x16x32_bf16 v[72:75], v[48:51], v[24:27], v[72:75]
    v_mfma_f32_16x16x32_bf16 v[76:79], v[52:55], v[24:27], v[76:79]
    v_mfma_f32_16x16x32_bf16 v[80:83], v[40:43], v[28:31], v[80:83]
    v_mfma_f32_16x16x32_bf16 v[84:87], v[44:47], v[28:31], v[84:87]
    v_mfma_f32_16x16x32_bf16 v[88:91], v[48:51], v[28:31], v[88:91]
    v_mfma_f32_16x16x32_bf16 v[92:95], v[52:55], v[28:31], v[92:95]
    v_mfma_f32_16x16x32_bf16 v[96:99], v[40:43], v[32:35], v[96:99]
    v_mfma_f32_16x16x32_bf16 v[100:103], v[44:47], v[32:35], v[100:103]
    v_mfma_f32_16x16x32_bf16 v[104:107], v[48:51], v[32:35], v[104:107]
    v_mfma_f32_16x16x32_bf16 v[108:111], v[52:55], v[32:35], v[108:111]
    v_mfma_f32_16x16x32_bf16 v[112:115], v[40:43], v[36:39], v[112:115]
    v_mfma_f32_16x16x32_bf16 v[116:119], v[44:47], v[36:39], v[116:119]
    v_mfma_f32_16x16x32_bf16 v[120:123], v[48:51], v[36:39], v[120:123]
    v_mfma_f32_16x16x32_bf16 v[124:127], v[52:55], v[36:39], v[124:127]
    s_waitcnt vmcnt(20)
    s_barrier
    s_add_u32 s13, s17, 32768
    s_mov_b32 m0, s13
    s_mov_b32 s13, 10240
    buffer_load_dwordx4 v4, s[8:11], s13 offen offset:0 lds
    buffer_load_dwordx4 v5, s[8:11], s13 offen offset:1024 lds
    buffer_load_dwordx4 v6, s[8:11], s13 offen offset:2048 lds
    buffer_load_dwordx4 v7, s[8:11], s13 offen offset:3072 lds
    ds_read_b128 v[24:27], v11 offset:0
    ds_read_b128 v[28:31], v11 offset:1024
    ds_read_b128 v[32:35], v11 offset:2048
    ds_read_b128 v[36:39], v11 offset:3072
    ds_read_b128 v[40:43], v12 offset:0
    ds_read_b128 v[44:47], v12 offset:1024
    ds_read_b128 v[48:51], v12 offset:2048
    ds_read_b128 v[52:55], v12 offset:3072
    s_waitcnt lgkmcnt(8)
    v_mfma_f32_16x16x32_bf16 v[64:67], v[144:147], v[128:131], v[64:67]
    v_mfma_f32_16x16x32_bf16 v[68:71], v[148:151], v[128:131], v[68:71]
    v_mfma_f32_16x16x32_bf16 v[72:75], v[152:155], v[128:131], v[72:75]
    v_mfma_f32_16x16x32_bf16 v[76:79], v[156:159], v[128:131], v[76:79]
    v_mfma_f32_16x16x32_bf16 v[80:83], v[144:147], v[132:135], v[80:83]
    v_mfma_f32_16x16x32_bf16 v[84:87], v[148:151], v[132:135], v[84:87]
    v_mfma_f32_16x16x32_bf16 v[88:91], v[152:155], v[132:135], v[88:91]
    v_mfma_f32_16x16x32_bf16 v[92:95], v[156:159], v[132:135], v[92:95]
    v_mfma_f32_16x16x32_bf16 v[96:99], v[144:147], v[136:139], v[96:99]
    v_mfma_f32_16x16x32_bf16 v[100:103], v[148:151], v[136:139], v[100:103]
    v_mfma_f32_16x16x32_bf16 v[104:107], v[152:155], v[136:139], v[104:107]
    v_mfma_f32_16x16x32_bf16 v[108:111], v[156:159], v[136:139], v[108:111]
    v_mfma_f32_16x16x32_bf16 v[112:115], v[144:147], v[140:143], v[112:115]
    v_mfma_f32_16x16x32_bf16 v[116:119], v[148:151], v[140:143], v[116:119]
    v_mfma_f32_16x16x32_bf16 v[120:123], v[152:155], v[140:143], v[120:123]
    v_mfma_f32_16x16x32_bf16 v[124:127], v[156:159], v[140:143], v[124:127]
    s_waitcnt vmcnt(20)
    s_barrier
    s_add_u32 s13, s17, 49152
    s_mov_b32 m0, s13
    s_mov_b32 s13, 11264
    buffer_load_dwordx4 v4, s[8:11], s13 offen offset:0 lds
    buffer_load_dwordx4 v5, s[8:11], s13 offen offset:1024 lds
    buffer_load_dwordx4 v6, s[8:11], s13 offen offset:2048 lds
    buffer_load_dwordx4 v7, s[8:11], s13 offen offset:3072 lds
    ds_read_b128 v[128:131], v11 offset:16384
    ds_read_b128 v[132:135], v11 offset:17408
    ds_read_b128 v[136:139], v11 offset:18432
    ds_read_b128 v[140:143], v11 offset:19456
    ds_read_b128 v[144:147], v12 offset:16384
    ds_read_b128 v[148:151], v12 offset:17408
    ds_read_b128 v[152:155], v12 offset:18432
    ds_read_b128 v[156:159], v12 offset:19456
    s_waitcnt lgkmcnt(8)
    v_mfma_f32_16x16x32_bf16 v[64:67], v[40:43], v[24:27], v[64:67]
    v_mfma_f32_16x16x32_bf16 v[68:71], v[44:47], v[24:27], v[68:71]
    v_mfma_f32_16x16x32_bf16 v[72:75], v[48:51], v[24:27], v[72:75]
    v_mfma_f32_16x16x32_bf16 v[76:79], v[52:55], v[24:27], v[76:79]
    v_mfma_f32_16x16x32_bf16 v[80:83], v[40:43], v[28:31], v[80:83]
    v_mfma_f32_16x16x32_bf16 v[84:87], v[44:47], v[28:31], v[84:87]
    v_mfma_f32_16x16x32_bf16 v[88:91], v[48:51], v[28:31], v[88:91]
    v_mfma_f32_16x16x32_bf16 v[92:95], v[52:55], v[28:31], v[92:95]
    v_mfma_f32_16x16x32_bf16 v[96:99], v[40:43], v[32:35], v[96:99]
    v_mfma_f32_16x16x32_bf16 v[100:103], v[44:47], v[32:35], v[100:103]
    v_mfma_f32_16x16x32_bf16 v[104:107], v[48:51], v[32:35], v[104:107]
    v_mfma_f32_16x16x32_bf16 v[108:111], v[52:55], v[32:35], v[108:111]
    v_mfma_f32_16x16x32_bf16 v[112:115], v[40:43], v[36:39], v[112:115]
    v_mfma_f32_16x16x32_bf16 v[116:119], v[44:47], v[36:39], v[116:119]
    v_mfma_f32_16x16x32_bf16 v[120:123], v[48:51], v[36:39], v[120:123]
    v_mfma_f32_16x16x32_bf16 v[124:127], v[52:55], v[36:39], v[124:127]
    s_waitcnt vmcnt(20)
    s_barrier
    s_add_u32 s13, s17, 65536
    s_mov_b32 m0, s13
    s_mov_b32 s13, 12288
    buffer_load_dwordx4 v4, s[8:11], s13 offen offset:0 lds
    buffer_load_dwordx4 v5, s[8:11], s13 offen offset:1024 lds
    buffer_load_dwordx4 v6, s[8:11], s13 offen offset:2048 lds
    buffer_load_dwordx4 v7, s[8:11], s13 offen offset:3072 lds
    ds_read_b128 v[24:27], v11 offset:32768
    ds_read_b128 v[28:31], v11 offset:33792
    ds_read_b128 v[32:35], v11 offset:34816
    ds_read_b128 v[36:39], v11 offset:35840
    ds_read_b128 v[40:43], v12 offset:32768
    ds_read_b128 v[44:47], v12 offset:33792
    ds_read_b128 v[48:51], v12 offset:34816
    ds_read_b128 v[52:55], v12 offset:35840
    s_waitcnt lgkmcnt(8)
    v_mfma_f32_16x16x32_bf16 v[64:67], v[144:147], v[128:131], v[64:67]
    v_mfma_f32_16x16x32_bf16 v[68:71], v[148:151], v[128:131], v[68:71]
    v_mfma_f32_16x16x32_bf16 v[72:75], v[152:155], v[128:131], v[72:75]
    v_mfma_f32_16x16x32_bf16 v[76:79], v[156:159], v[128:131], v[76:79]
    v_mfma_f32_16x16x32_bf16 v[80:83], v[144:147], v[132:135], v[80:83]
    v_mfma_f32_16x16x32_bf16 v[84:87], v[148:151], v[132:135], v[84:87]
    v_mfma_f32_16x16x32_bf16 v[88:91], v[152:155], v[132:135], v[88:91]
    v_mfma_f32_16x16x32_bf16 v[92:95], v[156:159], v[132:135], v[92:95]
    v_mfma_f32_16x16x32_bf16 v[96:99], v[144:147], v[136:139], v[96:99]
    v_mfma_f32_16x16x32_bf16 v[100:103], v[148:151], v[136:139], v[100:103]
    v_mfma_f32_16x16x32_bf16 v[104:107], v[152:155], v[136:139], v[104:107]
    v_mfma_f32_16x16x32_bf16 v[108:111], v[156:159], v[136:139], v[108:111]
    v_mfma_f32_16x16x32_bf16 v[112:115], v[144:147], v[140:143], v[112:115]
    v_mfma_f32_16x16x32_bf16 v[116:119], v[148:151], v[140:143], v[116:119]
    v_mfma_f32_16x16x32_bf16 v[120:123], v[152:155], v[140:143], v[120:123]
    v_mfma_f32_16x16x32_bf16 v[124:127], v[156:159], v[140:143], v[124:127]
    s_waitcnt vmcnt(20)
    s_barrier
    s_add_u32 s13, s17, 81920
    s_mov_b32 m0, s13
    s_mov_b32 s13, 13312
    buffer_load_dwordx4 v4, s[8:11], s13 offen offset:0 lds
    buffer_load_dwordx4 v5, s[8:11], s13 offen offset:1024 lds
    buffer_load_dwordx4 v6, s[8:11], s13 offen offset:2048 lds
    buffer_load_dwordx4 v7, s[8:11], s13 offen offset:3072 lds
    ds_read_b128 v[128:131], v11 offset:49152
    ds_read_b128 v[132:135], v11 offset:50176
    ds_read_b128 v[136:139], v11 offset:51200
    ds_read_b128 v[140:143], v11 offset:52224
    ds_read_b128 v[144:147], v12 offset:49152
    ds_read_b128 v[148:151], v12 offset:50176
    ds_read_b128 v[152:155], v12 offset:51200
    ds_read_b128 v[156:159], v12 offset:52224
    s_waitcnt lgkmcnt(8)
    v_mfma_f32_16x16x32_bf16 v[64:67], v[40:43], v[24:27], v[64:67]
    v_mfma_f32_16x16x32_bf16 v[68:71], v[44:47], v[24:27], v[68:71]
    v_mfma_f32_16x16x32_bf16 v[72:75], v[48:51], v[24:27], v[72:75]
    v_mfma_f32_16x16x32_bf16 v[76:79], v[52:55], v[24:27], v[76:79]
    v_mfma_f32_16x16x32_bf16 v[80:83], v[40:43], v[28:31], v[80:83]
    v_mfma_f32_16x16x32_bf16 v[84:87], v[44:47], v[28:31], v[84:87]
    v_mfma_f32_16x16x32_bf16 v[88:91], v[48:51], v[28:31], v[88:91]
    v_mfma_f32_16x16x32_bf16 v[92:95], v[52:55], v[28:31], v[92:95]
    v_mfma_f32_16x16x32_bf16 v[96:99], v[40:43], v[32:35], v[96:99]
    v_mfma_f32_16x16x32_bf16 v[100:103], v[44:47], v[32:35], v[100:103]
    v_mfma_f32_16x16x32_bf16 v[104:107], v[48:51], v[32:35], v[104:107]
    v_mfma_f32_16x16x32_bf16 v[108:111], v[52:55], v[32:35], v[108:111]
    v_mfma_f32_16x16x32_bf16 v[112:115], v[40:43], v[36:39], v[112:115]
    v_mfma_f32_16x16x32_bf16 v[116:119], v[44:47], v[36:39], v[116:119]
    v_mfma_f32_16x16x32_bf16 v[120:123], v[48:51], v[36:39], v[120:123]
    v_mfma_f32_16x16x32_bf16 v[124:127], v[52:55], v[36:39], v[124:127]
    s_waitcnt vmcnt(20)
    s_barrier
    s_add_u32 s13, s17, 98304
    s_mov_b32 m0, s13
    s_mov_b32 s13, 14336
    buffer_load_dwordx4 v4, s[8:11], s13 offen offset:0 lds
    buffer_load_dwordx4 v5, s[8:11], s13 offen offset:1024 lds
    buffer_load_dwordx4 v6, s[8:11], s13 offen offset:2048 lds
    buffer_load_dwordx4 v7, s[8:11], s13 offen offset:3072 lds
    ds_read_b128 v[24:27], v9 offset:0
    ds_read_b128 v[28:31], v9 offset:1024
    ds_read_b128 v[32:35], v9 offset:2048
    ds_read_b128 v[36:39], v9 offset:3072
    ds_read_b128 v[40:43], v10 offset:0
    ds_read_b128 v[44:47], v10 offset:1024
    ds_read_b128 v[48:51], v10 offset:2048
    ds_read_b128 v[52:55], v10 offset:3072
    s_waitcnt lgkmcnt(8)
    v_mfma_f32_16x16x32_bf16 v[64:67], v[144:147], v[128:131], v[64:67]
    v_mfma_f32_16x16x32_bf16 v[68:71], v[148:151], v[128:131], v[68:71]
    v_mfma_f32_16x16x32_bf16 v[72:75], v[152:155], v[128:131], v[72:75]
    v_mfma_f32_16x16x32_bf16 v[76:79], v[156:159], v[128:131], v[76:79]
    v_mfma_f32_16x16x32_bf16 v[80:83], v[144:147], v[132:135], v[80:83]
    v_mfma_f32_16x16x32_bf16 v[84:87], v[148:151], v[132:135], v[84:87]
    v_mfma_f32_16x16x32_bf16 v[88:91], v[152:155], v[132:135], v[88:91]
    v_mfma_f32_16x16x32_bf16 v[92:95], v[156:159], v[132:135], v[92:95]
    v_mfma_f32_16x16x32_bf16 v[96:99], v[144:147], v[136:139], v[96:99]
    v_mfma_f32_16x16x32_bf16 v[100:103], v[148:151], v[136:139], v[100:103]
    v_mfma_f32_16x16x32_bf16 v[104:107], v[152:155], v[136:139], v[104:107]
    v_mfma_f32_16x16x32_bf16 v[108:111], v[156:159], v[136:139], v[108:111]
    v_mfma_f32_16x16x32_bf16 v[112:115], v[144:147], v[140:143], v[112:115]
    v_mfma_f32_16x16x32_bf16 v[116:119], v[148:151], v[140:143], v[116:119]
    v_mfma_f32_16x16x32_bf16 v[120:123], v[152:155], v[140:143], v[120:123]
    v_mfma_f32_16x16x32_bf16 v[124:127], v[156:159], v[140:143], v[124:127]
    s_waitcnt vmcnt(20)
    s_barrier
    s_add_u32 s13, s17, 114688
    s_mov_b32 m0, s13
    s_mov_b32 s13, 15360
    buffer_load_dwordx4 v4, s[8:11], s13 offen offset:0 lds
    buffer_load_dwordx4 v5, s[8:11], s13 offen offset:1024 lds
    buffer_load_dwordx4 v6, s[8:11], s13 offen offset:2048 lds
    buffer_load_dwordx4 v7, s[8:11], s13 offen offset:3072 lds
    ds_read_b128 v[128:131], v9 offset:16384
    ds_read_b128 v[132:135], v9 offset:17408
    ds_read_b128 v[136:139], v9 offset:18432
    ds_read_b128 v[140:143], v9 offset:19456
    ds_read_b128 v[144:147], v10 offset:16384
    ds_read_b128 v[148:151], v10 offset:17408
    ds_read_b128 v[152:155], v10 offset:18432
    ds_read_b128 v[156:159], v10 offset:19456
    s_waitcnt lgkmcnt(8)
    v_mfma_f32_16x16x32_bf16 v[64:67], v[40:43], v[24:27], v[64:67]
    v_mfma_f32_16x16x32_bf16 v[68:71], v[44:47], v[24:27], v[68:71]
    v_mfma_f32_16x16x32_bf16 v[72:75], v[48:51], v[24:27], v[72:75]
    v_mfma_f32_16x16x32_bf16 v[76:79], v[52:55], v[24:27], v[76:79]
    v_mfma_f32_16x16x32_bf16 v[80:83], v[40:43], v[28:31], v[80:83]
    v_mfma_f32_16x16x32_bf16 v[84:87], v[44:47], v[28:31], v[84:87]
    v_mfma_f32_16x16x32_bf16 v[88:91], v[48:51], v[28:31], v[88:91]
    v_mfma_f32_16x16x32_bf16 v[92:95], v[52:55], v[28:31], v[92:95]
    v_mfma_f32_16x16x32_bf16 v[96:99], v[40:43], v[32:35], v[96:99]
    v_mfma_f32_16x16x32_bf16 v[100:103], v[44:47], v[32:35], v[100:103]
    v_mfma_f32_16x16x32_bf16 v[104:107], v[48:51], v[32:35], v[104:107]
    v_mfma_f32_16x16x32_bf16 v[108:111], v[52:55], v[32:35], v[108:111]
    v_mfma_f32_16x16x32_bf16 v[112:115], v[40:43], v[36:39], v[112:115]
    v_mfma_f32_16x16x32_bf16 v[116:119], v[44:47], v[36:39], v[116:119]
    v_mfma_f32_16x16x32_bf16 v[120:123], v[48:51], v[36:39], v[120:123]
    v_mfma_f32_16x16x32_bf16 v[124:127], v[52:55], v[36:39], v[124:127]
    s_waitcnt vmcnt(20)
    s_barrier
    ds_read_b128 v[24:27], v9 offset:32768
    ds_read_b128 v[28:31], v9 offset:33792
    ds_read_b128 v[32:35], v9 offset:34816
    ds_read_b128 v[36:39], v9 offset:35840
    ds_read_b128 v[40:43], v10 offset:32768
    ds_read_b128 v[44:47], v10 offset:33792
    ds_read_b128 v[48:51], v10 offset:34816
    ds_read_b128 v[52:55], v10 offset:35840
    s_waitcnt lgkmcnt(8)
    v_mfma_f32_16x16x32_bf16 v[64:67], v[144:147], v[128:131], v[64:67]
    v_mfma_f32_16x16x32_bf16 v[68:71], v[148:151], v[128:131], v[68:71]
    v_mfma_f32_16x16x32_bf16 v[72:75], v[152:155], v[128:131], v[72:75]
    v_mfma_f32_16x16x32_bf16 v[76:79], v[156:159], v[128:131], v[76:79]
    v_mfma_f32_16x16x32_bf16 v[80:83], v[144:147], v[132:135], v[80:83]
    v_mfma_f32_16x16x32_bf16 v[84:87], v[148:151], v[132:135], v[84:87]
    v_mfma_f32_16x16x32_bf16 v[88:91], v[152:155], v[132:135], v[88:91]
    v_mfma_f32_16x16x32_bf16 v[92:95], v[156:159], v[132:135], v[92:95]
    v_mfma_f32_16x16x32_bf16 v[96:99], v[144:147], v[136:139], v[96:99]
    v_mfma_f32_16x16x32_bf16 v[100:103], v[148:151], v[136:139], v[100:103]
    v_mfma_f32_16x16x32_bf16 v[104:107], v[152:155], v[136:139], v[104:107]
    v_mfma_f32_16x16x32_bf16 v[108:111], v[156:159], v[136:139], v[108:111]
    v_mfma_f32_16x16x32_bf16 v[112:115], v[144:147], v[140:143], v[112:115]
    v_mfma_f32_16x16x32_bf16 v[116:119], v[148:151], v[140:143], v[116:119]
    v_mfma_f32_16x16x32_bf16 v[120:123], v[152:155], v[140:143], v[120:123]
    v_mfma_f32_16x16x32_bf16 v[124:127], v[156:159], v[140:143], v[124:127]
    s_waitcnt vmcnt(16)
    s_barrier
    ds_read_b128 v[128:131], v9 offset:49152
    ds_read_b128 v[132:135], v9 offset:50176
    ds_read_b128 v[136:139], v9 offset:51200
    ds_read_b128 v[140:143], v9 offset:52224
    ds_read_b128 v[144:147], v10 offset:49152
    ds_read_b128 v[148:151], v10 offset:50176
    ds_read_b128 v[152:155], v10 offset:51200
    ds_read_b128 v[156:159], v10 offset:52224
    s_waitcnt lgkmcnt(8)
    v_mfma_f32_16x16x32_bf16 v[64:67], v[40:43], v[24:27], v[64:67]
    v_mfma_f32_16x16x32_bf16 v[68:71], v[44:47], v[24:27], v[68:71]
    v_mfma_f32_16x16x32_bf16 v[72:75], v[48:51], v[24:27], v[72:75]
    v_mfma_f32_16x16x32_bf16 v[76:79], v[52:55], v[24:27], v[76:79]
    v_mfma_f32_16x16x32_bf16 v[80:83], v[40:43], v[28:31], v[80:83]
    v_mfma_f32_16x16x32_bf16 v[84:87], v[44:47], v[28:31], v[84:87]
    v_mfma_f32_16x16x32_bf16 v[88:91], v[48:51], v[28:31], v[88:91]
    v_mfma_f32_16x16x32_bf16 v[92:95], v[52:55], v[28:31], v[92:95]
    v_mfma_f32_16x16x32_bf16 v[96:99], v[40:43], v[32:35], v[96:99]
    v_mfma_f32_16x16x32_bf16 v[100:103], v[44:47], v[32:35], v[100:103]
    v_mfma_f32_16x16x32_bf16 v[104:107], v[48:51], v[32:35], v[104:107]
    v_mfma_f32_16x16x32_bf16 v[108:111], v[52:55], v[32:35], v[108:111]
    v_mfma_f32_16x16x32_bf16 v[112:115], v[40:43], v[36:39], v[112:115]
    v_mfma_f32_16x16x32_bf16 v[116:119], v[44:47], v[36:39], v[116:119]
    v_mfma_f32_16x16x32_bf16 v[120:123], v[48:51], v[36:39], v[120:123]
    v_mfma_f32_16x16x32_bf16 v[124:127], v[52:55], v[36:39], v[124:127]
    s_waitcnt vmcnt(12)
    s_barrier
    ds_read_b128 v[24:27], v11 offset:0
    ds_read_b128 v[28:31], v11 offset:1024
    ds_read_b128 v[32:35], v11 offset:2048
    ds_read_b128 v[36:39], v11 offset:3072
    ds_read_b128 v[40:43], v12 offset:0
    ds_read_b128 v[44:47], v12 offset:1024
    ds_read_b128 v[48:51], v12 offset:2048
    ds_read_b128 v[52:55], v12 offset:3072
    s_waitcnt lgkmcnt(8)
    v_mfma_f32_16x16x32_bf16 v[64:67], v[144:147], v[128:131], v[64:67]
    v_mfma_f32_16x16x32_bf16 v[68:71], v[148:151], v[128:131], v[68:71]
    v_mfma_f32_16x16x32_bf16 v[72:75], v[152:155], v[128:131], v[72:75]
    v_mfma_f32_16x16x32_bf16 v[76:79], v[156:159], v[128:131], v[76:79]
    v_mfma_f32_16x16x32_bf16 v[80:83], v[144:147], v[132:135], v[80:83]
    v_mfma_f32_16x16x32_bf16 v[84:87], v[148:151], v[132:135], v[84:87]
    v_mfma_f32_16x16x32_bf16 v[88:91], v[152:155], v[132:135], v[88:91]
    v_mfma_f32_16x16x32_bf16 v[92:95], v[156:159], v[132:135], v[92:95]
    v_mfma_f32_16x16x32_bf16 v[96:99], v[144:147], v[136:139], v[96:99]
    v_mfma_f32_16x16x32_bf16 v[100:103], v[148:151], v[136:139], v[100:103]
    v_mfma_f32_16x16x32_bf16 v[104:107], v[152:155], v[136:139], v[104:107]
    v_mfma_f32_16x16x32_bf16 v[108:111], v[156:159], v[136:139], v[108:111]
    v_mfma_f32_16x16x32_bf16 v[112:115], v[144:147], v[140:143], v[112:115]
    v_mfma_f32_16x16x32_bf16 v[116:119], v[148:151], v[140:143], v[116:119]
    v_mfma_f32_16x16x32_bf16 v[120:123], v[152:155], v[140:143], v[120:123]
    v_mfma_f32_16x16x32_bf16 v[124:127], v[156:159], v[140:143], v[124:127]
    s_waitcnt vmcnt(8)
    s_barrier
    ds_read_b128 v[128:131], v11 offset:16384
    ds_read_b128 v[132:135], v11 offset:17408
    ds_read_b128 v[136:139], v11 offset:18432
    ds_read_b128 v[140:143], v11 offset:19456
    ds_read_b128 v[144:147], v12 offset:16384
    ds_read_b128 v[148:151], v12 offset:17408
    ds_read_b128 v[152:155], v12 offset:18432
    ds_read_b128 v[156:159], v12 offset:19456
    s_waitcnt lgkmcnt(8)
    v_mfma_f32_16x16x32_bf16 v[64:67], v[40:43], v[24:27], v[64:67]
    v_mfma_f32_16x16x32_bf16 v[68:71], v[44:47], v[24:27], v[68:71]
    v_mfma_f32_16x16x32_bf16 v[72:75], v[48:51], v[24:27], v[72:75]
    v_mfma_f32_16x16x32_bf16 v[76:79], v[52:55], v[24:27], v[76:79]
    v_mfma_f32_16x16x32_bf16 v[80:83], v[40:43], v[28:31], v[80:83]
    v_mfma_f32_16x16x32_bf16 v[84:87], v[44:47], v[28:31], v[84:87]
    v_mfma_f32_16x16x32_bf16 v[88:91], v[48:51], v[28:31], v[88:91]
    v_mfma_f32_16x16x32_bf16 v[92:95], v[52:55], v[28:31], v[92:95]
    v_mfma_f32_16x16x32_bf16 v[96:99], v[40:43], v[32:35], v[96:99]
    v_mfma_f32_16x16x32_bf16 v[100:103], v[44:47], v[32:35], v[100:103]
    v_mfma_f32_16x16x32_bf16 v[104:107], v[48:51], v[32:35], v[104:107]
    v_mfma_f32_16x16x32_bf16 v[108:111], v[52:55], v[32:35], v[108:111]
    v_mfma_f32_16x16x32_bf16 v[112:115], v[40:43], v[36:39], v[112:115]
    v_mfma_f32_16x16x32_bf16 v[116:119], v[44:47], v[36:39], v[116:119]
    v_mfma_f32_16x16x32_bf16 v[120:123], v[48:51], v[36:39], v[120:123]
    v_mfma_f32_16x16x32_bf16 v[124:127], v[52:55], v[36:39], v[124:127]
    s_waitcnt vmcnt(4)
    s_barrier
    ds_read_b128 v[24:27], v11 offset:32768
    ds_read_b128 v[28:31], v11 offset:33792
    ds_read_b128 v[32:35], v11 offset:34816
    ds_read_b128 v[36:39], v11 offset:35840
    ds_read_b128 v[40:43], v12 offset:32768
    ds_read_b128 v[44:47], v12 offset:33792
    ds_read_b128 v[48:51], v12 offset:34816
    ds_read_b128 v[52:55], v12 offset:35840
    s_waitcnt lgkmcnt(8)
    v_mfma_f32_16x16x32_bf16 v[64:67], v[144:147], v[128:131], v[64:67]
    v_mfma_f32_16x16x32_bf16 v[68:71], v[148:151], v[128:131], v[68:71]
    v_mfma_f32_16x16x32_bf16 v[72:75], v[152:155], v[128:131], v[72:75]
    v_mfma_f32_16x16x32_bf16 v[76:79], v[156:159], v[128:131], v[76:79]
    v_mfma_f32_16x16x32_bf16 v[80:83], v[144:147], v[132:135], v[80:83]
    v_mfma_f32_16x16x32_bf16 v[84:87], v[148:151], v[132:135], v[84:87]
    v_mfma_f32_16x16x32_bf16 v[88:91], v[152:155], v[132:135], v[88:91]
    v_mfma_f32_16x16x32_bf16 v[92:95], v[156:159], v[132:135], v[92:95]
    v_mfma_f32_16x16x32_bf16 v[96:99], v[144:147], v[136:139], v[96:99]
    v_mfma_f32_16x16x32_bf16 v[100:103], v[148:151], v[136:139], v[100:103]
    v_mfma_f32_16x16x32_bf16 v[104:107], v[152:155], v[136:139], v[104:107]
    v_mfma_f32_16x16x32_bf16 v[108:111], v[156:159], v[136:139], v[108:111]
    v_mfma_f32_16x16x32_bf16 v[112:115], v[144:147], v[140:143], v[112:115]
    v_mfma_f32_16x16x32_bf16 v[116:119], v[148:151], v[140:143], v[116:119]
    v_mfma_f32_16x16x32_bf16 v[120:123], v[152:155], v[140:143], v[120:123]
    v_mfma_f32_16x16x32_bf16 v[124:127], v[156:159], v[140:143], v[124:127]
    s_waitcnt vmcnt(0)
    s_barrier
    ds_read_b128 v[128:131], v11 offset:49152
    ds_read_b128 v[132:135], v11 offset:50176
    ds_read_b128 v[136:139], v11 offset:51200
    ds_read_b128 v[140:143], v11 offset:52224
    ds_read_b128 v[144:147], v12 offset:49152
    ds_read_b128 v[148:151], v12 offset:50176
    ds_read_b128 v[152:155], v12 offset:51200
    ds_read_b128 v[156:159], v12 offset:52224
    s_waitcnt lgkmcnt(8)
    v_mfma_f32_16x16x32_bf16 v[64:67], v[40:43], v[24:27], v[64:67]
    v_mfma_f32_16x16x32_bf16 v[68:71], v[44:47], v[24:27], v[68:71]
    v_mfma_f32_16x16x32_bf16 v[72:75], v[48:51], v[24:27], v[72:75]
    v_mfma_f32_16x16x32_bf16 v[76:79], v[52:55], v[24:27], v[76:79]
    v_mfma_f32_16x16x32_bf16 v[80:83], v[40:43], v[28:31], v[80:83]
    v_mfma_f32_16x16x32_bf16 v[84:87], v[44:47], v[28:31], v[84:87]
    v_mfma_f32_16x16x32_bf16 v[88:91], v[48:51], v[28:31], v[88:91]
    v_mfma_f32_16x16x32_bf16 v[92:95], v[52:55], v[28:31], v[92:95]
    v_mfma_f32_16x16x32_bf16 v[96:99], v[40:43], v[32:35], v[96:99]
    v_mfma_f32_16x16x32_bf16 v[100:103], v[44:47], v[32:35], v[100:103]
    v_mfma_f32_16x16x32_bf16 v[104:107], v[48:51], v[32:35], v[104:107]
    v_mfma_f32_16x16x32_bf16 v[108:111], v[52:55], v[32:35], v[108:111]
    v_mfma_f32_16x16x32_bf16 v[112:115], v[40:43], v[36:39], v[112:115]
    v_mfma_f32_16x16x32_bf16 v[116:119], v[44:47], v[36:39], v[116:119]
    v_mfma_f32_16x16x32_bf16 v[120:123], v[48:51], v[36:39], v[120:123]
    v_mfma_f32_16x16x32_bf16 v[124:127], v[52:55], v[36:39], v[124:127]
    s_waitcnt lgkmcnt(0)
    v_mfma_f32_16x16x32_bf16 v[64:67], v[144:147], v[128:131], v[64:67]
    v_mfma_f32_16x16x32_bf16 v[68:71], v[148:151], v[128:131], v[68:71]
    v_mfma_f32_16x16x32_bf16 v[72:75], v[152:155], v[128:131], v[72:75]
    v_mfma_f32_16x16x32_bf16 v[76:79], v[156:159], v[128:131], v[76:79]
    v_mfma_f32_16x16x32_bf16 v[80:83], v[144:147], v[132:135], v[80:83]
    v_mfma_f32_16x16x32_bf16 v[84:87], v[148:151], v[132:135], v[84:87]
    v_mfma_f32_16x16x32_bf16 v[88:91], v[152:155], v[132:135], v[88:91]
    v_mfma_f32_16x16x32_bf16 v[92:95], v[156:159], v[132:135], v[92:95]
    v_mfma_f32_16x16x32_bf16 v[96:99], v[144:147], v[136:139], v[96:99]
    v_mfma_f32_16x16x32_bf16 v[100:103], v[148:151], v[136:139], v[100:103]
    v_mfma_f32_16x16x32_bf16 v[104:107], v[152:155], v[136:139], v[104:107]
    v_mfma_f32_16x16x32_bf16 v[108:111], v[156:159], v[136:139], v[108:111]
    v_mfma_f32_16x16x32_bf16 v[112:115], v[144:147], v[140:143], v[112:115]
    v_mfma_f32_16x16x32_bf16 v[116:119], v[148:151], v[140:143], v[116:119]
    v_mfma_f32_16x16x32_bf16 v[120:123], v[152:155], v[140:143], v[120:123]
    v_mfma_f32_16x16x32_bf16 v[124:127], v[156:159], v[140:143], v[124:127]
    s_nop 7
    s_nop 1
    s_mov_b32 s26, 20971520
    s_mov_b32 s27, 37748736
    s_cmp_eq_u32 s22, 0
    s_cselect_b32 s26, s26, s27
    s_lshr_b32 s27, s12, 1
    s_and_b32 s28, s12, 1
    s_lshl_b32 s29, s20, 2
    s_lshl_b32 s30, s27, 1
    s_add_u32 s29, s29, s30
    s_lshl_b32 s29, s29, 5
    s_add_u32 s29, s29, s23
    s_lshl_b32 s29, s29, 13
    s_add_u32 s26, s26, s29
    s_lshl_b32 s28, s28, 11
    s_add_u32 s26, s26, s28
    v_lshlrev_b32 v4, 4, v1
    v_add_u32 v4, s26, v4
    v_add_u32 v5, 4096, v4
    v_add_u32 v6, 262144, v4
    v_add_u32 v7, 4096, v6
    v_cvt_pk_bf16_f32 v32, v64, v68
    v_cvt_pk_bf16_f32 v33, v65, v69
    v_cvt_pk_bf16_f32 v34, v66, v70
    v_cvt_pk_bf16_f32 v35, v67, v71
    global_store_dwordx4 v4, v[32:35], s[4:5] offset:0 sc1
    v_cvt_pk_bf16_f32 v36, v72, v76
    v_cvt_pk_bf16_f32 v37, v73, v77
    v_cvt_pk_bf16_f32 v38, v74, v78
    v_cvt_pk_bf16_f32 v39, v75, v79
    global_store_dwordx4 v4, v[36:39], s[4:5] offset:1024 sc1
    v_cvt_pk_bf16_f32 v40, v80, v84
    v_cvt_pk_bf16_f32 v41, v81, v85
    v_cvt_pk_bf16_f32 v42, v82, v86
    v_cvt_pk_bf16_f32 v43, v83, v87
    global_store_dwordx4 v5, v[40:43], s[4:5] offset:0 sc1
    v_cvt_pk_bf16_f32 v44, v88, v92
    v_cvt_pk_bf16_f32 v45, v89, v93
    v_cvt_pk_bf16_f32 v46, v90, v94
    v_cvt_pk_bf16_f32 v47, v91, v95
    global_store_dwordx4 v5, v[44:47], s[4:5] offset:1024 sc1
    v_cvt_pk_bf16_f32 v32, v96, v100
    v_cvt_pk_bf16_f32 v33, v97, v101
    v_cvt_pk_bf16_f32 v34, v98, v102
    v_cvt_pk_bf16_f32 v35, v99, v103
    global_store_dwordx4 v6, v[32:35], s[4:5] offset:0 sc1
    v_cvt_pk_bf16_f32 v36, v104, v108
    v_cvt_pk_bf16_f32 v37, v105, v109
    v_cvt_pk_bf16_f32 v38, v106, v110
    v_cvt_pk_bf16_f32 v39, v107, v111
    global_store_dwordx4 v6, v[36:39], s[4:5] offset:1024 sc1
    v_cvt_pk_bf16_f32 v40, v112, v116
    v_cvt_pk_bf16_f32 v41, v113, v117
    v_cvt_pk_bf16_f32 v42, v114, v118
    v_cvt_pk_bf16_f32 v43, v115, v119
    global_store_dwordx4 v7, v[40:43], s[4:5] offset:0 sc1
    v_cvt_pk_bf16_f32 v44, v120, v124
    v_cvt_pk_bf16_f32 v45, v121, v125
    v_cvt_pk_bf16_f32 v46, v122, v126
    v_cvt_pk_bf16_f32 v47, v123, v127
    global_store_dwordx4 v7, v[44:47], s[4:5] offset:1024 sc1
    s_branch w_chain_kernel_54
L_chain_kernel_55:
    s_and_b32 s13, s12, 1
    s_mul_i32 s14, s13, 65536
    s_add_u32 s14, s14, s24
    s_mul_i32 s15, s13, 65536
    s_add_u32 s15, s15, s25
    s_cmp_lt_u32 s12, 2
    s_cselect_b32 s14, s14, s15
    v_lshlrev_b32 v8, 4, v1
    v_add_u32 v4, s14, v8
    s_mov_b32 s16, 15360
    s_mov_b32 s17, 15360
    s_cselect_b32 s16, s16, s17
    v_add_u32 v5, s16, v4
    s_mov_b32 s16, 30720
    s_mov_b32 s17, 30720
    s_cselect_b32 s16, s16, s17
    v_add_u32 v6, s16, v4
    s_mov_b32 s16, 46080
    s_mov_b32 s17, 46080
    s_cselect_b32 s16, s16, s17
    v_add_u32 v7, s16, v4
    s_lshl_b32 s17, s12, 12
    s_lshr_b32 s18, s12, 1
    s_lshl_b32 s18, s18, 12
    v_add_u32 v9, s18, v8
    s_lshl_b32 s19, s13, 12
    v_add_u32 v10, s19, v8
    v_add_u32 v10, 8192, v10
    v_add_u32 v11, 65536, v9
    v_add_u32 v12, 65536, v10
    v_mov_b32 v64, 0
    v_mov_b32 v65, 0
    v_mov_b32 v66, 0
    v_mov_b32 v67, 0
    v_mov_b32 v68, 0
    v_mov_b32 v69, 0
    v_mov_b32 v70, 0
    v_mov_b32 v71, 0
    v_mov_b32 v72, 0
    v_mov_b32 v73, 0
    v_mov_b32 v74, 0
    v_mov_b32 v75, 0
    v_mov_b32 v76, 0
    v_mov_b32 v77, 0
    v_mov_b32 v78, 0
    v_mov_b32 v79, 0
    v_mov_b32 v80, 0
    v_mov_b32 v81, 0
    v_mov_b32 v82, 0
    v_mov_b32 v83, 0
    v_mov_b32 v84, 0
    v_mov_b32 v85, 0
    v_mov_b32 v86, 0
    v_mov_b32 v87, 0
    v_mov_b32 v88, 0
    v_mov_b32 v89, 0
    v_mov_b32 v90, 0
    v_mov_b32 v91, 0
    v_mov_b32 v92, 0
    v_mov_b32 v93, 0
    v_mov_b32 v94, 0
    v_mov_b32 v95, 0
    v_mov_b32 v96, 0
    v_mov_b32 v97, 0
    v_mov_b32 v98, 0
    v_mov_b32 v99, 0
    v_mov_b32 v100, 0
    v_mov_b32 v101, 0
    v_mov_b32 v102, 0
    v_mov_b32 v103, 0
    v_mov_b32 v104, 0
    v_mov_b32 v105, 0
    v_mov_b32 v106, 0
    v_mov_b32 v107, 0
    v_mov_b32 v108, 0
    v_mov_b32 v109, 0
    v_mov_b32 v110, 0
    v_mov_b32 v111, 0
    v_mov_b32 v112, 0
    v_mov_b32 v113, 0
    v_mov_b32 v114, 0
    v_mov_b32 v115, 0
    v_mov_b32 v116, 0
    v_mov_b32 v117, 0
    v_mov_b32 v118, 0
    v_mov_b32 v119, 0
    v_mov_b32 v120, 0
    v_mov_b32 v121, 0
    v_mov_b32 v122, 0
    v_mov_b32 v123, 0
    v_mov_b32 v124, 0
    v_mov_b32 v125, 0
    v_mov_b32 v126, 0
    v_mov_b32 v127, 0
    s_add_u32 s13, s17, 0
    s_mov_b32 m0, s13
    s_mov_b32 s13, 0
    buffer_load_dwordx4 v4, s[8:11], s13 offen offset:0 lds
    buffer_load_dwordx4 v5, s[8:11], s13 offen offset:1024 lds
    buffer_load_dwordx4 v6, s[8:11], s13 offen offset:2048 lds
    buffer_load_dwordx4 v7, s[8:11], s13 offen offset:3072 lds
    s_add_u32 s13, s17, 16384
    s_mov_b32 m0, s13
    s_mov_b32 s13, 1024
    buffer_load_dwordx4 v4, s[8:11], s13 offen offset:0 lds
    buffer_load_dwordx4 v5, s[8:11], s13 offen offset:1024 lds
    buffer_load_dwordx4 v6, s[8:11], s13 offen offset:2048 lds
    buffer_load_dwordx4 v7, s[8:11], s13 offen offset:3072 lds
    s_add_u32 s13, s17, 32768
    s_mov_b32 m0, s13
    s_mov_b32 s13, 2048
    buffer_load_dwordx4 v4, s[8:11], s13 offen offset:0 lds
    buffer_load_dwordx4 v5, s[8:11], s13 offen offset:1024 lds
    buffer_load_dwordx4 v6, s[8:11], s13 offen offset:2048 lds
    buffer_load_dwordx4 v7, s[8:11], s13 offen offset:3072 lds
    s_add_u32 s13, s17, 49152
    s_mov_b32 m0, s13
    s_mov_b32 s13, 3072
    buffer_load_dwordx4 v4, s[8:11], s13 offen offset:0 lds
    buffer_load_dwordx4 v5, s[8:11], s13 offen offset:1024 lds
    buffer_load_dwordx4 v6, s[8:11], s13 offen offset:2048 lds
    buffer_load_dwordx4 v7, s[8:11], s13 offen offset:3072 lds
    s_add_u32 s13, s17, 65536
    s_mov_b32 m0, s13
    s_mov_b32 s13, 4096
    buffer_load_dwordx4 v4, s[8:11], s13 offen offset:0 lds
    buffer_load_dwordx4 v5, s[8:11], s13 offen offset:1024 lds
    buffer_load_dwordx4 v6, s[8:11], s13 offen offset:2048 lds
    buffer_load_dwordx4 v7, s[8:11], s13 offen offset:3072 lds
    s_add_u32 s13, s17, 81920
    s_mov_b32 m0, s13
    s_mov_b32 s13, 5120
    buffer_load_dwordx4 v4, s[8:11], s13 offen offset:0 lds
    buffer_load_dwordx4 v5, s[8:11], s13 offen offset:1024 lds
    buffer_load_dwordx4 v6, s[8:11], s13 offen offset:2048 lds
    buffer_load_dwordx4 v7, s[8:11], s13 offen offset:3072 lds
    s_add_u32 s13, s17, 98304
    s_mov_b32 m0, s13
    s_mov_b32 s13, 6144
    buffer_load_dwordx4 v4, s[8:11], s13 offen offset:0 lds
    buffer_load_dwordx4 v5, s[8:11], s13 offen offset:1024 lds
    buffer_load_dwordx4 v6, s[8:11], s13 offen offset:2048 lds
    buffer_load_dwordx4 v7, s[8:11], s13 offen offset:3072 lds
    s_waitcnt vmcnt(24)
    s_barrier
    ds_read_b128 v[24:27], v9 offset:0
    ds_read_b128 v[28:31], v9 offset:1024
    ds_read_b128 v[32:35], v9 offset:2048
    ds_read_b128 v[36:39], v9 offset:3072
    ds_read_b128 v[40:43], v10 offset:0
    ds_read_b128 v[44:47], v10 offset:1024
    ds_read_b128 v[48:51], v10 offset:2048
    ds_read_b128 v[52:55], v10 offset:3072
    s_waitcnt vmcnt(20)
    s_barrier
    s_add_u32 s13, s17, 114688
    s_mov_b32 m0, s13
    s_mov_b32 s13, 7168
    buffer_load_dwordx4 v4, s[8:11], s13 offen offset:0 lds
    buffer_load_dwordx4 v5, s[8:11], s13 offen offset:1024 lds
    buffer_load_dwordx4 v6, s[8:11], s13 offen offset:2048 lds
    buffer_load_dwordx4 v7, s[8:11], s13 offen offset:3072 lds
    ds_read_b128 v[128:131], v9 offset:16384
    ds_read_b128 v[132:135], v9 offset:17408
    ds_read_b128 v[136:139], v9 offset:18432
    ds_read_b128 v[140:143], v9 offset:19456
    ds_read_b128 v[144:147], v10 offset:16384
    ds_read_b128 v[148:151], v10 offset:17408
    ds_read_b128 v[152:155], v10 offset:18432
    ds_read_b128 v[156:159], v10 offset:19456
    s_waitcnt lgkmcnt(8)
    v_mfma_f32_16x16x32_bf16 v[64:67], v[24:27], v[40:43], v[64:67]
    v_mfma_f32_16x16x32_bf16 v[68:71], v[24:27], v[44:47], v[68:71]
    v_mfma_f32_16x16x32_bf16 v[72:75], v[24:27], v[48:51], v[72:75]
    v_mfma_f32_16x16x32_bf16 v[76:79], v[24:27], v[52:55], v[76:79]
    v_mfma_f32_16x16x32_bf16 v[80:83], v[28:31], v[40:43], v[80:83]
    v_mfma_f32_16x16x32_bf16 v[84:87], v[28:31], v[44:47], v[84:87]
    v_mfma_f32_16x16x32_bf16 v[88:91], v[28:31], v[48:51], v[88:91]
    v_mfma_f32_16x16x32_bf16 v[92:95], v[28:31], v[52:55], v[92:95]
    v_mfma_f32_16x16x32_bf16 v[96:99], v[32:35], v[40:43], v[96:99]
    v_mfma_f32_16x16x32_bf16 v[100:103], v[32:35], v[44:47], v[100:103]
    v_mfma_f32_16x16x32_bf16 v[104:107], v[32:35], v[48:51], v[104:107]
    v_mfma_f32_16x16x32_bf16 v[108:111], v[32:35], v[52:55], v[108:111]
    v_mfma_f32_16x16x32_bf16 v[112:115], v[36:39], v[40:43], v[112:115]
    v_mfma_f32_16x16x32_bf16 v[116:119], v[36:39], v[44:47], v[116:119]
    v_mfma_f32_16x16x32_bf16 v[120:123], v[36:39], v[48:51], v[120:123]
    v_mfma_f32_16x16x32_bf16 v[124:127], v[36:39], v[52:55], v[124:127]
    s_waitcnt vmcnt(20)
    s_barrier
    s_add_u32 s13, s17, 0
    s_mov_b32 m0, s13
    s_mov_b32 s13, 8192
    buffer_load_dwordx4 v4, s[8:11], s13 offen offset:0 lds
    buffer_load_dwordx4 v5, s[8:11], s13 offen offset:1024 lds
    buffer_load_dwordx4 v6, s[8:11], s13 offen offset:2048 lds
    buffer_load_dwordx4 v7, s[8:11], s13 offen offset:3072 lds
    ds_read_b128 v[24:27], v9 offset:32768
    ds_read_b128 v[28:31], v9 offset:33792
    ds_read_b128 v[32:35], v9 offset:34816
    ds_read_b128 v[36:39], v9 offset:35840
    ds_read_b128 v[40:43], v10 offset:32768
    ds_read_b128 v[44:47], v10 offset:33792
    ds_read_b128 v[48:51], v10 offset:34816
    ds_read_b128 v[52:55], v10 offset:35840
    s_waitcnt lgkmcnt(8)
    v_mfma_f32_16x16x32_bf16 v[64:67], v[128:131], v[144:147], v[64:67]
    v_mfma_f32_16x16x32_bf16 v[68:71], v[128:131], v[148:151], v[68:71]
    v_mfma_f32_16x16x32_bf16 v[72:75], v[128:131], v[152:155], v[72:75]
    v_mfma_f32_16x16x32_bf16 v[76:79], v[128:131], v[156:159], v[76:79]
    v_mfma_f32_16x16x32_bf16 v[80:83], v[132:135], v[144:147], v[80:83]
    v_mfma_f32_16x16x32_bf16 v[84:87], v[132:135], v[148:151], v[84:87]
    v_mfma_f32_16x16x32_bf16 v[88:91], v[132:135], v[152:155], v[88:91]
    v_mfma_f32_16x16x32_bf16 v[92:95], v[132:135], v[156:159], v[92:95]
    v_mfma_f32_16x16x32_bf16 v[96:99], v[136:139], v[144:147], v[96:99]
    v_mfma_f32_16x16x32_bf16 v[100:103], v[136:139], v[148:151], v[100:103]
    v_mfma_f32_16x16x32_bf16 v[104:107], v[136:139], v[152:155], v[104:107]
    v_mfma_f32_16x16x32_bf16 v[108:111], v[136:139], v[156:159], v[108:111]
    v_mfma_f32_16x16x32_bf16 v[112:115], v[140:143], v[144:147], v[112:115]
    v_mfma_f32_16x16x32_bf16 v[116:119], v[140:143], v[148:151], v[116:119]
    v_mfma_f32_16x16x32_bf16 v[120:123], v[140:143], v[152:155], v[120:123]
    v_mfma_f32_16x16x32_bf16 v[124:127], v[140:143], v[156:159], v[124:127]
    s_waitcnt vmcnt(20)
    s_barrier
    s_add_u32 s13, s17, 16384
    s_mov_b32 m0, s13
    s_mov_b32 s13, 9216
    buffer_load_dwordx4 v4, s[8:11], s13 offen offset:0 lds
    buffer_load_dwordx4 v5, s[8:11], s13 offen offset:1024 lds
    buffer_load_dwordx4 v6, s[8:11], s13 offen offset:2048 lds
    buffer_load_dwordx4 v7, s[8:11], s13 offen offset:3072 lds
    ds_read_b128 v[128:131], v9 offset:49152
    ds_read_b128 v[132:135], v9 offset:50176
    ds_read_b128 v[136:139], v9 offset:51200
    ds_read_b128 v[140:143], v9 offset:52224
    ds_read_b128 v[144:147], v10 offset:49152
    ds_read_b128 v[148:151], v10 offset:50176
    ds_read_b128 v[152:155], v10 offset:51200
    ds_read_b128 v[156:159], v10 offset:52224
    s_waitcnt lgkmcnt(8)
    v_mfma_f32_16x16x32_bf16 v[64:67], v[24:27], v[40:43], v[64:67]
    v_mfma_f32_16x16x32_bf16 v[68:71], v[24:27], v[44:47], v[68:71]
    v_mfma_f32_16x16x32_bf16 v[72:75], v[24:27], v[48:51], v[72:75]
    v_mfma_f32_16x16x32_bf16 v[76:79], v[24:27], v[52:55], v[76:79]
    v_mfma_f32_16x16x32_bf16 v[80:83], v[28:31], v[40:43], v[80:83]
    v_mfma_f32_16x16x32_bf16 v[84:87], v[28:31], v[44:47], v[84:87]
    v_mfma_f32_16x16x32_bf16 v[88:91], v[28:31], v[48:51], v[88:91]
    v_mfma_f32_16x16x32_bf16 v[92:95], v[28:31], v[52:55], v[92:95]
    v_mfma_f32_16x16x32_bf16 v[96:99], v[32:35], v[40:43], v[96:99]
    v_mfma_f32_16x16x32_bf16 v[100:103], v[32:35], v[44:47], v[100:103]
    v_mfma_f32_16x16x32_bf16 v[104:107], v[32:35], v[48:51], v[104:107]
    v_mfma_f32_16x16x32_bf16 v[108:111], v[32:35], v[52:55], v[108:111]
    v_mfma_f32_16x16x32_bf16 v[112:115], v[36:39], v[40:43], v[112:115]
    v_mfma_f32_16x16x32_bf16 v[116:119], v[36:39], v[44:47], v[116:119]
    v_mfma_f32_16x16x32_bf16 v[120:123], v[36:39], v[48:51], v[120:123]
    v_mfma_f32_16x16x32_bf16 v[124:127], v[36:39], v[52:55], v[124:127]
    s_waitcnt vmcnt(20)
    s_barrier
    s_add_u32 s13, s17, 32768
    s_mov_b32 m0, s13
    s_mov_b32 s13, 10240
    buffer_load_dwordx4 v4, s[8:11], s13 offen offset:0 lds
    buffer_load_dwordx4 v5, s[8:11], s13 offen offset:1024 lds
    buffer_load_dwordx4 v6, s[8:11], s13 offen offset:2048 lds
    buffer_load_dwordx4 v7, s[8:11], s13 offen offset:3072 lds
    ds_read_b128 v[24:27], v11 offset:0
    ds_read_b128 v[28:31], v11 offset:1024
    ds_read_b128 v[32:35], v11 offset:2048
    ds_read_b128 v[36:39], v11 offset:3072
    ds_read_b128 v[40:43], v12 offset:0
    ds_read_b128 v[44:47], v12 offset:1024
    ds_read_b128 v[48:51], v12 offset:2048
    ds_read_b128 v[52:55], v12 offset:3072
    s_waitcnt lgkmcnt(8)
    v_mfma_f32_16x16x32_bf16 v[64:67], v[128:131], v[144:147], v[64:67]
    v_mfma_f32_16x16x32_bf16 v[68:71], v[128:131], v[148:151], v[68:71]
    v_mfma_f32_16x16x32_bf16 v[72:75], v[128:131], v[152:155], v[72:75]
    v_mfma_f32_16x16x32_bf16 v[76:79], v[128:131], v[156:159], v[76:79]
    v_mfma_f32_16x16x32_bf16 v[80:83], v[132:135], v[144:147], v[80:83]
    v_mfma_f32_16x16x32_bf16 v[84:87], v[132:135], v[148:151], v[84:87]
    v_mfma_f32_16x16x32_bf16 v[88:91], v[132:135], v[152:155], v[88:91]
    v_mfma_f32_16x16x32_bf16 v[92:95], v[132:135], v[156:159], v[92:95]
    v_mfma_f32_16x16x32_bf16 v[96:99], v[136:139], v[144:147], v[96:99]
    v_mfma_f32_16x16x32_bf16 v[100:103], v[136:139], v[148:151], v[100:103]
    v_mfma_f32_16x16x32_bf16 v[104:107], v[136:139], v[152:155], v[104:107]
    v_mfma_f32_16x16x32_bf16 v[108:111], v[136:139], v[156:159], v[108:111]
    v_mfma_f32_16x16x32_bf16 v[112:115], v[140:143], v[144:147], v[112:115]
    v_mfma_f32_16x16x32_bf16 v[116:119], v[140:143], v[148:151], v[116:119]
    v_mfma_f32_16x16x32_bf16 v[120:123], v[140:143], v[152:155], v[120:123]
    v_mfma_f32_16x16x32_bf16 v[124:127], v[140:143], v[156:159], v[124:127]
    s_waitcnt vmcnt(20)
    s_barrier
    s_add_u32 s13, s17, 49152
    s_mov_b32 m0, s13
    s_mov_b32 s13, 11264
    buffer_load_dwordx4 v4, s[8:11], s13 offen offset:0 lds
    buffer_load_dwordx4 v5, s[8:11], s13 offen offset:1024 lds
    buffer_load_dwordx4 v6, s[8:11], s13 offen offset:2048 lds
    buffer_load_dwordx4 v7, s[8:11], s13 offen offset:3072 lds
    ds_read_b128 v[128:131], v11 offset:16384
    ds_read_b128 v[132:135], v11 offset:17408
    ds_read_b128 v[136:139], v11 offset:18432
    ds_read_b128 v[140:143], v11 offset:19456
    ds_read_b128 v[144:147], v12 offset:16384
    ds_read_b128 v[148:151], v12 offset:17408
    ds_read_b128 v[152:155], v12 offset:18432
    ds_read_b128 v[156:159], v12 offset:19456
    s_waitcnt lgkmcnt(8)
    v_mfma_f32_16x16x32_bf16 v[64:67], v[24:27], v[40:43], v[64:67]
    v_mfma_f32_16x16x32_bf16 v[68:71], v[24:27], v[44:47], v[68:71]
    v_mfma_f32_16x16x32_bf16 v[72:75], v[24:27], v[48:51], v[72:75]
    v_mfma_f32_16x16x32_bf16 v[76:79], v[24:27], v[52:55], v[76:79]
    v_mfma_f32_16x16x32_bf16 v[80:83], v[28:31], v[40:43], v[80:83]
    v_mfma_f32_16x16x32_bf16 v[84:87], v[28:31], v[44:47], v[84:87]
    v_mfma_f32_16x16x32_bf16 v[88:91], v[28:31], v[48:51], v[88:91]
    v_mfma_f32_16x16x32_bf16 v[92:95], v[28:31], v[52:55], v[92:95]
    v_mfma_f32_16x16x32_bf16 v[96:99], v[32:35], v[40:43], v[96:99]
    v_mfma_f32_16x16x32_bf16 v[100:103], v[32:35], v[44:47], v[100:103]
    v_mfma_f32_16x16x32_bf16 v[104:107], v[32:35], v[48:51], v[104:107]
    v_mfma_f32_16x16x32_bf16 v[108:111], v[32:35], v[52:55], v[108:111]
    v_mfma_f32_16x16x32_bf16 v[112:115], v[36:39], v[40:43], v[112:115]
    v_mfma_f32_16x16x32_bf16 v[116:119], v[36:39], v[44:47], v[116:119]
    v_mfma_f32_16x16x32_bf16 v[120:123], v[36:39], v[48:51], v[120:123]
    v_mfma_f32_16x16x32_bf16 v[124:127], v[36:39], v[52:55], v[124:127]
    s_waitcnt vmcnt(20)
    s_barrier
    s_add_u32 s13, s17, 65536
    s_mov_b32 m0, s13
    s_mov_b32 s13, 12288
    buffer_load_dwordx4 v4, s[8:11], s13 offen offset:0 lds
    buffer_load_dwordx4 v5, s[8:11], s13 offen offset:1024 lds
    buffer_load_dwordx4 v6, s[8:11], s13 offen offset:2048 lds
    buffer_load_dwordx4 v7, s[8:11], s13 offen offset:3072 lds
    ds_read_b128 v[24:27], v11 offset:32768
    ds_read_b128 v[28:31], v11 offset:33792
    ds_read_b128 v[32:35], v11 offset:34816
    ds_read_b128 v[36:39], v11 offset:35840
    ds_read_b128 v[40:43], v12 offset:32768
    ds_read_b128 v[44:47], v12 offset:33792
    ds_read_b128 v[48:51], v12 offset:34816
    ds_read_b128 v[52:55], v12 offset:35840
    s_waitcnt lgkmcnt(8)
    v_mfma_f32_16x16x32_bf16 v[64:67], v[128:131], v[144:147], v[64:67]
    v_mfma_f32_16x16x32_bf16 v[68:71], v[128:131], v[148:151], v[68:71]
    v_mfma_f32_16x16x32_bf16 v[72:75], v[128:131], v[152:155], v[72:75]
    v_mfma_f32_16x16x32_bf16 v[76:79], v[128:131], v[156:159], v[76:79]
    v_mfma_f32_16x16x32_bf16 v[80:83], v[132:135], v[144:147], v[80:83]
    v_mfma_f32_16x16x32_bf16 v[84:87], v[132:135], v[148:151], v[84:87]
    v_mfma_f32_16x16x32_bf16 v[88:91], v[132:135], v[152:155], v[88:91]
    v_mfma_f32_16x16x32_bf16 v[92:95], v[132:135], v[156:159], v[92:95]
    v_mfma_f32_16x16x32_bf16 v[96:99], v[136:139], v[144:147], v[96:99]
    v_mfma_f32_16x16x32_bf16 v[100:103], v[136:139], v[148:151], v[100:103]
    v_mfma_f32_16x16x32_bf16 v[104:107], v[136:139], v[152:155], v[104:107]
    v_mfma_f32_16x16x32_bf16 v[108:111], v[136:139], v[156:159], v[108:111]
    v_mfma_f32_16x16x32_bf16 v[112:115], v[140:143], v[144:147], v[112:115]
    v_mfma_f32_16x16x32_bf16 v[116:119], v[140:143], v[148:151], v[116:119]
    v_mfma_f32_16x16x32_bf16 v[120:123], v[140:143], v[152:155], v[120:123]
    v_mfma_f32_16x16x32_bf16 v[124:127], v[140:143], v[156:159], v[124:127]
    s_waitcnt vmcnt(20)
    s_barrier
    s_add_u32 s13, s17, 81920
    s_mov_b32 m0, s13
    s_mov_b32 s13, 13312
    buffer_load_dwordx4 v4, s[8:11], s13 offen offset:0 lds
    buffer_load_dwordx4 v5, s[8:11], s13 offen offset:1024 lds
    buffer_load_dwordx4 v6, s[8:11], s13 offen offset:2048 lds
    buffer_load_dwordx4 v7, s[8:11], s13 offen offset:3072 lds
    ds_read_b128 v[128:131], v11 offset:49152
    ds_read_b128 v[132:135], v11 offset:50176
    ds_read_b128 v[136:139], v11 offset:51200
    ds_read_b128 v[140:143], v11 offset:52224
    ds_read_b128 v[144:147], v12 offset:49152
    ds_read_b128 v[148:151], v12 offset:50176
    ds_read_b128 v[152:155], v12 offset:51200
    ds_read_b128 v[156:159], v12 offset:52224
    s_waitcnt lgkmcnt(8)
    v_mfma_f32_16x16x32_bf16 v[64:67], v[24:27], v[40:43], v[64:67]
    v_mfma_f32_16x16x32_bf16 v[68:71], v[24:27], v[44:47], v[68:71]
    v_mfma_f32_16x16x32_bf16 v[72:75], v[24:27], v[48:51], v[72:75]
    v_mfma_f32_16x16x32_bf16 v[76:79], v[24:27], v[52:55], v[76:79]
    v_mfma_f32_16x16x32_bf16 v[80:83], v[28:31], v[40:43], v[80:83]
    v_mfma_f32_16x16x32_bf16 v[84:87], v[28:31], v[44:47], v[84:87]
    v_mfma_f32_16x16x32_bf16 v[88:91], v[28:31], v[48:51], v[88:91]
    v_mfma_f32_16x16x32_bf16 v[92:95], v[28:31], v[52:55], v[92:95]
    v_mfma_f32_16x16x32_bf16 v[96:99], v[32:35], v[40:43], v[96:99]
    v_mfma_f32_16x16x32_bf16 v[100:103], v[32:35], v[44:47], v[100:103]
    v_mfma_f32_16x16x32_bf16 v[104:107], v[32:35], v[48:51], v[104:107]
    v_mfma_f32_16x16x32_bf16 v[108:111], v[32:35], v[52:55], v[108:111]
    v_mfma_f32_16x16x32_bf16 v[112:115], v[36:39], v[40:43], v[112:115]
    v_mfma_f32_16x16x32_bf16 v[116:119], v[36:39], v[44:47], v[116:119]
    v_mfma_f32_16x16x32_bf16 v[120:123], v[36:39], v[48:51], v[120:123]
    v_mfma_f32_16x16x32_bf16 v[124:127], v[36:39], v[52:55], v[124:127]
    s_waitcnt vmcnt(20)
    s_barrier
    s_add_u32 s13, s17, 98304
    s_mov_b32 m0, s13
    s_mov_b32 s13, 14336
    buffer_load_dwordx4 v4, s[8:11], s13 offen offset:0 lds
    buffer_load_dwordx4 v5, s[8:11], s13 offen offset:1024 lds
    buffer_load_dwordx4 v6, s[8:11], s13 offen offset:2048 lds
    buffer_load_dwordx4 v7, s[8:11], s13 offen offset:3072 lds
    ds_read_b128 v[24:27], v9 offset:0
    ds_read_b128 v[28:31], v9 offset:1024
    ds_read_b128 v[32:35], v9 offset:2048
    ds_read_b128 v[36:39], v9 offset:3072
    ds_read_b128 v[40:43], v10 offset:0
    ds_read_b128 v[44:47], v10 offset:1024
    ds_read_b128 v[48:51], v10 offset:2048
    ds_read_b128 v[52:55], v10 offset:3072
    s_waitcnt lgkmcnt(8)
    v_mfma_f32_16x16x32_bf16 v[64:67], v[128:131], v[144:147], v[64:67]
    v_mfma_f32_16x16x32_bf16 v[68:71], v[128:131], v[148:151], v[68:71]
    v_mfma_f32_16x16x32_bf16 v[72:75], v[128:131], v[152:155], v[72:75]
    v_mfma_f32_16x16x32_bf16 v[76:79], v[128:131], v[156:159], v[76:79]
    v_mfma_f32_16x16x32_bf16 v[80:83], v[132:135], v[144:147], v[80:83]
    v_mfma_f32_16x16x32_bf16 v[84:87], v[132:135], v[148:151], v[84:87]
    v_mfma_f32_16x16x32_bf16 v[88:91], v[132:135], v[152:155], v[88:91]
    v_mfma_f32_16x16x32_bf16 v[92:95], v[132:135], v[156:159], v[92:95]
    v_mfma_f32_16x16x32_bf16 v[96:99], v[136:139], v[144:147], v[96:99]
    v_mfma_f32_16x16x32_bf16 v[100:103], v[136:139], v[148:151], v[100:103]
    v_mfma_f32_16x16x32_bf16 v[104:107], v[136:139], v[152:155], v[104:107]
    v_mfma_f32_16x16x32_bf16 v[108:111], v[136:139], v[156:159], v[108:111]
    v_mfma_f32_16x16x32_bf16 v[112:115], v[140:143], v[144:147], v[112:115]
    v_mfma_f32_16x16x32_bf16 v[116:119], v[140:143], v[148:151], v[116:119]
    v_mfma_f32_16x16x32_bf16 v[120:123], v[140:143], v[152:155], v[120:123]
    v_mfma_f32_16x16x32_bf16 v[124:127], v[140:143], v[156:159], v[124:127]
    s_waitcnt vmcnt(20)
    s_barrier
    s_add_u32 s13, s17, 114688
    s_mov_b32 m0, s13
    s_mov_b32 s13, 15360
    buffer_load_dwordx4 v4, s[8:11], s13 offen offset:0 lds
    buffer_load_dwordx4 v5, s[8:11], s13 offen offset:1024 lds
    buffer_load_dwordx4 v6, s[8:11], s13 offen offset:2048 lds
    buffer_load_dwordx4 v7, s[8:11], s13 offen offset:3072 lds
    ds_read_b128 v[128:131], v9 offset:16384
    ds_read_b128 v[132:135], v9 offset:17408
    ds_read_b128 v[136:139], v9 offset:18432
    ds_read_b128 v[140:143], v9 offset:19456
    ds_read_b128 v[144:147], v10 offset:16384
    ds_read_b128 v[148:151], v10 offset:17408
    ds_read_b128 v[152:155], v10 offset:18432
    ds_read_b128 v[156:159], v10 offset:19456
    s_waitcnt lgkmcnt(8)
    v_mfma_f32_16x16x32_bf16 v[64:67], v[24:27], v[40:43], v[64:67]
    v_mfma_f32_16x16x32_bf16 v[68:71], v[24:27], v[44:47], v[68:71]
    v_mfma_f32_16x16x32_bf16 v[72:75], v[24:27], v[48:51], v[72:75]
    v_mfma_f32_16x16x32_bf16 v[76:79], v[24:27], v[52:55], v[76:79]
    v_mfma_f32_16x16x32_bf16 v[80:83], v[28:31], v[40:43], v[80:83]
    v_mfma_f32_16x16x32_bf16 v[84:87], v[28:31], v[44:47], v[84:87]
    v_mfma_f32_16x16x32_bf16 v[88:91], v[28:31], v[48:51], v[88:91]
    v_mfma_f32_16x16x32_bf16 v[92:95], v[28:31], v[52:55], v[92:95]
    v_mfma_f32_16x16x32_bf16 v[96:99], v[32:35], v[40:43], v[96:99]
    v_mfma_f32_16x16x32_bf16 v[100:103], v[32:35], v[44:47], v[100:103]
    v_mfma_f32_16x16x32_bf16 v[104:107], v[32:35], v[48:51], v[104:107]
    v_mfma_f32_16x16x32_bf16 v[108:111], v[32:35], v[52:55], v[108:111]
    v_mfma_f32_16x16x32_bf16 v[112:115], v[36:39], v[40:43], v[112:115]
    v_mfma_f32_16x16x32_bf16 v[116:119], v[36:39], v[44:47], v[116:119]
    v_mfma_f32_16x16x32_bf16 v[120:123], v[36:39], v[48:51], v[120:123]
    v_mfma_f32_16x16x32_bf16 v[124:127], v[36:39], v[52:55], v[124:127]
    s_waitcnt vmcnt(20)
    s_barrier
    ds_read_b128 v[24:27], v9 offset:32768
    ds_read_b128 v[28:31], v9 offset:33792
    ds_read_b128 v[32:35], v9 offset:34816
    ds_read_b128 v[36:39], v9 offset:35840
    ds_read_b128 v[40:43], v10 offset:32768
    ds_read_b128 v[44:47], v10 offset:33792
    ds_read_b128 v[48:51], v10 offset:34816
    ds_read_b128 v[52:55], v10 offset:35840
    s_waitcnt lgkmcnt(8)
    v_mfma_f32_16x16x32_bf16 v[64:67], v[128:131], v[144:147], v[64:67]
    v_mfma_f32_16x16x32_bf16 v[68:71], v[128:131], v[148:151], v[68:71]
    v_mfma_f32_16x16x32_bf16 v[72:75], v[128:131], v[152:155], v[72:75]
    v_mfma_f32_16x16x32_bf16 v[76:79], v[128:131], v[156:159], v[76:79]
    v_mfma_f32_16x16x32_bf16 v[80:83], v[132:135], v[144:147], v[80:83]
    v_mfma_f32_16x16x32_bf16 v[84:87], v[132:135], v[148:151], v[84:87]
    v_mfma_f32_16x16x32_bf16 v[88:91], v[132:135], v[152:155], v[88:91]
    v_mfma_f32_16x16x32_bf16 v[92:95], v[132:135], v[156:159], v[92:95]
    v_mfma_f32_16x16x32_bf16 v[96:99], v[136:139], v[144:147], v[96:99]
    v_mfma_f32_16x16x32_bf16 v[100:103], v[136:139], v[148:151], v[100:103]
    v_mfma_f32_16x16x32_bf16 v[104:107], v[136:139], v[152:155], v[104:107]
    v_mfma_f32_16x16x32_bf16 v[108:111], v[136:139], v[156:159], v[108:111]
    v_mfma_f32_16x16x32_bf16 v[112:115], v[140:143], v[144:147], v[112:115]
    v_mfma_f32_16x16x32_bf16 v[116:119], v[140:143], v[148:151], v[116:119]
    v_mfma_f32_16x16x32_bf16 v[120:123], v[140:143], v[152:155], v[120:123]
    v_mfma_f32_16x16x32_bf16 v[124:127], v[140:143], v[156:159], v[124:127]
    s_waitcnt vmcnt(16)
    s_barrier
    ds_read_b128 v[128:131], v9 offset:49152
    ds_read_b128 v[132:135], v9 offset:50176
    ds_read_b128 v[136:139], v9 offset:51200
    ds_read_b128 v[140:143], v9 offset:52224
    ds_read_b128 v[144:147], v10 offset:49152
    ds_read_b128 v[148:151], v10 offset:50176
    ds_read_b128 v[152:155], v10 offset:51200
    ds_read_b128 v[156:159], v10 offset:52224
    s_waitcnt lgkmcnt(8)
    v_mfma_f32_16x16x32_bf16 v[64:67], v[24:27], v[40:43], v[64:67]
    v_mfma_f32_16x16x32_bf16 v[68:71], v[24:27], v[44:47], v[68:71]
    v_mfma_f32_16x16x32_bf16 v[72:75], v[24:27], v[48:51], v[72:75]
    v_mfma_f32_16x16x32_bf16 v[76:79], v[24:27], v[52:55], v[76:79]
    v_mfma_f32_16x16x32_bf16 v[80:83], v[28:31], v[40:43], v[80:83]
    v_mfma_f32_16x16x32_bf16 v[84:87], v[28:31], v[44:47], v[84:87]
    v_mfma_f32_16x16x32_bf16 v[88:91], v[28:31], v[48:51], v[88:91]
    v_mfma_f32_16x16x32_bf16 v[92:95], v[28:31], v[52:55], v[92:95]
    v_mfma_f32_16x16x32_bf16 v[96:99], v[32:35], v[40:43], v[96:99]
    v_mfma_f32_16x16x32_bf16 v[100:103], v[32:35], v[44:47], v[100:103]
    v_mfma_f32_16x16x32_bf16 v[104:107], v[32:35], v[48:51], v[104:107]
    v_mfma_f32_16x16x32_bf16 v[108:111], v[32:35], v[52:55], v[108:111]
    v_mfma_f32_16x16x32_bf16 v[112:115], v[36:39], v[40:43], v[112:115]
    v_mfma_f32_16x16x32_bf16 v[116:119], v[36:39], v[44:47], v[116:119]
    v_mfma_f32_16x16x32_bf16 v[120:123], v[36:39], v[48:51], v[120:123]
    v_mfma_f32_16x16x32_bf16 v[124:127], v[36:39], v[52:55], v[124:127]
    s_waitcnt vmcnt(12)
    s_barrier
    ds_read_b128 v[24:27], v11 offset:0
    ds_read_b128 v[28:31], v11 offset:1024
    ds_read_b128 v[32:35], v11 offset:2048
    ds_read_b128 v[36:39], v11 offset:3072
    ds_read_b128 v[40:43], v12 offset:0
    ds_read_b128 v[44:47], v12 offset:1024
    ds_read_b128 v[48:51], v12 offset:2048
    ds_read_b128 v[52:55], v12 offset:3072
    s_waitcnt lgkmcnt(8)
    v_mfma_f32_16x16x32_bf16 v[64:67], v[128:131], v[144:147], v[64:67]
    v_mfma_f32_16x16x32_bf16 v[68:71], v[128:131], v[148:151], v[68:71]
    v_mfma_f32_16x16x32_bf16 v[72:75], v[128:131], v[152:155], v[72:75]
    v_mfma_f32_16x16x32_bf16 v[76:79], v[128:131], v[156:159], v[76:79]
    v_mfma_f32_16x16x32_bf16 v[80:83], v[132:135], v[144:147], v[80:83]
    v_mfma_f32_16x16x32_bf16 v[84:87], v[132:135], v[148:151], v[84:87]
    v_mfma_f32_16x16x32_bf16 v[88:91], v[132:135], v[152:155], v[88:91]
    v_mfma_f32_16x16x32_bf16 v[92:95], v[132:135], v[156:159], v[92:95]
    v_mfma_f32_16x16x32_bf16 v[96:99], v[136:139], v[144:147], v[96:99]
    v_mfma_f32_16x16x32_bf16 v[100:103], v[136:139], v[148:151], v[100:103]
    v_mfma_f32_16x16x32_bf16 v[104:107], v[136:139], v[152:155], v[104:107]
    v_mfma_f32_16x16x32_bf16 v[108:111], v[136:139], v[156:159], v[108:111]
    v_mfma_f32_16x16x32_bf16 v[112:115], v[140:143], v[144:147], v[112:115]
    v_mfma_f32_16x16x32_bf16 v[116:119], v[140:143], v[148:151], v[116:119]
    v_mfma_f32_16x16x32_bf16 v[120:123], v[140:143], v[152:155], v[120:123]
    v_mfma_f32_16x16x32_bf16 v[124:127], v[140:143], v[156:159], v[124:127]
    s_waitcnt vmcnt(8)
    s_barrier
    ds_read_b128 v[128:131], v11 offset:16384
    ds_read_b128 v[132:135], v11 offset:17408
    ds_read_b128 v[136:139], v11 offset:18432
    ds_read_b128 v[140:143], v11 offset:19456
    ds_read_b128 v[144:147], v12 offset:16384
    ds_read_b128 v[148:151], v12 offset:17408
    ds_read_b128 v[152:155], v12 offset:18432
    ds_read_b128 v[156:159], v12 offset:19456
    s_waitcnt lgkmcnt(8)
    v_mfma_f32_16x16x32_bf16 v[64:67], v[24:27], v[40:43], v[64:67]
    v_mfma_f32_16x16x32_bf16 v[68:71], v[24:27], v[44:47], v[68:71]
    v_mfma_f32_16x16x32_bf16 v[72:75], v[24:27], v[48:51], v[72:75]
    v_mfma_f32_16x16x32_bf16 v[76:79], v[24:27], v[52:55], v[76:79]
    v_mfma_f32_16x16x32_bf16 v[80:83], v[28:31], v[40:43], v[80:83]
    v_mfma_f32_16x16x32_bf16 v[84:87], v[28:31], v[44:47], v[84:87]
    v_mfma_f32_16x16x32_bf16 v[88:91], v[28:31], v[48:51], v[88:91]
    v_mfma_f32_16x16x32_bf16 v[92:95], v[28:31], v[52:55], v[92:95]
    v_mfma_f32_16x16x32_bf16 v[96:99], v[32:35], v[40:43], v[96:99]
    v_mfma_f32_16x16x32_bf16 v[100:103], v[32:35], v[44:47], v[100:103]
    v_mfma_f32_16x16x32_bf16 v[104:107], v[32:35], v[48:51], v[104:107]
    v_mfma_f32_16x16x32_bf16 v[108:111], v[32:35], v[52:55], v[108:111]
    v_mfma_f32_16x16x32_bf16 v[112:115], v[36:39], v[40:43], v[112:115]
    v_mfma_f32_16x16x32_bf16 v[116:119], v[36:39], v[44:47], v[116:119]
    v_mfma_f32_16x16x32_bf16 v[120:123], v[36:39], v[48:51], v[120:123]
    v_mfma_f32_16x16x32_bf16 v[124:127], v[36:39], v[52:55], v[124:127]
    s_waitcnt vmcnt(4)
    s_barrier
    ds_read_b128 v[24:27], v11 offset:32768
    ds_read_b128 v[28:31], v11 offset:33792
    ds_read_b128 v[32:35], v11 offset:34816
    ds_read_b128 v[36:39], v11 offset:35840
    ds_read_b128 v[40:43], v12 offset:32768
    ds_read_b128 v[44:47], v12 offset:33792
    ds_read_b128 v[48:51], v12 offset:34816
    ds_read_b128 v[52:55], v12 offset:35840
    s_waitcnt lgkmcnt(8)
    v_mfma_f32_16x16x32_bf16 v[64:67], v[128:131], v[144:147], v[64:67]
    v_mfma_f32_16x16x32_bf16 v[68:71], v[128:131], v[148:151], v[68:71]
    v_mfma_f32_16x16x32_bf16 v[72:75], v[128:131], v[152:155], v[72:75]
    v_mfma_f32_16x16x32_bf16 v[76:79], v[128:131], v[156:159], v[76:79]
    v_mfma_f32_16x16x32_bf16 v[80:83], v[132:135], v[144:147], v[80:83]
    v_mfma_f32_16x16x32_bf16 v[84:87], v[132:135], v[148:151], v[84:87]
    v_mfma_f32_16x16x32_bf16 v[88:91], v[132:135], v[152:155], v[88:91]
    v_mfma_f32_16x16x32_bf16 v[92:95], v[132:135], v[156:159], v[92:95]
    v_mfma_f32_16x16x32_bf16 v[96:99], v[136:139], v[144:147], v[96:99]
    v_mfma_f32_16x16x32_bf16 v[100:103], v[136:139], v[148:151], v[100:103]
    v_mfma_f32_16x16x32_bf16 v[104:107], v[136:139], v[152:155], v[104:107]
    v_mfma_f32_16x16x32_bf16 v[108:111], v[136:139], v[156:159], v[108:111]
    v_mfma_f32_16x16x32_bf16 v[112:115], v[140:143], v[144:147], v[112:115]
    v_mfma_f32_16x16x32_bf16 v[116:119], v[140:143], v[148:151], v[116:119]
    v_mfma_f32_16x16x32_bf16 v[120:123], v[140:143], v[152:155], v[120:123]
    v_mfma_f32_16x16x32_bf16 v[124:127], v[140:143], v[156:159], v[124:127]
    s_waitcnt vmcnt(0)
    s_barrier
    ds_read_b128 v[128:131], v11 offset:49152
    ds_read_b128 v[132:135], v11 offset:50176
    ds_read_b128 v[136:139], v11 offset:51200
    ds_read_b128 v[140:143], v11 offset:52224
    ds_read_b128 v[144:147], v12 offset:49152
    ds_read_b128 v[148:151], v12 offset:50176
    ds_read_b128 v[152:155], v12 offset:51200
    ds_read_b128 v[156:159], v12 offset:52224
    s_waitcnt lgkmcnt(8)
    v_mfma_f32_16x16x32_bf16 v[64:67], v[24:27], v[40:43], v[64:67]
    v_mfma_f32_16x16x32_bf16 v[68:71], v[24:27], v[44:47], v[68:71]
    v_mfma_f32_16x16x32_bf16 v[72:75], v[24:27], v[48:51], v[72:75]
    v_mfma_f32_16x16x32_bf16 v[76:79], v[24:27], v[52:55], v[76:79]
    v_mfma_f32_16x16x32_bf16 v[80:83], v[28:31], v[40:43], v[80:83]
    v_mfma_f32_16x16x32_bf16 v[84:87], v[28:31], v[44:47], v[84:87]
    v_mfma_f32_16x16x32_bf16 v[88:91], v[28:31], v[48:51], v[88:91]
    v_mfma_f32_16x16x32_bf16 v[92:95], v[28:31], v[52:55], v[92:95]
    v_mfma_f32_16x16x32_bf16 v[96:99], v[32:35], v[40:43], v[96:99]
    v_mfma_f32_16x16x32_bf16 v[100:103], v[32:35], v[44:47], v[100:103]
    v_mfma_f32_16x16x32_bf16 v[104:107], v[32:35], v[48:51], v[104:107]
    v_mfma_f32_16x16x32_bf16 v[108:111], v[32:35], v[52:55], v[108:111]
    v_mfma_f32_16x16x32_bf16 v[112:115], v[36:39], v[40:43], v[112:115]
    v_mfma_f32_16x16x32_bf16 v[116:119], v[36:39], v[44:47], v[116:119]
    v_mfma_f32_16x16x32_bf16 v[120:123], v[36:39], v[48:51], v[120:123]
    v_mfma_f32_16x16x32_bf16 v[124:127], v[36:39], v[52:55], v[124:127]
    s_waitcnt lgkmcnt(0)
    v_mfma_f32_16x16x32_bf16 v[64:67], v[128:131], v[144:147], v[64:67]
    v_mfma_f32_16x16x32_bf16 v[68:71], v[128:131], v[148:151], v[68:71]
    v_mfma_f32_16x16x32_bf16 v[72:75], v[128:131], v[152:155], v[72:75]
    v_mfma_f32_16x16x32_bf16 v[76:79], v[128:131], v[156:159], v[76:79]
    v_mfma_f32_16x16x32_bf16 v[80:83], v[132:135], v[144:147], v[80:83]
    v_mfma_f32_16x16x32_bf16 v[84:87], v[132:135], v[148:151], v[84:87]
    v_mfma_f32_16x16x32_bf16 v[88:91], v[132:135], v[152:155], v[88:91]
    v_mfma_f32_16x16x32_bf16 v[92:95], v[132:135], v[156:159], v[92:95]
    v_mfma_f32_16x16x32_bf16 v[96:99], v[136:139], v[144:147], v[96:99]
    v_mfma_f32_16x16x32_bf16 v[100:103], v[136:139], v[148:151], v[100:103]
    v_mfma_f32_16x16x32_bf16 v[104:107], v[136:139], v[152:155], v[104:107]
    v_mfma_f32_16x16x32_bf16 v[108:111], v[136:139], v[156:159], v[108:111]
    v_mfma_f32_16x16x32_bf16 v[112:115], v[140:143], v[144:147], v[112:115]
    v_mfma_f32_16x16x32_bf16 v[116:119], v[140:143], v[148:151], v[116:119]
    v_mfma_f32_16x16x32_bf16 v[120:123], v[140:143], v[152:155], v[120:123]
    v_mfma_f32_16x16x32_bf16 v[124:127], v[140:143], v[156:159], v[124:127]
    s_nop 7
    s_nop 1
    s_lshr_b32 s27, s12, 1
    s_and_b32 s28, s12, 1
    s_lshl_b32 s29, s20, 2
    s_lshl_b32 s30, s27, 1
    s_add_u32 s29, s29, s30
    s_lshl_b32 s29, s29, 5
    s_add_u32 s29, s29, s23
    s_lshl_b32 s29, s29, 13
    s_add_u32 s26, s29, 54525952
    s_lshl_b32 s28, s28, 12
    s_add_u32 s26, s26, s28
    v_lshlrev_b32 v4, 4, v1
    v_add_u32 v4, s26, v4
    v_add_u32 v5, 262144, v4
    v_cvt_pk_bf16_f32 v32, v64, v65
    v_cvt_pk_bf16_f32 v33, v66, v67
    v_cvt_pk_bf16_f32 v34, v80, v81
    v_cvt_pk_bf16_f32 v35, v82, v83
    global_store_dwordx4 v4, v[32:35], s[4:5] offset:0 sc1
    v_cvt_pk_bf16_f32 v36, v68, v69
    v_cvt_pk_bf16_f32 v37, v70, v71
    v_cvt_pk_bf16_f32 v38, v84, v85
    v_cvt_pk_bf16_f32 v39, v86, v87
    global_store_dwordx4 v4, v[36:39], s[4:5] offset:1024 sc1
    v_cvt_pk_bf16_f32 v40, v72, v73
    v_cvt_pk_bf16_f32 v41, v74, v75
    v_cvt_pk_bf16_f32 v42, v88, v89
    v_cvt_pk_bf16_f32 v43, v90, v91
    global_store_dwordx4 v4, v[40:43], s[4:5] offset:2048 sc1
    v_cvt_pk_bf16_f32 v44, v76, v77
    v_cvt_pk_bf16_f32 v45, v78, v79
    v_cvt_pk_bf16_f32 v46, v92, v93
    v_cvt_pk_bf16_f32 v47, v94, v95
    global_store_dwordx4 v4, v[44:47], s[4:5] offset:3072 sc1
    v_cvt_pk_bf16_f32 v32, v96, v97
    v_cvt_pk_bf16_f32 v33, v98, v99
    v_cvt_pk_bf16_f32 v34, v112, v113
    v_cvt_pk_bf16_f32 v35, v114, v115
    global_store_dwordx4 v5, v[32:35], s[4:5] offset:0 sc1
    v_cvt_pk_bf16_f32 v36, v100, v101
    v_cvt_pk_bf16_f32 v37, v102, v103
    v_cvt_pk_bf16_f32 v38, v116, v117
    v_cvt_pk_bf16_f32 v39, v118, v119
    global_store_dwordx4 v5, v[36:39], s[4:5] offset:1024 sc1
    v_cvt_pk_bf16_f32 v40, v104, v105
    v_cvt_pk_bf16_f32 v41, v106, v107
    v_cvt_pk_bf16_f32 v42, v120, v121
    v_cvt_pk_bf16_f32 v43, v122, v123
    global_store_dwordx4 v5, v[40:43], s[4:5] offset:2048 sc1
    v_cvt_pk_bf16_f32 v44, v108, v109
    v_cvt_pk_bf16_f32 v45, v110, v111
    v_cvt_pk_bf16_f32 v46, v124, v125
    v_cvt_pk_bf16_f32 v47, v126, v127
    global_store_dwordx4 v5, v[44:47], s[4:5] offset:3072 sc1
w_chain_kernel_54:
    s_waitcnt vmcnt(0)
    s_barrier
    s_cmp_lg_u32 s12, 0
    s_cbranch_scc1 w_chain_kernel_45
    s_lshl_b32 s14, s41, 2
    s_add_u32 s14, s14, 129015808
    s_mov_b64 exec, 1
    v_mov_b32 v6, s14
    v_mov_b32 v7, 1
    global_atomic_add v6, v7, s[4:5] sc1
    s_mov_b64 exec, -1
    s_branch w_chain_kernel_45
w_chain_kernel_46:
    s_endpgm
.globl g3_kernel
.p2align 8
.type g3_kernel,@function
g3_kernel:
    s_cmp_ge_u32 s2, 192
    s_cbranch_scc1 L_g3_kernel_1
    s_load_dwordx2 s[4:5], s[0:1], 96
    v_and_b32 v1, 63, v0
    v_lshrrev_b32 v4, 6, v0
    v_bfe_u32 v2, v0, 4, 2
    v_and_b32 v3, 15, v0
    s_nop 0
    v_readfirstlane_b32 s12, v4
    s_waitcnt lgkmcnt(0)
    s_mov_b32 s8, s4
    s_and_b32 s9, s5, 0xffff
    s_mov_b32 s10, 0x10000000
    s_mov_b32 s11, 0x00020000
    s_mov_b32 s30, 1069066811
    s_and_b32 s20, s2, 15
    s_lshl_b32 s24, s20, 17
    s_add_u32 s24, s24, 18874368
    s_cmp_ge_u32 s2, 64
    s_cbranch_scc1 L_g3_kernel_2
    s_lshr_b32 s21, s2, 4
    s_lshl_b32 s25, s21, 17
    s_add_u32 s25, s25, 16777216
    s_and_b32 s13, s12, 1
    s_mul_i32 s14, s13, 65536
    s_add_u32 s14, s14, s24
    s_mul_i32 s15, s13, 65536
    s_add_u32 s15, s15, s25
    s_cmp_lt_u32 s12, 2
    s_cselect_b32 s14, s14, s15
    v_lshlrev_b32 v8, 4, v1
    v_add_u32 v4, s14, v8
    s_mov_b32 s16, 15360
    s_mov_b32 s17, 15360
    s_cselect_b32 s16, s16, s17
    v_add_u32 v5, s16, v4
    s_mov_b32 s16, 30720
    s_mov_b32 s17, 30720
    s_cselect_b32 s16, s16, s17
    v_add_u32 v6, s16, v4
    s_mov_b32 s16, 46080
    s_mov_b32 s17, 46080
    s_cselect_b32 s16, s16, s17
    v_add_u32 v7, s16, v4
    s_lshl_b32 s17, s12, 12
    s_lshr_b32 s18, s12, 1
    s_lshl_b32 s18, s18, 12
    v_add_u32 v9, s18, v8
    s_lshl_b32 s19, s13, 12
    v_add_u32 v10, s19, v8
    v_add_u32 v10, 8192, v10
    v_mov_b32 v64, 0
    v_mov_b32 v65, 0
    v_mov_b32 v66, 0
    v_mov_b32 v67, 0
    v_mov_b32 v68, 0
    v_mov_b32 v69, 0
    v_mov_b32 v70, 0
    v_mov_b32 v71, 0
    v_mov_b32 v72, 0
    v_mov_b32 v73, 0
    v_mov_b32 v74, 0
    v_mov_b32 v75, 0
    v_mov_b32 v76, 0
    v_mov_b32 v77, 0
    v_mov_b32 v78, 0
    v_mov_b32 v79, 0
    v_mov_b32 v80, 0
    v_mov_b32 v81, 0
    v_mov_b32 v82, 0
    v_mov_b32 v83, 0
    v_mov_b32 v84, 0
    v_mov_b32 v85, 0
    v_mov_b32 v86, 0
    v_mov_b32 v87, 0
    v_mov_b32 v88, 0
    v_mov_b32 v89, 0
    v_mov_b32 v90, 0
    v_mov_b32 v91, 0
    v_mov_b32 v92, 0
    v_mov_b32 v93, 0
    v_mov_b32 v94, 0
    v_mov_b32 v95, 0
    v_mov_b32 v96, 0
    v_mov_b32 v97, 0
    v_mov_b32 v98, 0
    v_mov_b32 v99, 0
    v_mov_b32 v100, 0
    v_mov_b32 v101, 0
    v_mov_b32 v102, 0
    v_mov_b32 v103, 0
    v_mov_b32 v104, 0
    v_mov_b32 v105, 0
    v_mov_b32 v106, 0
    v_mov_b32 v107, 0
    v_mov_b32 v108, 0
    v_mov_b32 v109, 0
    v_mov_b32 v110, 0
    v_mov_b32 v111, 0
    v_mov_b32 v112, 0
    v_mov_b32 v113, 0
    v_mov_b32 v114, 0
    v_mov_b32 v115, 0
    v_mov_b32 v116, 0
    v_mov_b32 v117, 0
    v_mov_b32 v118, 0
    v_mov_b32 v119, 0
    v_mov_b32 v120, 0
    v_mov_b32 v121, 0
    v_mov_b32 v122, 0
    v_mov_b32 v123, 0
    v_mov_b32 v124, 0
    v_mov_b32 v125, 0
    v_mov_b32 v126, 0
    v_mov_b32 v127, 0
    s_add_u32 s13, s17, 0
    s_mov_b32 m0, s13
    s_mov_b32 s13, 0
    buffer_load_dwordx4 v4, s[8:11], s13 offen offset:0 lds
    buffer_load_dwordx4 v5, s[8:11], s13 offen offset:1024 lds
    buffer_load_dwordx4 v6, s[8:11], s13 offen offset:2048 lds
    buffer_load_dwordx4 v7, s[8:11], s13 offen offset:3072 lds
    s_add_u32 s13, s17, 16384
    s_mov_b32 m0, s13
    s_mov_b32 s13, 1024
    buffer_load_dwordx4 v4, s[8:11], s13 offen offset:0 lds
    buffer_load_dwordx4 v5, s[8:11], s13 offen offset:1024 lds
    buffer_load_dwordx4 v6, s[8:11], s13 offen offset:2048 lds
    buffer_load_dwordx4 v7, s[8:11], s13 offen offset:3072 lds
    s_add_u32 s13, s17, 32768
    s_mov_b32 m0, s13
    s_mov_b32 s13, 2048
    buffer_load_dwordx4 v4, s[8:11], s13 offen offset:0 lds
    buffer_load_dwordx4 v5, s[8:11], s13 offen offset:1024 lds
    buffer_load_dwordx4 v6, s[8:11], s13 offen offset:2048 lds
    buffer_load_dwordx4 v7, s[8:11], s13 offen offset:3072 lds
    s_waitcnt vmcnt(8)
    s_barrier
    ds_read_b128 v[24:27], v9 offset:0
    ds_read_b128 v[28:31], v9 offset:1024
    ds_read_b128 v[32:35], v9 offset:2048
    ds_read_b128 v[36:39], v9 offset:3072
    ds_read_b128 v[40:43], v10 offset:0
    ds_read_b128 v[44:47], v10 offset:1024
    ds_read_b128 v[48:51], v10 offset:2048
    ds_read_b128 v[52:55], v10 offset:3072
    s_waitcnt vmcnt(4)
    s_barrier
    s_add_u32 s13, s17, 49152
    s_mov_b32 m0, s13
    s_mov_b32 s13, 3072
    buffer_load_dwordx4 v4, s[8:11], s13 offen offset:0 lds
    buffer_load_dwordx4 v5, s[8:11], s13 offen offset:1024 lds
    buffer_load_dwordx4 v6, s[8:11], s13 offen offset:2048 lds
    buffer_load_dwordx4 v7, s[8:11], s13 offen offset:3072 lds
    ds_read_b128 v[128:131], v9 offset:16384
    ds_read_b128 v[132:135], v9 offset:17408
    ds_read_b128 v[136:139], v9 offset:18432
    ds_read_b128 v[140:143], v9 offset:19456
    ds_read_b128 v[144:147], v10 offset:16384
    ds_read_b128 v[148:151], v10 offset:17408
    ds_read_b128 v[152:155], v10 offset:18432
    ds_read_b128 v[156:159], v10 offset:19456
    s_waitcnt lgkmcnt(8)
    v_mfma_f32_16x16x32_bf16 v[64:67], v[40:43], v[24:27], v[64:67]
    v_mfma_f32_16x16x32_bf16 v[68:71], v[44:47], v[24:27], v[68:71]
    v_mfma_f32_16x16x32_bf16 v[72:75], v[48:51], v[24:27], v[72:75]
    v_mfma_f32_16x16x32_bf16 v[76:79], v[52:55], v[24:27], v[76:79]
    v_mfma_f32_16x16x32_bf16 v[80:83], v[40:43], v[28:31], v[80:83]
    v_mfma_f32_16x16x32_bf16 v[84:87], v[44:47], v[28:31], v[84:87]
    v_mfma_f32_16x16x32_bf16 v[88:91], v[48:51], v[28:31], v[88:91]
    v_mfma_f32_16x16x32_bf16 v[92:95], v[52:55], v[28:31], v[92:95]
    v_mfma_f32_16x16x32_bf16 v[96:99], v[40:43], v[32:35], v[96:99]
    v_mfma_f32_16x16x32_bf16 v[100:103], v[44:47], v[32:35], v[100:103]
    v_mfma_f32_16x16x32_bf16 v[104:107], v[48:51], v[32:35], v[104:107]
    v_mfma_f32_16x16x32_bf16 v[108:111], v[52:55], v[32:35], v[108:111]
    v_mfma_f32_16x16x32_bf16 v[112:115], v[40:43], v[36:39], v[112:115]
    v_mfma_f32_16x16x32_bf16 v[116:119], v[44:47], v[36:39], v[116:119]
    v_mfma_f32_16x16x32_bf16 v[120:123], v[48:51], v[36:39], v[120:123]
    v_mfma_f32_16x16x32_bf16 v[124:127], v[52:55], v[36:39], v[124:127]
    s_waitcnt vmcnt(4)
    s_barrier
    s_add_u32 s13, s17, 0
    s_mov_b32 m0, s13
    s_mov_b32 s13, 4096
    buffer_load_dwordx4 v4, s[8:11], s13 offen offset:0 lds
    buffer_load_dwordx4 v5, s[8:11], s13 offen offset:1024 lds
    buffer_load_dwordx4 v6, s[8:11], s13 offen offset:2048 lds
    buffer_load_dwordx4 v7, s[8:11], s13 offen offset:3072 lds
    ds_read_b128 v[24:27], v9 offset:32768
    ds_read_b128 v[28:31], v9 offset:33792
    ds_read_b128 v[32:35], v9 offset:34816
    ds_read_b128 v[36:39], v9 offset:35840
    ds_read_b128 v[40:43], v10 offset:32768
    ds_read_b128 v[44:47], v10 offset:33792
    ds_read_b128 v[48:51], v10 offset:34816
    ds_read_b128 v[52:55], v10 offset:35840
    s_waitcnt lgkmcnt(8)
    v_mfma_f32_16x16x32_bf16 v[64:67], v[144:147], v[128:131], v[64:67]
    v_mfma_f32_16x16x32_bf16 v[68:71], v[148:151], v[128:131], v[68:71]
    v_mfma_f32_16x16x32_bf16 v[72:75], v[152:155], v[128:131], v[72:75]
    v_mfma_f32_16x16x32_bf16 v[76:79], v[156:159], v[128:131], v[76:79]
    v_mfma_f32_16x16x32_bf16 v[80:83], v[144:147], v[132:135], v[80:83]
    v_mfma_f32_16x16x32_bf16 v[84:87], v[148:151], v[132:135], v[84:87]
    v_mfma_f32_16x16x32_bf16 v[88:91], v[152:155], v[132:135], v[88:91]
    v_mfma_f32_16x16x32_bf16 v[92:95], v[156:159], v[132:135], v[92:95]
    v_mfma_f32_16x16x32_bf16 v[96:99], v[144:147], v[136:139], v[96:99]
    v_mfma_f32_16x16x32_bf16 v[100:103], v[148:151], v[136:139], v[100:103]
    v_mfma_f32_16x16x32_bf16 v[104:107], v[152:155], v[136:139], v[104:107]
    v_mfma_f32_16x16x32_bf16 v[108:111], v[156:159], v[136:139], v[108:111]
    v_mfma_f32_16x16x32_bf16 v[112:115], v[144:147], v[140:143], v[112:115]
    v_mfma_f32_16x16x32_bf16 v[116:119], v[148:151], v[140:143], v[116:119]
    v_mfma_f32_16x16x32_bf16 v[120:123], v[152:155], v[140:143], v[120:123]
    v_mfma_f32_16x16x32_bf16 v[124:127], v[156:159], v[140:143], v[124:127]
    s_waitcnt vmcnt(4)
    s_barrier
    s_add_u32 s13, s17, 16384
    s_mov_b32 m0, s13
    s_mov_b32 s13, 5120
    buffer_load_dwordx4 v4, s[8:11], s13 offen offset:0 lds
    buffer_load_dwordx4 v5, s[8:11], s13 offen offset:1024 lds
    buffer_load_dwordx4 v6, s[8:11], s13 offen offset:2048 lds
    buffer_load_dwordx4 v7, s[8:11], s13 offen offset:3072 lds
    ds_read_b128 v[128:131], v9 offset:49152
    ds_read_b128 v[132:135], v9 offset:50176
    ds_read_b128 v[136:139], v9 offset:51200
    ds_read_b128 v[140:143], v9 offset:52224
    ds_read_b128 v[144:147], v10 offset:49152
    ds_read_b128 v[148:151], v10 offset:50176
    ds_read_b128 v[152:155], v10 offset:51200
    ds_read_b128 v[156:159], v10 offset:52224
    s_waitcnt lgkmcnt(8)
    v_mfma_f32_16x16x32_bf16 v[64:67], v[40:43], v[24:27], v[64:67]
    v_mfma_f32_16x16x32_bf16 v[68:71], v[44:47], v[24:27], v[68:71]
    v_mfma_f32_16x16x32_bf16 v[72:75], v[48:51], v[24:27], v[72:75]
    v_mfma_f32_16x16x32_bf16 v[76:79], v[52:55], v[24:27], v[76:79]
    v_mfma_f32_16x16x32_bf16 v[80:83], v[40:43], v[28:31], v[80:83]
    v_mfma_f32_16x16x32_bf16 v[84:87], v[44:47], v[28:31], v[84:87]
    v_mfma_f32_16x16x32_bf16 v[88:91], v[48:51], v[28:31], v[88:91]
    v_mfma_f32_16x16x32_bf16 v[92:95], v[52:55], v[28:31], v[92:95]
    v_mfma_f32_16x16x32_bf16 v[96:99], v[40:43], v[32:35], v[96:99]
    v_mfma_f32_16x16x32_bf16 v[100:103], v[44:47], v[32:35], v[100:103]
    v_mfma_f32_16x16x32_bf16 v[104:107], v[48:51], v[32:35], v[104:107]
    v_mfma_f32_16x16x32_bf16 v[108:111], v[52:55], v[32:35], v[108:111]
    v_mfma_f32_16x16x32_bf16 v[112:115], v[40:43], v[36:39], v[112:115]
    v_mfma_f32_16x16x32_bf16 v[116:119], v[44:47], v[36:39], v[116:119]
    v_mfma_f32_16x16x32_bf16 v[120:123], v[48:51], v[36:39], v[120:123]
    v_mfma_f32_16x16x32_bf16 v[124:127], v[52:55], v[36:39], v[124:127]
    s_waitcnt vmcnt(4)
    s_barrier
    s_add_u32 s13, s17, 32768
    s_mov_b32 m0, s13
    s_mov_b32 s13, 6144
    buffer_load_dwordx4 v4, s[8:11], s13 offen offset:0 lds
    buffer_load_dwordx4 v5, s[8:11], s13 offen offset:1024 lds
    buffer_load_dwordx4 v6, s[8:11], s13 offen offset:2048 lds
    buffer_load_dwordx4 v7, s[8:11], s13 offen offset:3072 lds
    ds_read_b128 v[24:27], v9 offset:0
    ds_read_b128 v[28:31], v9 offset:1024
    ds_read_b128 v[32:35], v9 offset:2048
    ds_read_b128 v[36:39], v9 offset:3072
    ds_read_b128 v[40:43], v10 offset:0
    ds_read_b128 v[44:47], v10 offset:1024
    ds_read_b128 v[48:51], v10 offset:2048
    ds_read_b128 v[52:55], v10 offset:3072
    s_waitcnt lgkmcnt(8)
    v_mfma_f32_16x16x32_bf16 v[64:67], v[144:147], v[128:131], v[64:67]
    v_mfma_f32_16x16x32_bf16 v[68:71], v[148:151], v[128:131], v[68:71]
    v_mfma_f32_16x16x32_bf16 v[72:75], v[152:155], v[128:131], v[72:75]
    v_mfma_f32_16x16x32_bf16 v[76:79], v[156:159], v[128:131], v[76:79]
    v_mfma_f32_16x16x32_bf16 v[80:83], v[144:147], v[132:135], v[80:83]
    v_mfma_f32_16x16x32_bf16 v[84:87], v[148:151], v[132:135], v[84:87]
    v_mfma_f32_16x16x32_bf16 v[88:91], v[152:155], v[132:135], v[88:91]
    v_mfma_f32_16x16x32_bf16 v[92:95], v[156:159], v[132:135], v[92:95]
    v_mfma_f32_16x16x32_bf16 v[96:99], v[144:147], v[136:139], v[96:99]
    v_mfma_f32_16x16x32_bf16 v[100:103], v[148:151], v[136:139], v[100:103]
    v_mfma_f32_16x16x32_bf16 v[104:107], v[152:155], v[136:139], v[104:107]
    v_mfma_f32_16x16x32_bf16 v[108:111], v[156:159], v[136:139], v[108:111]
    v_mfma_f32_16x16x32_bf16 v[112:115], v[144:147], v[140:143], v[112:115]
    v_mfma_f32_16x16x32_bf16 v[116:119], v[148:151], v[140:143], v[116:119]
    v_mfma_f32_16x16x32_bf16 v[120:123], v[152:155], v[140:143], v[120:123]
    v_mfma_f32_16x16x32_bf16 v[124:127], v[156:159], v[140:143], v[124:127]
    s_waitcnt vmcnt(4)
    s_barrier
    s_add_u32 s13, s17, 49152
    s_mov_b32 m0, s13
    s_mov_b32 s13, 7168
    buffer_load_dwordx4 v4, s[8:11], s13 offen offset:0 lds
    buffer_load_dwordx4 v5, s[8:11], s13 offen offset:1024 lds
    buffer_load_dwordx4 v6, s[8:11], s13 offen offset:2048 lds
    buffer_load_dwordx4 v7, s[8:11], s13 offen offset:3072 lds
    ds_read_b128 v[128:131], v9 offset:16384
    ds_read_b128 v[132:135], v9 offset:17408
    ds_read_b128 v[136:139], v9 offset:18432
    ds_read_b128 v[140:143], v9 offset:19456
    ds_read_b128 v[144:147], v10 offset:16384
    ds_read_b128 v[148:151], v10 offset:17408
    ds_read_b128 v[152:155], v10 offset:18432
    ds_read_b128 v[156:159], v10 offset:19456
    s_waitcnt lgkmcnt(8)
    v_mfma_f32_16x16x32_bf16 v[64:67], v[40:43], v[24:27], v[64:67]
    v_mfma_f32_16x16x32_bf16 v[68:71], v[44:47], v[24:27], v[68:71]
    v_mfma_f32_16x16x32_bf16 v[72:75], v[48:51], v[24:27], v[72:75]
    v_mfma_f32_16x16x32_bf16 v[76:79], v[52:55], v[24:27], v[76:79]
    v_mfma_f32_16x16x32_bf16 v[80:83], v[40:43], v[28:31], v[80:83]
    v_mfma_f32_16x16x32_bf16 v[84:87], v[44:47], v[28:31], v[84:87]
    v_mfma_f32_16x16x32_bf16 v[88:91], v[48:51], v[28:31], v[88:91]
    v_mfma_f32_16x16x32_bf16 v[92:95], v[52:55], v[28:31], v[92:95]
    v_mfma_f32_16x16x32_bf16 v[96:99], v[40:43], v[32:35], v[96:99]
    v_mfma_f32_16x16x32_bf16 v[100:103], v[44:47], v[32:35], v[100:103]
    v_mfma_f32_16x16x32_bf16 v[104:107], v[48:51], v[32:35], v[104:107]
    v_mfma_f32_16x16x32_bf16 v[108:111], v[52:55], v[32:35], v[108:111]
    v_mfma_f32_16x16x32_bf16 v[112:115], v[40:43], v[36:39], v[112:115]
    v_mfma_f32_16x16x32_bf16 v[116:119], v[44:47], v[36:39], v[116:119]
    v_mfma_f32_16x16x32_bf16 v[120:123], v[48:51], v[36:39], v[120:123]
    v_mfma_f32_16x16x32_bf16 v[124:127], v[52:55], v[36:39], v[124:127]
    s_waitcnt vmcnt(4)
    s_barrier
    s_add_u32 s13, s17, 0
    s_mov_b32 m0, s13
    s_mov_b32 s13, 8192
    buffer_load_dwordx4 v4, s[8:11], s13 offen offset:0 lds
    buffer_load_dwordx4 v5, s[8:11], s13 offen offset:1024 lds
    buffer_load_dwordx4 v6, s[8:11], s13 offen offset:2048 lds
    buffer_load_dwordx4 v7, s[8:11], s13 offen offset:3072 lds
    ds_read_b128 v[24:27], v9 offset:32768
    ds_read_b128 v[28:31], v9 offset:33792
    ds_read_b128 v[32:35], v9 offset:34816
    ds_read_b128 v[36:39], v9 offset:35840
    ds_read_b128 v[40:43], v10 offset:32768
    ds_read_b128 v[44:47], v10 offset:33792
    ds_read_b128 v[48:51], v10 offset:34816
    ds_read_b128 v[52:55], v10 offset:35840
    s_waitcnt lgkmcnt(8)
    v_mfma_f32_16x16x32_bf16 v[64:67], v[144:147], v[128:131], v[64:67]
    v_mfma_f32_16x16x32_bf16 v[68:71], v[148:151], v[128:131], v[68:71]
    v_mfma_f32_16x16x32_bf16 v[72:75], v[152:155], v[128:131], v[72:75]
    v_mfma_f32_16x16x32_bf16 v[76:79], v[156:159], v[128:131], v[76:79]
    v_mfma_f32_16x16x32_bf16 v[80:83], v[144:147], v[132:135], v[80:83]
    v_mfma_f32_16x16x32_bf16 v[84:87], v[148:151], v[132:135], v[84:87]
    v_mfma_f32_16x16x32_bf16 v[88:91], v[152:155], v[132:135], v[88:91]
    v_mfma_f32_16x16x32_bf16 v[92:95], v[156:159], v[132:135], v[92:95]
    v_mfma_f32_16x16x32_bf16 v[96:99], v[144:147], v[136:139], v[96:99]
    v_mfma_f32_16x16x32_bf16 v[100:103], v[148:151], v[136:139], v[100:103]
    v_mfma_f32_16x16x32_bf16 v[104:107], v[152:155], v[136:139], v[104:107]
    v_mfma_f32_16x16x32_bf16 v[108:111], v[156:159], v[136:139], v[108:111]
    v_mfma_f32_16x16x32_bf16 v[112:115], v[144:147], v[140:143], v[112:115]
    v_mfma_f32_16x16x32_bf16 v[116:119], v[148:151], v[140:143], v[116:119]
    v_mfma_f32_16x16x32_bf16 v[120:123], v[152:155], v[140:143], v[120:123]
    v_mfma_f32_16x16x32_bf16 v[124:127], v[156:159], v[140:143], v[124:127]
    s_waitcnt vmcnt(4)
    s_barrier
    s_add_u32 s13, s17, 16384
    s_mov_b32 m0, s13
    s_mov_b32 s13, 9216
    buffer_load_dwordx4 v4, s[8:11], s13 offen offset:0 lds
    buffer_load_dwordx4 v5, s[8:11], s13 offen offset:1024 lds
    buffer_load_dwordx4 v6, s[8:11], s13 offen offset:2048 lds
    buffer_load_dwordx4 v7, s[8:11], s13 offen offset:3072 lds
    ds_read_b128 v[128:131], v9 offset:49152
    ds_read_b128 v[132:135], v9 offset:50176
    ds_read_b128 v[136:139], v9 offset:51200
    ds_read_b128 v[140:143], v9 offset:52224
    ds_read_b128 v[144:147], v10 offset:49152
    ds_read_b128 v[148:151], v10 offset:50176
    ds_read_b128 v[152:155], v10 offset:51200
    ds_read_b128 v[156:159], v10 offset:52224
    s_waitcnt lgkmcnt(8)
    v_mfma_f32_16x16x32_bf16 v[64:67], v[40:43], v[24:27], v[64:67]
    v_mfma_f32_16x16x32_bf16 v[68:71], v[44:47], v[24:27], v[68:71]
    v_mfma_f32_16x16x32_bf16 v[72:75], v[48:51], v[24:27], v[72:75]
    v_mfma_f32_16x16x32_bf16 v[76:79], v[52:55], v[24:27], v[76:79]
    v_mfma_f32_16x16x32_bf16 v[80:83], v[40:43], v[28:31], v[80:83]
    v_mfma_f32_16x16x32_bf16 v[84:87], v[44:47], v[28:31], v[84:87]
    v_mfma_f32_16x16x32_bf16 v[88:91], v[48:51], v[28:31], v[88:91]
    v_mfma_f32_16x16x32_bf16 v[92:95], v[52:55], v[28:31], v[92:95]
    v_mfma_f32_16x16x32_bf16 v[96:99], v[40:43], v[32:35], v[96:99]
    v_mfma_f32_16x16x32_bf16 v[100:103], v[44:47], v[32:35], v[100:103]
    v_mfma_f32_16x16x32_bf16 v[104:107], v[48:51], v[32:35], v[104:107]
    v_mfma_f32_16x16x32_bf16 v[108:111], v[52:55], v[32:35], v[108:111]
    v_mfma_f32_16x16x32_bf16 v[112:115], v[40:43], v[36:39], v[112:115]
    v_mfma_f32_16x16x32_bf16 v[116:119], v[44:47], v[36:39], v[116:119]
    v_mfma_f32_16x16x32_bf16 v[120:123], v[48:51], v[36:39], v[120:123]
    v_mfma_f32_16x16x32_bf16 v[124:127], v[52:55], v[36:39], v[124:127]
    s_waitcnt vmcnt(4)
    s_barrier
    s_add_u32 s13, s17, 32768
    s_mov_b32 m0, s13
    s_mov_b32 s13, 10240
    buffer_load_dwordx4 v4, s[8:11], s13 offen offset:0 lds
    buffer_load_dwordx4 v5, s[8:11], s13 offen offset:1024 lds
    buffer_load_dwordx4 v6, s[8:11], s13 offen offset:2048 lds
    buffer_load_dwordx4 v7, s[8:11], s13 offen offset:3072 lds
    ds_read_b128 v[24:27], v9 offset:0
    ds_read_b128 v[28:31], v9 offset:1024
    ds_read_b128 v[32:35], v9 offset:2048
    ds_read_b128 v[36:39], v9 offset:3072
    ds_read_b128 v[40:43], v10 offset:0
    ds_read_b128 v[44:47], v10 offset:1024
    ds_read_b128 v[48:51], v10 offset:2048
    ds_read_b128 v[52:55], v10 offset:3072
    s_waitcnt lgkmcnt(8)
    v_mfma_f32_16x16x32_bf16 v[64:67], v[144:147], v[128:131], v[64:67]
    v_mfma_f32_16x16x32_bf16 v[68:71], v[148:151], v[128:131], v[68:71]
    v_mfma_f32_16x16x32_bf16 v[72:75], v[152:155], v[128:131], v[72:75]
    v_mfma_f32_16x16x32_bf16 v[76:79], v[156:159], v[128:131], v[76:79]
    v_mfma_f32_16x16x32_bf16 v[80:83], v[144:147], v[132:135], v[80:83]
    v_mfma_f32_16x16x32_bf16 v[84:87], v[148:151], v[132:135], v[84:87]
    v_mfma_f32_16x16x32_bf16 v[88:91], v[152:155], v[132:135], v[88:91]
    v_mfma_f32_16x16x32_bf16 v[92:95], v[156:159], v[132:135], v[92:95]
    v_mfma_f32_16x16x32_bf16 v[96:99], v[144:147], v[136:139], v[96:99]
    v_mfma_f32_16x16x32_bf16 v[100:103], v[148:151], v[136:139], v[100:103]
    v_mfma_f32_16x16x32_bf16 v[104:107], v[152:155], v[136:139], v[104:107]
    v_mfma_f32_16x16x32_bf16 v[108:111], v[156:159], v[136:139], v[108:111]
    v_mfma_f32_16x16x32_bf16 v[112:115], v[144:147], v[140:143], v[112:115]
    v_mfma_f32_16x16x32_bf16 v[116:119], v[148:151], v[140:143], v[116:119]
    v_mfma_f32_16x16x32_bf16 v[120:123], v[152:155], v[140:143], v[120:123]
    v_mfma_f32_16x16x32_bf16 v[124:127], v[156:159], v[140:143], v[124:127]
    s_waitcnt vmcnt(4)
    s_barrier
    s_add_u32 s13, s17, 49152
    s_mov_b32 m0, s13
    s_mov_b32 s13, 11264
    buffer_load_dwordx4 v4, s[8:11], s13 offen offset:0 lds
    buffer_load_dwordx4 v5, s[8:11], s13 offen offset:1024 lds
    buffer_load_dwordx4 v6, s[8:11], s13 offen offset:2048 lds
    buffer_load_dwordx4 v7, s[8:11], s13 offen offset:3072 lds
    ds_read_b128 v[128:131], v9 offset:16384
    ds_read_b128 v[132:135], v9 offset:17408
    ds_read_b128 v[136:139], v9 offset:18432
    ds_read_b128 v[140:143], v9 offset:19456
    ds_read_b128 v[144:147], v10 offset:16384
    ds_read_b128 v[148:151], v10 offset:17408
    ds_read_b128 v[152:155], v10 offset:18432
    ds_read_b128 v[156:159], v10 offset:19456
    s_waitcnt lgkmcnt(8)
    v_mfma_f32_16x16x32_bf16 v[64:67], v[40:43], v[24:27], v[64:67]
    v_mfma_f32_16x16x32_bf16 v[68:71], v[44:47], v[24:27], v[68:71]
    v_mfma_f32_16x16x32_bf16 v[72:75], v[48:51], v[24:27], v[72:75]
    v_mfma_f32_16x16x32_bf16 v[76:79], v[52:55], v[24:27], v[76:79]
    v_mfma_f32_16x16x32_bf16 v[80:83], v[40:43], v[28:31], v[80:83]
    v_mfma_f32_16x16x32_bf16 v[84:87], v[44:47], v[28:31], v[84:87]
    v_mfma_f32_16x16x32_bf16 v[88:91], v[48:51], v[28:31], v[88:91]
    v_mfma_f32_16x16x32_bf16 v[92:95], v[52:55], v[28:31], v[92:95]
    v_mfma_f32_16x16x32_bf16 v[96:99], v[40:43], v[32:35], v[96:99]
    v_mfma_f32_16x16x32_bf16 v[100:103], v[44:47], v[32:35], v[100:103]
    v_mfma_f32_16x16x32_bf16 v[104:107], v[48:51], v[32:35], v[104:107]
    v_mfma_f32_16x16x32_bf16 v[108:111], v[52:55], v[32:35], v[108:111]
    v_mfma_f32_16x16x32_bf16 v[112:115], v[40:43], v[36:39], v[112:115]
    v_mfma_f32_16x16x32_bf16 v[116:119], v[44:47], v[36:39], v[116:119]
    v_mfma_f32_16x16x32_bf16 v[120:123], v[48:51], v[36:39], v[120:123]
    v_mfma_f32_16x16x32_bf16 v[124:127], v[52:55], v[36:39], v[124:127]
    s_waitcnt vmcnt(4)
    s_barrier
    s_add_u32 s13, s17, 0
    s_mov_b32 m0, s13
    s_mov_b32 s13, 12288
    buffer_load_dwordx4 v4, s[8:11], s13 offen offset:0 lds
    buffer_load_dwordx4 v5, s[8:11], s13 offen offset:1024 lds
    buffer_load_dwordx4 v6, s[8:11], s13 offen offset:2048 lds
    buffer_load_dwordx4 v7, s[8:11], s13 offen offset:3072 lds
    ds_read_b128 v[24:27], v9 offset:32768
    ds_read_b128 v[28:31], v9 offset:33792
    ds_read_b128 v[32:35], v9 offset:34816
    ds_read_b128 v[36:39], v9 offset:35840
    ds_read_b128 v[40:43], v10 offset:32768
    ds_read_b128 v[44:47], v10 offset:33792
    ds_read_b128 v[48:51], v10 offset:34816
    ds_read_b128 v[52:55], v10 offset:35840
    s_waitcnt lgkmcnt(8)
    v_mfma_f32_16x16x32_bf16 v[64:67], v[144:147], v[128:131], v[64:67]
    v_mfma_f32_16x16x32_bf16 v[68:71], v[148:151], v[128:131], v[68:71]
    v_mfma_f32_16x16x32_bf16 v[72:75], v[152:155], v[128:131], v[72:75]
    v_mfma_f32_16x16x32_bf16 v[76:79], v[156:159], v[128:131], v[76:79]
    v_mfma_f32_16x16x32_bf16 v[80:83], v[144:147], v[132:135], v[80:83]
    v_mfma_f32_16x16x32_bf16 v[84:87], v[148:151], v[132:135], v[84:87]
    v_mfma_f32_16x16x32_bf16 v[88:91], v[152:155], v[132:135], v[88:91]
    v_mfma_f32_16x16x32_bf16 v[92:95], v[156:159], v[132:135], v[92:95]
    v_mfma_f32_16x16x32_bf16 v[96:99], v[144:147], v[136:139], v[96:99]
    v_mfma_f32_16x16x32_bf16 v[100:103], v[148:151], v[136:139], v[100:103]
    v_mfma_f32_16x16x32_bf16 v[104:107], v[152:155], v[136:139], v[104:107]
    v_mfma_f32_16x16x32_bf16 v[108:111], v[156:159], v[136:139], v[108:111]
    v_mfma_f32_16x16x32_bf16 v[112:115], v[144:147], v[140:143], v[112:115]
    v_mfma_f32_16x16x32_bf16 v[116:119], v[148:151], v[140:143], v[116:119]
    v_mfma_f32_16x16x32_bf16 v[120:123], v[152:155], v[140:143], v[120:123]
    v_mfma_f32_16x16x32_bf16 v[124:127], v[156:159], v[140:143], v[124:127]
    s_waitcnt vmcnt(4)
    s_barrier
    s_add_u32 s13, s17, 16384
    s_mov_b32 m0, s13
    s_mov_b32 s13, 13312
    buffer_load_dwordx4 v4, s[8:11], s13 offen offset:0 lds
    buffer_load_dwordx4 v5, s[8:11], s13 offen offset:1024 lds
    buffer_load_dwordx4 v6, s[8:11], s13 offen offset:2048 lds
    buffer_load_dwordx4 v7, s[8:11], s13 offen offset:3072 lds
    ds_read_b128 v[128:131], v9 offset:49152
    ds_read_b128 v[132:135], v9 offset:50176
    ds_read_b128 v[136:139], v9 offset:51200
    ds_read_b128 v[140:143], v9 offset:52224
    ds_read_b128 v[144:147], v10 offset:49152
    ds_read_b128 v[148:151], v10 offset:50176
    ds_read_b128 v[152:155], v10 offset:51200
    ds_read_b128 v[156:159], v10 offset:52224
    s_waitcnt lgkmcnt(8)
    v_mfma_f32_16x16x32_bf16 v[64:67], v[40:43], v[24:27], v[64:67]
    v_mfma_f32_16x16x32_bf16 v[68:71], v[44:47], v[24:27], v[68:71]
    v_mfma_f32_16x16x32_bf16 v[72:75], v[48:51], v[24:27], v[72:75]
    v_mfma_f32_16x16x32_bf16 v[76:79], v[52:55], v[24:27], v[76:79]
    v_mfma_f32_16x16x32_bf16 v[80:83], v[40:43], v[28:31], v[80:83]
    v_mfma_f32_16x16x32_bf16 v[84:87], v[44:47], v[28:31], v[84:87]
    v_mfma_f32_16x16x32_bf16 v[88:91], v[48:51], v[28:31], v[88:91]
    v_mfma_f32_16x16x32_bf16 v[92:95], v[52:55], v[28:31], v[92:95]
    v_mfma_f32_16x16x32_bf16 v[96:99], v[40:43], v[32:35], v[96:99]
    v_mfma_f32_16x16x32_bf16 v[100:103], v[44:47], v[32:35], v[100:103]
    v_mfma_f32_16x16x32_bf16 v[104:107], v[48:51], v[32:35], v[104:107]
    v_mfma_f32_16x16x32_bf16 v[108:111], v[52:55], v[32:35], v[108:111]
    v_mfma_f32_16x16x32_bf16 v[112:115], v[40:43], v[36:39], v[112:115]
    v_mfma_f32_16x16x32_bf16 v[116:119], v[44:47], v[36:39], v[116:119]
    v_mfma_f32_16x16x32_bf16 v[120:123], v[48:51], v[36:39], v[120:123]
    v_mfma_f32_16x16x32_bf16 v[124:127], v[52:55], v[36:39], v[124:127]
    s_waitcnt vmcnt(4)
    s_barrier
    s_add_u32 s13, s17, 32768
    s_mov_b32 m0, s13
    s_mov_b32 s13, 14336
    buffer_load_dwordx4 v4, s[8:11], s13 offen offset:0 lds
    buffer_load_dwordx4 v5, s[8:11], s13 offen offset:1024 lds
    buffer_load_dwordx4 v6, s[8:11], s13 offen offset:2048 lds
    buffer_load_dwordx4 v7, s[8:11], s13 offen offset:3072 lds
    ds_read_b128 v[24:27], v9 offset:0
    ds_read_b128 v[28:31], v9 offset:1024
    ds_read_b128 v[32:35], v9 offset:2048
    ds_read_b128 v[36:39], v9 offset:3072
    ds_read_b128 v[40:43], v10 offset:0
    ds_read_b128 v[44:47], v10 offset:1024
    ds_read_b128 v[48:51], v10 offset:2048
    ds_read_b128 v[52:55], v10 offset:3072
    s_waitcnt lgkmcnt(8)
    v_mfma_f32_16x16x32_bf16 v[64:67], v[144:147], v[128:131], v[64:67]
    v_mfma_f32_16x16x32_bf16 v[68:71], v[148:151], v[128:131], v[68:71]
    v_mfma_f32_16x16x32_bf16 v[72:75], v[152:155], v[128:131], v[72:75]
    v_mfma_f32_16x16x32_bf16 v[76:79], v[156:159], v[128:131], v[76:79]
    v_mfma_f32_16x16x32_bf16 v[80:83], v[144:147], v[132:135], v[80:83]
    v_mfma_f32_16x16x32_bf16 v[84:87], v[148:151], v[132:135], v[84:87]
    v_mfma_f32_16x16x32_bf16 v[88:91], v[152:155], v[132:135], v[88:91]
    v_mfma_f32_16x16x32_bf16 v[92:95], v[156:159], v[132:135], v[92:95]
    v_mfma_f32_16x16x32_bf16 v[96:99], v[144:147], v[136:139], v[96:99]
    v_mfma_f32_16x16x32_bf16 v[100:103], v[148:151], v[136:139], v[100:103]
    v_mfma_f32_16x16x32_bf16 v[104:107], v[152:155], v[136:139], v[104:107]
    v_mfma_f32_16x16x32_bf16 v[108:111], v[156:159], v[136:139], v[108:111]
    v_mfma_f32_16x16x32_bf16 v[112:115], v[144:147], v[140:143], v[112:115]
    v_mfma_f32_16x16x32_bf16 v[116:119], v[148:151], v[140:143], v[116:119]
    v_mfma_f32_16x16x32_bf16 v[120:123], v[152:155], v[140:143], v[120:123]
    v_mfma_f32_16x16x32_bf16 v[124:127], v[156:159], v[140:143], v[124:127]
    s_waitcnt vmcnt(4)
    s_barrier
    s_add_u32 s13, s17, 49152
    s_mov_b32 m0, s13
    s_mov_b32 s13, 15360
    buffer_load_dwordx4 v4, s[8:11], s13 offen offset:0 lds
    buffer_load_dwordx4 v5, s[8:11], s13 offen offset:1024 lds
    buffer_load_dwordx4 v6, s[8:11], s13 offen offset:2048 lds
    buffer_load_dwordx4 v7, s[8:11], s13 offen offset:3072 lds
    ds_read_b128 v[128:131], v9 offset:16384
    ds_read_b128 v[132:135], v9 offset:17408
    ds_read_b128 v[136:139], v9 offset:18432
    ds_read_b128 v[140:143], v9 offset:19456
    ds_read_b128 v[144:147], v10 offset:16384
    ds_read_b128 v[148:151], v10 offset:17408
    ds_read_b128 v[152:155], v10 offset:18432
    ds_read_b128 v[156:159], v10 offset:19456
    s_waitcnt lgkmcnt(8)
    v_mfma_f32_16x16x32_bf16 v[64:67], v[40:43], v[24:27], v[64:67]
    v_mfma_f32_16x16x32_bf16 v[68:71], v[44:47], v[24:27], v[68:71]
    v_mfma_f32_16x16x32_bf16 v[72:75], v[48:51], v[24:27], v[72:75]
    v_mfma_f32_16x16x32_bf16 v[76:79], v[52:55], v[24:27], v[76:79]
    v_mfma_f32_16x16x32_bf16 v[80:83], v[40:43], v[28:31], v[80:83]
    v_mfma_f32_16x16x32_bf16 v[84:87], v[44:47], v[28:31], v[84:87]
    v_mfma_f32_16x16x32_bf16 v[88:91], v[48:51], v[28:31], v[88:91]
    v_mfma_f32_16x16x32_bf16 v[92:95], v[52:55], v[28:31], v[92:95]
    v_mfma_f32_16x16x32_bf16 v[96:99], v[40:43], v[32:35], v[96:99]
    v_mfma_f32_16x16x32_bf16 v[100:103], v[44:47], v[32:35], v[100:103]
    v_mfma_f32_16x16x32_bf16 v[104:107], v[48:51], v[32:35], v[104:107]
    v_mfma_f32_16x16x32_bf16 v[108:111], v[52:55], v[32:35], v[108:111]
    v_mfma_f32_16x16x32_bf16 v[112:115], v[40:43], v[36:39], v[112:115]
    v_mfma_f32_16x16x32_bf16 v[116:119], v[44:47], v[36:39], v[116:119]
    v_mfma_f32_16x16x32_bf16 v[120:123], v[48:51], v[36:39], v[120:123]
    v_mfma_f32_16x16x32_bf16 v[124:127], v[52:55], v[36:39], v[124:127]
    s_waitcnt vmcnt(4)
    s_barrier
    ds_read_b128 v[24:27], v9 offset:32768
    ds_read_b128 v[28:31], v9 offset:33792
    ds_read_b128 v[32:35], v9 offset:34816
    ds_read_b128 v[36:39], v9 offset:35840
    ds_read_b128 v[40:43], v10 offset:32768
    ds_read_b128 v[44:47], v10 offset:33792
    ds_read_b128 v[48:51], v10 offset:34816
    ds_read_b128 v[52:55], v10 offset:35840
    s_waitcnt lgkmcnt(8)
    v_mfma_f32_16x16x32_bf16 v[64:67], v[144:147], v[128:131], v[64:67]
    v_mfma_f32_16x16x32_bf16 v[68:71], v[148:151], v[128:131], v[68:71]
    v_mfma_f32_16x16x32_bf16 v[72:75], v[152:155], v[128:131], v[72:75]
    v_mfma_f32_16x16x32_bf16 v[76:79], v[156:159], v[128:131], v[76:79]
    v_mfma_f32_16x16x32_bf16 v[80:83], v[144:147], v[132:135], v[80:83]
    v_mfma_f32_16x16x32_bf16 v[84:87], v[148:151], v[132:135], v[84:87]
    v_mfma_f32_16x16x32_bf16 v[88:91], v[152:155], v[132:135], v[88:91]
    v_mfma_f32_16x16x32_bf16 v[92:95], v[156:159], v[132:135], v[92:95]
    v_mfma_f32_16x16x32_bf16 v[96:99], v[144:147], v[136:139], v[96:99]
    v_mfma_f32_16x16x32_bf16 v[100:103], v[148:151], v[136:139], v[100:103]
    v_mfma_f32_16x16x32_bf16 v[104:107], v[152:155], v[136:139], v[104:107]
    v_mfma_f32_16x16x32_bf16 v[108:111], v[156:159], v[136:139], v[108:111]
    v_mfma_f32_16x16x32_bf16 v[112:115], v[144:147], v[140:143], v[112:115]
    v_mfma_f32_16x16x32_bf16 v[116:119], v[148:151], v[140:143], v[116:119]
    v_mfma_f32_16x16x32_bf16 v[120:123], v[152:155], v[140:143], v[120:123]
    v_mfma_f32_16x16x32_bf16 v[124:127], v[156:159], v[140:143], v[124:127]
    s_waitcnt vmcnt(0)
    s_barrier
    ds_read_b128 v[128:131], v9 offset:49152
    ds_read_b128 v[132:135], v9 offset:50176
    ds_read_b128 v[136:139], v9 offset:51200
    ds_read_b128 v[140:143], v9 offset:52224
    ds_read_b128 v[144:147], v10 offset:49152
    ds_read_b128 v[148:151], v10 offset:50176
    ds_read_b128 v[152:155], v10 offset:51200
    ds_read_b128 v[156:159], v10 offset:52224
    s_waitcnt lgkmcnt(8)
    v_mfma_f32_16x16x32_bf16 v[64:67], v[40:43], v[24:27], v[64:67]
    v_mfma_f32_16x16x32_bf16 v[68:71], v[44:47], v[24:27], v[68:71]
    v_mfma_f32_16x16x32_bf16 v[72:75], v[48:51], v[24:27], v[72:75]
    v_mfma_f32_16x16x32_bf16 v[76:79], v[52:55], v[24:27], v[76:79]
    v_mfma_f32_16x16x32_bf16 v[80:83], v[40:43], v[28:31], v[80:83]
    v_mfma_f32_16x16x32_bf16 v[84:87], v[44:47], v[28:31], v[84:87]
    v_mfma_f32_16x16x32_bf16 v[88:91], v[48:51], v[28:31], v[88:91]
    v_mfma_f32_16x16x32_bf16 v[92:95], v[52:55], v[28:31], v[92:95]
    v_mfma_f32_16x16x32_bf16 v[96:99], v[40:43], v[32:35], v[96:99]
    v_mfma_f32_16x16x32_bf16 v[100:103], v[44:47], v[32:35], v[100:103]
    v_mfma_f32_16x16x32_bf16 v[104:107], v[48:51], v[32:35], v[104:107]
    v_mfma_f32_16x16x32_bf16 v[108:111], v[52:55], v[32:35], v[108:111]
    v_mfma_f32_16x16x32_bf16 v[112:115], v[40:43], v[36:39], v[112:115]
    v_mfma_f32_16x16x32_bf16 v[116:119], v[44:47], v[36:39], v[116:119]
    v_mfma_f32_16x16x32_bf16 v[120:123], v[48:51], v[36:39], v[120:123]
    v_mfma_f32_16x16x32_bf16 v[124:127], v[52:55], v[36:39], v[124:127]
    s_waitcnt lgkmcnt(0)
    v_mfma_f32_16x16x32_bf16 v[64:67], v[144:147], v[128:131], v[64:67]
    v_mfma_f32_16x16x32_bf16 v[68:71], v[148:151], v[128:131], v[68:71]
    v_mfma_f32_16x16x32_bf16 v[72:75], v[152:155], v[128:131], v[72:75]
    v_mfma_f32_16x16x32_bf16 v[76:79], v[156:159], v[128:131], v[76:79]
    v_mfma_f32_16x16x32_bf16 v[80:83], v[144:147], v[132:135], v[80:83]
    v_mfma_f32_16x16x32_bf16 v[84:87], v[148:151], v[132:135], v[84:87]
    v_mfma_f32_16x16x32_bf16 v[88:91], v[152:155], v[132:135], v[88:91]
    v_mfma_f32_16x16x32_bf16 v[92:95], v[156:159], v[132:135], v[92:95]
    v_mfma_f32_16x16x32_bf16 v[96:99], v[144:147], v[136:139], v[96:99]
    v_mfma_f32_16x16x32_bf16 v[100:103], v[148:151], v[136:139], v[100:103]
    v_mfma_f32_16x16x32_bf16 v[104:107], v[152:155], v[136:139], v[104:107]
    v_mfma_f32_16x16x32_bf16 v[108:111], v[156:159], v[136:139], v[108:111]
    v_mfma_f32_16x16x32_bf16 v[112:115], v[144:147], v[140:143], v[112:115]
    v_mfma_f32_16x16x32_bf16 v[116:119], v[148:151], v[140:143], v[116:119]
    v_mfma_f32_16x16x32_bf16 v[120:123], v[152:155], v[140:143], v[120:123]
    v_mfma_f32_16x16x32_bf16 v[124:127], v[156:159], v[140:143], v[124:127]
    s_nop 7
    s_nop 1
    s_lshr_b32 s27, s12, 1
    s_and_b32 s28, s12, 1
    s_lshl_b32 s29, s20, 3
    s_lshl_b32 s31, s27, 2
    s_add_u32 s29, s29, s31
    s_lshl_b32 s29, s29, 4
    s_lshl_b32 s31, s21, 2
    s_add_u32 s29, s29, s31
    s_lshl_b32 s31, s28, 1
    s_add_u32 s29, s29, s31
    s_lshl_b32 s29, s29, 10
    s_add_u32 s29, s29, 130023424
    v_lshlrev_b32 v4, 4, v1
    v_add_u32 v4, s29, v4
    v_cvt_pk_bf16_f32 v11, v64, v65
    v_lshlrev_b32 v64, 16, v11
    v_and_b32 v65, 0xffff0000, v11
    v_mul_f32 v12, s30, v64
    v_exp_f32 v12, v12
    v_add_f32 v13, 1.0, v64
    v_cmp_lt_f32 vcc, 0, v64
    s_nop 1
    v_cndmask_b32 v64, v12, v13, vcc
    v_mul_f32 v12, s30, v65
    v_exp_f32 v12, v12
    v_add_f32 v13, 1.0, v65
    v_cmp_lt_f32 vcc, 0, v65
    s_nop 1
    v_cndmask_b32 v65, v12, v13, vcc
    v_cvt_pk_bf16_f32 v11, v64, v65
    v_lshlrev_b32 v64, 16, v11
    v_and_b32 v65, 0xffff0000, v11
    v_add_f32 v64, 0x358637bd, v64
    v_add_f32 v65, 0x358637bd, v65
    v_cvt_pk_bf16_f32 v11, v64, v65
    v_lshlrev_b32 v64, 16, v11
    v_and_b32 v65, 0xffff0000, v11
    v_cvt_pk_bf16_f32 v11, v66, v67
    v_lshlrev_b32 v66, 16, v11
    v_and_b32 v67, 0xffff0000, v11
    v_mul_f32 v12, s30, v66
    v_exp_f32 v12, v12
    v_add_f32 v13, 1.0, v66
    v_cmp_lt_f32 vcc, 0, v66
    s_nop 1
    v_cndmask_b32 v66, v12, v13, vcc
    v_mul_f32 v12, s30, v67
    v_exp_f32 v12, v12
    v_add_f32 v13, 1.0, v67
    v_cmp_lt_f32 vcc, 0, v67
    s_nop 1
    v_cndmask_b32 v67, v12, v13, vcc
    v_cvt_pk_bf16_f32 v11, v66, v67
    v_lshlrev_b32 v66, 16, v11
    v_and_b32 v67, 0xffff0000, v11
    v_add_f32 v66, 0x358637bd, v66
    v_add_f32 v67, 0x358637bd, v67
    v_cvt_pk_bf16_f32 v11, v66, v67
    v_lshlrev_b32 v66, 16, v11
    v_and_b32 v67, 0xffff0000, v11
    v_cvt_pk_bf16_f32 v11, v68, v69
    v_lshlrev_b32 v68, 16, v11
    v_and_b32 v69, 0xffff0000, v11
    v_mul_f32 v12, s30, v68
    v_exp_f32 v12, v12
    v_add_f32 v13, 1.0, v68
    v_cmp_lt_f32 vcc, 0, v68
    s_nop 1
    v_cndmask_b32 v68, v12, v13, vcc
    v_mul_f32 v12, s30, v69
    v_exp_f32 v12, v12
    v_add_f32 v13, 1.0, v69
    v_cmp_lt_f32 vcc, 0, v69
    s_nop 1
    v_cndmask_b32 v69, v12, v13, vcc
    v_cvt_pk_bf16_f32 v11, v68, v69
    v_lshlrev_b32 v68, 16, v11
    v_and_b32 v69, 0xffff0000, v11
    v_add_f32 v68, 0x358637bd, v68
    v_add_f32 v69, 0x358637bd, v69
    v_cvt_pk_bf16_f32 v11, v68, v69
    v_lshlrev_b32 v68, 16, v11
    v_and_b32 v69, 0xffff0000, v11
    v_cvt_pk_bf16_f32 v11, v70, v71
    v_lshlrev_b32 v70, 16, v11
    v_and_b32 v71, 0xffff0000, v11
    v_mul_f32 v12, s30, v70
    v_exp_f32 v12, v12
    v_add_f32 v13, 1.0, v70
    v_cmp_lt_f32 vcc, 0, v70
    s_nop 1
    v_cndmask_b32 v70, v12, v13, vcc
    v_mul_f32 v12, s30, v71
    v_exp_f32 v12, v12
    v_add_f32 v13, 1.0, v71
    v_cmp_lt_f32 vcc, 0, v71
    s_nop 1
    v_cndmask_b32 v71, v12, v13, vcc
    v_cvt_pk_bf16_f32 v11, v70, v71
    v_lshlrev_b32 v70, 16, v11
    v_and_b32 v71, 0xffff0000, v11
    v_add_f32 v70, 0x358637bd, v70
    v_add_f32 v71, 0x358637bd, v71
    v_cvt_pk_bf16_f32 v11, v70, v71
    v_lshlrev_b32 v70, 16, v11
    v_and_b32 v71, 0xffff0000, v11
    v_cvt_pk_bf16_f32 v32, v64, v65
    v_cvt_pk_bf16_f32 v33, v66, v67
    v_cvt_pk_bf16_f32 v34, v68, v69
    v_cvt_pk_bf16_f32 v35, v70, v71
    global_store_dwordx4 v4, v[32:35], s[4:5] offset:0
    v_cvt_pk_bf16_f32 v11, v72, v73
    v_lshlrev_b32 v72, 16, v11
    v_and_b32 v73, 0xffff0000, v11
    v_mul_f32 v12, s30, v72
    v_exp_f32 v12, v12
    v_add_f32 v13, 1.0, v72
    v_cmp_lt_f32 vcc, 0, v72
    s_nop 1
    v_cndmask_b32 v72, v12, v13, vcc
    v_mul_f32 v12, s30, v73
    v_exp_f32 v12, v12
    v_add_f32 v13, 1.0, v73
    v_cmp_lt_f32 vcc, 0, v73
    s_nop 1
    v_cndmask_b32 v73, v12, v13, vcc
    v_cvt_pk_bf16_f32 v11, v72, v73
    v_lshlrev_b32 v72, 16, v11
    v_and_b32 v73, 0xffff0000, v11
    v_add_f32 v72, 0x358637bd, v72
    v_add_f32 v73, 0x358637bd, v73
    v_cvt_pk_bf16_f32 v11, v72, v73
    v_lshlrev_b32 v72, 16, v11
    v_and_b32 v73, 0xffff0000, v11
    v_cvt_pk_bf16_f32 v11, v74, v75
    v_lshlrev_b32 v74, 16, v11
    v_and_b32 v75, 0xffff0000, v11
    v_mul_f32 v12, s30, v74
    v_exp_f32 v12, v12
    v_add_f32 v13, 1.0, v74
    v_cmp_lt_f32 vcc, 0, v74
    s_nop 1
    v_cndmask_b32 v74, v12, v13, vcc
    v_mul_f32 v12, s30, v75
    v_exp_f32 v12, v12
    v_add_f32 v13, 1.0, v75
    v_cmp_lt_f32 vcc, 0, v75
    s_nop 1
    v_cndmask_b32 v75, v12, v13, vcc
    v_cvt_pk_bf16_f32 v11, v74, v75
    v_lshlrev_b32 v74, 16, v11
    v_and_b32 v75, 0xffff0000, v11
    v_add_f32 v74, 0x358637bd, v74
    v_add_f32 v75, 0x358637bd, v75
    v_cvt_pk_bf16_f32 v11, v74, v75
    v_lshlrev_b32 v74, 16, v11
    v_and_b32 v75, 0xffff0000, v11
    v_cvt_pk_bf16_f32 v11, v76, v77
    v_lshlrev_b32 v76, 16, v11
    v_and_b32 v77, 0xffff0000, v11
    v_mul_f32 v12, s30, v76
    v_exp_f32 v12, v12
    v_add_f32 v13, 1.0, v76
    v_cmp_lt_f32 vcc, 0, v76
    s_nop 1
    v_cndmask_b32 v76, v12, v13, vcc
    v_mul_f32 v12, s30, v77
    v_exp_f32 v12, v12
    v_add_f32 v13, 1.0, v77
    v_cmp_lt_f32 vcc, 0, v77
    s_nop 1
    v_cndmask_b32 v77, v12, v13, vcc
    v_cvt_pk_bf16_f32 v11, v76, v77
    v_lshlrev_b32 v76, 16, v11
    v_and_b32 v77, 0xffff0000, v11
    v_add_f32 v76, 0x358637bd, v76
    v_add_f32 v77, 0x358637bd, v77
    v_cvt_pk_bf16_f32 v11, v76, v77
    v_lshlrev_b32 v76, 16, v11
    v_and_b32 v77, 0xffff0000, v11
    v_cvt_pk_bf16_f32 v11, v78, v79
    v_lshlrev_b32 v78, 16, v11
    v_and_b32 v79, 0xffff0000, v11
    v_mul_f32 v12, s30, v78
    v_exp_f32 v12, v12
    v_add_f32 v13, 1.0, v78
    v_cmp_lt_f32 vcc, 0, v78
    s_nop 1
    v_cndmask_b32 v78, v12, v13, vcc
    v_mul_f32 v12, s30, v79
    v_exp_f32 v12, v12
    v_add_f32 v13, 1.0, v79
    v_cmp_lt_f32 vcc, 0, v79
    s_nop 1
    v_cndmask_b32 v79, v12, v13, vcc
    v_cvt_pk_bf16_f32 v11, v78, v79
    v_lshlrev_b32 v78, 16, v11
    v_and_b32 v79, 0xffff0000, v11
    v_add_f32 v78, 0x358637bd, v78
    v_add_f32 v79, 0x358637bd, v79
    v_cvt_pk_bf16_f32 v11, v78, v79
    v_lshlrev_b32 v78, 16, v11
    v_and_b32 v79, 0xffff0000, v11
    v_cvt_pk_bf16_f32 v36, v72, v73
    v_cvt_pk_bf16_f32 v37, v74, v75
    v_cvt_pk_bf16_f32 v38, v76, v77
    v_cvt_pk_bf16_f32 v39, v78, v79
    global_store_dwordx4 v4, v[36:39], s[4:5] offset:1024
    v_add_u32 v4, 16384, v4
    v_cvt_pk_bf16_f32 v11, v80, v81
    v_lshlrev_b32 v80, 16, v11
    v_and_b32 v81, 0xffff0000, v11
    v_mul_f32 v12, s30, v80
    v_exp_f32 v12, v12
    v_add_f32 v13, 1.0, v80
    v_cmp_lt_f32 vcc, 0, v80
    s_nop 1
    v_cndmask_b32 v80, v12, v13, vcc
    v_mul_f32 v12, s30, v81
    v_exp_f32 v12, v12
    v_add_f32 v13, 1.0, v81
    v_cmp_lt_f32 vcc, 0, v81
    s_nop 1
    v_cndmask_b32 v81, v12, v13, vcc
    v_cvt_pk_bf16_f32 v11, v80, v81
    v_lshlrev_b32 v80, 16, v11
    v_and_b32 v81, 0xffff0000, v11
    v_add_f32 v80, 0x358637bd, v80
    v_add_f32 v81, 0x358637bd, v81
    v_cvt_pk_bf16_f32 v11, v80, v81
    v_lshlrev_b32 v80, 16, v11
    v_and_b32 v81, 0xffff0000, v11
    v_cvt_pk_bf16_f32 v11, v82, v83
    v_lshlrev_b32 v82, 16, v11
    v_and_b32 v83, 0xffff0000, v11
    v_mul_f32 v12, s30, v82
    v_exp_f32 v12, v12
    v_add_f32 v13, 1.0, v82
    v_cmp_lt_f32 vcc, 0, v82
    s_nop 1
    v_cndmask_b32 v82, v12, v13, vcc
    v_mul_f32 v12, s30, v83
    v_exp_f32 v12, v12
    v_add_f32 v13, 1.0, v83
    v_cmp_lt_f32 vcc, 0, v83
    s_nop 1
    v_cndmask_b32 v83, v12, v13, vcc
    v_cvt_pk_bf16_f32 v11, v82, v83
    v_lshlrev_b32 v82, 16, v11
    v_and_b32 v83, 0xffff0000, v11
    v_add_f32 v82, 0x358637bd, v82
    v_add_f32 v83, 0x358637bd, v83
    v_cvt_pk_bf16_f32 v11, v82, v83
    v_lshlrev_b32 v82, 16, v11
    v_and_b32 v83, 0xffff0000, v11
    v_cvt_pk_bf16_f32 v11, v84, v85
    v_lshlrev_b32 v84, 16, v11
    v_and_b32 v85, 0xffff0000, v11
    v_mul_f32 v12, s30, v84
    v_exp_f32 v12, v12
    v_add_f32 v13, 1.0, v84
    v_cmp_lt_f32 vcc, 0, v84
    s_nop 1
    v_cndmask_b32 v84, v12, v13, vcc
    v_mul_f32 v12, s30, v85
    v_exp_f32 v12, v12
    v_add_f32 v13, 1.0, v85
    v_cmp_lt_f32 vcc, 0, v85
    s_nop 1
    v_cndmask_b32 v85, v12, v13, vcc
    v_cvt_pk_bf16_f32 v11, v84, v85
    v_lshlrev_b32 v84, 16, v11
    v_and_b32 v85, 0xffff0000, v11
    v_add_f32 v84, 0x358637bd, v84
    v_add_f32 v85, 0x358637bd, v85
    v_cvt_pk_bf16_f32 v11, v84, v85
    v_lshlrev_b32 v84, 16, v11
    v_and_b32 v85, 0xffff0000, v11
    v_cvt_pk_bf16_f32 v11, v86, v87
    v_lshlrev_b32 v86, 16, v11
    v_and_b32 v87, 0xffff0000, v11
    v_mul_f32 v12, s30, v86
    v_exp_f32 v12, v12
    v_add_f32 v13, 1.0, v86
    v_cmp_lt_f32 vcc, 0, v86
    s_nop 1
    v_cndmask_b32 v86, v12, v13, vcc
    v_mul_f32 v12, s30, v87
    v_exp_f32 v12, v12
    v_add_f32 v13, 1.0, v87
    v_cmp_lt_f32 vcc, 0, v87
    s_nop 1
    v_cndmask_b32 v87, v12, v13, vcc
    v_cvt_pk_bf16_f32 v11, v86, v87
    v_lshlrev_b32 v86, 16, v11
    v_and_b32 v87, 0xffff0000, v11
    v_add_f32 v86, 0x358637bd, v86
    v_add_f32 v87, 0x358637bd, v87
    v_cvt_pk_bf16_f32 v11, v86, v87
    v_lshlrev_b32 v86, 16, v11
    v_and_b32 v87, 0xffff0000, v11
    v_cvt_pk_bf16_f32 v40, v80, v81
    v_cvt_pk_bf16_f32 v41, v82, v83
    v_cvt_pk_bf16_f32 v42, v84, v85
    v_cvt_pk_bf16_f32 v43, v86, v87
    global_store_dwordx4 v4, v[40:43], s[4:5] offset:0
    v_cvt_pk_bf16_f32 v11, v88, v89
    v_lshlrev_b32 v88, 16, v11
    v_and_b32 v89, 0xffff0000, v11
    v_mul_f32 v12, s30, v88
    v_exp_f32 v12, v12
    v_add_f32 v13, 1.0, v88
    v_cmp_lt_f32 vcc, 0, v88
    s_nop 1
    v_cndmask_b32 v88, v12, v13, vcc
    v_mul_f32 v12, s30, v89
    v_exp_f32 v12, v12
    v_add_f32 v13, 1.0, v89
    v_cmp_lt_f32 vcc, 0, v89
    s_nop 1
    v_cndmask_b32 v89, v12, v13, vcc
    v_cvt_pk_bf16_f32 v11, v88, v89
    v_lshlrev_b32 v88, 16, v11
    v_and_b32 v89, 0xffff0000, v11
    v_add_f32 v88, 0x358637bd, v88
    v_add_f32 v89, 0x358637bd, v89
    v_cvt_pk_bf16_f32 v11, v88, v89
    v_lshlrev_b32 v88, 16, v11
    v_and_b32 v89, 0xffff0000, v11
    v_cvt_pk_bf16_f32 v11, v90, v91
    v_lshlrev_b32 v90, 16, v11
    v_and_b32 v91, 0xffff0000, v11
    v_mul_f32 v12, s30, v90
    v_exp_f32 v12, v12
    v_add_f32 v13, 1.0, v90
    v_cmp_lt_f32 vcc, 0, v90
    s_nop 1
    v_cndmask_b32 v90, v12, v13, vcc
    v_mul_f32 v12, s30, v91
    v_exp_f32 v12, v12
    v_add_f32 v13, 1.0, v91
    v_cmp_lt_f32 vcc, 0, v91
    s_nop 1
    v_cndmask_b32 v91, v12, v13, vcc
    v_cvt_pk_bf16_f32 v11, v90, v91
    v_lshlrev_b32 v90, 16, v11
    v_and_b32 v91, 0xffff0000, v11
    v_add_f32 v90, 0x358637bd, v90
    v_add_f32 v91, 0x358637bd, v91
    v_cvt_pk_bf16_f32 v11, v90, v91
    v_lshlrev_b32 v90, 16, v11
    v_and_b32 v91, 0xffff0000, v11
    v_cvt_pk_bf16_f32 v11, v92, v93
    v_lshlrev_b32 v92, 16, v11
    v_and_b32 v93, 0xffff0000, v11
    v_mul_f32 v12, s30, v92
    v_exp_f32 v12, v12
    v_add_f32 v13, 1.0, v92
    v_cmp_lt_f32 vcc, 0, v92
    s_nop 1
    v_cndmask_b32 v92, v12, v13, vcc
    v_mul_f32 v12, s30, v93
    v_exp_f32 v12, v12
    v_add_f32 v13, 1.0, v93
    v_cmp_lt_f32 vcc, 0, v93
    s_nop 1
    v_cndmask_b32 v93, v12, v13, vcc
    v_cvt_pk_bf16_f32 v11, v92, v93
    v_lshlrev_b32 v92, 16, v11
    v_and_b32 v93, 0xffff0000, v11
    v_add_f32 v92, 0x358637bd, v92
    v_add_f32 v93, 0x358637bd, v93
    v_cvt_pk_bf16_f32 v11, v92, v93
    v_lshlrev_b32 v92, 16, v11
    v_and_b32 v93, 0xffff0000, v11
    v_cvt_pk_bf16_f32 v11, v94, v95
    v_lshlrev_b32 v94, 16, v11
    v_and_b32 v95, 0xffff0000, v11
    v_mul_f32 v12, s30, v94
    v_exp_f32 v12, v12
    v_add_f32 v13, 1.0, v94
    v_cmp_lt_f32 vcc, 0, v94
    s_nop 1
    v_cndmask_b32 v94, v12, v13, vcc
    v_mul_f32 v12, s30, v95
    v_exp_f32 v12, v12
    v_add_f32 v13, 1.0, v95
    v_cmp_lt_f32 vcc, 0, v95
    s_nop 1
    v_cndmask_b32 v95, v12, v13, vcc
    v_cvt_pk_bf16_f32 v11, v94, v95
    v_lshlrev_b32 v94, 16, v11
    v_and_b32 v95, 0xffff0000, v11
    v_add_f32 v94, 0x358637bd, v94
    v_add_f32 v95, 0x358637bd, v95
    v_cvt_pk_bf16_f32 v11, v94, v95
    v_lshlrev_b32 v94, 16, v11
    v_and_b32 v95, 0xffff0000, v11
    v_cvt_pk_bf16_f32 v44, v88, v89
    v_cvt_pk_bf16_f32 v45, v90, v91
    v_cvt_pk_bf16_f32 v46, v92, v93
    v_cvt_pk_bf16_f32 v47, v94, v95
    global_store_dwordx4 v4, v[44:47], s[4:5] offset:1024
    v_add_u32 v4, 16384, v4
    v_cvt_pk_bf16_f32 v11, v96, v97
    v_lshlrev_b32 v96, 16, v11
    v_and_b32 v97, 0xffff0000, v11
    v_mul_f32 v12, s30, v96
    v_exp_f32 v12, v12
    v_add_f32 v13, 1.0, v96
    v_cmp_lt_f32 vcc, 0, v96
    s_nop 1
    v_cndmask_b32 v96, v12, v13, vcc
    v_mul_f32 v12, s30, v97
    v_exp_f32 v12, v12
    v_add_f32 v13, 1.0, v97
    v_cmp_lt_f32 vcc, 0, v97
    s_nop 1
    v_cndmask_b32 v97, v12, v13, vcc
    v_cvt_pk_bf16_f32 v11, v96, v97
    v_lshlrev_b32 v96, 16, v11
    v_and_b32 v97, 0xffff0000, v11
    v_add_f32 v96, 0x358637bd, v96
    v_add_f32 v97, 0x358637bd, v97
    v_cvt_pk_bf16_f32 v11, v96, v97
    v_lshlrev_b32 v96, 16, v11
    v_and_b32 v97, 0xffff0000, v11
    v_cvt_pk_bf16_f32 v11, v98, v99
    v_lshlrev_b32 v98, 16, v11
    v_and_b32 v99, 0xffff0000, v11
    v_mul_f32 v12, s30, v98
    v_exp_f32 v12, v12
    v_add_f32 v13, 1.0, v98
    v_cmp_lt_f32 vcc, 0, v98
    s_nop 1
    v_cndmask_b32 v98, v12, v13, vcc
    v_mul_f32 v12, s30, v99
    v_exp_f32 v12, v12
    v_add_f32 v13, 1.0, v99
    v_cmp_lt_f32 vcc, 0, v99
    s_nop 1
    v_cndmask_b32 v99, v12, v13, vcc
    v_cvt_pk_bf16_f32 v11, v98, v99
    v_lshlrev_b32 v98, 16, v11
    v_and_b32 v99, 0xffff0000, v11
    v_add_f32 v98, 0x358637bd, v98
    v_add_f32 v99, 0x358637bd, v99
    v_cvt_pk_bf16_f32 v11, v98, v99
    v_lshlrev_b32 v98, 16, v11
    v_and_b32 v99, 0xffff0000, v11
    v_cvt_pk_bf16_f32 v11, v100, v101
    v_lshlrev_b32 v100, 16, v11
    v_and_b32 v101, 0xffff0000, v11
    v_mul_f32 v12, s30, v100
    v_exp_f32 v12, v12
    v_add_f32 v13, 1.0, v100
    v_cmp_lt_f32 vcc, 0, v100
    s_nop 1
    v_cndmask_b32 v100, v12, v13, vcc
    v_mul_f32 v12, s30, v101
    v_exp_f32 v12, v12
    v_add_f32 v13, 1.0, v101
    v_cmp_lt_f32 vcc, 0, v101
    s_nop 1
    v_cndmask_b32 v101, v12, v13, vcc
    v_cvt_pk_bf16_f32 v11, v100, v101
    v_lshlrev_b32 v100, 16, v11
    v_and_b32 v101, 0xffff0000, v11
    v_add_f32 v100, 0x358637bd, v100
    v_add_f32 v101, 0x358637bd, v101
    v_cvt_pk_bf16_f32 v11, v100, v101
    v_lshlrev_b32 v100, 16, v11
    v_and_b32 v101, 0xffff0000, v11
    v_cvt_pk_bf16_f32 v11, v102, v103
    v_lshlrev_b32 v102, 16, v11
    v_and_b32 v103, 0xffff0000, v11
    v_mul_f32 v12, s30, v102
    v_exp_f32 v12, v12
    v_add_f32 v13, 1.0, v102
    v_cmp_lt_f32 vcc, 0, v102
    s_nop 1
    v_cndmask_b32 v102, v12, v13, vcc
    v_mul_f32 v12, s30, v103
    v_exp_f32 v12, v12
    v_add_f32 v13, 1.0, v103
    v_cmp_lt_f32 vcc, 0, v103
    s_nop 1
    v_cndmask_b32 v103, v12, v13, vcc
    v_cvt_pk_bf16_f32 v11, v102, v103
    v_lshlrev_b32 v102, 16, v11
    v_and_b32 v103, 0xffff0000, v11
    v_add_f32 v102, 0x358637bd, v102
    v_add_f32 v103, 0x358637bd, v103
    v_cvt_pk_bf16_f32 v11, v102, v103
    v_lshlrev_b32 v102, 16, v11
    v_and_b32 v103, 0xffff0000, v11
    v_cvt_pk_bf16_f32 v32, v96, v97
    v_cvt_pk_bf16_f32 v33, v98, v99
    v_cvt_pk_bf16_f32 v34, v100, v101
    v_cvt_pk_bf16_f32 v35, v102, v103
    global_store_dwordx4 v4, v[32:35], s[4:5] offset:0
    v_cvt_pk_bf16_f32 v11, v104, v105
    v_lshlrev_b32 v104, 16, v11
    v_and_b32 v105, 0xffff0000, v11
    v_mul_f32 v12, s30, v104
    v_exp_f32 v12, v12
    v_add_f32 v13, 1.0, v104
    v_cmp_lt_f32 vcc, 0, v104
    s_nop 1
    v_cndmask_b32 v104, v12, v13, vcc
    v_mul_f32 v12, s30, v105
    v_exp_f32 v12, v12
    v_add_f32 v13, 1.0, v105
    v_cmp_lt_f32 vcc, 0, v105
    s_nop 1
    v_cndmask_b32 v105, v12, v13, vcc
    v_cvt_pk_bf16_f32 v11, v104, v105
    v_lshlrev_b32 v104, 16, v11
    v_and_b32 v105, 0xffff0000, v11
    v_add_f32 v104, 0x358637bd, v104
    v_add_f32 v105, 0x358637bd, v105
    v_cvt_pk_bf16_f32 v11, v104, v105
    v_lshlrev_b32 v104, 16, v11
    v_and_b32 v105, 0xffff0000, v11
    v_cvt_pk_bf16_f32 v11, v106, v107
    v_lshlrev_b32 v106, 16, v11
    v_and_b32 v107, 0xffff0000, v11
    v_mul_f32 v12, s30, v106
    v_exp_f32 v12, v12
    v_add_f32 v13, 1.0, v106
    v_cmp_lt_f32 vcc, 0, v106
    s_nop 1
    v_cndmask_b32 v106, v12, v13, vcc
    v_mul_f32 v12, s30, v107
    v_exp_f32 v12, v12
    v_add_f32 v13, 1.0, v107
    v_cmp_lt_f32 vcc, 0, v107
    s_nop 1
    v_cndmask_b32 v107, v12, v13, vcc
    v_cvt_pk_bf16_f32 v11, v106, v107
    v_lshlrev_b32 v106, 16, v11
    v_and_b32 v107, 0xffff0000, v11
    v_add_f32 v106, 0x358637bd, v106
    v_add_f32 v107, 0x358637bd, v107
    v_cvt_pk_bf16_f32 v11, v106, v107
    v_lshlrev_b32 v106, 16, v11
    v_and_b32 v107, 0xffff0000, v11
    v_cvt_pk_bf16_f32 v11, v108, v109
    v_lshlrev_b32 v108, 16, v11
    v_and_b32 v109, 0xffff0000, v11
    v_mul_f32 v12, s30, v108
    v_exp_f32 v12, v12
    v_add_f32 v13, 1.0, v108
    v_cmp_lt_f32 vcc, 0, v108
    s_nop 1
    v_cndmask_b32 v108, v12, v13, vcc
    v_mul_f32 v12, s30, v109
    v_exp_f32 v12, v12
    v_add_f32 v13, 1.0, v109
    v_cmp_lt_f32 vcc, 0, v109
    s_nop 1
    v_cndmask_b32 v109, v12, v13, vcc
    v_cvt_pk_bf16_f32 v11, v108, v109
    v_lshlrev_b32 v108, 16, v11
    v_and_b32 v109, 0xffff0000, v11
    v_add_f32 v108, 0x358637bd, v108
    v_add_f32 v109, 0x358637bd, v109
    v_cvt_pk_bf16_f32 v11, v108, v109
    v_lshlrev_b32 v108, 16, v11
    v_and_b32 v109, 0xffff0000, v11
    v_cvt_pk_bf16_f32 v11, v110, v111
    v_lshlrev_b32 v110, 16, v11
    v_and_b32 v111, 0xffff0000, v11
    v_mul_f32 v12, s30, v110
    v_exp_f32 v12, v12
    v_add_f32 v13, 1.0, v110
    v_cmp_lt_f32 vcc, 0, v110
    s_nop 1
    v_cndmask_b32 v110, v12, v13, vcc
    v_mul_f32 v12, s30, v111
    v_exp_f32 v12, v12
    v_add_f32 v13, 1.0, v111
    v_cmp_lt_f32 vcc, 0, v111
    s_nop 1
    v_cndmask_b32 v111, v12, v13, vcc
    v_cvt_pk_bf16_f32 v11, v110, v111
    v_lshlrev_b32 v110, 16, v11
    v_and_b32 v111, 0xffff0000, v11
    v_add_f32 v110, 0x358637bd, v110
    v_add_f32 v111, 0x358637bd, v111
    v_cvt_pk_bf16_f32 v11, v110, v111
    v_lshlrev_b32 v110, 16, v11
    v_and_b32 v111, 0xffff0000, v11
    v_cvt_pk_bf16_f32 v36, v104, v105
    v_cvt_pk_bf16_f32 v37, v106, v107
    v_cvt_pk_bf16_f32 v38, v108, v109
    v_cvt_pk_bf16_f32 v39, v110, v111
    global_store_dwordx4 v4, v[36:39], s[4:5] offset:1024
    v_add_u32 v4, 16384, v4
    v_cvt_pk_bf16_f32 v11, v112, v113
    v_lshlrev_b32 v112, 16, v11
    v_and_b32 v113, 0xffff0000, v11
    v_mul_f32 v12, s30, v112
    v_exp_f32 v12, v12
    v_add_f32 v13, 1.0, v112
    v_cmp_lt_f32 vcc, 0, v112
    s_nop 1
    v_cndmask_b32 v112, v12, v13, vcc
    v_mul_f32 v12, s30, v113
    v_exp_f32 v12, v12
    v_add_f32 v13, 1.0, v113
    v_cmp_lt_f32 vcc, 0, v113
    s_nop 1
    v_cndmask_b32 v113, v12, v13, vcc
    v_cvt_pk_bf16_f32 v11, v112, v113
    v_lshlrev_b32 v112, 16, v11
    v_and_b32 v113, 0xffff0000, v11
    v_add_f32 v112, 0x358637bd, v112
    v_add_f32 v113, 0x358637bd, v113
    v_cvt_pk_bf16_f32 v11, v112, v113
    v_lshlrev_b32 v112, 16, v11
    v_and_b32 v113, 0xffff0000, v11
    v_cvt_pk_bf16_f32 v11, v114, v115
    v_lshlrev_b32 v114, 16, v11
    v_and_b32 v115, 0xffff0000, v11
    v_mul_f32 v12, s30, v114
    v_exp_f32 v12, v12
    v_add_f32 v13, 1.0, v114
    v_cmp_lt_f32 vcc, 0, v114
    s_nop 1
    v_cndmask_b32 v114, v12, v13, vcc
    v_mul_f32 v12, s30, v115
    v_exp_f32 v12, v12
    v_add_f32 v13, 1.0, v115
    v_cmp_lt_f32 vcc, 0, v115
    s_nop 1
    v_cndmask_b32 v115, v12, v13, vcc
    v_cvt_pk_bf16_f32 v11, v114, v115
    v_lshlrev_b32 v114, 16, v11
    v_and_b32 v115, 0xffff0000, v11
    v_add_f32 v114, 0x358637bd, v114
    v_add_f32 v115, 0x358637bd, v115
    v_cvt_pk_bf16_f32 v11, v114, v115
    v_lshlrev_b32 v114, 16, v11
    v_and_b32 v115, 0xffff0000, v11
    v_cvt_pk_bf16_f32 v11, v116, v117
    v_lshlrev_b32 v116, 16, v11
    v_and_b32 v117, 0xffff0000, v11
    v_mul_f32 v12, s30, v116
    v_exp_f32 v12, v12
    v_add_f32 v13, 1.0, v116
    v_cmp_lt_f32 vcc, 0, v116
    s_nop 1
    v_cndmask_b32 v116, v12, v13, vcc
    v_mul_f32 v12, s30, v117
    v_exp_f32 v12, v12
    v_add_f32 v13, 1.0, v117
    v_cmp_lt_f32 vcc, 0, v117
    s_nop 1
    v_cndmask_b32 v117, v12, v13, vcc
    v_cvt_pk_bf16_f32 v11, v116, v117
    v_lshlrev_b32 v116, 16, v11
    v_and_b32 v117, 0xffff0000, v11
    v_add_f32 v116, 0x358637bd, v116
    v_add_f32 v117, 0x358637bd, v117
    v_cvt_pk_bf16_f32 v11, v116, v117
    v_lshlrev_b32 v116, 16, v11
    v_and_b32 v117, 0xffff0000, v11
    v_cvt_pk_bf16_f32 v11, v118, v119
    v_lshlrev_b32 v118, 16, v11
    v_and_b32 v119, 0xffff0000, v11
    v_mul_f32 v12, s30, v118
    v_exp_f32 v12, v12
    v_add_f32 v13, 1.0, v118
    v_cmp_lt_f32 vcc, 0, v118
    s_nop 1
    v_cndmask_b32 v118, v12, v13, vcc
    v_mul_f32 v12, s30, v119
    v_exp_f32 v12, v12
    v_add_f32 v13, 1.0, v119
    v_cmp_lt_f32 vcc, 0, v119
    s_nop 1
    v_cndmask_b32 v119, v12, v13, vcc
    v_cvt_pk_bf16_f32 v11, v118, v119
    v_lshlrev_b32 v118, 16, v11
    v_and_b32 v119, 0xffff0000, v11
    v_add_f32 v118, 0x358637bd, v118
    v_add_f32 v119, 0x358637bd, v119
    v_cvt_pk_bf16_f32 v11, v118, v119
    v_lshlrev_b32 v118, 16, v11
    v_and_b32 v119, 0xffff0000, v11
    v_cvt_pk_bf16_f32 v40, v112, v113
    v_cvt_pk_bf16_f32 v41, v114, v115
    v_cvt_pk_bf16_f32 v42, v116, v117
    v_cvt_pk_bf16_f32 v43, v118, v119
    global_store_dwordx4 v4, v[40:43], s[4:5] offset:0
    v_cvt_pk_bf16_f32 v11, v120, v121
    v_lshlrev_b32 v120, 16, v11
    v_and_b32 v121, 0xffff0000, v11
    v_mul_f32 v12, s30, v120
    v_exp_f32 v12, v12
    v_add_f32 v13, 1.0, v120
    v_cmp_lt_f32 vcc, 0, v120
    s_nop 1
    v_cndmask_b32 v120, v12, v13, vcc
    v_mul_f32 v12, s30, v121
    v_exp_f32 v12, v12
    v_add_f32 v13, 1.0, v121
    v_cmp_lt_f32 vcc, 0, v121
    s_nop 1
    v_cndmask_b32 v121, v12, v13, vcc
    v_cvt_pk_bf16_f32 v11, v120, v121
    v_lshlrev_b32 v120, 16, v11
    v_and_b32 v121, 0xffff0000, v11
    v_add_f32 v120, 0x358637bd, v120
    v_add_f32 v121, 0x358637bd, v121
    v_cvt_pk_bf16_f32 v11, v120, v121
    v_lshlrev_b32 v120, 16, v11
    v_and_b32 v121, 0xffff0000, v11
    v_cvt_pk_bf16_f32 v11, v122, v123
    v_lshlrev_b32 v122, 16, v11
    v_and_b32 v123, 0xffff0000, v11
    v_mul_f32 v12, s30, v122
    v_exp_f32 v12, v12
    v_add_f32 v13, 1.0, v122
    v_cmp_lt_f32 vcc, 0, v122
    s_nop 1
    v_cndmask_b32 v122, v12, v13, vcc
    v_mul_f32 v12, s30, v123
    v_exp_f32 v12, v12
    v_add_f32 v13, 1.0, v123
    v_cmp_lt_f32 vcc, 0, v123
    s_nop 1
    v_cndmask_b32 v123, v12, v13, vcc
    v_cvt_pk_bf16_f32 v11, v122, v123
    v_lshlrev_b32 v122, 16, v11
    v_and_b32 v123, 0xffff0000, v11
    v_add_f32 v122, 0x358637bd, v122
    v_add_f32 v123, 0x358637bd, v123
    v_cvt_pk_bf16_f32 v11, v122, v123
    v_lshlrev_b32 v122, 16, v11
    v_and_b32 v123, 0xffff0000, v11
    v_cvt_pk_bf16_f32 v11, v124, v125
    v_lshlrev_b32 v124, 16, v11
    v_and_b32 v125, 0xffff0000, v11
    v_mul_f32 v12, s30, v124
    v_exp_f32 v12, v12
    v_add_f32 v13, 1.0, v124
    v_cmp_lt_f32 vcc, 0, v124
    s_nop 1
    v_cndmask_b32 v124, v12, v13, vcc
    v_mul_f32 v12, s30, v125
    v_exp_f32 v12, v12
    v_add_f32 v13, 1.0, v125
    v_cmp_lt_f32 vcc, 0, v125
    s_nop 1
    v_cndmask_b32 v125, v12, v13, vcc
    v_cvt_pk_bf16_f32 v11, v124, v125
    v_lshlrev_b32 v124, 16, v11
    v_and_b32 v125, 0xffff0000, v11
    v_add_f32 v124, 0x358637bd, v124
    v_add_f32 v125, 0x358637bd, v125
    v_cvt_pk_bf16_f32 v11, v124, v125
    v_lshlrev_b32 v124, 16, v11
    v_and_b32 v125, 0xffff0000, v11
    v_cvt_pk_bf16_f32 v11, v126, v127
    v_lshlrev_b32 v126, 16, v11
    v_and_b32 v127, 0xffff0000, v11
    v_mul_f32 v12, s30, v126
    v_exp_f32 v12, v12
    v_add_f32 v13, 1.0, v126
    v_cmp_lt_f32 vcc, 0, v126
    s_nop 1
    v_cndmask_b32 v126, v12, v13, vcc
    v_mul_f32 v12, s30, v127
    v_exp_f32 v12, v12
    v_add_f32 v13, 1.0, v127
    v_cmp_lt_f32 vcc, 0, v127
    s_nop 1
    v_cndmask_b32 v127, v12, v13, vcc
    v_cvt_pk_bf16_f32 v11, v126, v127
    v_lshlrev_b32 v126, 16, v11
    v_and_b32 v127, 0xffff0000, v11
    v_add_f32 v126, 0x358637bd, v126
    v_add_f32 v127, 0x358637bd, v127
    v_cvt_pk_bf16_f32 v11, v126, v127
    v_lshlrev_b32 v126, 16, v11
    v_and_b32 v127, 0xffff0000, v11
    v_cvt_pk_bf16_f32 v44, v120, v121
    v_cvt_pk_bf16_f32 v45, v122, v123
    v_cvt_pk_bf16_f32 v46, v124, v125
    v_cvt_pk_bf16_f32 v47, v126, v127
    global_store_dwordx4 v4, v[44:47], s[4:5] offset:1024
    s_branch L_g3_kernel_1
L_g3_kernel_2:
    s_sub_u32 s21, s2, 64
    s_lshr_b32 s21, s21, 4
    s_lshl_b32 s25, s21, 16
    s_add_u32 s25, s25, 17301504
    s_and_b32 s13, s12, 1
    s_mul_i32 s14, s13, 65536
    s_add_u32 s14, s14, s24
    s_mul_i32 s15, s13, 32768
    s_add_u32 s15, s15, s25
    s_cmp_lt_u32 s12, 2
    s_cselect_b32 s14, s14, s15
    v_lshlrev_b32 v8, 4, v1
    v_add_u32 v4, s14, v8
    s_mov_b32 s16, 15360
    s_mov_b32 s17, 15360
    s_cselect_b32 s16, s16, s17
    v_add_u32 v5, s16, v4
    s_mov_b32 s16, 30720
    s_mov_b32 s17, 522240
    s_cselect_b32 s16, s16, s17
    v_add_u32 v6, s16, v4
    s_mov_b32 s16, 46080
    s_mov_b32 s17, 537600
    s_cselect_b32 s16, s16, s17
    v_add_u32 v7, s16, v4
    s_lshl_b32 s17, s12, 12
    s_lshr_b32 s18, s12, 1
    s_lshl_b32 s18, s18, 12
    v_add_u32 v9, s18, v8
    s_lshl_b32 s19, s13, 12
    v_add_u32 v10, s19, v8
    v_add_u32 v10, 8192, v10
    v_mov_b32 v64, 0
    v_mov_b32 v65, 0
    v_mov_b32 v66, 0
    v_mov_b32 v67, 0
    v_mov_b32 v68, 0
    v_mov_b32 v69, 0
    v_mov_b32 v70, 0
    v_mov_b32 v71, 0
    v_mov_b32 v72, 0
    v_mov_b32 v73, 0
    v_mov_b32 v74, 0
    v_mov_b32 v75, 0
    v_mov_b32 v76, 0
    v_mov_b32 v77, 0
    v_mov_b32 v78, 0
    v_mov_b32 v79, 0
    v_mov_b32 v80, 0
    v_mov_b32 v81, 0
    v_mov_b32 v82, 0
    v_mov_b32 v83, 0
    v_mov_b32 v84, 0
    v_mov_b32 v85, 0
    v_mov_b32 v86, 0
    v_mov_b32 v87, 0
    v_mov_b32 v88, 0
    v_mov_b32 v89, 0
    v_mov_b32 v90, 0
    v_mov_b32 v91, 0
    v_mov_b32 v92, 0
    v_mov_b32 v93, 0
    v_mov_b32 v94, 0
    v_mov_b32 v95, 0
    v_mov_b32 v96, 0
    v_mov_b32 v97, 0
    v_mov_b32 v98, 0
    v_mov_b32 v99, 0
    v_mov_b32 v100, 0
    v_mov_b32 v101, 0
    v_mov_b32 v102, 0
    v_mov_b32 v103, 0
    v_mov_b32 v104, 0
    v_mov_b32 v105, 0
    v_mov_b32 v106, 0
    v_mov_b32 v107, 0
    v_mov_b32 v108, 0
    v_mov_b32 v109, 0
    v_mov_b32 v110, 0
    v_mov_b32 v111, 0
    v_mov_b32 v112, 0
    v_mov_b32 v113, 0
    v_mov_b32 v114, 0
    v_mov_b32 v115, 0
    v_mov_b32 v116, 0
    v_mov_b32 v117, 0
    v_mov_b32 v118, 0
    v_mov_b32 v119, 0
    v_mov_b32 v120, 0
    v_mov_b32 v121, 0
    v_mov_b32 v122, 0
    v_mov_b32 v123, 0
    v_mov_b32 v124, 0
    v_mov_b32 v125, 0
    v_mov_b32 v126, 0
    v_mov_b32 v127, 0
    s_add_u32 s13, s17, 0
    s_mov_b32 m0, s13
    s_mov_b32 s13, 0
    buffer_load_dwordx4 v4, s[8:11], s13 offen offset:0 lds
    buffer_load_dwordx4 v5, s[8:11], s13 offen offset:1024 lds
    buffer_load_dwordx4 v6, s[8:11], s13 offen offset:2048 lds
    buffer_load_dwordx4 v7, s[8:11], s13 offen offset:3072 lds
    s_add_u32 s13, s17, 16384
    s_mov_b32 m0, s13
    s_mov_b32 s13, 1024
    buffer_load_dwordx4 v4, s[8:11], s13 offen offset:0 lds
    buffer_load_dwordx4 v5, s[8:11], s13 offen offset:1024 lds
    buffer_load_dwordx4 v6, s[8:11], s13 offen offset:2048 lds
    buffer_load_dwordx4 v7, s[8:11], s13 offen offset:3072 lds
    s_add_u32 s13, s17, 32768
    s_mov_b32 m0, s13
    s_mov_b32 s13, 2048
    buffer_load_dwordx4 v4, s[8:11], s13 offen offset:0 lds
    buffer_load_dwordx4 v5, s[8:11], s13 offen offset:1024 lds
    buffer_load_dwordx4 v6, s[8:11], s13 offen offset:2048 lds
    buffer_load_dwordx4 v7, s[8:11], s13 offen offset:3072 lds
    s_waitcnt vmcnt(8)
    s_barrier
    ds_read_b128 v[24:27], v9 offset:0
    ds_read_b128 v[28:31], v9 offset:1024
    ds_read_b128 v[32:35], v9 offset:2048
    ds_read_b128 v[36:39], v9 offset:3072
    ds_read_b128 v[40:43], v10 offset:0
    ds_read_b128 v[44:47], v10 offset:1024
    ds_read_b128 v[48:51], v10 offset:2048
    ds_read_b128 v[52:55], v10 offset:3072
    s_waitcnt vmcnt(4)
    s_barrier
    s_add_u32 s13, s17, 49152
    s_mov_b32 m0, s13
    s_mov_b32 s13, 3072
    buffer_load_dwordx4 v4, s[8:11], s13 offen offset:0 lds
    buffer_load_dwordx4 v5, s[8:11], s13 offen offset:1024 lds
    buffer_load_dwordx4 v6, s[8:11], s13 offen offset:2048 lds
    buffer_load_dwordx4 v7, s[8:11], s13 offen offset:3072 lds
    ds_read_b128 v[128:131], v9 offset:16384
    ds_read_b128 v[132:135], v9 offset:17408
    ds_read_b128 v[136:139], v9 offset:18432
    ds_read_b128 v[140:143], v9 offset:19456
    ds_read_b128 v[144:147], v10 offset:16384
    ds_read_b128 v[148:151], v10 offset:17408
    ds_read_b128 v[152:155], v10 offset:18432
    ds_read_b128 v[156:159], v10 offset:19456
    s_waitcnt lgkmcnt(8)
    v_mfma_f32_16x16x32_bf16 v[64:67], v[24:27], v[40:43], v[64:67]
    v_mfma_f32_16x16x32_bf16 v[68:71], v[24:27], v[44:47], v[68:71]
    v_mfma_f32_16x16x32_bf16 v[72:75], v[24:27], v[48:51], v[72:75]
    v_mfma_f32_16x16x32_bf16 v[76:79], v[24:27], v[52:55], v[76:79]
    v_mfma_f32_16x16x32_bf16 v[80:83], v[28:31], v[40:43], v[80:83]
    v_mfma_f32_16x16x32_bf16 v[84:87], v[28:31], v[44:47], v[84:87]
    v_mfma_f32_16x16x32_bf16 v[88:91], v[28:31], v[48:51], v[88:91]
    v_mfma_f32_16x16x32_bf16 v[92:95], v[28:31], v[52:55], v[92:95]
    v_mfma_f32_16x16x32_bf16 v[96:99], v[32:35], v[40:43], v[96:99]
    v_mfma_f32_16x16x32_bf16 v[100:103], v[32:35], v[44:47], v[100:103]
    v_mfma_f32_16x16x32_bf16 v[104:107], v[32:35], v[48:51], v[104:107]
    v_mfma_f32_16x16x32_bf16 v[108:111], v[32:35], v[52:55], v[108:111]
    v_mfma_f32_16x16x32_bf16 v[112:115], v[36:39], v[40:43], v[112:115]
    v_mfma_f32_16x16x32_bf16 v[116:119], v[36:39], v[44:47], v[116:119]
    v_mfma_f32_16x16x32_bf16 v[120:123], v[36:39], v[48:51], v[120:123]
    v_mfma_f32_16x16x32_bf16 v[124:127], v[36:39], v[52:55], v[124:127]
    s_waitcnt vmcnt(4)
    s_barrier
    s_add_u32 s13, s17, 0
    s_mov_b32 m0, s13
    s_mov_b32 s13, 4096
    buffer_load_dwordx4 v4, s[8:11], s13 offen offset:0 lds
    buffer_load_dwordx4 v5, s[8:11], s13 offen offset:1024 lds
    buffer_load_dwordx4 v6, s[8:11], s13 offen offset:2048 lds
    buffer_load_dwordx4 v7, s[8:11], s13 offen offset:3072 lds
    ds_read_b128 v[24:27], v9 offset:32768
    ds_read_b128 v[28:31], v9 offset:33792
    ds_read_b128 v[32:35], v9 offset:34816
    ds_read_b128 v[36:39], v9 offset:35840
    ds_read_b128 v[40:43], v10 offset:32768
    ds_read_b128 v[44:47], v10 offset:33792
    ds_read_b128 v[48:51], v10 offset:34816
    ds_read_b128 v[52:55], v10 offset:35840
    s_waitcnt lgkmcnt(8)
    v_mfma_f32_16x16x32_bf16 v[64:67], v[128:131], v[144:147], v[64:67]
    v_mfma_f32_16x16x32_bf16 v[68:71], v[128:131], v[148:151], v[68:71]
    v_mfma_f32_16x16x32_bf16 v[72:75], v[128:131], v[152:155], v[72:75]
    v_mfma_f32_16x16x32_bf16 v[76:79], v[128:131], v[156:159], v[76:79]
    v_mfma_f32_16x16x32_bf16 v[80:83], v[132:135], v[144:147], v[80:83]
    v_mfma_f32_16x16x32_bf16 v[84:87], v[132:135], v[148:151], v[84:87]
    v_mfma_f32_16x16x32_bf16 v[88:91], v[132:135], v[152:155], v[88:91]
    v_mfma_f32_16x16x32_bf16 v[92:95], v[132:135], v[156:159], v[92:95]
    v_mfma_f32_16x16x32_bf16 v[96:99], v[136:139], v[144:147], v[96:99]
    v_mfma_f32_16x16x32_bf16 v[100:103], v[136:139], v[148:151], v[100:103]
    v_mfma_f32_16x16x32_bf16 v[104:107], v[136:139], v[152:155], v[104:107]
    v_mfma_f32_16x16x32_bf16 v[108:111], v[136:139], v[156:159], v[108:111]
    v_mfma_f32_16x16x32_bf16 v[112:115], v[140:143], v[144:147], v[112:115]
    v_mfma_f32_16x16x32_bf16 v[116:119], v[140:143], v[148:151], v[116:119]
    v_mfma_f32_16x16x32_bf16 v[120:123], v[140:143], v[152:155], v[120:123]
    v_mfma_f32_16x16x32_bf16 v[124:127], v[140:143], v[156:159], v[124:127]
    s_waitcnt vmcnt(4)
    s_barrier
    s_add_u32 s13, s17, 16384
    s_mov_b32 m0, s13
    s_mov_b32 s13, 5120
    buffer_load_dwordx4 v4, s[8:11], s13 offen offset:0 lds
    buffer_load_dwordx4 v5, s[8:11], s13 offen offset:1024 lds
    buffer_load_dwordx4 v6, s[8:11], s13 offen offset:2048 lds
    buffer_load_dwordx4 v7, s[8:11], s13 offen offset:3072 lds
    ds_read_b128 v[128:131], v9 offset:49152
    ds_read_b128 v[132:135], v9 offset:50176
    ds_read_b128 v[136:139], v9 offset:51200
    ds_read_b128 v[140:143], v9 offset:52224
    ds_read_b128 v[144:147], v10 offset:49152
    ds_read_b128 v[148:151], v10 offset:50176
    ds_read_b128 v[152:155], v10 offset:51200
    ds_read_b128 v[156:159], v10 offset:52224
    s_waitcnt lgkmcnt(8)
    v_mfma_f32_16x16x32_bf16 v[64:67], v[24:27], v[40:43], v[64:67]
    v_mfma_f32_16x16x32_bf16 v[68:71], v[24:27], v[44:47], v[68:71]
    v_mfma_f32_16x16x32_bf16 v[72:75], v[24:27], v[48:51], v[72:75]
    v_mfma_f32_16x16x32_bf16 v[76:79], v[24:27], v[52:55], v[76:79]
    v_mfma_f32_16x16x32_bf16 v[80:83], v[28:31], v[40:43], v[80:83]
    v_mfma_f32_16x16x32_bf16 v[84:87], v[28:31], v[44:47], v[84:87]
    v_mfma_f32_16x16x32_bf16 v[88:91], v[28:31], v[48:51], v[88:91]
    v_mfma_f32_16x16x32_bf16 v[92:95], v[28:31], v[52:55], v[92:95]
    v_mfma_f32_16x16x32_bf16 v[96:99], v[32:35], v[40:43], v[96:99]
    v_mfma_f32_16x16x32_bf16 v[100:103], v[32:35], v[44:47], v[100:103]
    v_mfma_f32_16x16x32_bf16 v[104:107], v[32:35], v[48:51], v[104:107]
    v_mfma_f32_16x16x32_bf16 v[108:111], v[32:35], v[52:55], v[108:111]
    v_mfma_f32_16x16x32_bf16 v[112:115], v[36:39], v[40:43], v[112:115]
    v_mfma_f32_16x16x32_bf16 v[116:119], v[36:39], v[44:47], v[116:119]
    v_mfma_f32_16x16x32_bf16 v[120:123], v[36:39], v[48:51], v[120:123]
    v_mfma_f32_16x16x32_bf16 v[124:127], v[36:39], v[52:55], v[124:127]
    s_waitcnt vmcnt(4)
    s_barrier
    s_add_u32 s13, s17, 32768
    s_mov_b32 m0, s13
    s_mov_b32 s13, 6144
    buffer_load_dwordx4 v4, s[8:11], s13 offen offset:0 lds
    buffer_load_dwordx4 v5, s[8:11], s13 offen offset:1024 lds
    buffer_load_dwordx4 v6, s[8:11], s13 offen offset:2048 lds
    buffer_load_dwordx4 v7, s[8:11], s13 offen offset:3072 lds
    ds_read_b128 v[24:27], v9 offset:0
    ds_read_b128 v[28:31], v9 offset:1024
    ds_read_b128 v[32:35], v9 offset:2048
    ds_read_b128 v[36:39], v9 offset:3072
    ds_read_b128 v[40:43], v10 offset:0
    ds_read_b128 v[44:47], v10 offset:1024
    ds_read_b128 v[48:51], v10 offset:2048
    ds_read_b128 v[52:55], v10 offset:3072
    s_waitcnt lgkmcnt(8)
    v_mfma_f32_16x16x32_bf16 v[64:67], v[128:131], v[144:147], v[64:67]
    v_mfma_f32_16x16x32_bf16 v[68:71], v[128:131], v[148:151], v[68:71]
    v_mfma_f32_16x16x32_bf16 v[72:75], v[128:131], v[152:155], v[72:75]
    v_mfma_f32_16x16x32_bf16 v[76:79], v[128:131], v[156:159], v[76:79]
    v_mfma_f32_16x16x32_bf16 v[80:83], v[132:135], v[144:147], v[80:83]
    v_mfma_f32_16x16x32_bf16 v[84:87], v[132:135], v[148:151], v[84:87]
    v_mfma_f32_16x16x32_bf16 v[88:91], v[132:135], v[152:155], v[88:91]
    v_mfma_f32_16x16x32_bf16 v[92:95], v[132:135], v[156:159], v[92:95]
    v_mfma_f32_16x16x32_bf16 v[96:99], v[136:139], v[144:147], v[96:99]
    v_mfma_f32_16x16x32_bf16 v[100:103], v[136:139], v[148:151], v[100:103]
    v_mfma_f32_16x16x32_bf16 v[104:107], v[136:139], v[152:155], v[104:107]
    v_mfma_f32_16x16x32_bf16 v[108:111], v[136:139], v[156:159], v[108:111]
    v_mfma_f32_16x16x32_bf16 v[112:115], v[140:143], v[144:147], v[112:115]
    v_mfma_f32_16x16x32_bf16 v[116:119], v[140:143], v[148:151], v[116:119]
    v_mfma_f32_16x16x32_bf16 v[120:123], v[140:143], v[152:155], v[120:123]
    v_mfma_f32_16x16x32_bf16 v[124:127], v[140:143], v[156:159], v[124:127]
    s_waitcnt vmcnt(4)
    s_barrier
    s_add_u32 s13, s17, 49152
    s_mov_b32 m0, s13
    s_mov_b32 s13, 7168
    buffer_load_dwordx4 v4, s[8:11], s13 offen offset:0 lds
    buffer_load_dwordx4 v5, s[8:11], s13 offen offset:1024 lds
    buffer_load_dwordx4 v6, s[8:11], s13 offen offset:2048 lds
    buffer_load_dwordx4 v7, s[8:11], s13 offen offset:3072 lds
    ds_read_b128 v[128:131], v9 offset:16384
    ds_read_b128 v[132:135], v9 offset:17408
    ds_read_b128 v[136:139], v9 offset:18432
    ds_read_b128 v[140:143], v9 offset:19456
    ds_read_b128 v[144:147], v10 offset:16384
    ds_read_b128 v[148:151], v10 offset:17408
    ds_read_b128 v[152:155], v10 offset:18432
    ds_read_b128 v[156:159], v10 offset:19456
    s_waitcnt lgkmcnt(8)
    v_mfma_f32_16x16x32_bf16 v[64:67], v[24:27], v[40:43], v[64:67]
    v_mfma_f32_16x16x32_bf16 v[68:71], v[24:27], v[44:47], v[68:71]
    v_mfma_f32_16x16x32_bf16 v[72:75], v[24:27], v[48:51], v[72:75]
    v_mfma_f32_16x16x32_bf16 v[76:79], v[24:27], v[52:55], v[76:79]
    v_mfma_f32_16x16x32_bf16 v[80:83], v[28:31], v[40:43], v[80:83]
    v_mfma_f32_16x16x32_bf16 v[84:87], v[28:31], v[44:47], v[84:87]
    v_mfma_f32_16x16x32_bf16 v[88:91], v[28:31], v[48:51], v[88:91]
    v_mfma_f32_16x16x32_bf16 v[92:95], v[28:31], v[52:55], v[92:95]
    v_mfma_f32_16x16x32_bf16 v[96:99], v[32:35], v[40:43], v[96:99]
    v_mfma_f32_16x16x32_bf16 v[100:103], v[32:35], v[44:47], v[100:103]
    v_mfma_f32_16x16x32_bf16 v[104:107], v[32:35], v[48:51], v[104:107]
    v_mfma_f32_16x16x32_bf16 v[108:111], v[32:35], v[52:55], v[108:111]
    v_mfma_f32_16x16x32_bf16 v[112:115], v[36:39], v[40:43], v[112:115]
    v_mfma_f32_16x16x32_bf16 v[116:119], v[36:39], v[44:47], v[116:119]
    v_mfma_f32_16x16x32_bf16 v[120:123], v[36:39], v[48:51], v[120:123]
    v_mfma_f32_16x16x32_bf16 v[124:127], v[36:39], v[52:55], v[124:127]
    s_waitcnt vmcnt(4)
    s_barrier
    s_add_u32 s13, s17, 0
    s_mov_b32 m0, s13
    s_mov_b32 s13, 8192
    buffer_load_dwordx4 v4, s[8:11], s13 offen offset:0 lds
    buffer_load_dwordx4 v5, s[8:11], s13 offen offset:1024 lds
    buffer_load_dwordx4 v6, s[8:11], s13 offen offset:2048 lds
    buffer_load_dwordx4 v7, s[8:11], s13 offen offset:3072 lds
    ds_read_b128 v[24:27], v9 offset:32768
    ds_read_b128 v[28:31], v9 offset:33792
    ds_read_b128 v[32:35], v9 offset:34816
    ds_read_b128 v[36:39], v9 offset:35840
    ds_read_b128 v[40:43], v10 offset:32768
    ds_read_b128 v[44:47], v10 offset:33792
    ds_read_b128 v[48:51], v10 offset:34816
    ds_read_b128 v[52:55], v10 offset:35840
    s_waitcnt lgkmcnt(8)
    v_mfma_f32_16x16x32_bf16 v[64:67], v[128:131], v[144:147], v[64:67]
    v_mfma_f32_16x16x32_bf16 v[68:71], v[128:131], v[148:151], v[68:71]
    v_mfma_f32_16x16x32_bf16 v[72:75], v[128:131], v[152:155], v[72:75]
    v_mfma_f32_16x16x32_bf16 v[76:79], v[128:131], v[156:159], v[76:79]
    v_mfma_f32_16x16x32_bf16 v[80:83], v[132:135], v[144:147], v[80:83]
    v_mfma_f32_16x16x32_bf16 v[84:87], v[132:135], v[148:151], v[84:87]
    v_mfma_f32_16x16x32_bf16 v[88:91], v[132:135], v[152:155], v[88:91]
    v_mfma_f32_16x16x32_bf16 v[92:95], v[132:135], v[156:159], v[92:95]
    v_mfma_f32_16x16x32_bf16 v[96:99], v[136:139], v[144:147], v[96:99]
    v_mfma_f32_16x16x32_bf16 v[100:103], v[136:139], v[148:151], v[100:103]
    v_mfma_f32_16x16x32_bf16 v[104:107], v[136:139], v[152:155], v[104:107]
    v_mfma_f32_16x16x32_bf16 v[108:111], v[136:139], v[156:159], v[108:111]
    v_mfma_f32_16x16x32_bf16 v[112:115], v[140:143], v[144:147], v[112:115]
    v_mfma_f32_16x16x32_bf16 v[116:119], v[140:143], v[148:151], v[116:119]
    v_mfma_f32_16x16x32_bf16 v[120:123], v[140:143], v[152:155], v[120:123]
    v_mfma_f32_16x16x32_bf16 v[124:127], v[140:143], v[156:159], v[124:127]
    s_waitcnt vmcnt(4)
    s_barrier
    s_add_u32 s13, s17, 16384
    s_mov_b32 m0, s13
    s_mov_b32 s13, 9216
    buffer_load_dwordx4 v4, s[8:11], s13 offen offset:0 lds
    buffer_load_dwordx4 v5, s[8:11], s13 offen offset:1024 lds
    buffer_load_dwordx4 v6, s[8:11], s13 offen offset:2048 lds
    buffer_load_dwordx4 v7, s[8:11], s13 offen offset:3072 lds
    ds_read_b128 v[128:131], v9 offset:49152
    ds_read_b128 v[132:135], v9 offset:50176
    ds_read_b128 v[136:139], v9 offset:51200
    ds_read_b128 v[140:143], v9 offset:52224
    ds_read_b128 v[144:147], v10 offset:49152
    ds_read_b128 v[148:151], v10 offset:50176
    ds_read_b128 v[152:155], v10 offset:51200
    ds_read_b128 v[156:159], v10 offset:52224
    s_waitcnt lgkmcnt(8)
    v_mfma_f32_16x16x32_bf16 v[64:67], v[24:27], v[40:43], v[64:67]
    v_mfma_f32_16x16x32_bf16 v[68:71], v[24:27], v[44:47], v[68:71]
    v_mfma_f32_16x16x32_bf16 v[72:75], v[24:27], v[48:51], v[72:75]
    v_mfma_f32_16x16x32_bf16 v[76:79], v[24:27], v[52:55], v[76:79]
    v_mfma_f32_16x16x32_bf16 v[80:83], v[28:31], v[40:43], v[80:83]
    v_mfma_f32_16x16x32_bf16 v[84:87], v[28:31], v[44:47], v[84:87]
    v_mfma_f32_16x16x32_bf16 v[88:91], v[28:31], v[48:51], v[88:91]
    v_mfma_f32_16x16x32_bf16 v[92:95], v[28:31], v[52:55], v[92:95]
    v_mfma_f32_16x16x32_bf16 v[96:99], v[32:35], v[40:43], v[96:99]
    v_mfma_f32_16x16x32_bf16 v[100:103], v[32:35], v[44:47], v[100:103]
    v_mfma_f32_16x16x32_bf16 v[104:107], v[32:35], v[48:51], v[104:107]
    v_mfma_f32_16x16x32_bf16 v[108:111], v[32:35], v[52:55], v[108:111]
    v_mfma_f32_16x16x32_bf16 v[112:115], v[36:39], v[40:43], v[112:115]
    v_mfma_f32_16x16x32_bf16 v[116:119], v[36:39], v[44:47], v[116:119]
    v_mfma_f32_16x16x32_bf16 v[120:123], v[36:39], v[48:51], v[120:123]
    v_mfma_f32_16x16x32_bf16 v[124:127], v[36:39], v[52:55], v[124:127]
    s_waitcnt vmcnt(4)
    s_barrier
    s_add_u32 s13, s17, 32768
    s_mov_b32 m0, s13
    s_mov_b32 s13, 10240
    buffer_load_dwordx4 v4, s[8:11], s13 offen offset:0 lds
    buffer_load_dwordx4 v5, s[8:11], s13 offen offset:1024 lds
    buffer_load_dwordx4 v6, s[8:11], s13 offen offset:2048 lds
    buffer_load_dwordx4 v7, s[8:11], s13 offen offset:3072 lds
    ds_read_b128 v[24:27], v9 offset:0
    ds_read_b128 v[28:31], v9 offset:1024
    ds_read_b128 v[32:35], v9 offset:2048
    ds_read_b128 v[36:39], v9 offset:3072
    ds_read_b128 v[40:43], v10 offset:0
    ds_read_b128 v[44:47], v10 offset:1024
    ds_read_b128 v[48:51], v10 offset:2048
    ds_read_b128 v[52:55], v10 offset:3072
    s_waitcnt lgkmcnt(8)
    v_mfma_f32_16x16x32_bf16 v[64:67], v[128:131], v[144:147], v[64:67]
    v_mfma_f32_16x16x32_bf16 v[68:71], v[128:131], v[148:151], v[68:71]
    v_mfma_f32_16x16x32_bf16 v[72:75], v[128:131], v[152:155], v[72:75]
    v_mfma_f32_16x16x32_bf16 v[76:79], v[128:131], v[156:159], v[76:79]
    v_mfma_f32_16x16x32_bf16 v[80:83], v[132:135], v[144:147], v[80:83]
    v_mfma_f32_16x16x32_bf16 v[84:87], v[132:135], v[148:151], v[84:87]
    v_mfma_f32_16x16x32_bf16 v[88:91], v[132:135], v[152:155], v[88:91]
    v_mfma_f32_16x16x32_bf16 v[92:95], v[132:135], v[156:159], v[92:95]
    v_mfma_f32_16x16x32_bf16 v[96:99], v[136:139], v[144:147], v[96:99]
    v_mfma_f32_16x16x32_bf16 v[100:103], v[136:139], v[148:151], v[100:103]
    v_mfma_f32_16x16x32_bf16 v[104:107], v[136:139], v[152:155], v[104:107]
    v_mfma_f32_16x16x32_bf16 v[108:111], v[136:139], v[156:159], v[108:111]
    v_mfma_f32_16x16x32_bf16 v[112:115], v[140:143], v[144:147], v[112:115]
    v_mfma_f32_16x16x32_bf16 v[116:119], v[140:143], v[148:151], v[116:119]
    v_mfma_f32_16x16x32_bf16 v[120:123], v[140:143], v[152:155], v[120:123]
    v_mfma_f32_16x16x32_bf16 v[124:127], v[140:143], v[156:159], v[124:127]
    s_waitcnt vmcnt(4)
    s_barrier
    s_add_u32 s13, s17, 49152
    s_mov_b32 m0, s13
    s_mov_b32 s13, 11264
    buffer_load_dwordx4 v4, s[8:11], s13 offen offset:0 lds
    buffer_load_dwordx4 v5, s[8:11], s13 offen offset:1024 lds
    buffer_load_dwordx4 v6, s[8:11], s13 offen offset:2048 lds
    buffer_load_dwordx4 v7, s[8:11], s13 offen offset:3072 lds
    ds_read_b128 v[128:131], v9 offset:16384
    ds_read_b128 v[132:135], v9 offset:17408
    ds_read_b128 v[136:139], v9 offset:18432
    ds_read_b128 v[140:143], v9 offset:19456
    ds_read_b128 v[144:147], v10 offset:16384
    ds_read_b128 v[148:151], v10 offset:17408
    ds_read_b128 v[152:155], v10 offset:18432
    ds_read_b128 v[156:159], v10 offset:19456
    s_waitcnt lgkmcnt(8)
    v_mfma_f32_16x16x32_bf16 v[64:67], v[24:27], v[40:43], v[64:67]
    v_mfma_f32_16x16x32_bf16 v[68:71], v[24:27], v[44:47], v[68:71]
    v_mfma_f32_16x16x32_bf16 v[72:75], v[24:27], v[48:51], v[72:75]
    v_mfma_f32_16x16x32_bf16 v[76:79], v[24:27], v[52:55], v[76:79]
    v_mfma_f32_16x16x32_bf16 v[80:83], v[28:31], v[40:43], v[80:83]
    v_mfma_f32_16x16x32_bf16 v[84:87], v[28:31], v[44:47], v[84:87]
    v_mfma_f32_16x16x32_bf16 v[88:91], v[28:31], v[48:51], v[88:91]
    v_mfma_f32_16x16x32_bf16 v[92:95], v[28:31], v[52:55], v[92:95]
    v_mfma_f32_16x16x32_bf16 v[96:99], v[32:35], v[40:43], v[96:99]
    v_mfma_f32_16x16x32_bf16 v[100:103], v[32:35], v[44:47], v[100:103]
    v_mfma_f32_16x16x32_bf16 v[104:107], v[32:35], v[48:51], v[104:107]
    v_mfma_f32_16x16x32_bf16 v[108:111], v[32:35], v[52:55], v[108:111]
    v_mfma_f32_16x16x32_bf16 v[112:115], v[36:39], v[40:43], v[112:115]
    v_mfma_f32_16x16x32_bf16 v[116:119], v[36:39], v[44:47], v[116:119]
    v_mfma_f32_16x16x32_bf16 v[120:123], v[36:39], v[48:51], v[120:123]
    v_mfma_f32_16x16x32_bf16 v[124:127], v[36:39], v[52:55], v[124:127]
    s_waitcnt vmcnt(4)
    s_barrier
    s_add_u32 s13, s17, 0
    s_mov_b32 m0, s13
    s_mov_b32 s13, 12288
    buffer_load_dwordx4 v4, s[8:11], s13 offen offset:0 lds
    buffer_load_dwordx4 v5, s[8:11], s13 offen offset:1024 lds
    buffer_load_dwordx4 v6, s[8:11], s13 offen offset:2048 lds
    buffer_load_dwordx4 v7, s[8:11], s13 offen offset:3072 lds
    ds_read_b128 v[24:27], v9 offset:32768
    ds_read_b128 v[28:31], v9 offset:33792
    ds_read_b128 v[32:35], v9 offset:34816
    ds_read_b128 v[36:39], v9 offset:35840
    ds_read_b128 v[40:43], v10 offset:32768
    ds_read_b128 v[44:47], v10 offset:33792
    ds_read_b128 v[48:51], v10 offset:34816
    ds_read_b128 v[52:55], v10 offset:35840
    s_waitcnt lgkmcnt(8)
    v_mfma_f32_16x16x32_bf16 v[64:67], v[128:131], v[144:147], v[64:67]
    v_mfma_f32_16x16x32_bf16 v[68:71], v[128:131], v[148:151], v[68:71]
    v_mfma_f32_16x16x32_bf16 v[72:75], v[128:131], v[152:155], v[72:75]
    v_mfma_f32_16x16x32_bf16 v[76:79], v[128:131], v[156:159], v[76:79]
    v_mfma_f32_16x16x32_bf16 v[80:83], v[132:135], v[144:147], v[80:83]
    v_mfma_f32_16x16x32_bf16 v[84:87], v[132:135], v[148:151], v[84:87]
    v_mfma_f32_16x16x32_bf16 v[88:91], v[132:135], v[152:155], v[88:91]
    v_mfma_f32_16x16x32_bf16 v[92:95], v[132:135], v[156:159], v[92:95]
    v_mfma_f32_16x16x32_bf16 v[96:99], v[136:139], v[144:147], v[96:99]
    v_mfma_f32_16x16x32_bf16 v[100:103], v[136:139], v[148:151], v[100:103]
    v_mfma_f32_16x16x32_bf16 v[104:107], v[136:139], v[152:155], v[104:107]
    v_mfma_f32_16x16x32_bf16 v[108:111], v[136:139], v[156:159], v[108:111]
    v_mfma_f32_16x16x32_bf16 v[112:115], v[140:143], v[144:147], v[112:115]
    v_mfma_f32_16x16x32_bf16 v[116:119], v[140:143], v[148:151], v[116:119]
    v_mfma_f32_16x16x32_bf16 v[120:123], v[140:143], v[152:155], v[120:123]
    v_mfma_f32_16x16x32_bf16 v[124:127], v[140:143], v[156:159], v[124:127]
    s_waitcnt vmcnt(4)
    s_barrier
    s_add_u32 s13, s17, 16384
    s_mov_b32 m0, s13
    s_mov_b32 s13, 13312
    buffer_load_dwordx4 v4, s[8:11], s13 offen offset:0 lds
    buffer_load_dwordx4 v5, s[8:11], s13 offen offset:1024 lds
    buffer_load_dwordx4 v6, s[8:11], s13 offen offset:2048 lds
    buffer_load_dwordx4 v7, s[8:11], s13 offen offset:3072 lds
    ds_read_b128 v[128:131], v9 offset:49152
    ds_read_b128 v[132:135], v9 offset:50176
    ds_read_b128 v[136:139], v9 offset:51200
    ds_read_b128 v[140:143], v9 offset:52224
    ds_read_b128 v[144:147], v10 offset:49152
    ds_read_b128 v[148:151], v10 offset:50176
    ds_read_b128 v[152:155], v10 offset:51200
    ds_read_b128 v[156:159], v10 offset:52224
    s_waitcnt lgkmcnt(8)
    v_mfma_f32_16x16x32_bf16 v[64:67], v[24:27], v[40:43], v[64:67]
    v_mfma_f32_16x16x32_bf16 v[68:71], v[24:27], v[44:47], v[68:71]
    v_mfma_f32_16x16x32_bf16 v[72:75], v[24:27], v[48:51], v[72:75]
    v_mfma_f32_16x16x32_bf16 v[76:79], v[24:27], v[52:55], v[76:79]
    v_mfma_f32_16x16x32_bf16 v[80:83], v[28:31], v[40:43], v[80:83]
    v_mfma_f32_16x16x32_bf16 v[84:87], v[28:31], v[44:47], v[84:87]
    v_mfma_f32_16x16x32_bf16 v[88:91], v[28:31], v[48:51], v[88:91]
    v_mfma_f32_16x16x32_bf16 v[92:95], v[28:31], v[52:55], v[92:95]
    v_mfma_f32_16x16x32_bf16 v[96:99], v[32:35], v[40:43], v[96:99]
    v_mfma_f32_16x16x32_bf16 v[100:103], v[32:35], v[44:47], v[100:103]
    v_mfma_f32_16x16x32_bf16 v[104:107], v[32:35], v[48:51], v[104:107]
    v_mfma_f32_16x16x32_bf16 v[108:111], v[32:35], v[52:55], v[108:111]
    v_mfma_f32_16x16x32_bf16 v[112:115], v[36:39], v[40:43], v[112:115]
    v_mfma_f32_16x16x32_bf16 v[116:119], v[36:39], v[44:47], v[116:119]
    v_mfma_f32_16x16x32_bf16 v[120:123], v[36:39], v[48:51], v[120:123]
    v_mfma_f32_16x16x32_bf16 v[124:127], v[36:39], v[52:55], v[124:127]
    s_waitcnt vmcnt(4)
    s_barrier
    s_add_u32 s13, s17, 32768
    s_mov_b32 m0, s13
    s_mov_b32 s13, 14336
    buffer_load_dwordx4 v4, s[8:11], s13 offen offset:0 lds
    buffer_load_dwordx4 v5, s[8:11], s13 offen offset:1024 lds
    buffer_load_dwordx4 v6, s[8:11], s13 offen offset:2048 lds
    buffer_load_dwordx4 v7, s[8:11], s13 offen offset:3072 lds
    ds_read_b128 v[24:27], v9 offset:0
    ds_read_b128 v[28:31], v9 offset:1024
    ds_read_b128 v[32:35], v9 offset:2048
    ds_read_b128 v[36:39], v9 offset:3072
    ds_read_b128 v[40:43], v10 offset:0
    ds_read_b128 v[44:47], v10 offset:1024
    ds_read_b128 v[48:51], v10 offset:2048
    ds_read_b128 v[52:55], v10 offset:3072
    s_waitcnt lgkmcnt(8)
    v_mfma_f32_16x16x32_bf16 v[64:67], v[128:131], v[144:147], v[64:67]
    v_mfma_f32_16x16x32_bf16 v[68:71], v[128:131], v[148:151], v[68:71]
    v_mfma_f32_16x16x32_bf16 v[72:75], v[128:131], v[152:155], v[72:75]
    v_mfma_f32_16x16x32_bf16 v[76:79], v[128:131], v[156:159], v[76:79]
    v_mfma_f32_16x16x32_bf16 v[80:83], v[132:135], v[144:147], v[80:83]
    v_mfma_f32_16x16x32_bf16 v[84:87], v[132:135], v[148:151], v[84:87]
    v_mfma_f32_16x16x32_bf16 v[88:91], v[132:135], v[152:155], v[88:91]
    v_mfma_f32_16x16x32_bf16 v[92:95], v[132:135], v[156:159], v[92:95]
    v_mfma_f32_16x16x32_bf16 v[96:99], v[136:139], v[144:147], v[96:99]
    v_mfma_f32_16x16x32_bf16 v[100:103], v[136:139], v[148:151], v[100:103]
    v_mfma_f32_16x16x32_bf16 v[104:107], v[136:139], v[152:155], v[104:107]
    v_mfma_f32_16x16x32_bf16 v[108:111], v[136:139], v[156:159], v[108:111]
    v_mfma_f32_16x16x32_bf16 v[112:115], v[140:143], v[144:147], v[112:115]
    v_mfma_f32_16x16x32_bf16 v[116:119], v[140:143], v[148:151], v[116:119]
    v_mfma_f32_16x16x32_bf16 v[120:123], v[140:143], v[152:155], v[120:123]
    v_mfma_f32_16x16x32_bf16 v[124:127], v[140:143], v[156:159], v[124:127]
    s_waitcnt vmcnt(4)
    s_barrier
    s_add_u32 s13, s17, 49152
    s_mov_b32 m0, s13
    s_mov_b32 s13, 15360
    buffer_load_dwordx4 v4, s[8:11], s13 offen offset:0 lds
    buffer_load_dwordx4 v5, s[8:11], s13 offen offset:1024 lds
    buffer_load_dwordx4 v6, s[8:11], s13 offen offset:2048 lds
    buffer_load_dwordx4 v7, s[8:11], s13 offen offset:3072 lds
    ds_read_b128 v[128:131], v9 offset:16384
    ds_read_b128 v[132:135], v9 offset:17408
    ds_read_b128 v[136:139], v9 offset:18432
    ds_read_b128 v[140:143], v9 offset:19456
    ds_read_b128 v[144:147], v10 offset:16384
    ds_read_b128 v[148:151], v10 offset:17408
    ds_read_b128 v[152:155], v10 offset:18432
    ds_read_b128 v[156:159], v10 offset:19456
    s_waitcnt lgkmcnt(8)
    v_mfma_f32_16x16x32_bf16 v[64:67], v[24:27], v[40:43], v[64:67]
    v_mfma_f32_16x16x32_bf16 v[68:71], v[24:27], v[44:47], v[68:71]
    v_mfma_f32_16x16x32_bf16 v[72:75], v[24:27], v[48:51], v[72:75]
    v_mfma_f32_16x16x32_bf16 v[76:79], v[24:27], v[52:55], v[76:79]
    v_mfma_f32_16x16x32_bf16 v[80:83], v[28:31], v[40:43], v[80:83]
    v_mfma_f32_16x16x32_bf16 v[84:87], v[28:31], v[44:47], v[84:87]
    v_mfma_f32_16x16x32_bf16 v[88:91], v[28:31], v[48:51], v[88:91]
    v_mfma_f32_16x16x32_bf16 v[92:95], v[28:31], v[52:55], v[92:95]
    v_mfma_f32_16x16x32_bf16 v[96:99], v[32:35], v[40:43], v[96:99]
    v_mfma_f32_16x16x32_bf16 v[100:103], v[32:35], v[44:47], v[100:103]
    v_mfma_f32_16x16x32_bf16 v[104:107], v[32:35], v[48:51], v[104:107]
    v_mfma_f32_16x16x32_bf16 v[108:111], v[32:35], v[52:55], v[108:111]
    v_mfma_f32_16x16x32_bf16 v[112:115], v[36:39], v[40:43], v[112:115]
    v_mfma_f32_16x16x32_bf16 v[116:119], v[36:39], v[44:47], v[116:119]
    v_mfma_f32_16x16x32_bf16 v[120:123], v[36:39], v[48:51], v[120:123]
    v_mfma_f32_16x16x32_bf16 v[124:127], v[36:39], v[52:55], v[124:127]
    s_waitcnt vmcnt(4)
    s_barrier
    ds_read_b128 v[24:27], v9 offset:32768
    ds_read_b128 v[28:31], v9 offset:33792
    ds_read_b128 v[32:35], v9 offset:34816
    ds_read_b128 v[36:39], v9 offset:35840
    ds_read_b128 v[40:43], v10 offset:32768
    ds_read_b128 v[44:47], v10 offset:33792
    ds_read_b128 v[48:51], v10 offset:34816
    ds_read_b128 v[52:55], v10 offset:35840
    s_waitcnt lgkmcnt(8)
    v_mfma_f32_16x16x32_bf16 v[64:67], v[128:131], v[144:147], v[64:67]
    v_mfma_f32_16x16x32_bf16 v[68:71], v[128:131], v[148:151], v[68:71]
    v_mfma_f32_16x16x32_bf16 v[72:75], v[128:131], v[152:155], v[72:75]
    v_mfma_f32_16x16x32_bf16 v[76:79], v[128:131], v[156:159], v[76:79]
    v_mfma_f32_16x16x32_bf16 v[80:83], v[132:135], v[144:147], v[80:83]
    v_mfma_f32_16x16x32_bf16 v[84:87], v[132:135], v[148:151], v[84:87]
    v_mfma_f32_16x16x32_bf16 v[88:91], v[132:135], v[152:155], v[88:91]
    v_mfma_f32_16x16x32_bf16 v[92:95], v[132:135], v[156:159], v[92:95]
    v_mfma_f32_16x16x32_bf16 v[96:99], v[136:139], v[144:147], v[96:99]
    v_mfma_f32_16x16x32_bf16 v[100:103], v[136:139], v[148:151], v[100:103]
    v_mfma_f32_16x16x32_bf16 v[104:107], v[136:139], v[152:155], v[104:107]
    v_mfma_f32_16x16x32_bf16 v[108:111], v[136:139], v[156:159], v[108:111]
    v_mfma_f32_16x16x32_bf16 v[112:115], v[140:143], v[144:147], v[112:115]
    v_mfma_f32_16x16x32_bf16 v[116:119], v[140:143], v[148:151], v[116:119]
    v_mfma_f32_16x16x32_bf16 v[120:123], v[140:143], v[152:155], v[120:123]
    v_mfma_f32_16x16x32_bf16 v[124:127], v[140:143], v[156:159], v[124:127]
    s_waitcnt vmcnt(0)
    s_barrier
    ds_read_b128 v[128:131], v9 offset:49152
    ds_read_b128 v[132:135], v9 offset:50176
    ds_read_b128 v[136:139], v9 offset:51200
    ds_read_b128 v[140:143], v9 offset:52224
    ds_read_b128 v[144:147], v10 offset:49152
    ds_read_b128 v[148:151], v10 offset:50176
    ds_read_b128 v[152:155], v10 offset:51200
    ds_read_b128 v[156:159], v10 offset:52224
    s_waitcnt lgkmcnt(8)
    v_mfma_f32_16x16x32_bf16 v[64:67], v[24:27], v[40:43], v[64:67]
    v_mfma_f32_16x16x32_bf16 v[68:71], v[24:27], v[44:47], v[68:71]
    v_mfma_f32_16x16x32_bf16 v[72:75], v[24:27], v[48:51], v[72:75]
    v_mfma_f32_16x16x32_bf16 v[76:79], v[24:27], v[52:55], v[76:79]
    v_mfma_f32_16x16x32_bf16 v[80:83], v[28:31], v[40:43], v[80:83]
    v_mfma_f32_16x16x32_bf16 v[84:87], v[28:31], v[44:47], v[84:87]
    v_mfma_f32_16x16x32_bf16 v[88:91], v[28:31], v[48:51], v[88:91]
    v_mfma_f32_16x16x32_bf16 v[92:95], v[28:31], v[52:55], v[92:95]
    v_mfma_f32_16x16x32_bf16 v[96:99], v[32:35], v[40:43], v[96:99]
    v_mfma_f32_16x16x32_bf16 v[100:103], v[32:35], v[44:47], v[100:103]
    v_mfma_f32_16x16x32_bf16 v[104:107], v[32:35], v[48:51], v[104:107]
    v_mfma_f32_16x16x32_bf16 v[108:111], v[32:35], v[52:55], v[108:111]
    v_mfma_f32_16x16x32_bf16 v[112:115], v[36:39], v[40:43], v[112:115]
    v_mfma_f32_16x16x32_bf16 v[116:119], v[36:39], v[44:47], v[116:119]
    v_mfma_f32_16x16x32_bf16 v[120:123], v[36:39], v[48:51], v[120:123]
    v_mfma_f32_16x16x32_bf16 v[124:127], v[36:39], v[52:55], v[124:127]
    s_waitcnt lgkmcnt(0)
    v_mfma_f32_16x16x32_bf16 v[64:67], v[128:131], v[144:147], v[64:67]
    v_mfma_f32_16x16x32_bf16 v[68:71], v[128:131], v[148:151], v[68:71]
    v_mfma_f32_16x16x32_bf16 v[72:75], v[128:131], v[152:155], v[72:75]
    v_mfma_f32_16x16x32_bf16 v[76:79], v[128:131], v[156:159], v[76:79]
    v_mfma_f32_16x16x32_bf16 v[80:83], v[132:135], v[144:147], v[80:83]
    v_mfma_f32_16x16x32_bf16 v[84:87], v[132:135], v[148:151], v[84:87]
    v_mfma_f32_16x16x32_bf16 v[88:91], v[132:135], v[152:155], v[88:91]
    v_mfma_f32_16x16x32_bf16 v[92:95], v[132:135], v[156:159], v[92:95]
    v_mfma_f32_16x16x32_bf16 v[96:99], v[136:139], v[144:147], v[96:99]
    v_mfma_f32_16x16x32_bf16 v[100:103], v[136:139], v[148:151], v[100:103]
    v_mfma_f32_16x16x32_bf16 v[104:107], v[136:139], v[152:155], v[104:107]
    v_mfma_f32_16x16x32_bf16 v[108:111], v[136:139], v[156:159], v[108:111]
    v_mfma_f32_16x16x32_bf16 v[112:115], v[140:143], v[144:147], v[112:115]
    v_mfma_f32_16x16x32_bf16 v[116:119], v[140:143], v[148:151], v[116:119]
    v_mfma_f32_16x16x32_bf16 v[120:123], v[140:143], v[152:155], v[120:123]
    v_mfma_f32_16x16x32_bf16 v[124:127], v[140:143], v[156:159], v[124:127]
    s_nop 7
    s_nop 1
    v_mov_b32 v16, 0x3f803f80
    v_mov_b32 v17, 0x3f803f80
    v_mov_b32 v18, 0x3f803f80
    v_mov_b32 v19, 0x3f803f80
    v_cvt_pk_bf16_f32 v11, v64, v65
    v_lshlrev_b32 v64, 16, v11
    v_and_b32 v65, 0xffff0000, v11
    v_mul_f32 v12, s30, v64
    v_exp_f32 v12, v12
    v_add_f32 v13, 1.0, v64
    v_cmp_lt_f32 vcc, 0, v64
    s_nop 1
    v_cndmask_b32 v64, v12, v13, vcc
    v_mul_f32 v12, s30, v65
    v_exp_f32 v12, v12
    v_add_f32 v13, 1.0, v65
    v_cmp_lt_f32 vcc, 0, v65
    s_nop 1
    v_cndmask_b32 v65, v12, v13, vcc
    v_cvt_pk_bf16_f32 v11, v64, v65
    v_lshlrev_b32 v64, 16, v11
    v_and_b32 v65, 0xffff0000, v11
    v_add_f32 v64, 0x358637bd, v64
    v_add_f32 v65, 0x358637bd, v65
    v_cvt_pk_bf16_f32 v11, v64, v65
    v_lshlrev_b32 v64, 16, v11
    v_and_b32 v65, 0xffff0000, v11
    v_cvt_pk_bf16_f32 v11, v66, v67
    v_lshlrev_b32 v66, 16, v11
    v_and_b32 v67, 0xffff0000, v11
    v_mul_f32 v12, s30, v66
    v_exp_f32 v12, v12
    v_add_f32 v13, 1.0, v66
    v_cmp_lt_f32 vcc, 0, v66
    s_nop 1
    v_cndmask_b32 v66, v12, v13, vcc
    v_mul_f32 v12, s30, v67
    v_exp_f32 v12, v12
    v_add_f32 v13, 1.0, v67
    v_cmp_lt_f32 vcc, 0, v67
    s_nop 1
    v_cndmask_b32 v67, v12, v13, vcc
    v_cvt_pk_bf16_f32 v11, v66, v67
    v_lshlrev_b32 v66, 16, v11
    v_and_b32 v67, 0xffff0000, v11
    v_add_f32 v66, 0x358637bd, v66
    v_add_f32 v67, 0x358637bd, v67
    v_cvt_pk_bf16_f32 v11, v66, v67
    v_lshlrev_b32 v66, 16, v11
    v_and_b32 v67, 0xffff0000, v11
    v_cvt_pk_bf16_f32 v11, v68, v69
    v_lshlrev_b32 v68, 16, v11
    v_and_b32 v69, 0xffff0000, v11
    v_mul_f32 v12, s30, v68
    v_exp_f32 v12, v12
    v_add_f32 v13, 1.0, v68
    v_cmp_lt_f32 vcc, 0, v68
    s_nop 1
    v_cndmask_b32 v68, v12, v13, vcc
    v_mul_f32 v12, s30, v69
    v_exp_f32 v12, v12
    v_add_f32 v13, 1.0, v69
    v_cmp_lt_f32 vcc, 0, v69
    s_nop 1
    v_cndmask_b32 v69, v12, v13, vcc
    v_cvt_pk_bf16_f32 v11, v68, v69
    v_lshlrev_b32 v68, 16, v11
    v_and_b32 v69, 0xffff0000, v11
    v_add_f32 v68, 0x358637bd, v68
    v_add_f32 v69, 0x358637bd, v69
    v_cvt_pk_bf16_f32 v11, v68, v69
    v_lshlrev_b32 v68, 16, v11
    v_and_b32 v69, 0xffff0000, v11
    v_cvt_pk_bf16_f32 v11, v70, v71
    v_lshlrev_b32 v70, 16, v11
    v_and_b32 v71, 0xffff0000, v11
    v_mul_f32 v12, s30, v70
    v_exp_f32 v12, v12
    v_add_f32 v13, 1.0, v70
    v_cmp_lt_f32 vcc, 0, v70
    s_nop 1
    v_cndmask_b32 v70, v12, v13, vcc
    v_mul_f32 v12, s30, v71
    v_exp_f32 v12, v12
    v_add_f32 v13, 1.0, v71
    v_cmp_lt_f32 vcc, 0, v71
    s_nop 1
    v_cndmask_b32 v71, v12, v13, vcc
    v_cvt_pk_bf16_f32 v11, v70, v71
    v_lshlrev_b32 v70, 16, v11
    v_and_b32 v71, 0xffff0000, v11
    v_add_f32 v70, 0x358637bd, v70
    v_add_f32 v71, 0x358637bd, v71
    v_cvt_pk_bf16_f32 v11, v70, v71
    v_lshlrev_b32 v70, 16, v11
    v_and_b32 v71, 0xffff0000, v11
    v_cvt_pk_bf16_f32 v11, v80, v81
    v_lshlrev_b32 v80, 16, v11
    v_and_b32 v81, 0xffff0000, v11
    v_mul_f32 v12, s30, v80
    v_exp_f32 v12, v12
    v_add_f32 v13, 1.0, v80
    v_cmp_lt_f32 vcc, 0, v80
    s_nop 1
    v_cndmask_b32 v80, v12, v13, vcc
    v_mul_f32 v12, s30, v81
    v_exp_f32 v12, v12
    v_add_f32 v13, 1.0, v81
    v_cmp_lt_f32 vcc, 0, v81
    s_nop 1
    v_cndmask_b32 v81, v12, v13, vcc
    v_cvt_pk_bf16_f32 v11, v80, v81
    v_lshlrev_b32 v80, 16, v11
    v_and_b32 v81, 0xffff0000, v11
    v_add_f32 v80, 0x358637bd, v80
    v_add_f32 v81, 0x358637bd, v81
    v_cvt_pk_bf16_f32 v11, v80, v81
    v_lshlrev_b32 v80, 16, v11
    v_and_b32 v81, 0xffff0000, v11
    v_cvt_pk_bf16_f32 v11, v82, v83
    v_lshlrev_b32 v82, 16, v11
    v_and_b32 v83, 0xffff0000, v11
    v_mul_f32 v12, s30, v82
    v_exp_f32 v12, v12
    v_add_f32 v13, 1.0, v82
    v_cmp_lt_f32 vcc, 0, v82
    s_nop 1
    v_cndmask_b32 v82, v12, v13, vcc
    v_mul_f32 v12, s30, v83
    v_exp_f32 v12, v12
    v_add_f32 v13, 1.0, v83
    v_cmp_lt_f32 vcc, 0, v83
    s_nop 1
    v_cndmask_b32 v83, v12, v13, vcc
    v_cvt_pk_bf16_f32 v11, v82, v83
    v_lshlrev_b32 v82, 16, v11
    v_and_b32 v83, 0xffff0000, v11
    v_add_f32 v82, 0x358637bd, v82
    v_add_f32 v83, 0x358637bd, v83
    v_cvt_pk_bf16_f32 v11, v82, v83
    v_lshlrev_b32 v82, 16, v11
    v_and_b32 v83, 0xffff0000, v11
    v_cvt_pk_bf16_f32 v11, v84, v85
    v_lshlrev_b32 v84, 16, v11
    v_and_b32 v85, 0xffff0000, v11
    v_mul_f32 v12, s30, v84
    v_exp_f32 v12, v12
    v_add_f32 v13, 1.0, v84
    v_cmp_lt_f32 vcc, 0, v84
    s_nop 1
    v_cndmask_b32 v84, v12, v13, vcc
    v_mul_f32 v12, s30, v85
    v_exp_f32 v12, v12
    v_add_f32 v13, 1.0, v85
    v_cmp_lt_f32 vcc, 0, v85
    s_nop 1
    v_cndmask_b32 v85, v12, v13, vcc
    v_cvt_pk_bf16_f32 v11, v84, v85
    v_lshlrev_b32 v84, 16, v11
    v_and_b32 v85, 0xffff0000, v11
    v_add_f32 v84, 0x358637bd, v84
    v_add_f32 v85, 0x358637bd, v85
    v_cvt_pk_bf16_f32 v11, v84, v85
    v_lshlrev_b32 v84, 16, v11
    v_and_b32 v85, 0xffff0000, v11
    v_cvt_pk_bf16_f32 v11, v86, v87
    v_lshlrev_b32 v86, 16, v11
    v_and_b32 v87, 0xffff0000, v11
    v_mul_f32 v12, s30, v86
    v_exp_f32 v12, v12
    v_add_f32 v13, 1.0, v86
    v_cmp_lt_f32 vcc, 0, v86
    s_nop 1
    v_cndmask_b32 v86, v12, v13, vcc
    v_mul_f32 v12, s30, v87
    v_exp_f32 v12, v12
    v_add_f32 v13, 1.0, v87
    v_cmp_lt_f32 vcc, 0, v87
    s_nop 1
    v_cndmask_b32 v87, v12, v13, vcc
    v_cvt_pk_bf16_f32 v11, v86, v87
    v_lshlrev_b32 v86, 16, v11
    v_and_b32 v87, 0xffff0000, v11
    v_add_f32 v86, 0x358637bd, v86
    v_add_f32 v87, 0x358637bd, v87
    v_cvt_pk_bf16_f32 v11, v86, v87
    v_lshlrev_b32 v86, 16, v11
    v_and_b32 v87, 0xffff0000, v11
    v_cvt_pk_bf16_f32 v11, v96, v97
    v_lshlrev_b32 v96, 16, v11
    v_and_b32 v97, 0xffff0000, v11
    v_mul_f32 v12, s30, v96
    v_exp_f32 v12, v12
    v_add_f32 v13, 1.0, v96
    v_cmp_lt_f32 vcc, 0, v96
    s_nop 1
    v_cndmask_b32 v96, v12, v13, vcc
    v_mul_f32 v12, s30, v97
    v_exp_f32 v12, v12
    v_add_f32 v13, 1.0, v97
    v_cmp_lt_f32 vcc, 0, v97
    s_nop 1
    v_cndmask_b32 v97, v12, v13, vcc
    v_cvt_pk_bf16_f32 v11, v96, v97
    v_lshlrev_b32 v96, 16, v11
    v_and_b32 v97, 0xffff0000, v11
    v_add_f32 v96, 0x358637bd, v96
    v_add_f32 v97, 0x358637bd, v97
    v_cvt_pk_bf16_f32 v11, v96, v97
    v_lshlrev_b32 v96, 16, v11
    v_and_b32 v97, 0xffff0000, v11
    v_cvt_pk_bf16_f32 v11, v98, v99
    v_lshlrev_b32 v98, 16, v11
    v_and_b32 v99, 0xffff0000, v11
    v_mul_f32 v12, s30, v98
    v_exp_f32 v12, v12
    v_add_f32 v13, 1.0, v98
    v_cmp_lt_f32 vcc, 0, v98
    s_nop 1
    v_cndmask_b32 v98, v12, v13, vcc
    v_mul_f32 v12, s30, v99
    v_exp_f32 v12, v12
    v_add_f32 v13, 1.0, v99
    v_cmp_lt_f32 vcc, 0, v99
    s_nop 1
    v_cndmask_b32 v99, v12, v13, vcc
    v_cvt_pk_bf16_f32 v11, v98, v99
    v_lshlrev_b32 v98, 16, v11
    v_and_b32 v99, 0xffff0000, v11
    v_add_f32 v98, 0x358637bd, v98
    v_add_f32 v99, 0x358637bd, v99
    v_cvt_pk_bf16_f32 v11, v98, v99
    v_lshlrev_b32 v98, 16, v11
    v_and_b32 v99, 0xffff0000, v11
    v_cvt_pk_bf16_f32 v11, v100, v101
    v_lshlrev_b32 v100, 16, v11
    v_and_b32 v101, 0xffff0000, v11
    v_mul_f32 v12, s30, v100
    v_exp_f32 v12, v12
    v_add_f32 v13, 1.0, v100
    v_cmp_lt_f32 vcc, 0, v100
    s_nop 1
    v_cndmask_b32 v100, v12, v13, vcc
    v_mul_f32 v12, s30, v101
    v_exp_f32 v12, v12
    v_add_f32 v13, 1.0, v101
    v_cmp_lt_f32 vcc, 0, v101
    s_nop 1
    v_cndmask_b32 v101, v12, v13, vcc
    v_cvt_pk_bf16_f32 v11, v100, v101
    v_lshlrev_b32 v100, 16, v11
    v_and_b32 v101, 0xffff0000, v11
    v_add_f32 v100, 0x358637bd, v100
    v_add_f32 v101, 0x358637bd, v101
    v_cvt_pk_bf16_f32 v11, v100, v101
    v_lshlrev_b32 v100, 16, v11
    v_and_b32 v101, 0xffff0000, v11
    v_cvt_pk_bf16_f32 v11, v102, v103
    v_lshlrev_b32 v102, 16, v11
    v_and_b32 v103, 0xffff0000, v11
    v_mul_f32 v12, s30, v102
    v_exp_f32 v12, v12
    v_add_f32 v13, 1.0, v102
    v_cmp_lt_f32 vcc, 0, v102
    s_nop 1
    v_cndmask_b32 v102, v12, v13, vcc
    v_mul_f32 v12, s30, v103
    v_exp_f32 v12, v12
    v_add_f32 v13, 1.0, v103
    v_cmp_lt_f32 vcc, 0, v103
    s_nop 1
    v_cndmask_b32 v103, v12, v13, vcc
    v_cvt_pk_bf16_f32 v11, v102, v103
    v_lshlrev_b32 v102, 16, v11
    v_and_b32 v103, 0xffff0000, v11
    v_add_f32 v102, 0x358637bd, v102
    v_add_f32 v103, 0x358637bd, v103
    v_cvt_pk_bf16_f32 v11, v102, v103
    v_lshlrev_b32 v102, 16, v11
    v_and_b32 v103, 0xffff0000, v11
    v_cvt_pk_bf16_f32 v11, v112, v113
    v_lshlrev_b32 v112, 16, v11
    v_and_b32 v113, 0xffff0000, v11
    v_mul_f32 v12, s30, v112
    v_exp_f32 v12, v12
    v_add_f32 v13, 1.0, v112
    v_cmp_lt_f32 vcc, 0, v112
    s_nop 1
    v_cndmask_b32 v112, v12, v13, vcc
    v_mul_f32 v12, s30, v113
    v_exp_f32 v12, v12
    v_add_f32 v13, 1.0, v113
    v_cmp_lt_f32 vcc, 0, v113
    s_nop 1
    v_cndmask_b32 v113, v12, v13, vcc
    v_cvt_pk_bf16_f32 v11, v112, v113
    v_lshlrev_b32 v112, 16, v11
    v_and_b32 v113, 0xffff0000, v11
    v_add_f32 v112, 0x358637bd, v112
    v_add_f32 v113, 0x358637bd, v113
    v_cvt_pk_bf16_f32 v11, v112, v113
    v_lshlrev_b32 v112, 16, v11
    v_and_b32 v113, 0xffff0000, v11
    v_cvt_pk_bf16_f32 v11, v114, v115
    v_lshlrev_b32 v114, 16, v11
    v_and_b32 v115, 0xffff0000, v11
    v_mul_f32 v12, s30, v114
    v_exp_f32 v12, v12
    v_add_f32 v13, 1.0, v114
    v_cmp_lt_f32 vcc, 0, v114
    s_nop 1
    v_cndmask_b32 v114, v12, v13, vcc
    v_mul_f32 v12, s30, v115
    v_exp_f32 v12, v12
    v_add_f32 v13, 1.0, v115
    v_cmp_lt_f32 vcc, 0, v115
    s_nop 1
    v_cndmask_b32 v115, v12, v13, vcc
    v_cvt_pk_bf16_f32 v11, v114, v115
    v_lshlrev_b32 v114, 16, v11
    v_and_b32 v115, 0xffff0000, v11
    v_add_f32 v114, 0x358637bd, v114
    v_add_f32 v115, 0x358637bd, v115
    v_cvt_pk_bf16_f32 v11, v114, v115
    v_lshlrev_b32 v114, 16, v11
    v_and_b32 v115, 0xffff0000, v11
    v_cvt_pk_bf16_f32 v11, v116, v117
    v_lshlrev_b32 v116, 16, v11
    v_and_b32 v117, 0xffff0000, v11
    v_mul_f32 v12, s30, v116
    v_exp_f32 v12, v12
    v_add_f32 v13, 1.0, v116
    v_cmp_lt_f32 vcc, 0, v116
    s_nop 1
    v_cndmask_b32 v116, v12, v13, vcc
    v_mul_f32 v12, s30, v117
    v_exp_f32 v12, v12
    v_add_f32 v13, 1.0, v117
    v_cmp_lt_f32 vcc, 0, v117
    s_nop 1
    v_cndmask_b32 v117, v12, v13, vcc
    v_cvt_pk_bf16_f32 v11, v116, v117
    v_lshlrev_b32 v116, 16, v11
    v_and_b32 v117, 0xffff0000, v11
    v_add_f32 v116, 0x358637bd, v116
    v_add_f32 v117, 0x358637bd, v117
    v_cvt_pk_bf16_f32 v11, v116, v117
    v_lshlrev_b32 v116, 16, v11
    v_and_b32 v117, 0xffff0000, v11
    v_cvt_pk_bf16_f32 v11, v118, v119
    v_lshlrev_b32 v118, 16, v11
    v_and_b32 v119, 0xffff0000, v11
    v_mul_f32 v12, s30, v118
    v_exp_f32 v12, v12
    v_add_f32 v13, 1.0, v118
    v_cmp_lt_f32 vcc, 0, v118
    s_nop 1
    v_cndmask_b32 v118, v12, v13, vcc
    v_mul_f32 v12, s30, v119
    v_exp_f32 v12, v12
    v_add_f32 v13, 1.0, v119
    v_cmp_lt_f32 vcc, 0, v119
    s_nop 1
    v_cndmask_b32 v119, v12, v13, vcc
    v_cvt_pk_bf16_f32 v11, v118, v119
    v_lshlrev_b32 v118, 16, v11
    v_and_b32 v119, 0xffff0000, v11
    v_add_f32 v118, 0x358637bd, v118
    v_add_f32 v119, 0x358637bd, v119
    v_cvt_pk_bf16_f32 v11, v118, v119
    v_lshlrev_b32 v118, 16, v11
    v_and_b32 v119, 0xffff0000, v11
    v_cvt_pk_bf16_f32 v32, v64, v65
    v_cvt_pk_bf16_f32 v33, v66, v67
    v_cvt_pk_bf16_f32 v48, v72, v73
    v_cvt_pk_bf16_f32 v49, v74, v75
    v_cvt_pk_bf16_f32 v34, v80, v81
    v_cvt_pk_bf16_f32 v35, v82, v83
    v_cvt_pk_bf16_f32 v50, v88, v89
    v_cvt_pk_bf16_f32 v51, v90, v91
    v_cvt_pk_bf16_f32 v36, v96, v97
    v_cvt_pk_bf16_f32 v37, v98, v99
    v_cvt_pk_bf16_f32 v52, v104, v105
    v_cvt_pk_bf16_f32 v53, v106, v107
    v_cvt_pk_bf16_f32 v38, v112, v113
    v_cvt_pk_bf16_f32 v39, v114, v115
    v_cvt_pk_bf16_f32 v54, v120, v121
    v_cvt_pk_bf16_f32 v55, v122, v123
    v_cvt_pk_bf16_f32 v40, v68, v69
    v_cvt_pk_bf16_f32 v41, v70, v71
    v_cvt_pk_bf16_f32 v56, v76, v77
    v_cvt_pk_bf16_f32 v57, v78, v79
    v_cvt_pk_bf16_f32 v42, v84, v85
    v_cvt_pk_bf16_f32 v43, v86, v87
    v_cvt_pk_bf16_f32 v58, v92, v93
    v_cvt_pk_bf16_f32 v59, v94, v95
    v_cvt_pk_bf16_f32 v44, v100, v101
    v_cvt_pk_bf16_f32 v45, v102, v103
    v_cvt_pk_bf16_f32 v60, v108, v109
    v_cvt_pk_bf16_f32 v61, v110, v111
    v_cvt_pk_bf16_f32 v46, v116, v117
    v_cvt_pk_bf16_f32 v47, v118, v119
    v_cvt_pk_bf16_f32 v62, v124, v125
    v_cvt_pk_bf16_f32 v63, v126, v127
    s_nop 1
    v_mfma_f32_16x16x32_bf16 v[64:67], v[32:35], v[48:51], 0
    v_mfma_f32_16x16x32_bf16 v[68:71], v[32:35], v[16:19], 0
    v_mfma_f32_16x16x32_bf16 v[64:67], v[36:39], v[52:55], v[64:67]
    v_mfma_f32_16x16x32_bf16 v[68:71], v[36:39], v[16:19], v[68:71]
    v_mfma_f32_16x16x32_bf16 v[72:75], v[40:43], v[56:59], 0
    v_mfma_f32_16x16x32_bf16 v[76:79], v[40:43], v[16:19], 0
    v_mfma_f32_16x16x32_bf16 v[72:75], v[44:47], v[60:63], v[72:75]
    v_mfma_f32_16x16x32_bf16 v[76:79], v[44:47], v[16:19], v[76:79]
    s_lshr_b32 s27, s12, 1
    s_and_b32 s28, s12, 1
    s_lshl_b32 s29, s20, 1
    s_add_u32 s29, s29, s27
    s_lshl_b32 s29, s29, 5
    s_lshl_b32 s31, s21, 2
    s_add_u32 s29, s29, s31
    s_lshl_b32 s31, s28, 1
    s_add_u32 s29, s29, s31
    s_lshl_b32 s29, s29, 11
    s_add_u32 s29, s29, 132120576
    v_lshlrev_b32 v4, 4, v1
    v_add_u32 v4, s29, v4
    s_nop 7
    global_store_dwordx4 v4, v[64:67], s[4:5] offset:0
    global_store_dwordx4 v4, v[68:71], s[4:5] offset:1024
    global_store_dwordx4 v4, v[72:75], s[4:5] offset:2048
    global_store_dwordx4 v4, v[76:79], s[4:5] offset:3072
L_g3_kernel_1:
    s_endpgm
.globl kvred_kernel
.p2align 8
.type kvred_kernel,@function
kvred_kernel:
    s_cmp_ge_u32 s2, 64
    s_cbranch_scc1 L_kvred_kernel_1
    s_load_dwordx2 s[4:5], s[0:1], 96
    s_lshl_b32 s6, s2, 10
    v_lshlrev_b32 v1, 4, v0
    v_add_u32 v1, s6, v1
    v_add_u32 v1, 132120576, v1
    s_waitcnt lgkmcnt(0)
    global_load_dwordx4 v[8:11], v1, s[4:5]
    v_add_u32 v1, 65536, v1
    global_load_dwordx4 v[12:15], v1, s[4:5]
    v_add_u32 v1, 65536, v1
    global_load_dwordx4 v[16:19], v1, s[4:5]
    v_add_u32 v1, 65536, v1
    global_load_dwordx4 v[20:23], v1, s[4:5]
    v_add_u32 v1, 65536, v1
    global_load_dwordx4 v[24:27], v1, s[4:5]
    v_add_u32 v1, 65536, v1
    global_load_dwordx4 v[28:31], v1, s[4:5]
    v_add_u32 v1, 65536, v1
    global_load_dwordx4 v[32:35], v1, s[4:5]
    v_add_u32 v1, 65536, v1
    global_load_dwordx4 v[36:39], v1, s[4:5]
    v_add_u32 v1, 65536, v1
    global_load_dwordx4 v[40:43], v1, s[4:5]
    v_add_u32 v1, 65536, v1
    global_load_dwordx4 v[44:47], v1, s[4:5]
    v_add_u32 v1, 65536, v1
    global_load_dwordx4 v[48:51], v1, s[4:5]
    v_add_u32 v1, 65536, v1
    global_load_dwordx4 v[52:55], v1, s[4:5]
    v_add_u32 v1, 65536, v1
    global_load_dwordx4 v[56:59], v1, s[4:5]
    v_add_u32 v1, 65536, v1
    global_load_dwordx4 v[60:63], v1, s[4:5]
    v_add_u32 v1, 65536, v1
    global_load_dwordx4 v[64:67], v1, s[4:5]
    v_add_u32 v1, 65536, v1
    global_load_dwordx4 v[68:71], v1, s[4:5]
    v_add_u32 v1, 65536, v1
    global_load_dwordx4 v[72:75], v1, s[4:5]
    v_add_u32 v1, 65536, v1
    global_load_dwordx4 v[76:79], v1, s[4:5]
    v_add_u32 v1, 65536, v1
    global_load_dwordx4 v[80:83], v1, s[4:5]
    v_add_u32 v1, 65536, v1
    global_load_dwordx4 v[84:87], v1, s[4:5]
    v_add_u32 v1, 65536, v1
    global_load_dwordx4 v[88:91], v1, s[4:5]
    v_add_u32 v1, 65536, v1
    global_load_dwordx4 v[92:95], v1, s[4:5]
    v_add_u32 v1, 65536, v1
    global_load_dwordx4 v[96:99], v1, s[4:5]
    v_add_u32 v1, 65536, v1
    global_load_dwordx4 v[100:103], v1, s[4:5]
    v_add_u32 v1, 65536, v1
    global_load_dwordx4 v[104:107], v1, s[4:5]
    v_add_u32 v1, 65536, v1
    global_load_dwordx4 v[108:111], v1, s[4:5]
    v_add_u32 v1, 65536, v1
    global_load_dwordx4 v[112:115], v1, s[4:5]
    v_add_u32 v1, 65536, v1
    global_load_dwordx4 v[116:119], v1, s[4:5]
    v_add_u32 v1, 65536, v1
    global_load_dwordx4 v[120:123], v1, s[4:5]
    v_add_u32 v1, 65536, v1
    global_load_dwordx4 v[124:127], v1, s[4:5]
    v_add_u32 v1, 65536, v1
    global_load_dwordx4 v[128:131], v1, s[4:5]
    v_add_u32 v1, 65536, v1
    global_load_dwordx4 v[132:135], v1, s[4:5]
    s_waitcnt vmcnt(0)
    v_pk_add_f32 v[8:9], v[8:9], v[72:73]
    v_pk_add_f32 v[10:11], v[10:11], v[74:75]
    v_pk_add_f32 v[12:13], v[12:13], v[76:77]
    v_pk_add_f32 v[14:15], v[14:15], v[78:79]
    v_pk_add_f32 v[16:17], v[16:17], v[80:81]
    v_pk_add_f32 v[18:19], v[18:19], v[82:83]
    v_pk_add_f32 v[20:21], v[20:21], v[84:85]
    v_pk_add_f32 v[22:23], v[22:23], v[86:87]
    v_pk_add_f32 v[24:25], v[24:25], v[88:89]
    v_pk_add_f32 v[26:27], v[26:27], v[90:91]
    v_pk_add_f32 v[28:29], v[28:29], v[92:93]
    v_pk_add_f32 v[30:31], v[30:31], v[94:95]
    v_pk_add_f32 v[32:33], v[32:33], v[96:97]
    v_pk_add_f32 v[34:35], v[34:35], v[98:99]
    v_pk_add_f32 v[36:37], v[36:37], v[100:101]
    v_pk_add_f32 v[38:39], v[38:39], v[102:103]
    v_pk_add_f32 v[40:41], v[40:41], v[104:105]
    v_pk_add_f32 v[42:43], v[42:43], v[106:107]
    v_pk_add_f32 v[44:45], v[44:45], v[108:109]
    v_pk_add_f32 v[46:47], v[46:47], v[110:111]
    v_pk_add_f32 v[48:49], v[48:49], v[112:113]
    v_pk_add_f32 v[50:51], v[50:51], v[114:115]
    v_pk_add_f32 v[52:53], v[52:53], v[116:117]
    v_pk_add_f32 v[54:55], v[54:55], v[118:119]
    v_pk_add_f32 v[56:57], v[56:57], v[120:121]
    v_pk_add_f32 v[58:59], v[58:59], v[122:123]
    v_pk_add_f32 v[60:61], v[60:61], v[124:125]
    v_pk_add_f32 v[62:63], v[62:63], v[126:127]
    v_pk_add_f32 v[64:65], v[64:65], v[128:129]
    v_pk_add_f32 v[66:67], v[66:67], v[130:131]
    v_pk_add_f32 v[68:69], v[68:69], v[132:133]
    v_pk_add_f32 v[70:71], v[70:71], v[134:135]
    v_pk_add_f32 v[8:9], v[8:9], v[40:41]
    v_pk_add_f32 v[10:11], v[10:11], v[42:43]
    v_pk_add_f32 v[12:13], v[12:13], v[44:45]
    v_pk_add_f32 v[14:15], v[14:15], v[46:47]
    v_pk_add_f32 v[16:17], v[16:17], v[48:49]
    v_pk_add_f32 v[18:19], v[18:19], v[50:51]
    v_pk_add_f32 v[20:21], v[20:21], v[52:53]
    v_pk_add_f32 v[22:23], v[22:23], v[54:55]
    v_pk_add_f32 v[24:25], v[24:25], v[56:57]
    v_pk_add_f32 v[26:27], v[26:27], v[58:59]
    v_pk_add_f32 v[28:29], v[28:29], v[60:61]
    v_pk_add_f32 v[30:31], v[30:31], v[62:63]
    v_pk_add_f32 v[32:33], v[32:33], v[64:65]
    v_pk_add_f32 v[34:35], v[34:35], v[66:67]
    v_pk_add_f32 v[36:37], v[36:37], v[68:69]
    v_pk_add_f32 v[38:39], v[38:39], v[70:71]
    v_pk_add_f32 v[8:9], v[8:9], v[24:25]
    v_pk_add_f32 v[10:11], v[10:11], v[26:27]
    v_pk_add_f32 v[12:13], v[12:13], v[28:29]
    v_pk_add_f32 v[14:15], v[14:15], v[30:31]
    v_pk_add_f32 v[16:17], v[16:17], v[32:33]
    v_pk_add_f32 v[18:19], v[18:19], v[34:35]
    v_pk_add_f32 v[20:21], v[20:21], v[36:37]
    v_pk_add_f32 v[22:23], v[22:23], v[38:39]
    v_pk_add_f32 v[8:9], v[8:9], v[16:17]
    v_pk_add_f32 v[10:11], v[10:11], v[18:19]
    v_pk_add_f32 v[12:13], v[12:13], v[20:21]
    v_pk_add_f32 v[14:15], v[14:15], v[22:23]
    v_pk_add_f32 v[8:9], v[8:9], v[12:13]
    v_pk_add_f32 v[10:11], v[10:11], v[14:15]
    v_cvt_pk_bf16_f32 v2, v8, v9
    v_cvt_pk_bf16_f32 v3, v10, v11
    s_lshl_b32 s6, s2, 9
    v_lshlrev_b32 v1, 3, v0
    v_add_u32 v1, s6, v1
    v_add_u32 v1, 134217728, v1
    global_store_dwordx2 v1, v[2:3], s[4:5]
L_kvred_kernel_1:
    s_endpgm
.globl b2af_kernel
.p2align 8
.type b2af_kernel,@function
b2af_kernel:
    s_cmp_ge_u32 s2, 193
    s_cbranch_scc1 M_b2af_kernel_end
    s_cmp_ge_u32 s2, 128
    s_cbranch_scc1 M_b2af_kernel_1
M_b2af_kernel_0:
    s_cmp_ge_u32 s2, 128
    s_cbranch_scc1 L_b2a_kernel_1
    s_load_dwordx2 s[4:5], s[0:1], 96
    s_load_dwordx2 s[6:7], s[0:1], 80
    v_and_b32 v1, 63, v0
    v_lshrrev_b32 v4, 6, v0
    v_bfe_u32 v2, v0, 4, 2
    v_and_b32 v3, 15, v0
    v_lshlrev_b32 v5, 4, v1
    s_nop 0
    v_readfirstlane_b32 s12, v4
    s_lshl_b32 s13, s2, 14
    s_lshl_b32 s14, s12, 12
    s_add_u32 s13, s13, s14
    v_add_u32 v6, s13, v5
    v_add_u32 v6, 130023424, v6
    s_lshl_b32 s14, s12, 13
    v_lshrrev_b32 v7, 1, v5
    v_add_u32 v7, s14, v7
    v_add_u32 v7, 134217728, v7
    v_add_u32 v8, 4096, v7
    s_waitcnt lgkmcnt(0)
    s_add_u32 s6, s4, 123731968
    s_addc_u32 s7, s5, 0
    global_load_dwordx4 v[16:19], v6, s[4:5] offset:0
    global_load_dwordx4 v[20:23], v6, s[4:5] offset:1024
    global_load_dwordx4 v[24:27], v6, s[4:5] offset:2048
    global_load_dwordx4 v[28:31], v6, s[4:5] offset:3072
    global_load_dwordx2 v[32:33], v7, s[4:5] offset:0
    global_load_dwordx2 v[34:35], v7, s[4:5] offset:512
    global_load_dwordx2 v[36:37], v7, s[4:5] offset:1024
    global_load_dwordx2 v[38:39], v7, s[4:5] offset:1536
    global_load_dwordx2 v[40:41], v7, s[4:5] offset:2048
    global_load_dwordx2 v[42:43], v7, s[4:5] offset:2560
    global_load_dwordx2 v[44:45], v7, s[4:5] offset:3072
    global_load_dwordx2 v[46:47], v7, s[4:5] offset:3584
    global_load_dwordx2 v[48:49], v8, s[4:5] offset:0
    global_load_dwordx2 v[50:51], v8, s[4:5] offset:512
    global_load_dwordx2 v[52:53], v8, s[4:5] offset:1024
    global_load_dwordx2 v[54:55], v8, s[4:5] offset:1536
    global_load_dwordx2 v[56:57], v8, s[4:5] offset:2048
    global_load_dwordx2 v[58:59], v8, s[4:5] offset:2560
    global_load_dwordx2 v[60:61], v8, s[4:5] offset:3072
    global_load_dwordx2 v[62:63], v8, s[4:5] offset:3584
    s_lshl_b32 s14, s12, 17
    v_add_u32 v9, s14, v5
    v_add_u32 v9, 18350080, v9
    s_waitcnt vmcnt(0)
    v_add_u32 v10, 0, v9
    global_load_dwordx4 v[128:131], v10, s[4:5]
    v_add_u32 v10, 16384, v9
    global_load_dwordx4 v[132:135], v10, s[4:5]
    v_add_u32 v10, 32768, v9
    global_load_dwordx4 v[136:139], v10, s[4:5]
    v_add_u32 v10, 49152, v9
    global_load_dwordx4 v[140:143], v10, s[4:5]
    v_add_u32 v10, 65536, v9
    global_load_dwordx4 v[144:147], v10, s[4:5]
    v_add_u32 v10, 81920, v9
    global_load_dwordx4 v[148:151], v10, s[4:5]
    v_add_u32 v10, 98304, v9
    global_load_dwordx4 v[152:155], v10, s[4:5]
    v_add_u32 v10, 114688, v9
    global_load_dwordx4 v[156:159], v10, s[4:5]
    v_mfma_f32_16x16x16_bf16 v[64:67], v[32:33], v[16:17], 0
    v_mfma_f32_16x16x16_bf16 v[68:71], v[34:35], v[16:17], 0
    v_mfma_f32_16x16x16_bf16 v[72:75], v[36:37], v[18:19], 0
    v_mfma_f32_16x16x16_bf16 v[76:79], v[38:39], v[18:19], 0
    v_mfma_f32_16x16x16_bf16 v[80:83], v[40:41], v[20:21], 0
    v_mfma_f32_16x16x16_bf16 v[84:87], v[42:43], v[20:21], 0
    v_mfma_f32_16x16x16_bf16 v[88:91], v[44:45], v[22:23], 0
    v_mfma_f32_16x16x16_bf16 v[92:95], v[46:47], v[22:23], 0
    v_mfma_f32_16x16x16_bf16 v[96:99], v[48:49], v[24:25], 0
    v_mfma_f32_16x16x16_bf16 v[100:103], v[50:51], v[24:25], 0
    v_mfma_f32_16x16x16_bf16 v[104:107], v[52:53], v[26:27], 0
    v_mfma_f32_16x16x16_bf16 v[108:111], v[54:55], v[26:27], 0
    v_mfma_f32_16x16x16_bf16 v[112:115], v[56:57], v[28:29], 0
    v_mfma_f32_16x16x16_bf16 v[116:119], v[58:59], v[28:29], 0
    v_mfma_f32_16x16x16_bf16 v[120:123], v[60:61], v[30:31], 0
    v_mfma_f32_16x16x16_bf16 v[124:127], v[62:63], v[30:31], 0
    s_nop 7
    v_cvt_pk_bf16_f32 v11, v64, v65
    v_lshlrev_b32 v64, 16, v11
    v_and_b32 v65, 0xffff0000, v11
    v_cvt_pk_bf16_f32 v11, v66, v67
    v_lshlrev_b32 v66, 16, v11
    v_and_b32 v67, 0xffff0000, v11
    v_cvt_pk_bf16_f32 v11, v68, v68
    v_lshlrev_b32 v68, 16, v11
    v_add_f32 v68, 0x358637bd, v68
    v_cvt_pk_bf16_f32 v11, v68, v68
    v_lshlrev_b32 v68, 16, v11
    v_rcp_f32 v12, v68
    s_nop 0
    v_mul_f32 v13, v64, v12
    v_fma_f32 v14, -v13, v68, v64
    v_fma_f32 v64, v14, v12, v13
    v_mul_f32 v13, v65, v12
    v_fma_f32 v14, -v13, v68, v65
    v_fma_f32 v65, v14, v12, v13
    v_mul_f32 v13, v66, v12
    v_fma_f32 v14, -v13, v68, v66
    v_fma_f32 v66, v14, v12, v13
    v_mul_f32 v13, v67, v12
    v_fma_f32 v14, -v13, v68, v67
    v_fma_f32 v67, v14, v12, v13
    v_cvt_pk_bf16_f32 v16, v64, v65
    v_cvt_pk_bf16_f32 v17, v66, v67
    v_cvt_pk_bf16_f32 v11, v72, v73
    v_lshlrev_b32 v72, 16, v11
    v_and_b32 v73, 0xffff0000, v11
    v_cvt_pk_bf16_f32 v11, v74, v75
    v_lshlrev_b32 v74, 16, v11
    v_and_b32 v75, 0xffff0000, v11
    v_cvt_pk_bf16_f32 v11, v76, v76
    v_lshlrev_b32 v76, 16, v11
    v_add_f32 v76, 0x358637bd, v76
    v_cvt_pk_bf16_f32 v11, v76, v76
    v_lshlrev_b32 v76, 16, v11
    v_rcp_f32 v12, v76
    s_nop 0
    v_mul_f32 v13, v72, v12
    v_fma_f32 v14, -v13, v76, v72
    v_fma_f32 v72, v14, v12, v13
    v_mul_f32 v13, v73, v12
    v_fma_f32 v14, -v13, v76, v73
    v_fma_f32 v73, v14, v12, v13
    v_mul_f32 v13, v74, v12
    v_fma_f32 v14, -v13, v76, v74
    v_fma_f32 v74, v14, v12, v13
    v_mul_f32 v13, v75, v12
    v_fma_f32 v14, -v13, v76, v75
    v_fma_f32 v75, v14, v12, v13
    v_cvt_pk_bf16_f32 v18, v72, v73
    v_cvt_pk_bf16_f32 v19, v74, v75
    v_cvt_pk_bf16_f32 v11, v80, v81
    v_lshlrev_b32 v80, 16, v11
    v_and_b32 v81, 0xffff0000, v11
    v_cvt_pk_bf16_f32 v11, v82, v83
    v_lshlrev_b32 v82, 16, v11
    v_and_b32 v83, 0xffff0000, v11
    v_cvt_pk_bf16_f32 v11, v84, v84
    v_lshlrev_b32 v84, 16, v11
    v_add_f32 v84, 0x358637bd, v84
    v_cvt_pk_bf16_f32 v11, v84, v84
    v_lshlrev_b32 v84, 16, v11
    v_rcp_f32 v12, v84
    s_nop 0
    v_mul_f32 v13, v80, v12
    v_fma_f32 v14, -v13, v84, v80
    v_fma_f32 v80, v14, v12, v13
    v_mul_f32 v13, v81, v12
    v_fma_f32 v14, -v13, v84, v81
    v_fma_f32 v81, v14, v12, v13
    v_mul_f32 v13, v82, v12
    v_fma_f32 v14, -v13, v84, v82
    v_fma_f32 v82, v14, v12, v13
    v_mul_f32 v13, v83, v12
    v_fma_f32 v14, -v13, v84, v83
    v_fma_f32 v83, v14, v12, v13
    v_cvt_pk_bf16_f32 v20, v80, v81
    v_cvt_pk_bf16_f32 v21, v82, v83
    v_cvt_pk_bf16_f32 v11, v88, v89
    v_lshlrev_b32 v88, 16, v11
    v_and_b32 v89, 0xffff0000, v11
    v_cvt_pk_bf16_f32 v11, v90, v91
    v_lshlrev_b32 v90, 16, v11
    v_and_b32 v91, 0xffff0000, v11
    v_cvt_pk_bf16_f32 v11, v92, v92
    v_lshlrev_b32 v92, 16, v11
    v_add_f32 v92, 0x358637bd, v92
    v_cvt_pk_bf16_f32 v11, v92, v92
    v_lshlrev_b32 v92, 16, v11
    v_rcp_f32 v12, v92
    s_nop 0
    v_mul_f32 v13, v88, v12
    v_fma_f32 v14, -v13, v92, v88
    v_fma_f32 v88, v14, v12, v13
    v_mul_f32 v13, v89, v12
    v_fma_f32 v14, -v13, v92, v89
    v_fma_f32 v89, v14, v12, v13
    v_mul_f32 v13, v90, v12
    v_fma_f32 v14, -v13, v92, v90
    v_fma_f32 v90, v14, v12, v13
    v_mul_f32 v13, v91, v12
    v_fma_f32 v14, -v13, v92, v91
    v_fma_f32 v91, v14, v12, v13
    v_cvt_pk_bf16_f32 v22, v88, v89
    v_cvt_pk_bf16_f32 v23, v90, v91
    v_cvt_pk_bf16_f32 v11, v96, v97
    v_lshlrev_b32 v96, 16, v11
    v_and_b32 v97, 0xffff0000, v11
    v_cvt_pk_bf16_f32 v11, v98, v99
    v_lshlrev_b32 v98, 16, v11
    v_and_b32 v99, 0xffff0000, v11
    v_cvt_pk_bf16_f32 v11, v100, v100
    v_lshlrev_b32 v100, 16, v11
    v_add_f32 v100, 0x358637bd, v100
    v_cvt_pk_bf16_f32 v11, v100, v100
    v_lshlrev_b32 v100, 16, v11
    v_rcp_f32 v12, v100
    s_nop 0
    v_mul_f32 v13, v96, v12
    v_fma_f32 v14, -v13, v100, v96
    v_fma_f32 v96, v14, v12, v13
    v_mul_f32 v13, v97, v12
    v_fma_f32 v14, -v13, v100, v97
    v_fma_f32 v97, v14, v12, v13
    v_mul_f32 v13, v98, v12
    v_fma_f32 v14, -v13, v100, v98
    v_fma_f32 v98, v14, v12, v13
    v_mul_f32 v13, v99, v12
    v_fma_f32 v14, -v13, v100, v99
    v_fma_f32 v99, v14, v12, v13
    v_cvt_pk_bf16_f32 v24, v96, v97
    v_cvt_pk_bf16_f32 v25, v98, v99
    v_cvt_pk_bf16_f32 v11, v104, v105
    v_lshlrev_b32 v104, 16, v11
    v_and_b32 v105, 0xffff0000, v11
    v_cvt_pk_bf16_f32 v11, v106, v107
    v_lshlrev_b32 v106, 16, v11
    v_and_b32 v107, 0xffff0000, v11
    v_cvt_pk_bf16_f32 v11, v108, v108
    v_lshlrev_b32 v108, 16, v11
    v_add_f32 v108, 0x358637bd, v108
    v_cvt_pk_bf16_f32 v11, v108, v108
    v_lshlrev_b32 v108, 16, v11
    v_rcp_f32 v12, v108
    s_nop 0
    v_mul_f32 v13, v104, v12
    v_fma_f32 v14, -v13, v108, v104
    v_fma_f32 v104, v14, v12, v13
    v_mul_f32 v13, v105, v12
    v_fma_f32 v14, -v13, v108, v105
    v_fma_f32 v105, v14, v12, v13
    v_mul_f32 v13, v106, v12
    v_fma_f32 v14, -v13, v108, v106
    v_fma_f32 v106, v14, v12, v13
    v_mul_f32 v13, v107, v12
    v_fma_f32 v14, -v13, v108, v107
    v_fma_f32 v107, v14, v12, v13
    v_cvt_pk_bf16_f32 v26, v104, v105
    v_cvt_pk_bf16_f32 v27, v106, v107
    v_cvt_pk_bf16_f32 v11, v112, v113
    v_lshlrev_b32 v112, 16, v11
    v_and_b32 v113, 0xffff0000, v11
    v_cvt_pk_bf16_f32 v11, v114, v115
    v_lshlrev_b32 v114, 16, v11
    v_and_b32 v115, 0xffff0000, v11
    v_cvt_pk_bf16_f32 v11, v116, v116
    v_lshlrev_b32 v116, 16, v11
    v_add_f32 v116, 0x358637bd, v116
    v_cvt_pk_bf16_f32 v11, v116, v116
    v_lshlrev_b32 v116, 16, v11
    v_rcp_f32 v12, v116
    s_nop 0
    v_mul_f32 v13, v112, v12
    v_fma_f32 v14, -v13, v116, v112
    v_fma_f32 v112, v14, v12, v13
    v_mul_f32 v13, v113, v12
    v_fma_f32 v14, -v13, v116, v113
    v_fma_f32 v113, v14, v12, v13
    v_mul_f32 v13, v114, v12
    v_fma_f32 v14, -v13, v116, v114
    v_fma_f32 v114, v14, v12, v13
    v_mul_f32 v13, v115, v12
    v_fma_f32 v14, -v13, v116, v115
    v_fma_f32 v115, v14, v12, v13
    v_cvt_pk_bf16_f32 v28, v112, v113
    v_cvt_pk_bf16_f32 v29, v114, v115
    v_cvt_pk_bf16_f32 v11, v120, v121
    v_lshlrev_b32 v120, 16, v11
    v_and_b32 v121, 0xffff0000, v11
    v_cvt_pk_bf16_f32 v11, v122, v123
    v_lshlrev_b32 v122, 16, v11
    v_and_b32 v123, 0xffff0000, v11
    v_cvt_pk_bf16_f32 v11, v124, v124
    v_lshlrev_b32 v124, 16, v11
    v_add_f32 v124, 0x358637bd, v124
    v_cvt_pk_bf16_f32 v11, v124, v124
    v_lshlrev_b32 v124, 16, v11
    v_rcp_f32 v12, v124
    s_nop 0
    v_mul_f32 v13, v120, v12
    v_fma_f32 v14, -v13, v124, v120
    v_fma_f32 v120, v14, v12, v13
    v_mul_f32 v13, v121, v12
    v_fma_f32 v14, -v13, v124, v121
    v_fma_f32 v121, v14, v12, v13
    v_mul_f32 v13, v122, v12
    v_fma_f32 v14, -v13, v124, v122
    v_fma_f32 v122, v14, v12, v13
    v_mul_f32 v13, v123, v12
    v_fma_f32 v14, -v13, v124, v123
    v_fma_f32 v123, v14, v12, v13
    v_cvt_pk_bf16_f32 v30, v120, v121
    v_cvt_pk_bf16_f32 v31, v122, v123
    s_lshl_b32 s14, s12, 12
    v_add_u32 v10, s14, v5
    ds_write_b128 v10, v[16:19] offset:0
    ds_write_b128 v10, v[20:23] offset:1024
    ds_write_b128 v10, v[24:27] offset:2048
    ds_write_b128 v10, v[28:31] offset:3072
    s_waitcnt lgkmcnt(0)
    s_barrier
    ds_read_b128 v[64:67], v5 offset:0
    ds_read_b128 v[68:71], v5 offset:1024
    ds_read_b128 v[72:75], v5 offset:2048
    ds_read_b128 v[76:79], v5 offset:3072
    ds_read_b128 v[80:83], v5 offset:4096
    ds_read_b128 v[84:87], v5 offset:5120
    ds_read_b128 v[88:91], v5 offset:6144
    ds_read_b128 v[92:95], v5 offset:7168
    ds_read_b128 v[96:99], v5 offset:8192
    ds_read_b128 v[100:103], v5 offset:9216
    ds_read_b128 v[104:107], v5 offset:10240
    ds_read_b128 v[108:111], v5 offset:11264
    ds_read_b128 v[112:115], v5 offset:12288
    ds_read_b128 v[116:119], v5 offset:13312
    ds_read_b128 v[120:123], v5 offset:14336
    ds_read_b128 v[124:127], v5 offset:15360
    v_add_u32 v10, 1024, v9
    global_load_dwordx4 v[160:163], v10, s[4:5]
    v_add_u32 v10, 17408, v9
    global_load_dwordx4 v[164:167], v10, s[4:5]
    v_add_u32 v10, 33792, v9
    global_load_dwordx4 v[168:171], v10, s[4:5]
    v_add_u32 v10, 50176, v9
    global_load_dwordx4 v[172:175], v10, s[4:5]
    v_add_u32 v10, 66560, v9
    global_load_dwordx4 v[176:179], v10, s[4:5]
    v_add_u32 v10, 82944, v9
    global_load_dwordx4 v[180:183], v10, s[4:5]
    v_add_u32 v10, 99328, v9
    global_load_dwordx4 v[184:187], v10, s[4:5]
    v_add_u32 v10, 115712, v9
    global_load_dwordx4 v[188:191], v10, s[4:5]
    s_waitcnt vmcnt(8) lgkmcnt(0)
    v_mfma_f32_16x16x32_bf16 v[16:19], v[128:131], v[64:67], 0
    v_mfma_f32_16x16x32_bf16 v[20:23], v[132:135], v[64:67], 0
    v_mfma_f32_16x16x32_bf16 v[24:27], v[136:139], v[64:67], 0
    v_mfma_f32_16x16x32_bf16 v[28:31], v[140:143], v[64:67], 0
    v_mfma_f32_16x16x32_bf16 v[32:35], v[144:147], v[64:67], 0
    v_mfma_f32_16x16x32_bf16 v[36:39], v[148:151], v[64:67], 0
    v_mfma_f32_16x16x32_bf16 v[40:43], v[152:155], v[64:67], 0
    v_mfma_f32_16x16x32_bf16 v[44:47], v[156:159], v[64:67], 0
    v_add_u32 v10, 2048, v9
    global_load_dwordx4 v[128:131], v10, s[4:5]
    v_add_u32 v10, 18432, v9
    global_load_dwordx4 v[132:135], v10, s[4:5]
    v_add_u32 v10, 34816, v9
    global_load_dwordx4 v[136:139], v10, s[4:5]
    v_add_u32 v10, 51200, v9
    global_load_dwordx4 v[140:143], v10, s[4:5]
    v_add_u32 v10, 67584, v9
    global_load_dwordx4 v[144:147], v10, s[4:5]
    v_add_u32 v10, 83968, v9
    global_load_dwordx4 v[148:151], v10, s[4:5]
    v_add_u32 v10, 100352, v9
    global_load_dwordx4 v[152:155], v10, s[4:5]
    v_add_u32 v10, 116736, v9
    global_load_dwordx4 v[156:159], v10, s[4:5]
    s_waitcnt vmcnt(8) lgkmcnt(0)
    v_mfma_f32_16x16x32_bf16 v[16:19], v[160:163], v[68:71], v[16:19]
    v_mfma_f32_16x16x32_bf16 v[20:23], v[164:167], v[68:71], v[20:23]
    v_mfma_f32_16x16x32_bf16 v[24:27], v[168:171], v[68:71], v[24:27]
    v_mfma_f32_16x16x32_bf16 v[28:31], v[172:175], v[68:71], v[28:31]
    v_mfma_f32_16x16x32_bf16 v[32:35], v[176:179], v[68:71], v[32:35]
    v_mfma_f32_16x16x32_bf16 v[36:39], v[180:183], v[68:71], v[36:39]
    v_mfma_f32_16x16x32_bf16 v[40:43], v[184:187], v[68:71], v[40:43]
    v_mfma_f32_16x16x32_bf16 v[44:47], v[188:191], v[68:71], v[44:47]
    v_add_u32 v10, 3072, v9
    global_load_dwordx4 v[160:163], v10, s[4:5]
    v_add_u32 v10, 19456, v9
    global_load_dwordx4 v[164:167], v10, s[4:5]
    v_add_u32 v10, 35840, v9
    global_load_dwordx4 v[168:171], v10, s[4:5]
    v_add_u32 v10, 52224, v9
    global_load_dwordx4 v[172:175], v10, s[4:5]
    v_add_u32 v10, 68608, v9
    global_load_dwordx4 v[176:179], v10, s[4:5]
    v_add_u32 v10, 84992, v9
    global_load_dwordx4 v[180:183], v10, s[4:5]
    v_add_u32 v10, 101376, v9
    global_load_dwordx4 v[184:187], v10, s[4:5]
    v_add_u32 v10, 117760, v9
    global_load_dwordx4 v[188:191], v10, s[4:5]
    s_waitcnt vmcnt(8) lgkmcnt(0)
    v_mfma_f32_16x16x32_bf16 v[16:19], v[128:131], v[72:75], v[16:19]
    v_mfma_f32_16x16x32_bf16 v[20:23], v[132:135], v[72:75], v[20:23]
    v_mfma_f32_16x16x32_bf16 v[24:27], v[136:139], v[72:75], v[24:27]
    v_mfma_f32_16x16x32_bf16 v[28:31], v[140:143], v[72:75], v[28:31]
    v_mfma_f32_16x16x32_bf16 v[32:35], v[144:147], v[72:75], v[32:35]
    v_mfma_f32_16x16x32_bf16 v[36:39], v[148:151], v[72:75], v[36:39]
    v_mfma_f32_16x16x32_bf16 v[40:43], v[152:155], v[72:75], v[40:43]
    v_mfma_f32_16x16x32_bf16 v[44:47], v[156:159], v[72:75], v[44:47]
    v_add_u32 v10, 4096, v9
    global_load_dwordx4 v[128:131], v10, s[4:5]
    v_add_u32 v10, 20480, v9
    global_load_dwordx4 v[132:135], v10, s[4:5]
    v_add_u32 v10, 36864, v9
    global_load_dwordx4 v[136:139], v10, s[4:5]
    v_add_u32 v10, 53248, v9
    global_load_dwordx4 v[140:143], v10, s[4:5]
    v_add_u32 v10, 69632, v9
    global_load_dwordx4 v[144:147], v10, s[4:5]
    v_add_u32 v10, 86016, v9
    global_load_dwordx4 v[148:151], v10, s[4:5]
    v_add_u32 v10, 102400, v9
    global_load_dwordx4 v[152:155], v10, s[4:5]
    v_add_u32 v10, 118784, v9
    global_load_dwordx4 v[156:159], v10, s[4:5]
    s_waitcnt vmcnt(8) lgkmcnt(0)
    v_mfma_f32_16x16x32_bf16 v[16:19], v[160:163], v[76:79], v[16:19]
    v_mfma_f32_16x16x32_bf16 v[20:23], v[164:167], v[76:79], v[20:23]
    v_mfma_f32_16x16x32_bf16 v[24:27], v[168:171], v[76:79], v[24:27]
    v_mfma_f32_16x16x32_bf16 v[28:31], v[172:175], v[76:79], v[28:31]
    v_mfma_f32_16x16x32_bf16 v[32:35], v[176:179], v[76:79], v[32:35]
    v_mfma_f32_16x16x32_bf16 v[36:39], v[180:183], v[76:79], v[36:39]
    v_mfma_f32_16x16x32_bf16 v[40:43], v[184:187], v[76:79], v[40:43]
    v_mfma_f32_16x16x32_bf16 v[44:47], v[188:191], v[76:79], v[44:47]
    v_add_u32 v10, 5120, v9
    global_load_dwordx4 v[160:163], v10, s[4:5]
    v_add_u32 v10, 21504, v9
    global_load_dwordx4 v[164:167], v10, s[4:5]
    v_add_u32 v10, 37888, v9
    global_load_dwordx4 v[168:171], v10, s[4:5]
    v_add_u32 v10, 54272, v9
    global_load_dwordx4 v[172:175], v10, s[4:5]
    v_add_u32 v10, 70656, v9
    global_load_dwordx4 v[176:179], v10, s[4:5]
    v_add_u32 v10, 87040, v9
    global_load_dwordx4 v[180:183], v10, s[4:5]
    v_add_u32 v10, 103424, v9
    global_load_dwordx4 v[184:187], v10, s[4:5]
    v_add_u32 v10, 119808, v9
    global_load_dwordx4 v[188:191], v10, s[4:5]
    s_waitcnt vmcnt(8) lgkmcnt(0)
    v_mfma_f32_16x16x32_bf16 v[16:19], v[128:131], v[80:83], v[16:19]
    v_mfma_f32_16x16x32_bf16 v[20:23], v[132:135], v[80:83], v[20:23]
    v_mfma_f32_16x16x32_bf16 v[24:27], v[136:139], v[80:83], v[24:27]
    v_mfma_f32_16x16x32_bf16 v[28:31], v[140:143], v[80:83], v[28:31]
    v_mfma_f32_16x16x32_bf16 v[32:35], v[144:147], v[80:83], v[32:35]
    v_mfma_f32_16x16x32_bf16 v[36:39], v[148:151], v[80:83], v[36:39]
    v_mfma_f32_16x16x32_bf16 v[40:43], v[152:155], v[80:83], v[40:43]
    v_mfma_f32_16x16x32_bf16 v[44:47], v[156:159], v[80:83], v[44:47]
    v_add_u32 v10, 6144, v9
    global_load_dwordx4 v[128:131], v10, s[4:5]
    v_add_u32 v10, 22528, v9
    global_load_dwordx4 v[132:135], v10, s[4:5]
    v_add_u32 v10, 38912, v9
    global_load_dwordx4 v[136:139], v10, s[4:5]
    v_add_u32 v10, 55296, v9
    global_load_dwordx4 v[140:143], v10, s[4:5]
    v_add_u32 v10, 71680, v9
    global_load_dwordx4 v[144:147], v10, s[4:5]
    v_add_u32 v10, 88064, v9
    global_load_dwordx4 v[148:151], v10, s[4:5]
    v_add_u32 v10, 104448, v9
    global_load_dwordx4 v[152:155], v10, s[4:5]
    v_add_u32 v10, 120832, v9
    global_load_dwordx4 v[156:159], v10, s[4:5]
    s_waitcnt vmcnt(8) lgkmcnt(0)
    v_mfma_f32_16x16x32_bf16 v[16:19], v[160:163], v[84:87], v[16:19]
    v_mfma_f32_16x16x32_bf16 v[20:23], v[164:167], v[84:87], v[20:23]
    v_mfma_f32_16x16x32_bf16 v[24:27], v[168:171], v[84:87], v[24:27]
    v_mfma_f32_16x16x32_bf16 v[28:31], v[172:175], v[84:87], v[28:31]
    v_mfma_f32_16x16x32_bf16 v[32:35], v[176:179], v[84:87], v[32:35]
    v_mfma_f32_16x16x32_bf16 v[36:39], v[180:183], v[84:87], v[36:39]
    v_mfma_f32_16x16x32_bf16 v[40:43], v[184:187], v[84:87], v[40:43]
    v_mfma_f32_16x16x32_bf16 v[44:47], v[188:191], v[84:87], v[44:47]
    v_add_u32 v10, 7168, v9
    global_load_dwordx4 v[160:163], v10, s[4:5]
    v_add_u32 v10, 23552, v9
    global_load_dwordx4 v[164:167], v10, s[4:5]
    v_add_u32 v10, 39936, v9
    global_load_dwordx4 v[168:171], v10, s[4:5]
    v_add_u32 v10, 56320, v9
    global_load_dwordx4 v[172:175], v10, s[4:5]
    v_add_u32 v10, 72704, v9
    global_load_dwordx4 v[176:179], v10, s[4:5]
    v_add_u32 v10, 89088, v9
    global_load_dwordx4 v[180:183], v10, s[4:5]
    v_add_u32 v10, 105472, v9
    global_load_dwordx4 v[184:187], v10, s[4:5]
    v_add_u32 v10, 121856, v9
    global_load_dwordx4 v[188:191], v10, s[4:5]
    s_waitcnt vmcnt(8) lgkmcnt(0)
    v_mfma_f32_16x16x32_bf16 v[16:19], v[128:131], v[88:91], v[16:19]
    v_mfma_f32_16x16x32_bf16 v[20:23], v[132:135], v[88:91], v[20:23]
    v_mfma_f32_16x16x32_bf16 v[24:27], v[136:139], v[88:91], v[24:27]
    v_mfma_f32_16x16x32_bf16 v[28:31], v[140:143], v[88:91], v[28:31]
    v_mfma_f32_16x16x32_bf16 v[32:35], v[144:147], v[88:91], v[32:35]
    v_mfma_f32_16x16x32_bf16 v[36:39], v[148:151], v[88:91], v[36:39]
    v_mfma_f32_16x16x32_bf16 v[40:43], v[152:155], v[88:91], v[40:43]
    v_mfma_f32_16x16x32_bf16 v[44:47], v[156:159], v[88:91], v[44:47]
    v_add_u32 v10, 8192, v9
    global_load_dwordx4 v[128:131], v10, s[4:5]
    v_add_u32 v10, 24576, v9
    global_load_dwordx4 v[132:135], v10, s[4:5]
    v_add_u32 v10, 40960, v9
    global_load_dwordx4 v[136:139], v10, s[4:5]
    v_add_u32 v10, 57344, v9
    global_load_dwordx4 v[140:143], v10, s[4:5]
    v_add_u32 v10, 73728, v9
    global_load_dwordx4 v[144:147], v10, s[4:5]
    v_add_u32 v10, 90112, v9
    global_load_dwordx4 v[148:151], v10, s[4:5]
    v_add_u32 v10, 106496, v9
    global_load_dwordx4 v[152:155], v10, s[4:5]
    v_add_u32 v10, 122880, v9
    global_load_dwordx4 v[156:159], v10, s[4:5]
    s_waitcnt vmcnt(8) lgkmcnt(0)
    v_mfma_f32_16x16x32_bf16 v[16:19], v[160:163], v[92:95], v[16:19]
    v_mfma_f32_16x16x32_bf16 v[20:23], v[164:167], v[92:95], v[20:23]
    v_mfma_f32_16x16x32_bf16 v[24:27], v[168:171], v[92:95], v[24:27]
    v_mfma_f32_16x16x32_bf16 v[28:31], v[172:175], v[92:95], v[28:31]
    v_mfma_f32_16x16x32_bf16 v[32:35], v[176:179], v[92:95], v[32:35]
    v_mfma_f32_16x16x32_bf16 v[36:39], v[180:183], v[92:95], v[36:39]
    v_mfma_f32_16x16x32_bf16 v[40:43], v[184:187], v[92:95], v[40:43]
    v_mfma_f32_16x16x32_bf16 v[44:47], v[188:191], v[92:95], v[44:47]
    v_add_u32 v10, 9216, v9
    global_load_dwordx4 v[160:163], v10, s[4:5]
    v_add_u32 v10, 25600, v9
    global_load_dwordx4 v[164:167], v10, s[4:5]
    v_add_u32 v10, 41984, v9
    global_load_dwordx4 v[168:171], v10, s[4:5]
    v_add_u32 v10, 58368, v9
    global_load_dwordx4 v[172:175], v10, s[4:5]
    v_add_u32 v10, 74752, v9
    global_load_dwordx4 v[176:179], v10, s[4:5]
    v_add_u32 v10, 91136, v9
    global_load_dwordx4 v[180:183], v10, s[4:5]
    v_add_u32 v10, 107520, v9
    global_load_dwordx4 v[184:187], v10, s[4:5]
    v_add_u32 v10, 123904, v9
    global_load_dwordx4 v[188:191], v10, s[4:5]
    s_waitcnt vmcnt(8) lgkmcnt(0)
    v_mfma_f32_16x16x32_bf16 v[16:19], v[128:131], v[96:99], v[16:19]
    v_mfma_f32_16x16x32_bf16 v[20:23], v[132:135], v[96:99], v[20:23]
    v_mfma_f32_16x16x32_bf16 v[24:27], v[136:139], v[96:99], v[24:27]
    v_mfma_f32_16x16x32_bf16 v[28:31], v[140:143], v[96:99], v[28:31]
    v_mfma_f32_16x16x32_bf16 v[32:35], v[144:147], v[96:99], v[32:35]
    v_mfma_f32_16x16x32_bf16 v[36:39], v[148:151], v[96:99], v[36:39]
    v_mfma_f32_16x16x32_bf16 v[40:43], v[152:155], v[96:99], v[40:43]
    v_mfma_f32_16x16x32_bf16 v[44:47], v[156:159], v[96:99], v[44:47]
    v_add_u32 v10, 10240, v9
    global_load_dwordx4 v[128:131], v10, s[4:5]
    v_add_u32 v10, 26624, v9
    global_load_dwordx4 v[132:135], v10, s[4:5]
    v_add_u32 v10, 43008, v9
    global_load_dwordx4 v[136:139], v10, s[4:5]
    v_add_u32 v10, 59392, v9
    global_load_dwordx4 v[140:143], v10, s[4:5]
    v_add_u32 v10, 75776, v9
    global_load_dwordx4 v[144:147], v10, s[4:5]
    v_add_u32 v10, 92160, v9
    global_load_dwordx4 v[148:151], v10, s[4:5]
    v_add_u32 v10, 108544, v9
    global_load_dwordx4 v[152:155], v10, s[4:5]
    v_add_u32 v10, 124928, v9
    global_load_dwordx4 v[156:159], v10, s[4:5]
    s_waitcnt vmcnt(8) lgkmcnt(0)
    v_mfma_f32_16x16x32_bf16 v[16:19], v[160:163], v[100:103], v[16:19]
    v_mfma_f32_16x16x32_bf16 v[20:23], v[164:167], v[100:103], v[20:23]
    v_mfma_f32_16x16x32_bf16 v[24:27], v[168:171], v[100:103], v[24:27]
    v_mfma_f32_16x16x32_bf16 v[28:31], v[172:175], v[100:103], v[28:31]
    v_mfma_f32_16x16x32_bf16 v[32:35], v[176:179], v[100:103], v[32:35]
    v_mfma_f32_16x16x32_bf16 v[36:39], v[180:183], v[100:103], v[36:39]
    v_mfma_f32_16x16x32_bf16 v[40:43], v[184:187], v[100:103], v[40:43]
    v_mfma_f32_16x16x32_bf16 v[44:47], v[188:191], v[100:103], v[44:47]
    v_add_u32 v10, 11264, v9
    global_load_dwordx4 v[160:163], v10, s[4:5]
    v_add_u32 v10, 27648, v9
    global_load_dwordx4 v[164:167], v10, s[4:5]
    v_add_u32 v10, 44032, v9
    global_load_dwordx4 v[168:171], v10, s[4:5]
    v_add_u32 v10, 60416, v9
    global_load_dwordx4 v[172:175], v10, s[4:5]
    v_add_u32 v10, 76800, v9
    global_load_dwordx4 v[176:179], v10, s[4:5]
    v_add_u32 v10, 93184, v9
    global_load_dwordx4 v[180:183], v10, s[4:5]
    v_add_u32 v10, 109568, v9
    global_load_dwordx4 v[184:187], v10, s[4:5]
    v_add_u32 v10, 125952, v9
    global_load_dwordx4 v[188:191], v10, s[4:5]
    s_waitcnt vmcnt(8) lgkmcnt(0)
    v_mfma_f32_16x16x32_bf16 v[16:19], v[128:131], v[104:107], v[16:19]
    v_mfma_f32_16x16x32_bf16 v[20:23], v[132:135], v[104:107], v[20:23]
    v_mfma_f32_16x16x32_bf16 v[24:27], v[136:139], v[104:107], v[24:27]
    v_mfma_f32_16x16x32_bf16 v[28:31], v[140:143], v[104:107], v[28:31]
    v_mfma_f32_16x16x32_bf16 v[32:35], v[144:147], v[104:107], v[32:35]
    v_mfma_f32_16x16x32_bf16 v[36:39], v[148:151], v[104:107], v[36:39]
    v_mfma_f32_16x16x32_bf16 v[40:43], v[152:155], v[104:107], v[40:43]
    v_mfma_f32_16x16x32_bf16 v[44:47], v[156:159], v[104:107], v[44:47]
    v_add_u32 v10, 12288, v9
    global_load_dwordx4 v[128:131], v10, s[4:5]
    v_add_u32 v10, 28672, v9
    global_load_dwordx4 v[132:135], v10, s[4:5]
    v_add_u32 v10, 45056, v9
    global_load_dwordx4 v[136:139], v10, s[4:5]
    v_add_u32 v10, 61440, v9
    global_load_dwordx4 v[140:143], v10, s[4:5]
    v_add_u32 v10, 77824, v9
    global_load_dwordx4 v[144:147], v10, s[4:5]
    v_add_u32 v10, 94208, v9
    global_load_dwordx4 v[148:151], v10, s[4:5]
    v_add_u32 v10, 110592, v9
    global_load_dwordx4 v[152:155], v10, s[4:5]
    v_add_u32 v10, 126976, v9
    global_load_dwordx4 v[156:159], v10, s[4:5]
    s_waitcnt vmcnt(8) lgkmcnt(0)
    v_mfma_f32_16x16x32_bf16 v[16:19], v[160:163], v[108:111], v[16:19]
    v_mfma_f32_16x16x32_bf16 v[20:23], v[164:167], v[108:111], v[20:23]
    v_mfma_f32_16x16x32_bf16 v[24:27], v[168:171], v[108:111], v[24:27]
    v_mfma_f32_16x16x32_bf16 v[28:31], v[172:175], v[108:111], v[28:31]
    v_mfma_f32_16x16x32_bf16 v[32:35], v[176:179], v[108:111], v[32:35]
    v_mfma_f32_16x16x32_bf16 v[36:39], v[180:183], v[108:111], v[36:39]
    v_mfma_f32_16x16x32_bf16 v[40:43], v[184:187], v[108:111], v[40:43]
    v_mfma_f32_16x16x32_bf16 v[44:47], v[188:191], v[108:111], v[44:47]
    v_add_u32 v10, 13312, v9
    global_load_dwordx4 v[160:163], v10, s[4:5]
    v_add_u32 v10, 29696, v9
    global_load_dwordx4 v[164:167], v10, s[4:5]
    v_add_u32 v10, 46080, v9
    global_load_dwordx4 v[168:171], v10, s[4:5]
    v_add_u32 v10, 62464, v9
    global_load_dwordx4 v[172:175], v10, s[4:5]
    v_add_u32 v10, 78848, v9
    global_load_dwordx4 v[176:179], v10, s[4:5]
    v_add_u32 v10, 95232, v9
    global_load_dwordx4 v[180:183], v10, s[4:5]
    v_add_u32 v10, 111616, v9
    global_load_dwordx4 v[184:187], v10, s[4:5]
    v_add_u32 v10, 128000, v9
    global_load_dwordx4 v[188:191], v10, s[4:5]
    s_waitcnt vmcnt(8) lgkmcnt(0)
    v_mfma_f32_16x16x32_bf16 v[16:19], v[128:131], v[112:115], v[16:19]
    v_mfma_f32_16x16x32_bf16 v[20:23], v[132:135], v[112:115], v[20:23]
    v_mfma_f32_16x16x32_bf16 v[24:27], v[136:139], v[112:115], v[24:27]
    v_mfma_f32_16x16x32_bf16 v[28:31], v[140:143], v[112:115], v[28:31]
    v_mfma_f32_16x16x32_bf16 v[32:35], v[144:147], v[112:115], v[32:35]
    v_mfma_f32_16x16x32_bf16 v[36:39], v[148:151], v[112:115], v[36:39]
    v_mfma_f32_16x16x32_bf16 v[40:43], v[152:155], v[112:115], v[40:43]
    v_mfma_f32_16x16x32_bf16 v[44:47], v[156:159], v[112:115], v[44:47]
    v_add_u32 v10, 14336, v9
    global_load_dwordx4 v[128:131], v10, s[4:5]
    v_add_u32 v10, 30720, v9
    global_load_dwordx4 v[132:135], v10, s[4:5]
    v_add_u32 v10, 47104, v9
    global_load_dwordx4 v[136:139], v10, s[4:5]
    v_add_u32 v10, 63488, v9
    global_load_dwordx4 v[140:143], v10, s[4:5]
    v_add_u32 v10, 79872, v9
    global_load_dwordx4 v[144:147], v10, s[4:5]
    v_add_u32 v10, 96256, v9
    global_load_dwordx4 v[148:151], v10, s[4:5]
    v_add_u32 v10, 112640, v9
    global_load_dwordx4 v[152:155], v10, s[4:5]
    v_add_u32 v10, 129024, v9
    global_load_dwordx4 v[156:159], v10, s[4:5]
    s_waitcnt vmcnt(8) lgkmcnt(0)
    v_mfma_f32_16x16x32_bf16 v[16:19], v[160:163], v[116:119], v[16:19]
    v_mfma_f32_16x16x32_bf16 v[20:23], v[164:167], v[116:119], v[20:23]
    v_mfma_f32_16x16x32_bf16 v[24:27], v[168:171], v[116:119], v[24:27]
    v_mfma_f32_16x16x32_bf16 v[28:31], v[172:175], v[116:119], v[28:31]
    v_mfma_f32_16x16x32_bf16 v[32:35], v[176:179], v[116:119], v[32:35]
    v_mfma_f32_16x16x32_bf16 v[36:39], v[180:183], v[116:119], v[36:39]
    v_mfma_f32_16x16x32_bf16 v[40:43], v[184:187], v[116:119], v[40:43]
    v_mfma_f32_16x16x32_bf16 v[44:47], v[188:191], v[116:119], v[44:47]
    v_add_u32 v10, 15360, v9
    global_load_dwordx4 v[160:163], v10, s[4:5]
    v_add_u32 v10, 31744, v9
    global_load_dwordx4 v[164:167], v10, s[4:5]
    v_add_u32 v10, 48128, v9
    global_load_dwordx4 v[168:171], v10, s[4:5]
    v_add_u32 v10, 64512, v9
    global_load_dwordx4 v[172:175], v10, s[4:5]
    v_add_u32 v10, 80896, v9
    global_load_dwordx4 v[176:179], v10, s[4:5]
    v_add_u32 v10, 97280, v9
    global_load_dwordx4 v[180:183], v10, s[4:5]
    v_add_u32 v10, 113664, v9
    global_load_dwordx4 v[184:187], v10, s[4:5]
    v_add_u32 v10, 130048, v9
    global_load_dwordx4 v[188:191], v10, s[4:5]
    s_waitcnt vmcnt(8) lgkmcnt(0)
    v_mfma_f32_16x16x32_bf16 v[16:19], v[128:131], v[120:123], v[16:19]
    v_mfma_f32_16x16x32_bf16 v[20:23], v[132:135], v[120:123], v[20:23]
    v_mfma_f32_16x16x32_bf16 v[24:27], v[136:139], v[120:123], v[24:27]
    v_mfma_f32_16x16x32_bf16 v[28:31], v[140:143], v[120:123], v[28:31]
    v_mfma_f32_16x16x32_bf16 v[32:35], v[144:147], v[120:123], v[32:35]
    v_mfma_f32_16x16x32_bf16 v[36:39], v[148:151], v[120:123], v[36:39]
    v_mfma_f32_16x16x32_bf16 v[40:43], v[152:155], v[120:123], v[40:43]
    v_mfma_f32_16x16x32_bf16 v[44:47], v[156:159], v[120:123], v[44:47]
    s_waitcnt vmcnt(0)
    v_mfma_f32_16x16x32_bf16 v[16:19], v[160:163], v[124:127], v[16:19]
    v_mfma_f32_16x16x32_bf16 v[20:23], v[164:167], v[124:127], v[20:23]
    v_mfma_f32_16x16x32_bf16 v[24:27], v[168:171], v[124:127], v[24:27]
    v_mfma_f32_16x16x32_bf16 v[28:31], v[172:175], v[124:127], v[28:31]
    v_mfma_f32_16x16x32_bf16 v[32:35], v[176:179], v[124:127], v[32:35]
    v_mfma_f32_16x16x32_bf16 v[36:39], v[180:183], v[124:127], v[36:39]
    v_mfma_f32_16x16x32_bf16 v[40:43], v[184:187], v[124:127], v[40:43]
    v_mfma_f32_16x16x32_bf16 v[44:47], v[188:191], v[124:127], v[44:47]
    s_lshl_b32 s13, s2, 4
    v_add_u32 v6, s13, v3
    v_lshlrev_b32 v6, 10, v6
    s_lshl_b32 s14, s12, 8
    v_add_u32 v6, s14, v6
    v_lshl_add_u32 v6, v2, 3, v6
    v_add_u32 v7, 121634816, v6
    global_load_dwordx2 v[48:49], v7, s[4:5] offset:0
    global_load_dwordx2 v[50:51], v7, s[4:5] offset:32
    global_load_dwordx2 v[52:53], v7, s[4:5] offset:64
    global_load_dwordx2 v[54:55], v7, s[4:5] offset:96
    global_load_dwordx2 v[56:57], v7, s[4:5] offset:128
    global_load_dwordx2 v[58:59], v7, s[4:5] offset:160
    global_load_dwordx2 v[60:61], v7, s[4:5] offset:192
    global_load_dwordx2 v[62:63], v7, s[4:5] offset:224
    s_waitcnt vmcnt(0)
    v_cvt_pk_bf16_f32 v11, v16, v17
    v_lshlrev_b32 v16, 16, v11
    v_and_b32 v17, 0xffff0000, v11
    v_cvt_pk_bf16_f32 v11, v18, v19
    v_lshlrev_b32 v18, 16, v11
    v_and_b32 v19, 0xffff0000, v11
    v_lshlrev_b32 v12, 16, v48
    v_and_b32 v13, 0xffff0000, v48
    v_lshlrev_b32 v14, 16, v49
    v_and_b32 v15, 0xffff0000, v49
    v_add_f32 v16, v16, v12
    v_add_f32 v17, v17, v13
    v_add_f32 v18, v18, v14
    v_add_f32 v19, v19, v15
    v_cvt_pk_bf16_f32 v48, v16, v17
    v_cvt_pk_bf16_f32 v49, v18, v19
    global_store_dwordx2 v6, v[48:49], s[6:7] offset:0
    v_lshlrev_b32 v16, 16, v48
    v_and_b32 v17, 0xffff0000, v48
    v_lshlrev_b32 v18, 16, v49
    v_and_b32 v19, 0xffff0000, v49
    v_cvt_pk_bf16_f32 v11, v20, v21
    v_lshlrev_b32 v20, 16, v11
    v_and_b32 v21, 0xffff0000, v11
    v_cvt_pk_bf16_f32 v11, v22, v23
    v_lshlrev_b32 v22, 16, v11
    v_and_b32 v23, 0xffff0000, v11
    v_lshlrev_b32 v12, 16, v50
    v_and_b32 v13, 0xffff0000, v50
    v_lshlrev_b32 v14, 16, v51
    v_and_b32 v15, 0xffff0000, v51
    v_add_f32 v20, v20, v12
    v_add_f32 v21, v21, v13
    v_add_f32 v22, v22, v14
    v_add_f32 v23, v23, v15
    v_cvt_pk_bf16_f32 v50, v20, v21
    v_cvt_pk_bf16_f32 v51, v22, v23
    global_store_dwordx2 v6, v[50:51], s[6:7] offset:32
    v_lshlrev_b32 v20, 16, v50
    v_and_b32 v21, 0xffff0000, v50
    v_lshlrev_b32 v22, 16, v51
    v_and_b32 v23, 0xffff0000, v51
    v_cvt_pk_bf16_f32 v11, v24, v25
    v_lshlrev_b32 v24, 16, v11
    v_and_b32 v25, 0xffff0000, v11
    v_cvt_pk_bf16_f32 v11, v26, v27
    v_lshlrev_b32 v26, 16, v11
    v_and_b32 v27, 0xffff0000, v11
    v_lshlrev_b32 v12, 16, v52
    v_and_b32 v13, 0xffff0000, v52
    v_lshlrev_b32 v14, 16, v53
    v_and_b32 v15, 0xffff0000, v53
    v_add_f32 v24, v24, v12
    v_add_f32 v25, v25, v13
    v_add_f32 v26, v26, v14
    v_add_f32 v27, v27, v15
    v_cvt_pk_bf16_f32 v52, v24, v25
    v_cvt_pk_bf16_f32 v53, v26, v27
    global_store_dwordx2 v6, v[52:53], s[6:7] offset:64
    v_lshlrev_b32 v24, 16, v52
    v_and_b32 v25, 0xffff0000, v52
    v_lshlrev_b32 v26, 16, v53
    v_and_b32 v27, 0xffff0000, v53
    v_cvt_pk_bf16_f32 v11, v28, v29
    v_lshlrev_b32 v28, 16, v11
    v_and_b32 v29, 0xffff0000, v11
    v_cvt_pk_bf16_f32 v11, v30, v31
    v_lshlrev_b32 v30, 16, v11
    v_and_b32 v31, 0xffff0000, v11
    v_lshlrev_b32 v12, 16, v54
    v_and_b32 v13, 0xffff0000, v54
    v_lshlrev_b32 v14, 16, v55
    v_and_b32 v15, 0xffff0000, v55
    v_add_f32 v28, v28, v12
    v_add_f32 v29, v29, v13
    v_add_f32 v30, v30, v14
    v_add_f32 v31, v31, v15
    v_cvt_pk_bf16_f32 v54, v28, v29
    v_cvt_pk_bf16_f32 v55, v30, v31
    global_store_dwordx2 v6, v[54:55], s[6:7] offset:96
    v_lshlrev_b32 v28, 16, v54
    v_and_b32 v29, 0xffff0000, v54
    v_lshlrev_b32 v30, 16, v55
    v_and_b32 v31, 0xffff0000, v55
    v_cvt_pk_bf16_f32 v11, v32, v33
    v_lshlrev_b32 v32, 16, v11
    v_and_b32 v33, 0xffff0000, v11
    v_cvt_pk_bf16_f32 v11, v34, v35
    v_lshlrev_b32 v34, 16, v11
    v_and_b32 v35, 0xffff0000, v11
    v_lshlrev_b32 v12, 16, v56
    v_and_b32 v13, 0xffff0000, v56
    v_lshlrev_b32 v14, 16, v57
    v_and_b32 v15, 0xffff0000, v57
    v_add_f32 v32, v32, v12
    v_add_f32 v33, v33, v13
    v_add_f32 v34, v34, v14
    v_add_f32 v35, v35, v15
    v_cvt_pk_bf16_f32 v56, v32, v33
    v_cvt_pk_bf16_f32 v57, v34, v35
    global_store_dwordx2 v6, v[56:57], s[6:7] offset:128
    v_lshlrev_b32 v32, 16, v56
    v_and_b32 v33, 0xffff0000, v56
    v_lshlrev_b32 v34, 16, v57
    v_and_b32 v35, 0xffff0000, v57
    v_cvt_pk_bf16_f32 v11, v36, v37
    v_lshlrev_b32 v36, 16, v11
    v_and_b32 v37, 0xffff0000, v11
    v_cvt_pk_bf16_f32 v11, v38, v39
    v_lshlrev_b32 v38, 16, v11
    v_and_b32 v39, 0xffff0000, v11
    v_lshlrev_b32 v12, 16, v58
    v_and_b32 v13, 0xffff0000, v58
    v_lshlrev_b32 v14, 16, v59
    v_and_b32 v15, 0xffff0000, v59
    v_add_f32 v36, v36, v12
    v_add_f32 v37, v37, v13
    v_add_f32 v38, v38, v14
    v_add_f32 v39, v39, v15
    v_cvt_pk_bf16_f32 v58, v36, v37
    v_cvt_pk_bf16_f32 v59, v38, v39
    global_store_dwordx2 v6, v[58:59], s[6:7] offset:160
    v_lshlrev_b32 v36, 16, v58
    v_and_b32 v37, 0xffff0000, v58
    v_lshlrev_b32 v38, 16, v59
    v_and_b32 v39, 0xffff0000, v59
    v_cvt_pk_bf16_f32 v11, v40, v41
    v_lshlrev_b32 v40, 16, v11
    v_and_b32 v41, 0xffff0000, v11
    v_cvt_pk_bf16_f32 v11, v42, v43
    v_lshlrev_b32 v42, 16, v11
    v_and_b32 v43, 0xffff0000, v11
    v_lshlrev_b32 v12, 16, v60
    v_and_b32 v13, 0xffff0000, v60
    v_lshlrev_b32 v14, 16, v61
    v_and_b32 v15, 0xffff0000, v61
    v_add_f32 v40, v40, v12
    v_add_f32 v41, v41, v13
    v_add_f32 v42, v42, v14
    v_add_f32 v43, v43, v15
    v_cvt_pk_bf16_f32 v60, v40, v41
    v_cvt_pk_bf16_f32 v61, v42, v43
    global_store_dwordx2 v6, v[60:61], s[6:7] offset:192
    v_lshlrev_b32 v40, 16, v60
    v_and_b32 v41, 0xffff0000, v60
    v_lshlrev_b32 v42, 16, v61
    v_and_b32 v43, 0xffff0000, v61
    v_cvt_pk_bf16_f32 v11, v44, v45
    v_lshlrev_b32 v44, 16, v11
    v_and_b32 v45, 0xffff0000, v11
    v_cvt_pk_bf16_f32 v11, v46, v47
    v_lshlrev_b32 v46, 16, v11
    v_and_b32 v47, 0xffff0000, v11
    v_lshlrev_b32 v12, 16, v62
    v_and_b32 v13, 0xffff0000, v62
    v_lshlrev_b32 v14, 16, v63
    v_and_b32 v15, 0xffff0000, v63
    v_add_f32 v44, v44, v12
    v_add_f32 v45, v45, v13
    v_add_f32 v46, v46, v14
    v_add_f32 v47, v47, v15
    v_cvt_pk_bf16_f32 v62, v44, v45
    v_cvt_pk_bf16_f32 v63, v46, v47
    global_store_dwordx2 v6, v[62:63], s[6:7] offset:224
    v_lshlrev_b32 v44, 16, v62
    v_and_b32 v45, 0xffff0000, v62
    v_lshlrev_b32 v46, 16, v63
    v_and_b32 v47, 0xffff0000, v63
    v_add_f32 v8, v16, v17
    v_add_f32 v8, v8, v18
    v_add_f32 v8, v8, v19
    v_add_f32 v8, v8, v20
    v_add_f32 v8, v8, v21
    v_add_f32 v8, v8, v22
    v_add_f32 v8, v8, v23
    v_add_f32 v8, v8, v24
    v_add_f32 v8, v8, v25
    v_add_f32 v8, v8, v26
    v_add_f32 v8, v8, v27
    v_add_f32 v8, v8, v28
    v_add_f32 v8, v8, v29
    v_add_f32 v8, v8, v30
    v_add_f32 v8, v8, v31
    v_add_f32 v8, v8, v32
    v_add_f32 v8, v8, v33
    v_add_f32 v8, v8, v34
    v_add_f32 v8, v8, v35
    v_add_f32 v8, v8, v36
    v_add_f32 v8, v8, v37
    v_add_f32 v8, v8, v38
    v_add_f32 v8, v8, v39
    v_add_f32 v8, v8, v40
    v_add_f32 v8, v8, v41
    v_add_f32 v8, v8, v42
    v_add_f32 v8, v8, v43
    v_add_f32 v8, v8, v44
    v_add_f32 v8, v8, v45
    v_add_f32 v8, v8, v46
    v_add_f32 v8, v8, v47
    v_mov_b32 v9, v8
    v_mov_b32 v10, v8
    s_nop 1
    v_permlane32_swap_b32 v9, v10
    s_nop 1
    v_add_f32 v8, v9, v10
    v_mov_b32 v9, v8
    v_mov_b32 v10, v8
    s_nop 1
    v_permlane16_swap_b32 v9, v10
    s_nop 1
    v_add_f32 v8, v9, v10
    v_lshlrev_b32 v11, 2, v3
    v_add_u32 v11, 16384, v11
    s_lshl_b32 s14, s12, 6
    v_add_u32 v12, s14, v11
    ds_write_b32 v12, v8
    s_waitcnt lgkmcnt(0)
    s_barrier
    ds_read_b32 v8, v11
    ds_read_b32 v9, v11 offset:64
    ds_read_b32 v10, v11 offset:128
    ds_read_b32 v13, v11 offset:192
    s_waitcnt lgkmcnt(0)
    v_add_f32 v8, v8, v9
    v_add_f32 v10, v10, v13
    v_add_f32 v8, v8, v10
    v_mul_f32 v8, 0x3b000000, v8
    v_mov_b32 v14, 0
    v_sub_f32 v9, v16, v8
    v_fmac_f32 v14, v9, v9
    v_sub_f32 v9, v17, v8
    v_fmac_f32 v14, v9, v9
    v_sub_f32 v9, v18, v8
    v_fmac_f32 v14, v9, v9
    v_sub_f32 v9, v19, v8
    v_fmac_f32 v14, v9, v9
    v_sub_f32 v9, v20, v8
    v_fmac_f32 v14, v9, v9
    v_sub_f32 v9, v21, v8
    v_fmac_f32 v14, v9, v9
    v_sub_f32 v9, v22, v8
    v_fmac_f32 v14, v9, v9
    v_sub_f32 v9, v23, v8
    v_fmac_f32 v14, v9, v9
    v_sub_f32 v9, v24, v8
    v_fmac_f32 v14, v9, v9
    v_sub_f32 v9, v25, v8
    v_fmac_f32 v14, v9, v9
    v_sub_f32 v9, v26, v8
    v_fmac_f32 v14, v9, v9
    v_sub_f32 v9, v27, v8
    v_fmac_f32 v14, v9, v9
    v_sub_f32 v9, v28, v8
    v_fmac_f32 v14, v9, v9
    v_sub_f32 v9, v29, v8
    v_fmac_f32 v14, v9, v9
    v_sub_f32 v9, v30, v8
    v_fmac_f32 v14, v9, v9
    v_sub_f32 v9, v31, v8
    v_fmac_f32 v14, v9, v9
    v_sub_f32 v9, v32, v8
    v_fmac_f32 v14, v9, v9
    v_sub_f32 v9, v33, v8
    v_fmac_f32 v14, v9, v9
    v_sub_f32 v9, v34, v8
    v_fmac_f32 v14, v9, v9
    v_sub_f32 v9, v35, v8
    v_fmac_f32 v14, v9, v9
    v_sub_f32 v9, v36, v8
    v_fmac_f32 v14, v9, v9
    v_sub_f32 v9, v37, v8
    v_fmac_f32 v14, v9, v9
    v_sub_f32 v9, v38, v8
    v_fmac_f32 v14, v9, v9
    v_sub_f32 v9, v39, v8
    v_fmac_f32 v14, v9, v9
    v_sub_f32 v9, v40, v8
    v_fmac_f32 v14, v9, v9
    v_sub_f32 v9, v41, v8
    v_fmac_f32 v14, v9, v9
    v_sub_f32 v9, v42, v8
    v_fmac_f32 v14, v9, v9
    v_sub_f32 v9, v43, v8
    v_fmac_f32 v14, v9, v9
    v_sub_f32 v9, v44, v8
    v_fmac_f32 v14, v9, v9
    v_sub_f32 v9, v45, v8
    v_fmac_f32 v14, v9, v9
    v_sub_f32 v9, v46, v8
    v_fmac_f32 v14, v9, v9
    v_sub_f32 v9, v47, v8
    v_fmac_f32 v14, v9, v9
    v_mov_b32 v9, v14
    v_mov_b32 v10, v14
    s_nop 1
    v_permlane32_swap_b32 v9, v10
    s_nop 1
    v_add_f32 v14, v9, v10
    v_mov_b32 v9, v14
    v_mov_b32 v10, v14
    s_nop 1
    v_permlane16_swap_b32 v9, v10
    s_nop 1
    v_add_f32 v14, v9, v10
    ds_write_b32 v12, v14 offset:256
    s_waitcnt lgkmcnt(0)
    s_barrier
    ds_read_b32 v14, v11 offset:256
    ds_read_b32 v9, v11 offset:320
    ds_read_b32 v10, v11 offset:384
    ds_read_b32 v13, v11 offset:448
    s_waitcnt lgkmcnt(0)
    v_add_f32 v14, v14, v9
    v_add_f32 v10, v10, v13
    v_add_f32 v14, v14, v10
    v_mul_f32 v14, 0x3b000000, v14
    v_cvt_pk_bf16_f32 v9, v8, v14
    v_lshlrev_b32 v8, 16, v9
    v_and_b32 v14, 0xffff0000, v9
    v_add_f32 v14, 0x3727c5ac, v14
    v_cvt_pk_bf16_f32 v9, v14, v14
    v_lshlrev_b32 v14, 16, v9
    v_sqrt_f32 v14, v14
    s_nop 0
    v_cvt_pk_bf16_f32 v9, v14, v14
    v_lshlrev_b32 v14, 16, v9
    v_rcp_f32 v15, v14
    s_nop 0
    s_lshl_b32 s13, s2, 14
    s_lshl_b32 s14, s12, 12
    s_add_u32 s13, s13, s14
    s_add_u32 s13, s13, 18874368
    v_lshrrev_b32 v6, 1, v2
    v_lshlrev_b32 v6, 8, v6
    v_lshl_add_u32 v6, v3, 4, v6
    v_and_b32 v7, 1, v2
    v_lshl_add_u32 v6, v7, 3, v6
    v_add_u32 v6, s13, v6
    v_sub_f32 v16, v16, v8
    v_sub_f32 v17, v17, v8
    v_cvt_pk_bf16_f32 v9, v16, v17
    v_lshlrev_b32 v16, 16, v9
    v_and_b32 v17, 0xffff0000, v9
    v_mul_f32 v9, v16, v15
    v_fma_f32 v10, -v9, v14, v16
    v_fma_f32 v16, v10, v15, v9
    v_mul_f32 v9, v17, v15
    v_fma_f32 v10, -v9, v14, v17
    v_fma_f32 v17, v10, v15, v9
    v_sub_f32 v18, v18, v8
    v_sub_f32 v19, v19, v8
    v_cvt_pk_bf16_f32 v9, v18, v19
    v_lshlrev_b32 v18, 16, v9
    v_and_b32 v19, 0xffff0000, v9
    v_mul_f32 v9, v18, v15
    v_fma_f32 v10, -v9, v14, v18
    v_fma_f32 v18, v10, v15, v9
    v_mul_f32 v9, v19, v15
    v_fma_f32 v10, -v9, v14, v19
    v_fma_f32 v19, v10, v15, v9
    v_cvt_pk_bf16_f32 v64, v16, v17
    v_cvt_pk_bf16_f32 v65, v18, v19
    global_store_dwordx2 v6, v[64:65], s[4:5] offset:0
    v_sub_f32 v20, v20, v8
    v_sub_f32 v21, v21, v8
    v_cvt_pk_bf16_f32 v9, v20, v21
    v_lshlrev_b32 v20, 16, v9
    v_and_b32 v21, 0xffff0000, v9
    v_mul_f32 v9, v20, v15
    v_fma_f32 v10, -v9, v14, v20
    v_fma_f32 v20, v10, v15, v9
    v_mul_f32 v9, v21, v15
    v_fma_f32 v10, -v9, v14, v21
    v_fma_f32 v21, v10, v15, v9
    v_sub_f32 v22, v22, v8
    v_sub_f32 v23, v23, v8
    v_cvt_pk_bf16_f32 v9, v22, v23
    v_lshlrev_b32 v22, 16, v9
    v_and_b32 v23, 0xffff0000, v9
    v_mul_f32 v9, v22, v15
    v_fma_f32 v10, -v9, v14, v22
    v_fma_f32 v22, v10, v15, v9
    v_mul_f32 v9, v23, v15
    v_fma_f32 v10, -v9, v14, v23
    v_fma_f32 v23, v10, v15, v9
    v_cvt_pk_bf16_f32 v66, v20, v21
    v_cvt_pk_bf16_f32 v67, v22, v23
    global_store_dwordx2 v6, v[66:67], s[4:5] offset:512
    v_sub_f32 v24, v24, v8
    v_sub_f32 v25, v25, v8
    v_cvt_pk_bf16_f32 v9, v24, v25
    v_lshlrev_b32 v24, 16, v9
    v_and_b32 v25, 0xffff0000, v9
    v_mul_f32 v9, v24, v15
    v_fma_f32 v10, -v9, v14, v24
    v_fma_f32 v24, v10, v15, v9
    v_mul_f32 v9, v25, v15
    v_fma_f32 v10, -v9, v14, v25
    v_fma_f32 v25, v10, v15, v9
    v_sub_f32 v26, v26, v8
    v_sub_f32 v27, v27, v8
    v_cvt_pk_bf16_f32 v9, v26, v27
    v_lshlrev_b32 v26, 16, v9
    v_and_b32 v27, 0xffff0000, v9
    v_mul_f32 v9, v26, v15
    v_fma_f32 v10, -v9, v14, v26
    v_fma_f32 v26, v10, v15, v9
    v_mul_f32 v9, v27, v15
    v_fma_f32 v10, -v9, v14, v27
    v_fma_f32 v27, v10, v15, v9
    v_cvt_pk_bf16_f32 v68, v24, v25
    v_cvt_pk_bf16_f32 v69, v26, v27
    global_store_dwordx2 v6, v[68:69], s[4:5] offset:1024
    v_sub_f32 v28, v28, v8
    v_sub_f32 v29, v29, v8
    v_cvt_pk_bf16_f32 v9, v28, v29
    v_lshlrev_b32 v28, 16, v9
    v_and_b32 v29, 0xffff0000, v9
    v_mul_f32 v9, v28, v15
    v_fma_f32 v10, -v9, v14, v28
    v_fma_f32 v28, v10, v15, v9
    v_mul_f32 v9, v29, v15
    v_fma_f32 v10, -v9, v14, v29
    v_fma_f32 v29, v10, v15, v9
    v_sub_f32 v30, v30, v8
    v_sub_f32 v31, v31, v8
    v_cvt_pk_bf16_f32 v9, v30, v31
    v_lshlrev_b32 v30, 16, v9
    v_and_b32 v31, 0xffff0000, v9
    v_mul_f32 v9, v30, v15
    v_fma_f32 v10, -v9, v14, v30
    v_fma_f32 v30, v10, v15, v9
    v_mul_f32 v9, v31, v15
    v_fma_f32 v10, -v9, v14, v31
    v_fma_f32 v31, v10, v15, v9
    v_cvt_pk_bf16_f32 v70, v28, v29
    v_cvt_pk_bf16_f32 v71, v30, v31
    global_store_dwordx2 v6, v[70:71], s[4:5] offset:1536
    v_sub_f32 v32, v32, v8
    v_sub_f32 v33, v33, v8
    v_cvt_pk_bf16_f32 v9, v32, v33
    v_lshlrev_b32 v32, 16, v9
    v_and_b32 v33, 0xffff0000, v9
    v_mul_f32 v9, v32, v15
    v_fma_f32 v10, -v9, v14, v32
    v_fma_f32 v32, v10, v15, v9
    v_mul_f32 v9, v33, v15
    v_fma_f32 v10, -v9, v14, v33
    v_fma_f32 v33, v10, v15, v9
    v_sub_f32 v34, v34, v8
    v_sub_f32 v35, v35, v8
    v_cvt_pk_bf16_f32 v9, v34, v35
    v_lshlrev_b32 v34, 16, v9
    v_and_b32 v35, 0xffff0000, v9
    v_mul_f32 v9, v34, v15
    v_fma_f32 v10, -v9, v14, v34
    v_fma_f32 v34, v10, v15, v9
    v_mul_f32 v9, v35, v15
    v_fma_f32 v10, -v9, v14, v35
    v_fma_f32 v35, v10, v15, v9
    v_cvt_pk_bf16_f32 v72, v32, v33
    v_cvt_pk_bf16_f32 v73, v34, v35
    global_store_dwordx2 v6, v[72:73], s[4:5] offset:2048
    v_sub_f32 v36, v36, v8
    v_sub_f32 v37, v37, v8
    v_cvt_pk_bf16_f32 v9, v36, v37
    v_lshlrev_b32 v36, 16, v9
    v_and_b32 v37, 0xffff0000, v9
    v_mul_f32 v9, v36, v15
    v_fma_f32 v10, -v9, v14, v36
    v_fma_f32 v36, v10, v15, v9
    v_mul_f32 v9, v37, v15
    v_fma_f32 v10, -v9, v14, v37
    v_fma_f32 v37, v10, v15, v9
    v_sub_f32 v38, v38, v8
    v_sub_f32 v39, v39, v8
    v_cvt_pk_bf16_f32 v9, v38, v39
    v_lshlrev_b32 v38, 16, v9
    v_and_b32 v39, 0xffff0000, v9
    v_mul_f32 v9, v38, v15
    v_fma_f32 v10, -v9, v14, v38
    v_fma_f32 v38, v10, v15, v9
    v_mul_f32 v9, v39, v15
    v_fma_f32 v10, -v9, v14, v39
    v_fma_f32 v39, v10, v15, v9
    v_cvt_pk_bf16_f32 v74, v36, v37
    v_cvt_pk_bf16_f32 v75, v38, v39
    global_store_dwordx2 v6, v[74:75], s[4:5] offset:2560
    v_sub_f32 v40, v40, v8
    v_sub_f32 v41, v41, v8
    v_cvt_pk_bf16_f32 v9, v40, v41
    v_lshlrev_b32 v40, 16, v9
    v_and_b32 v41, 0xffff0000, v9
    v_mul_f32 v9, v40, v15
    v_fma_f32 v10, -v9, v14, v40
    v_fma_f32 v40, v10, v15, v9
    v_mul_f32 v9, v41, v15
    v_fma_f32 v10, -v9, v14, v41
    v_fma_f32 v41, v10, v15, v9
    v_sub_f32 v42, v42, v8
    v_sub_f32 v43, v43, v8
    v_cvt_pk_bf16_f32 v9, v42, v43
    v_lshlrev_b32 v42, 16, v9
    v_and_b32 v43, 0xffff0000, v9
    v_mul_f32 v9, v42, v15
    v_fma_f32 v10, -v9, v14, v42
    v_fma_f32 v42, v10, v15, v9
    v_mul_f32 v9, v43, v15
    v_fma_f32 v10, -v9, v14, v43
    v_fma_f32 v43, v10, v15, v9
    v_cvt_pk_bf16_f32 v76, v40, v41
    v_cvt_pk_bf16_f32 v77, v42, v43
    global_store_dwordx2 v6, v[76:77], s[4:5] offset:3072
    v_sub_f32 v44, v44, v8
    v_sub_f32 v45, v45, v8
    v_cvt_pk_bf16_f32 v9, v44, v45
    v_lshlrev_b32 v44, 16, v9
    v_and_b32 v45, 0xffff0000, v9
    v_mul_f32 v9, v44, v15
    v_fma_f32 v10, -v9, v14, v44
    v_fma_f32 v44, v10, v15, v9
    v_mul_f32 v9, v45, v15
    v_fma_f32 v10, -v9, v14, v45
    v_fma_f32 v45, v10, v15, v9
    v_sub_f32 v46, v46, v8
    v_sub_f32 v47, v47, v8
    v_cvt_pk_bf16_f32 v9, v46, v47
    v_lshlrev_b32 v46, 16, v9
    v_and_b32 v47, 0xffff0000, v9
    v_mul_f32 v9, v46, v15
    v_fma_f32 v10, -v9, v14, v46
    v_fma_f32 v46, v10, v15, v9
    v_mul_f32 v9, v47, v15
    v_fma_f32 v10, -v9, v14, v47
    v_fma_f32 v47, v10, v15, v9
    v_cvt_pk_bf16_f32 v78, v44, v45
    v_cvt_pk_bf16_f32 v79, v46, v47
    global_store_dwordx2 v6, v[78:79], s[4:5] offset:3584
L_b2a_kernel_1:
    s_endpgm
M_b2af_kernel_1:
    s_sub_u32 s2, s2, 128
    s_load_dwordx2 s[4:5], s[0:1], 96
    s_cmp_ge_u32 s2, 65
    s_cbranch_scc1 L_fillb_kernel_1
    v_mov_b32 v4, -1
    v_mov_b32 v5, -1
    v_mov_b32 v6, -1
    v_mov_b32 v7, -1
    s_lshl_b32 s6, s2, 14
    v_lshlrev_b32 v1, 4, v0
    v_add_u32 v1, s6, v1
    v_add_u32 v1, 127926272, v1
    s_waitcnt lgkmcnt(0)
    global_store_dwordx4 v1, v[4:7], s[4:5]
    v_add_u32 v1, 4096, v1
    global_store_dwordx4 v1, v[4:7], s[4:5]
    v_add_u32 v1, 4096, v1
    global_store_dwordx4 v1, v[4:7], s[4:5]
    v_add_u32 v1, 4096, v1
    global_store_dwordx4 v1, v[4:7], s[4:5]
    v_add_u32 v1, 4096, v1
    s_cmp_eq_u32 s2, 64
    s_cbranch_scc0 L_fillb_kernel_1
    global_store_dwordx4 v1, v[4:7], s[4:5]
    v_add_u32 v1, 4096, v1
    global_store_dwordx4 v1, v[4:7], s[4:5]
    v_add_u32 v1, 4096, v1
    v_mov_b32 v8, 0
    v_mov_b32 v9, 0
    v_mov_b32 v10, 0
    v_mov_b32 v11, 0
    v_lshlrev_b32 v1, 4, v0
    v_add_u32 v1, 129007616, v1
    global_store_dwordx4 v1, v[8:11], s[4:5]
    global_store_dwordx4 v1, v[8:11], s[4:5] offset:4080
    v_add_u32 v1, 8176, v1
    global_store_dwordx4 v1, v[8:11], s[4:5]
L_fillb_kernel_1:
    s_endpgm
M_b2af_kernel_end:
    s_endpgm
.globl b2b_kernel
.p2align 8
.type b2b_kernel,@function
b2b_kernel:
    s_cmp_ge_u32 s2, 128
    s_cbranch_scc1 L_b2b_kernel_1
    s_load_dwordx2 s[4:5], s[0:1], 96
    s_load_dwordx2 s[6:7], s[0:1], 80
    v_and_b32 v1, 63, v0
    v_lshrrev_b32 v4, 6, v0
    v_bfe_u32 v2, v0, 4, 2
    v_and_b32 v3, 15, v0
    v_lshlrev_b32 v5, 4, v1
    s_nop 0
    v_readfirstlane_b32 s12, v4
    s_lshl_b32 s13, s2, 14
    s_lshl_b32 s14, s12, 12
    s_add_u32 s13, s13, s14
    v_add_u32 v6, s13, v5
    v_add_u32 v6, 130023424, v6
    s_lshl_b32 s14, s12, 13
    v_lshrrev_b32 v7, 1, v5
    v_add_u32 v7, s14, v7
    v_add_u32 v7, 134217728, v7
    v_add_u32 v8, 4096, v7
    s_waitcnt lgkmcnt(0)
    global_load_dwordx4 v[16:19], v6, s[4:5] offset:0
    global_load_dwordx4 v[20:23], v6, s[4:5] offset:1024
    global_load_dwordx4 v[24:27], v6, s[4:5] offset:2048
    global_load_dwordx4 v[28:31], v6, s[4:5] offset:3072
    global_load_dwordx2 v[32:33], v7, s[4:5] offset:0
    global_load_dwordx2 v[34:35], v7, s[4:5] offset:512
    global_load_dwordx2 v[36:37], v7, s[4:5] offset:1024
    global_load_dwordx2 v[38:39], v7, s[4:5] offset:1536
    global_load_dwordx2 v[40:41], v7, s[4:5] offset:2048
    global_load_dwordx2 v[42:43], v7, s[4:5] offset:2560
    global_load_dwordx2 v[44:45], v7, s[4:5] offset:3072
    global_load_dwordx2 v[46:47], v7, s[4:5] offset:3584
    global_load_dwordx2 v[48:49], v8, s[4:5] offset:0
    global_load_dwordx2 v[50:51], v8, s[4:5] offset:512
    global_load_dwordx2 v[52:53], v8, s[4:5] offset:1024
    global_load_dwordx2 v[54:55], v8, s[4:5] offset:1536
    global_load_dwordx2 v[56:57], v8, s[4:5] offset:2048
    global_load_dwordx2 v[58:59], v8, s[4:5] offset:2560
    global_load_dwordx2 v[60:61], v8, s[4:5] offset:3072
    global_load_dwordx2 v[62:63], v8, s[4:5] offset:3584
    s_lshl_b32 s14, s12, 17
    v_add_u32 v9, s14, v5
    v_add_u32 v9, 18350080, v9
    s_waitcnt vmcnt(0)
    v_add_u32 v10, 0, v9
    global_load_dwordx4 v[128:131], v10, s[4:5]
    v_add_u32 v10, 16384, v9
    global_load_dwordx4 v[132:135], v10, s[4:5]
    v_add_u32 v10, 32768, v9
    global_load_dwordx4 v[136:139], v10, s[4:5]
    v_add_u32 v10, 49152, v9
    global_load_dwordx4 v[140:143], v10, s[4:5]
    v_add_u32 v10, 65536, v9
    global_load_dwordx4 v[144:147], v10, s[4:5]
    v_add_u32 v10, 81920, v9
    global_load_dwordx4 v[148:151], v10, s[4:5]
    v_add_u32 v10, 98304, v9
    global_load_dwordx4 v[152:155], v10, s[4:5]
    v_add_u32 v10, 114688, v9
    global_load_dwordx4 v[156:159], v10, s[4:5]
    v_mfma_f32_16x16x16_bf16 v[64:67], v[32:33], v[16:17], 0
    v_mfma_f32_16x16x16_bf16 v[68:71], v[34:35], v[16:17], 0
    v_mfma_f32_16x16x16_bf16 v[72:75], v[36:37], v[18:19], 0
    v_mfma_f32_16x16x16_bf16 v[76:79], v[38:39], v[18:19], 0
    v_mfma_f32_16x16x16_bf16 v[80:83], v[40:41], v[20:21], 0
    v_mfma_f32_16x16x16_bf16 v[84:87], v[42:43], v[20:21], 0
    v_mfma_f32_16x16x16_bf16 v[88:91], v[44:45], v[22:23], 0
    v_mfma_f32_16x16x16_bf16 v[92:95], v[46:47], v[22:23], 0
    v_mfma_f32_16x16x16_bf16 v[96:99], v[48:49], v[24:25], 0
    v_mfma_f32_16x16x16_bf16 v[100:103], v[50:51], v[24:25], 0
    v_mfma_f32_16x16x16_bf16 v[104:107], v[52:53], v[26:27], 0
    v_mfma_f32_16x16x16_bf16 v[108:111], v[54:55], v[26:27], 0
    v_mfma_f32_16x16x16_bf16 v[112:115], v[56:57], v[28:29], 0
    v_mfma_f32_16x16x16_bf16 v[116:119], v[58:59], v[28:29], 0
    v_mfma_f32_16x16x16_bf16 v[120:123], v[60:61], v[30:31], 0
    v_mfma_f32_16x16x16_bf16 v[124:127], v[62:63], v[30:31], 0
    s_nop 7
    v_cvt_pk_bf16_f32 v11, v64, v65
    v_lshlrev_b32 v64, 16, v11
    v_and_b32 v65, 0xffff0000, v11
    v_cvt_pk_bf16_f32 v11, v66, v67
    v_lshlrev_b32 v66, 16, v11
    v_and_b32 v67, 0xffff0000, v11
    v_cvt_pk_bf16_f32 v11, v68, v68
    v_lshlrev_b32 v68, 16, v11
    v_add_f32 v68, 0x358637bd, v68
    v_cvt_pk_bf16_f32 v11, v68, v68
    v_lshlrev_b32 v68, 16, v11
    v_rcp_f32 v12, v68
    s_nop 0
    v_mul_f32 v13, v64, v12
    v_fma_f32 v14, -v13, v68, v64
    v_fma_f32 v64, v14, v12, v13
    v_mul_f32 v13, v65, v12
    v_fma_f32 v14, -v13, v68, v65
    v_fma_f32 v65, v14, v12, v13
    v_mul_f32 v13, v66, v12
    v_fma_f32 v14, -v13, v68, v66
    v_fma_f32 v66, v14, v12, v13
    v_mul_f32 v13, v67, v12
    v_fma_f32 v14, -v13, v68, v67
    v_fma_f32 v67, v14, v12, v13
    v_cvt_pk_bf16_f32 v16, v64, v65
    v_cvt_pk_bf16_f32 v17, v66, v67
    v_cvt_pk_bf16_f32 v11, v72, v73
    v_lshlrev_b32 v72, 16, v11
    v_and_b32 v73, 0xffff0000, v11
    v_cvt_pk_bf16_f32 v11, v74, v75
    v_lshlrev_b32 v74, 16, v11
    v_and_b32 v75, 0xffff0000, v11
    v_cvt_pk_bf16_f32 v11, v76, v76
    v_lshlrev_b32 v76, 16, v11
    v_add_f32 v76, 0x358637bd, v76
    v_cvt_pk_bf16_f32 v11, v76, v76
    v_lshlrev_b32 v76, 16, v11
    v_rcp_f32 v12, v76
    s_nop 0
    v_mul_f32 v13, v72, v12
    v_fma_f32 v14, -v13, v76, v72
    v_fma_f32 v72, v14, v12, v13
    v_mul_f32 v13, v73, v12
    v_fma_f32 v14, -v13, v76, v73
    v_fma_f32 v73, v14, v12, v13
    v_mul_f32 v13, v74, v12
    v_fma_f32 v14, -v13, v76, v74
    v_fma_f32 v74, v14, v12, v13
    v_mul_f32 v13, v75, v12
    v_fma_f32 v14, -v13, v76, v75
    v_fma_f32 v75, v14, v12, v13
    v_cvt_pk_bf16_f32 v18, v72, v73
    v_cvt_pk_bf16_f32 v19, v74, v75
    v_cvt_pk_bf16_f32 v11, v80, v81
    v_lshlrev_b32 v80, 16, v11
    v_and_b32 v81, 0xffff0000, v11
    v_cvt_pk_bf16_f32 v11, v82, v83
    v_lshlrev_b32 v82, 16, v11
    v_and_b32 v83, 0xffff0000, v11
    v_cvt_pk_bf16_f32 v11, v84, v84
    v_lshlrev_b32 v84, 16, v11
    v_add_f32 v84, 0x358637bd, v84
    v_cvt_pk_bf16_f32 v11, v84, v84
    v_lshlrev_b32 v84, 16, v11
    v_rcp_f32 v12, v84
    s_nop 0
    v_mul_f32 v13, v80, v12
    v_fma_f32 v14, -v13, v84, v80
    v_fma_f32 v80, v14, v12, v13
    v_mul_f32 v13, v81, v12
    v_fma_f32 v14, -v13, v84, v81
    v_fma_f32 v81, v14, v12, v13
    v_mul_f32 v13, v82, v12
    v_fma_f32 v14, -v13, v84, v82
    v_fma_f32 v82, v14, v12, v13
    v_mul_f32 v13, v83, v12
    v_fma_f32 v14, -v13, v84, v83
    v_fma_f32 v83, v14, v12, v13
    v_cvt_pk_bf16_f32 v20, v80, v81
    v_cvt_pk_bf16_f32 v21, v82, v83
    v_cvt_pk_bf16_f32 v11, v88, v89
    v_lshlrev_b32 v88, 16, v11
    v_and_b32 v89, 0xffff0000, v11
    v_cvt_pk_bf16_f32 v11, v90, v91
    v_lshlrev_b32 v90, 16, v11
    v_and_b32 v91, 0xffff0000, v11
    v_cvt_pk_bf16_f32 v11, v92, v92
    v_lshlrev_b32 v92, 16, v11
    v_add_f32 v92, 0x358637bd, v92
    v_cvt_pk_bf16_f32 v11, v92, v92
    v_lshlrev_b32 v92, 16, v11
    v_rcp_f32 v12, v92
    s_nop 0
    v_mul_f32 v13, v88, v12
    v_fma_f32 v14, -v13, v92, v88
    v_fma_f32 v88, v14, v12, v13
    v_mul_f32 v13, v89, v12
    v_fma_f32 v14, -v13, v92, v89
    v_fma_f32 v89, v14, v12, v13
    v_mul_f32 v13, v90, v12
    v_fma_f32 v14, -v13, v92, v90
    v_fma_f32 v90, v14, v12, v13
    v_mul_f32 v13, v91, v12
    v_fma_f32 v14, -v13, v92, v91
    v_fma_f32 v91, v14, v12, v13
    v_cvt_pk_bf16_f32 v22, v88, v89
    v_cvt_pk_bf16_f32 v23, v90, v91
    v_cvt_pk_bf16_f32 v11, v96, v97
    v_lshlrev_b32 v96, 16, v11
    v_and_b32 v97, 0xffff0000, v11
    v_cvt_pk_bf16_f32 v11, v98, v99
    v_lshlrev_b32 v98, 16, v11
    v_and_b32 v99, 0xffff0000, v11
    v_cvt_pk_bf16_f32 v11, v100, v100
    v_lshlrev_b32 v100, 16, v11
    v_add_f32 v100, 0x358637bd, v100
    v_cvt_pk_bf16_f32 v11, v100, v100
    v_lshlrev_b32 v100, 16, v11
    v_rcp_f32 v12, v100
    s_nop 0
    v_mul_f32 v13, v96, v12
    v_fma_f32 v14, -v13, v100, v96
    v_fma_f32 v96, v14, v12, v13
    v_mul_f32 v13, v97, v12
    v_fma_f32 v14, -v13, v100, v97
    v_fma_f32 v97, v14, v12, v13
    v_mul_f32 v13, v98, v12
    v_fma_f32 v14, -v13, v100, v98
    v_fma_f32 v98, v14, v12, v13
    v_mul_f32 v13, v99, v12
    v_fma_f32 v14, -v13, v100, v99
    v_fma_f32 v99, v14, v12, v13
    v_cvt_pk_bf16_f32 v24, v96, v97
    v_cvt_pk_bf16_f32 v25, v98, v99
    v_cvt_pk_bf16_f32 v11, v104, v105
    v_lshlrev_b32 v104, 16, v11
    v_and_b32 v105, 0xffff0000, v11
    v_cvt_pk_bf16_f32 v11, v106, v107
    v_lshlrev_b32 v106, 16, v11
    v_and_b32 v107, 0xffff0000, v11
    v_cvt_pk_bf16_f32 v11, v108, v108
    v_lshlrev_b32 v108, 16, v11
    v_add_f32 v108, 0x358637bd, v108
    v_cvt_pk_bf16_f32 v11, v108, v108
    v_lshlrev_b32 v108, 16, v11
    v_rcp_f32 v12, v108
    s_nop 0
    v_mul_f32 v13, v104, v12
    v_fma_f32 v14, -v13, v108, v104
    v_fma_f32 v104, v14, v12, v13
    v_mul_f32 v13, v105, v12
    v_fma_f32 v14, -v13, v108, v105
    v_fma_f32 v105, v14, v12, v13
    v_mul_f32 v13, v106, v12
    v_fma_f32 v14, -v13, v108, v106
    v_fma_f32 v106, v14, v12, v13
    v_mul_f32 v13, v107, v12
    v_fma_f32 v14, -v13, v108, v107
    v_fma_f32 v107, v14, v12, v13
    v_cvt_pk_bf16_f32 v26, v104, v105
    v_cvt_pk_bf16_f32 v27, v106, v107
    v_cvt_pk_bf16_f32 v11, v112, v113
    v_lshlrev_b32 v112, 16, v11
    v_and_b32 v113, 0xffff0000, v11
    v_cvt_pk_bf16_f32 v11, v114, v115
    v_lshlrev_b32 v114, 16, v11
    v_and_b32 v115, 0xffff0000, v11
    v_cvt_pk_bf16_f32 v11, v116, v116
    v_lshlrev_b32 v116, 16, v11
    v_add_f32 v116, 0x358637bd, v116
    v_cvt_pk_bf16_f32 v11, v116, v116
    v_lshlrev_b32 v116, 16, v11
    v_rcp_f32 v12, v116
    s_nop 0
    v_mul_f32 v13, v112, v12
    v_fma_f32 v14, -v13, v116, v112
    v_fma_f32 v112, v14, v12, v13
    v_mul_f32 v13, v113, v12
    v_fma_f32 v14, -v13, v116, v113
    v_fma_f32 v113, v14, v12, v13
    v_mul_f32 v13, v114, v12
    v_fma_f32 v14, -v13, v116, v114
    v_fma_f32 v114, v14, v12, v13
    v_mul_f32 v13, v115, v12
    v_fma_f32 v14, -v13, v116, v115
    v_fma_f32 v115, v14, v12, v13
    v_cvt_pk_bf16_f32 v28, v112, v113
    v_cvt_pk_bf16_f32 v29, v114, v115
    v_cvt_pk_bf16_f32 v11, v120, v121
    v_lshlrev_b32 v120, 16, v11
    v_and_b32 v121, 0xffff0000, v11
    v_cvt_pk_bf16_f32 v11, v122, v123
    v_lshlrev_b32 v122, 16, v11
    v_and_b32 v123, 0xffff0000, v11
    v_cvt_pk_bf16_f32 v11, v124, v124
    v_lshlrev_b32 v124, 16, v11
    v_add_f32 v124, 0x358637bd, v124
    v_cvt_pk_bf16_f32 v11, v124, v124
    v_lshlrev_b32 v124, 16, v11
    v_rcp_f32 v12, v124
    s_nop 0
    v_mul_f32 v13, v120, v12
    v_fma_f32 v14, -v13, v124, v120
    v_fma_f32 v120, v14, v12, v13
    v_mul_f32 v13, v121, v12
    v_fma_f32 v14, -v13, v124, v121
    v_fma_f32 v121, v14, v12, v13
    v_mul_f32 v13, v122, v12
    v_fma_f32 v14, -v13, v124, v122
    v_fma_f32 v122, v14, v12, v13
    v_mul_f32 v13, v123, v12
    v_fma_f32 v14, -v13, v124, v123
    v_fma_f32 v123, v14, v12, v13
    v_cvt_pk_bf16_f32 v30, v120, v121
    v_cvt_pk_bf16_f32 v31, v122, v123
    s_lshl_b32 s14, s12, 12
    v_add_u32 v10, s14, v5
    ds_write_b128 v10, v[16:19] offset:0
    ds_write_b128 v10, v[20:23] offset:1024
    ds_write_b128 v10, v[24:27] offset:2048
    ds_write_b128 v10, v[28:31] offset:3072
    s_waitcnt lgkmcnt(0)
    s_barrier
    ds_read_b128 v[64:67], v5 offset:0
    ds_read_b128 v[68:71], v5 offset:1024
    ds_read_b128 v[72:75], v5 offset:2048
    ds_read_b128 v[76:79], v5 offset:3072
    ds_read_b128 v[80:83], v5 offset:4096
    ds_read_b128 v[84:87], v5 offset:5120
    ds_read_b128 v[88:91], v5 offset:6144
    ds_read_b128 v[92:95], v5 offset:7168
    ds_read_b128 v[96:99], v5 offset:8192
    ds_read_b128 v[100:103], v5 offset:9216
    ds_read_b128 v[104:107], v5 offset:10240
    ds_read_b128 v[108:111], v5 offset:11264
    ds_read_b128 v[112:115], v5 offset:12288
    ds_read_b128 v[116:119], v5 offset:13312
    ds_read_b128 v[120:123], v5 offset:14336
    ds_read_b128 v[124:127], v5 offset:15360
    v_add_u32 v10, 1024, v9
    global_load_dwordx4 v[160:163], v10, s[4:5]
    v_add_u32 v10, 17408, v9
    global_load_dwordx4 v[164:167], v10, s[4:5]
    v_add_u32 v10, 33792, v9
    global_load_dwordx4 v[168:171], v10, s[4:5]
    v_add_u32 v10, 50176, v9
    global_load_dwordx4 v[172:175], v10, s[4:5]
    v_add_u32 v10, 66560, v9
    global_load_dwordx4 v[176:179], v10, s[4:5]
    v_add_u32 v10, 82944, v9
    global_load_dwordx4 v[180:183], v10, s[4:5]
    v_add_u32 v10, 99328, v9
    global_load_dwordx4 v[184:187], v10, s[4:5]
    v_add_u32 v10, 115712, v9
    global_load_dwordx4 v[188:191], v10, s[4:5]
    s_waitcnt vmcnt(8) lgkmcnt(0)
    v_mfma_f32_16x16x32_bf16 v[16:19], v[128:131], v[64:67], 0
    v_mfma_f32_16x16x32_bf16 v[20:23], v[132:135], v[64:67], 0
    v_mfma_f32_16x16x32_bf16 v[24:27], v[136:139], v[64:67], 0
    v_mfma_f32_16x16x32_bf16 v[28:31], v[140:143], v[64:67], 0
    v_mfma_f32_16x16x32_bf16 v[32:35], v[144:147], v[64:67], 0
    v_mfma_f32_16x16x32_bf16 v[36:39], v[148:151], v[64:67], 0
    v_mfma_f32_16x16x32_bf16 v[40:43], v[152:155], v[64:67], 0
    v_mfma_f32_16x16x32_bf16 v[44:47], v[156:159], v[64:67], 0
    v_add_u32 v10, 2048, v9
    global_load_dwordx4 v[128:131], v10, s[4:5]
    v_add_u32 v10, 18432, v9
    global_load_dwordx4 v[132:135], v10, s[4:5]
    v_add_u32 v10, 34816, v9
    global_load_dwordx4 v[136:139], v10, s[4:5]
    v_add_u32 v10, 51200, v9
    global_load_dwordx4 v[140:143], v10, s[4:5]
    v_add_u32 v10, 67584, v9
    global_load_dwordx4 v[144:147], v10, s[4:5]
    v_add_u32 v10, 83968, v9
    global_load_dwordx4 v[148:151], v10, s[4:5]
    v_add_u32 v10, 100352, v9
    global_load_dwordx4 v[152:155], v10, s[4:5]
    v_add_u32 v10, 116736, v9
    global_load_dwordx4 v[156:159], v10, s[4:5]
    s_waitcnt vmcnt(8) lgkmcnt(0)
    v_mfma_f32_16x16x32_bf16 v[16:19], v[160:163], v[68:71], v[16:19]
    v_mfma_f32_16x16x32_bf16 v[20:23], v[164:167], v[68:71], v[20:23]
    v_mfma_f32_16x16x32_bf16 v[24:27], v[168:171], v[68:71], v[24:27]
    v_mfma_f32_16x16x32_bf16 v[28:31], v[172:175], v[68:71], v[28:31]
    v_mfma_f32_16x16x32_bf16 v[32:35], v[176:179], v[68:71], v[32:35]
    v_mfma_f32_16x16x32_bf16 v[36:39], v[180:183], v[68:71], v[36:39]
    v_mfma_f32_16x16x32_bf16 v[40:43], v[184:187], v[68:71], v[40:43]
    v_mfma_f32_16x16x32_bf16 v[44:47], v[188:191], v[68:71], v[44:47]
    v_add_u32 v10, 3072, v9
    global_load_dwordx4 v[160:163], v10, s[4:5]
    v_add_u32 v10, 19456, v9
    global_load_dwordx4 v[164:167], v10, s[4:5]
    v_add_u32 v10, 35840, v9
    global_load_dwordx4 v[168:171], v10, s[4:5]
    v_add_u32 v10, 52224, v9
    global_load_dwordx4 v[172:175], v10, s[4:5]
    v_add_u32 v10, 68608, v9
    global_load_dwordx4 v[176:179], v10, s[4:5]
    v_add_u32 v10, 84992, v9
    global_load_dwordx4 v[180:183], v10, s[4:5]
    v_add_u32 v10, 101376, v9
    global_load_dwordx4 v[184:187], v10, s[4:5]
    v_add_u32 v10, 117760, v9
    global_load_dwordx4 v[188:191], v10, s[4:5]
    s_waitcnt vmcnt(8) lgkmcnt(0)
    v_mfma_f32_16x16x32_bf16 v[16:19], v[128:131], v[72:75], v[16:19]
    v_mfma_f32_16x16x32_bf16 v[20:23], v[132:135], v[72:75], v[20:23]
    v_mfma_f32_16x16x32_bf16 v[24:27], v[136:139], v[72:75], v[24:27]
    v_mfma_f32_16x16x32_bf16 v[28:31], v[140:143], v[72:75], v[28:31]
    v_mfma_f32_16x16x32_bf16 v[32:35], v[144:147], v[72:75], v[32:35]
    v_mfma_f32_16x16x32_bf16 v[36:39], v[148:151], v[72:75], v[36:39]
    v_mfma_f32_16x16x32_bf16 v[40:43], v[152:155], v[72:75], v[40:43]
    v_mfma_f32_16x16x32_bf16 v[44:47], v[156:159], v[72:75], v[44:47]
    v_add_u32 v10, 4096, v9
    global_load_dwordx4 v[128:131], v10, s[4:5]
    v_add_u32 v10, 20480, v9
    global_load_dwordx4 v[132:135], v10, s[4:5]
    v_add_u32 v10, 36864, v9
    global_load_dwordx4 v[136:139], v10, s[4:5]
    v_add_u32 v10, 53248, v9
    global_load_dwordx4 v[140:143], v10, s[4:5]
    v_add_u32 v10, 69632, v9
    global_load_dwordx4 v[144:147], v10, s[4:5]
    v_add_u32 v10, 86016, v9
    global_load_dwordx4 v[148:151], v10, s[4:5]
    v_add_u32 v10, 102400, v9
    global_load_dwordx4 v[152:155], v10, s[4:5]
    v_add_u32 v10, 118784, v9
    global_load_dwordx4 v[156:159], v10, s[4:5]
    s_waitcnt vmcnt(8) lgkmcnt(0)
    v_mfma_f32_16x16x32_bf16 v[16:19], v[160:163], v[76:79], v[16:19]
    v_mfma_f32_16x16x32_bf16 v[20:23], v[164:167], v[76:79], v[20:23]
    v_mfma_f32_16x16x32_bf16 v[24:27], v[168:171], v[76:79], v[24:27]
    v_mfma_f32_16x16x32_bf16 v[28:31], v[172:175], v[76:79], v[28:31]
    v_mfma_f32_16x16x32_bf16 v[32:35], v[176:179], v[76:79], v[32:35]
    v_mfma_f32_16x16x32_bf16 v[36:39], v[180:183], v[76:79], v[36:39]
    v_mfma_f32_16x16x32_bf16 v[40:43], v[184:187], v[76:79], v[40:43]
    v_mfma_f32_16x16x32_bf16 v[44:47], v[188:191], v[76:79], v[44:47]
    v_add_u32 v10, 5120, v9
    global_load_dwordx4 v[160:163], v10, s[4:5]
    v_add_u32 v10, 21504, v9
    global_load_dwordx4 v[164:167], v10, s[4:5]
    v_add_u32 v10, 37888, v9
    global_load_dwordx4 v[168:171], v10, s[4:5]
    v_add_u32 v10, 54272, v9
    global_load_dwordx4 v[172:175], v10, s[4:5]
    v_add_u32 v10, 70656, v9
    global_load_dwordx4 v[176:179], v10, s[4:5]
    v_add_u32 v10, 87040, v9
    global_load_dwordx4 v[180:183], v10, s[4:5]
    v_add_u32 v10, 103424, v9
    global_load_dwordx4 v[184:187], v10, s[4:5]
    v_add_u32 v10, 119808, v9
    global_load_dwordx4 v[188:191], v10, s[4:5]
    s_waitcnt vmcnt(8) lgkmcnt(0)
    v_mfma_f32_16x16x32_bf16 v[16:19], v[128:131], v[80:83], v[16:19]
    v_mfma_f32_16x16x32_bf16 v[20:23], v[132:135], v[80:83], v[20:23]
    v_mfma_f32_16x16x32_bf16 v[24:27], v[136:139], v[80:83], v[24:27]
    v_mfma_f32_16x16x32_bf16 v[28:31], v[140:143], v[80:83], v[28:31]
    v_mfma_f32_16x16x32_bf16 v[32:35], v[144:147], v[80:83], v[32:35]
    v_mfma_f32_16x16x32_bf16 v[36:39], v[148:151], v[80:83], v[36:39]
    v_mfma_f32_16x16x32_bf16 v[40:43], v[152:155], v[80:83], v[40:43]
    v_mfma_f32_16x16x32_bf16 v[44:47], v[156:159], v[80:83], v[44:47]
    v_add_u32 v10, 6144, v9
    global_load_dwordx4 v[128:131], v10, s[4:5]
    v_add_u32 v10, 22528, v9
    global_load_dwordx4 v[132:135], v10, s[4:5]
    v_add_u32 v10, 38912, v9
    global_load_dwordx4 v[136:139], v10, s[4:5]
    v_add_u32 v10, 55296, v9
    global_load_dwordx4 v[140:143], v10, s[4:5]
    v_add_u32 v10, 71680, v9
    global_load_dwordx4 v[144:147], v10, s[4:5]
    v_add_u32 v10, 88064, v9
    global_load_dwordx4 v[148:151], v10, s[4:5]
    v_add_u32 v10, 104448, v9
    global_load_dwordx4 v[152:155], v10, s[4:5]
    v_add_u32 v10, 120832, v9
    global_load_dwordx4 v[156:159], v10, s[4:5]
    s_waitcnt vmcnt(8) lgkmcnt(0)
    v_mfma_f32_16x16x32_bf16 v[16:19], v[160:163], v[84:87], v[16:19]
    v_mfma_f32_16x16x32_bf16 v[20:23], v[164:167], v[84:87], v[20:23]
    v_mfma_f32_16x16x32_bf16 v[24:27], v[168:171], v[84:87], v[24:27]
    v_mfma_f32_16x16x32_bf16 v[28:31], v[172:175], v[84:87], v[28:31]
    v_mfma_f32_16x16x32_bf16 v[32:35], v[176:179], v[84:87], v[32:35]
    v_mfma_f32_16x16x32_bf16 v[36:39], v[180:183], v[84:87], v[36:39]
    v_mfma_f32_16x16x32_bf16 v[40:43], v[184:187], v[84:87], v[40:43]
    v_mfma_f32_16x16x32_bf16 v[44:47], v[188:191], v[84:87], v[44:47]
    v_add_u32 v10, 7168, v9
    global_load_dwordx4 v[160:163], v10, s[4:5]
    v_add_u32 v10, 23552, v9
    global_load_dwordx4 v[164:167], v10, s[4:5]
    v_add_u32 v10, 39936, v9
    global_load_dwordx4 v[168:171], v10, s[4:5]
    v_add_u32 v10, 56320, v9
    global_load_dwordx4 v[172:175], v10, s[4:5]
    v_add_u32 v10, 72704, v9
    global_load_dwordx4 v[176:179], v10, s[4:5]
    v_add_u32 v10, 89088, v9
    global_load_dwordx4 v[180:183], v10, s[4:5]
    v_add_u32 v10, 105472, v9
    global_load_dwordx4 v[184:187], v10, s[4:5]
    v_add_u32 v10, 121856, v9
    global_load_dwordx4 v[188:191], v10, s[4:5]
    s_waitcnt vmcnt(8) lgkmcnt(0)
    v_mfma_f32_16x16x32_bf16 v[16:19], v[128:131], v[88:91], v[16:19]
    v_mfma_f32_16x16x32_bf16 v[20:23], v[132:135], v[88:91], v[20:23]
    v_mfma_f32_16x16x32_bf16 v[24:27], v[136:139], v[88:91], v[24:27]
    v_mfma_f32_16x16x32_bf16 v[28:31], v[140:143], v[88:91], v[28:31]
    v_mfma_f32_16x16x32_bf16 v[32:35], v[144:147], v[88:91], v[32:35]
    v_mfma_f32_16x16x32_bf16 v[36:39], v[148:151], v[88:91], v[36:39]
    v_mfma_f32_16x16x32_bf16 v[40:43], v[152:155], v[88:91], v[40:43]
    v_mfma_f32_16x16x32_bf16 v[44:47], v[156:159], v[88:91], v[44:47]
    v_add_u32 v10, 8192, v9
    global_load_dwordx4 v[128:131], v10, s[4:5]
    v_add_u32 v10, 24576, v9
    global_load_dwordx4 v[132:135], v10, s[4:5]
    v_add_u32 v10, 40960, v9
    global_load_dwordx4 v[136:139], v10, s[4:5]
    v_add_u32 v10, 57344, v9
    global_load_dwordx4 v[140:143], v10, s[4:5]
    v_add_u32 v10, 73728, v9
    global_load_dwordx4 v[144:147], v10, s[4:5]
    v_add_u32 v10, 90112, v9
    global_load_dwordx4 v[148:151], v10, s[4:5]
    v_add_u32 v10, 106496, v9
    global_load_dwordx4 v[152:155], v10, s[4:5]
    v_add_u32 v10, 122880, v9
    global_load_dwordx4 v[156:159], v10, s[4:5]
    s_waitcnt vmcnt(8) lgkmcnt(0)
    v_mfma_f32_16x16x32_bf16 v[16:19], v[160:163], v[92:95], v[16:19]
    v_mfma_f32_16x16x32_bf16 v[20:23], v[164:167], v[92:95], v[20:23]
    v_mfma_f32_16x16x32_bf16 v[24:27], v[168:171], v[92:95], v[24:27]
    v_mfma_f32_16x16x32_bf16 v[28:31], v[172:175], v[92:95], v[28:31]
    v_mfma_f32_16x16x32_bf16 v[32:35], v[176:179], v[92:95], v[32:35]
    v_mfma_f32_16x16x32_bf16 v[36:39], v[180:183], v[92:95], v[36:39]
    v_mfma_f32_16x16x32_bf16 v[40:43], v[184:187], v[92:95], v[40:43]
    v_mfma_f32_16x16x32_bf16 v[44:47], v[188:191], v[92:95], v[44:47]
    v_add_u32 v10, 9216, v9
    global_load_dwordx4 v[160:163], v10, s[4:5]
    v_add_u32 v10, 25600, v9
    global_load_dwordx4 v[164:167], v10, s[4:5]
    v_add_u32 v10, 41984, v9
    global_load_dwordx4 v[168:171], v10, s[4:5]
    v_add_u32 v10, 58368, v9
    global_load_dwordx4 v[172:175], v10, s[4:5]
    v_add_u32 v10, 74752, v9
    global_load_dwordx4 v[176:179], v10, s[4:5]
    v_add_u32 v10, 91136, v9
    global_load_dwordx4 v[180:183], v10, s[4:5]
    v_add_u32 v10, 107520, v9
    global_load_dwordx4 v[184:187], v10, s[4:5]
    v_add_u32 v10, 123904, v9
    global_load_dwordx4 v[188:191], v10, s[4:5]
    s_waitcnt vmcnt(8) lgkmcnt(0)
    v_mfma_f32_16x16x32_bf16 v[16:19], v[128:131], v[96:99], v[16:19]
    v_mfma_f32_16x16x32_bf16 v[20:23], v[132:135], v[96:99], v[20:23]
    v_mfma_f32_16x16x32_bf16 v[24:27], v[136:139], v[96:99], v[24:27]
    v_mfma_f32_16x16x32_bf16 v[28:31], v[140:143], v[96:99], v[28:31]
    v_mfma_f32_16x16x32_bf16 v[32:35], v[144:147], v[96:99], v[32:35]
    v_mfma_f32_16x16x32_bf16 v[36:39], v[148:151], v[96:99], v[36:39]
    v_mfma_f32_16x16x32_bf16 v[40:43], v[152:155], v[96:99], v[40:43]
    v_mfma_f32_16x16x32_bf16 v[44:47], v[156:159], v[96:99], v[44:47]
    v_add_u32 v10, 10240, v9
    global_load_dwordx4 v[128:131], v10, s[4:5]
    v_add_u32 v10, 26624, v9
    global_load_dwordx4 v[132:135], v10, s[4:5]
    v_add_u32 v10, 43008, v9
    global_load_dwordx4 v[136:139], v10, s[4:5]
    v_add_u32 v10, 59392, v9
    global_load_dwordx4 v[140:143], v10, s[4:5]
    v_add_u32 v10, 75776, v9
    global_load_dwordx4 v[144:147], v10, s[4:5]
    v_add_u32 v10, 92160, v9
    global_load_dwordx4 v[148:151], v10, s[4:5]
    v_add_u32 v10, 108544, v9
    global_load_dwordx4 v[152:155], v10, s[4:5]
    v_add_u32 v10, 124928, v9
    global_load_dwordx4 v[156:159], v10, s[4:5]
    s_waitcnt vmcnt(8) lgkmcnt(0)
    v_mfma_f32_16x16x32_bf16 v[16:19], v[160:163], v[100:103], v[16:19]
    v_mfma_f32_16x16x32_bf16 v[20:23], v[164:167], v[100:103], v[20:23]
    v_mfma_f32_16x16x32_bf16 v[24:27], v[168:171], v[100:103], v[24:27]
    v_mfma_f32_16x16x32_bf16 v[28:31], v[172:175], v[100:103], v[28:31]
    v_mfma_f32_16x16x32_bf16 v[32:35], v[176:179], v[100:103], v[32:35]
    v_mfma_f32_16x16x32_bf16 v[36:39], v[180:183], v[100:103], v[36:39]
    v_mfma_f32_16x16x32_bf16 v[40:43], v[184:187], v[100:103], v[40:43]
    v_mfma_f32_16x16x32_bf16 v[44:47], v[188:191], v[100:103], v[44:47]
    v_add_u32 v10, 11264, v9
    global_load_dwordx4 v[160:163], v10, s[4:5]
    v_add_u32 v10, 27648, v9
    global_load_dwordx4 v[164:167], v10, s[4:5]
    v_add_u32 v10, 44032, v9
    global_load_dwordx4 v[168:171], v10, s[4:5]
    v_add_u32 v10, 60416, v9
    global_load_dwordx4 v[172:175], v10, s[4:5]
    v_add_u32 v10, 76800, v9
    global_load_dwordx4 v[176:179], v10, s[4:5]
    v_add_u32 v10, 93184, v9
    global_load_dwordx4 v[180:183], v10, s[4:5]
    v_add_u32 v10, 109568, v9
    global_load_dwordx4 v[184:187], v10, s[4:5]
    v_add_u32 v10, 125952, v9
    global_load_dwordx4 v[188:191], v10, s[4:5]
    s_waitcnt vmcnt(8) lgkmcnt(0)
    v_mfma_f32_16x16x32_bf16 v[16:19], v[128:131], v[104:107], v[16:19]
    v_mfma_f32_16x16x32_bf16 v[20:23], v[132:135], v[104:107], v[20:23]
    v_mfma_f32_16x16x32_bf16 v[24:27], v[136:139], v[104:107], v[24:27]
    v_mfma_f32_16x16x32_bf16 v[28:31], v[140:143], v[104:107], v[28:31]
    v_mfma_f32_16x16x32_bf16 v[32:35], v[144:147], v[104:107], v[32:35]
    v_mfma_f32_16x16x32_bf16 v[36:39], v[148:151], v[104:107], v[36:39]
    v_mfma_f32_16x16x32_bf16 v[40:43], v[152:155], v[104:107], v[40:43]
    v_mfma_f32_16x16x32_bf16 v[44:47], v[156:159], v[104:107], v[44:47]
    v_add_u32 v10, 12288, v9
    global_load_dwordx4 v[128:131], v10, s[4:5]
    v_add_u32 v10, 28672, v9
    global_load_dwordx4 v[132:135], v10, s[4:5]
    v_add_u32 v10, 45056, v9
    global_load_dwordx4 v[136:139], v10, s[4:5]
    v_add_u32 v10, 61440, v9
    global_load_dwordx4 v[140:143], v10, s[4:5]
    v_add_u32 v10, 77824, v9
    global_load_dwordx4 v[144:147], v10, s[4:5]
    v_add_u32 v10, 94208, v9
    global_load_dwordx4 v[148:151], v10, s[4:5]
    v_add_u32 v10, 110592, v9
    global_load_dwordx4 v[152:155], v10, s[4:5]
    v_add_u32 v10, 126976, v9
    global_load_dwordx4 v[156:159], v10, s[4:5]
    s_waitcnt vmcnt(8) lgkmcnt(0)
    v_mfma_f32_16x16x32_bf16 v[16:19], v[160:163], v[108:111], v[16:19]
    v_mfma_f32_16x16x32_bf16 v[20:23], v[164:167], v[108:111], v[20:23]
    v_mfma_f32_16x16x32_bf16 v[24:27], v[168:171], v[108:111], v[24:27]
    v_mfma_f32_16x16x32_bf16 v[28:31], v[172:175], v[108:111], v[28:31]
    v_mfma_f32_16x16x32_bf16 v[32:35], v[176:179], v[108:111], v[32:35]
    v_mfma_f32_16x16x32_bf16 v[36:39], v[180:183], v[108:111], v[36:39]
    v_mfma_f32_16x16x32_bf16 v[40:43], v[184:187], v[108:111], v[40:43]
    v_mfma_f32_16x16x32_bf16 v[44:47], v[188:191], v[108:111], v[44:47]
    v_add_u32 v10, 13312, v9
    global_load_dwordx4 v[160:163], v10, s[4:5]
    v_add_u32 v10, 29696, v9
    global_load_dwordx4 v[164:167], v10, s[4:5]
    v_add_u32 v10, 46080, v9
    global_load_dwordx4 v[168:171], v10, s[4:5]
    v_add_u32 v10, 62464, v9
    global_load_dwordx4 v[172:175], v10, s[4:5]
    v_add_u32 v10, 78848, v9
    global_load_dwordx4 v[176:179], v10, s[4:5]
    v_add_u32 v10, 95232, v9
    global_load_dwordx4 v[180:183], v10, s[4:5]
    v_add_u32 v10, 111616, v9
    global_load_dwordx4 v[184:187], v10, s[4:5]
    v_add_u32 v10, 128000, v9
    global_load_dwordx4 v[188:191], v10, s[4:5]
    s_waitcnt vmcnt(8) lgkmcnt(0)
    v_mfma_f32_16x16x32_bf16 v[16:19], v[128:131], v[112:115], v[16:19]
    v_mfma_f32_16x16x32_bf16 v[20:23], v[132:135], v[112:115], v[20:23]
    v_mfma_f32_16x16x32_bf16 v[24:27], v[136:139], v[112:115], v[24:27]
    v_mfma_f32_16x16x32_bf16 v[28:31], v[140:143], v[112:115], v[28:31]
    v_mfma_f32_16x16x32_bf16 v[32:35], v[144:147], v[112:115], v[32:35]
    v_mfma_f32_16x16x32_bf16 v[36:39], v[148:151], v[112:115], v[36:39]
    v_mfma_f32_16x16x32_bf16 v[40:43], v[152:155], v[112:115], v[40:43]
    v_mfma_f32_16x16x32_bf16 v[44:47], v[156:159], v[112:115], v[44:47]
    v_add_u32 v10, 14336, v9
    global_load_dwordx4 v[128:131], v10, s[4:5]
    v_add_u32 v10, 30720, v9
    global_load_dwordx4 v[132:135], v10, s[4:5]
    v_add_u32 v10, 47104, v9
    global_load_dwordx4 v[136:139], v10, s[4:5]
    v_add_u32 v10, 63488, v9
    global_load_dwordx4 v[140:143], v10, s[4:5]
    v_add_u32 v10, 79872, v9
    global_load_dwordx4 v[144:147], v10, s[4:5]
    v_add_u32 v10, 96256, v9
    global_load_dwordx4 v[148:151], v10, s[4:5]
    v_add_u32 v10, 112640, v9
    global_load_dwordx4 v[152:155], v10, s[4:5]
    v_add_u32 v10, 129024, v9
    global_load_dwordx4 v[156:159], v10, s[4:5]
    s_waitcnt vmcnt(8) lgkmcnt(0)
    v_mfma_f32_16x16x32_bf16 v[16:19], v[160:163], v[116:119], v[16:19]
    v_mfma_f32_16x16x32_bf16 v[20:23], v[164:167], v[116:119], v[20:23]
    v_mfma_f32_16x16x32_bf16 v[24:27], v[168:171], v[116:119], v[24:27]
    v_mfma_f32_16x16x32_bf16 v[28:31], v[172:175], v[116:119], v[28:31]
    v_mfma_f32_16x16x32_bf16 v[32:35], v[176:179], v[116:119], v[32:35]
    v_mfma_f32_16x16x32_bf16 v[36:39], v[180:183], v[116:119], v[36:39]
    v_mfma_f32_16x16x32_bf16 v[40:43], v[184:187], v[116:119], v[40:43]
    v_mfma_f32_16x16x32_bf16 v[44:47], v[188:191], v[116:119], v[44:47]
    v_add_u32 v10, 15360, v9
    global_load_dwordx4 v[160:163], v10, s[4:5]
    v_add_u32 v10, 31744, v9
    global_load_dwordx4 v[164:167], v10, s[4:5]
    v_add_u32 v10, 48128, v9
    global_load_dwordx4 v[168:171], v10, s[4:5]
    v_add_u32 v10, 64512, v9
    global_load_dwordx4 v[172:175], v10, s[4:5]
    v_add_u32 v10, 80896, v9
    global_load_dwordx4 v[176:179], v10, s[4:5]
    v_add_u32 v10, 97280, v9
    global_load_dwordx4 v[180:183], v10, s[4:5]
    v_add_u32 v10, 113664, v9
    global_load_dwordx4 v[184:187], v10, s[4:5]
    v_add_u32 v10, 130048, v9
    global_load_dwordx4 v[188:191], v10, s[4:5]
    s_waitcnt vmcnt(8) lgkmcnt(0)
    v_mfma_f32_16x16x32_bf16 v[16:19], v[128:131], v[120:123], v[16:19]
    v_mfma_f32_16x16x32_bf16 v[20:23], v[132:135], v[120:123], v[20:23]
    v_mfma_f32_16x16x32_bf16 v[24:27], v[136:139], v[120:123], v[24:27]
    v_mfma_f32_16x16x32_bf16 v[28:31], v[140:143], v[120:123], v[28:31]
    v_mfma_f32_16x16x32_bf16 v[32:35], v[144:147], v[120:123], v[32:35]
    v_mfma_f32_16x16x32_bf16 v[36:39], v[148:151], v[120:123], v[36:39]
    v_mfma_f32_16x16x32_bf16 v[40:43], v[152:155], v[120:123], v[40:43]
    v_mfma_f32_16x16x32_bf16 v[44:47], v[156:159], v[120:123], v[44:47]
    s_waitcnt vmcnt(0)
    v_mfma_f32_16x16x32_bf16 v[16:19], v[160:163], v[124:127], v[16:19]
    v_mfma_f32_16x16x32_bf16 v[20:23], v[164:167], v[124:127], v[20:23]
    v_mfma_f32_16x16x32_bf16 v[24:27], v[168:171], v[124:127], v[24:27]
    v_mfma_f32_16x16x32_bf16 v[28:31], v[172:175], v[124:127], v[28:31]
    v_mfma_f32_16x16x32_bf16 v[32:35], v[176:179], v[124:127], v[32:35]
    v_mfma_f32_16x16x32_bf16 v[36:39], v[180:183], v[124:127], v[36:39]
    v_mfma_f32_16x16x32_bf16 v[40:43], v[184:187], v[124:127], v[40:43]
    v_mfma_f32_16x16x32_bf16 v[44:47], v[188:191], v[124:127], v[44:47]
    s_lshl_b32 s13, s2, 4
    v_add_u32 v6, s13, v3
    v_lshlrev_b32 v6, 10, v6
    s_lshl_b32 s14, s12, 8
    v_add_u32 v6, s14, v6
    v_lshl_add_u32 v6, v2, 3, v6
    v_add_u32 v7, 125829120, v6
    global_load_dwordx2 v[48:49], v7, s[4:5] offset:0
    global_load_dwordx2 v[50:51], v7, s[4:5] offset:32
    global_load_dwordx2 v[52:53], v7, s[4:5] offset:64
    global_load_dwordx2 v[54:55], v7, s[4:5] offset:96
    global_load_dwordx2 v[56:57], v7, s[4:5] offset:128
    global_load_dwordx2 v[58:59], v7, s[4:5] offset:160
    global_load_dwordx2 v[60:61], v7, s[4:5] offset:192
    global_load_dwordx2 v[62:63], v7, s[4:5] offset:224
    s_waitcnt vmcnt(0)
    v_cvt_pk_bf16_f32 v11, v16, v17
    v_lshlrev_b32 v16, 16, v11
    v_and_b32 v17, 0xffff0000, v11
    v_cvt_pk_bf16_f32 v11, v18, v19
    v_lshlrev_b32 v18, 16, v11
    v_and_b32 v19, 0xffff0000, v11
    v_lshlrev_b32 v12, 16, v48
    v_and_b32 v13, 0xffff0000, v48
    v_lshlrev_b32 v14, 16, v49
    v_and_b32 v15, 0xffff0000, v49
    v_add_f32 v16, v16, v12
    v_add_f32 v17, v17, v13
    v_add_f32 v18, v18, v14
    v_add_f32 v19, v19, v15
    v_cvt_pk_bf16_f32 v48, v16, v17
    v_cvt_pk_bf16_f32 v49, v18, v19
    global_store_dwordx2 v6, v[48:49], s[6:7] offset:0
    v_cvt_pk_bf16_f32 v11, v20, v21
    v_lshlrev_b32 v20, 16, v11
    v_and_b32 v21, 0xffff0000, v11
    v_cvt_pk_bf16_f32 v11, v22, v23
    v_lshlrev_b32 v22, 16, v11
    v_and_b32 v23, 0xffff0000, v11
    v_lshlrev_b32 v12, 16, v50
    v_and_b32 v13, 0xffff0000, v50
    v_lshlrev_b32 v14, 16, v51
    v_and_b32 v15, 0xffff0000, v51
    v_add_f32 v20, v20, v12
    v_add_f32 v21, v21, v13
    v_add_f32 v22, v22, v14
    v_add_f32 v23, v23, v15
    v_cvt_pk_bf16_f32 v50, v20, v21
    v_cvt_pk_bf16_f32 v51, v22, v23
    global_store_dwordx2 v6, v[50:51], s[6:7] offset:32
    v_cvt_pk_bf16_f32 v11, v24, v25
    v_lshlrev_b32 v24, 16, v11
    v_and_b32 v25, 0xffff0000, v11
    v_cvt_pk_bf16_f32 v11, v26, v27
    v_lshlrev_b32 v26, 16, v11
    v_and_b32 v27, 0xffff0000, v11
    v_lshlrev_b32 v12, 16, v52
    v_and_b32 v13, 0xffff0000, v52
    v_lshlrev_b32 v14, 16, v53
    v_and_b32 v15, 0xffff0000, v53
    v_add_f32 v24, v24, v12
    v_add_f32 v25, v25, v13
    v_add_f32 v26, v26, v14
    v_add_f32 v27, v27, v15
    v_cvt_pk_bf16_f32 v52, v24, v25
    v_cvt_pk_bf16_f32 v53, v26, v27
    global_store_dwordx2 v6, v[52:53], s[6:7] offset:64
    v_cvt_pk_bf16_f32 v11, v28, v29
    v_lshlrev_b32 v28, 16, v11
    v_and_b32 v29, 0xffff0000, v11
    v_cvt_pk_bf16_f32 v11, v30, v31
    v_lshlrev_b32 v30, 16, v11
    v_and_b32 v31, 0xffff0000, v11
    v_lshlrev_b32 v12, 16, v54
    v_and_b32 v13, 0xffff0000, v54
    v_lshlrev_b32 v14, 16, v55
    v_and_b32 v15, 0xffff0000, v55
    v_add_f32 v28, v28, v12
    v_add_f32 v29, v29, v13
    v_add_f32 v30, v30, v14
    v_add_f32 v31, v31, v15
    v_cvt_pk_bf16_f32 v54, v28, v29
    v_cvt_pk_bf16_f32 v55, v30, v31
    global_store_dwordx2 v6, v[54:55], s[6:7] offset:96
    v_cvt_pk_bf16_f32 v11, v32, v33
    v_lshlrev_b32 v32, 16, v11
    v_and_b32 v33, 0xffff0000, v11
    v_cvt_pk_bf16_f32 v11, v34, v35
    v_lshlrev_b32 v34, 16, v11
    v_and_b32 v35, 0xffff0000, v11
    v_lshlrev_b32 v12, 16, v56
    v_and_b32 v13, 0xffff0000, v56
    v_lshlrev_b32 v14, 16, v57
    v_and_b32 v15, 0xffff0000, v57
    v_add_f32 v32, v32, v12
    v_add_f32 v33, v33, v13
    v_add_f32 v34, v34, v14
    v_add_f32 v35, v35, v15
    v_cvt_pk_bf16_f32 v56, v32, v33
    v_cvt_pk_bf16_f32 v57, v34, v35
    global_store_dwordx2 v6, v[56:57], s[6:7] offset:128
    v_cvt_pk_bf16_f32 v11, v36, v37
    v_lshlrev_b32 v36, 16, v11
    v_and_b32 v37, 0xffff0000, v11
    v_cvt_pk_bf16_f32 v11, v38, v39
    v_lshlrev_b32 v38, 16, v11
    v_and_b32 v39, 0xffff0000, v11
    v_lshlrev_b32 v12, 16, v58
    v_and_b32 v13, 0xffff0000, v58
    v_lshlrev_b32 v14, 16, v59
    v_and_b32 v15, 0xffff0000, v59
    v_add_f32 v36, v36, v12
    v_add_f32 v37, v37, v13
    v_add_f32 v38, v38, v14
    v_add_f32 v39, v39, v15
    v_cvt_pk_bf16_f32 v58, v36, v37
    v_cvt_pk_bf16_f32 v59, v38, v39
    global_store_dwordx2 v6, v[58:59], s[6:7] offset:160
    v_cvt_pk_bf16_f32 v11, v40, v41
    v_lshlrev_b32 v40, 16, v11
    v_and_b32 v41, 0xffff0000, v11
    v_cvt_pk_bf16_f32 v11, v42, v43
    v_lshlrev_b32 v42, 16, v11
    v_and_b32 v43, 0xffff0000, v11
    v_lshlrev_b32 v12, 16, v60
    v_and_b32 v13, 0xffff0000, v60
    v_lshlrev_b32 v14, 16, v61
    v_and_b32 v15, 0xffff0000, v61
    v_add_f32 v40, v40, v12
    v_add_f32 v41, v41, v13
    v_add_f32 v42, v42, v14
    v_add_f32 v43, v43, v15
    v_cvt_pk_bf16_f32 v60, v40, v41
    v_cvt_pk_bf16_f32 v61, v42, v43
    global_store_dwordx2 v6, v[60:61], s[6:7] offset:192
    v_cvt_pk_bf16_f32 v11, v44, v45
    v_lshlrev_b32 v44, 16, v11
    v_and_b32 v45, 0xffff0000, v11
    v_cvt_pk_bf16_f32 v11, v46, v47
    v_lshlrev_b32 v46, 16, v11
    v_and_b32 v47, 0xffff0000, v11
    v_lshlrev_b32 v12, 16, v62
    v_and_b32 v13, 0xffff0000, v62
    v_lshlrev_b32 v14, 16, v63
    v_and_b32 v15, 0xffff0000, v63
    v_add_f32 v44, v44, v12
    v_add_f32 v45, v45, v13
    v_add_f32 v46, v46, v14
    v_add_f32 v47, v47, v15
    v_cvt_pk_bf16_f32 v62, v44, v45
    v_cvt_pk_bf16_f32 v63, v46, v47
    global_store_dwordx2 v6, v[62:63], s[6:7] offset:224
L_b2b_kernel_1:
    s_endpgm
.section .rodata,"a"
.p2align 6
.amdhsa_kernel pre_kernel
  .amdhsa_next_free_vgpr 192
  .amdhsa_next_free_sgpr 32
  .amdhsa_accum_offset 192
  .amdhsa_group_segment_fixed_size 0
  .amdhsa_kernarg_size 104
  .amdhsa_user_sgpr_count 2
  .amdhsa_user_sgpr_kernarg_segment_ptr 1
  .amdhsa_system_sgpr_workgroup_id_x 1
.end_amdhsa_kernel
.p2align 6
.amdhsa_kernel ln1_kernel
  .amdhsa_next_free_vgpr 192
  .amdhsa_next_free_sgpr 32
  .amdhsa_accum_offset 192
  .amdhsa_group_segment_fixed_size 0
  .amdhsa_kernarg_size 104
  .amdhsa_user_sgpr_count 2
  .amdhsa_user_sgpr_kernarg_segment_ptr 1
  .amdhsa_system_sgpr_workgroup_id_x 1
.end_amdhsa_kernel
.p2align 6
.amdhsa_kernel ln3_kernel
  .amdhsa_next_free_vgpr 192
  .amdhsa_next_free_sgpr 32
  .amdhsa_accum_offset 192
  .amdhsa_group_segment_fixed_size 0
  .amdhsa_kernarg_size 104
  .amdhsa_user_sgpr_count 2
  .amdhsa_user_sgpr_kernarg_segment_ptr 1
  .amdhsa_system_sgpr_workgroup_id_x 1
.end_amdhsa_kernel
.p2align 6
.amdhsa_kernel chain_kernel
  .amdhsa_next_free_vgpr 512
  .amdhsa_next_free_sgpr 64
  .amdhsa_accum_offset 256
  .amdhsa_group_segment_fixed_size 0
  .amdhsa_kernarg_size 104
  .amdhsa_user_sgpr_count 2
  .amdhsa_user_sgpr_kernarg_segment_ptr 1
  .amdhsa_system_sgpr_workgroup_id_x 1
.end_amdhsa_kernel
.p2align 6
.amdhsa_kernel g3_kernel
  .amdhsa_next_free_vgpr 168
  .amdhsa_next_free_sgpr 40
  .amdhsa_accum_offset 168
  .amdhsa_group_segment_fixed_size 0
  .amdhsa_kernarg_size 104
  .amdhsa_user_sgpr_count 2
  .amdhsa_user_sgpr_kernarg_segment_ptr 1
  .amdhsa_system_sgpr_workgroup_id_x 1
.end_amdhsa_kernel
.p2align 6
.amdhsa_kernel kvred_kernel
  .amdhsa_next_free_vgpr 144
  .amdhsa_next_free_sgpr 16
  .amdhsa_accum_offset 144
  .amdhsa_group_segment_fixed_size 0
  .amdhsa_kernarg_size 104
  .amdhsa_user_sgpr_count 2
  .amdhsa_user_sgpr_kernarg_segment_ptr 1
  .amdhsa_system_sgpr_workgroup_id_x 1
.end_amdhsa_kernel
.p2align 6
.amdhsa_kernel b2af_kernel
  .amdhsa_next_free_vgpr 200
  .amdhsa_next_free_sgpr 40
  .amdhsa_accum_offset 200
  .amdhsa_group_segment_fixed_size 0
  .amdhsa_kernarg_size 104
  .amdhsa_user_sgpr_count 2
  .amdhsa_user_sgpr_kernarg_segment_ptr 1
  .amdhsa_system_sgpr_workgroup_id_x 1
.end_amdhsa_kernel
.p2align 6
.amdhsa_kernel b2b_kernel
  .amdhsa_next_free_vgpr 200
  .amdhsa_next_free_sgpr 40
  .amdhsa_accum_offset 200
  .amdhsa_group_segment_fixed_size 0
  .amdhsa_kernarg_size 104
  .amdhsa_user_sgpr_count 2
  .amdhsa_user_sgpr_kernarg_segment_ptr 1
  .amdhsa_system_sgpr_workgroup_id_x 1
.end_amdhsa_kernel
```
